```python
import torch

def _softmax(x, axis=-1):
    return torch.softmax(x, dim=axis)
def _gelu(x):
    return torch.nn.functional.gelu(x, approximate="tanh")
def _silu(x):
    return torch.nn.functional.silu(x)
def _sigmoid(x):
    return torch.sigmoid(x)
def _layernorm(x, axis=-1, eps=1e-5):
    m = x.mean(dim=axis, keepdim=True)
    v = x.var(dim=axis, keepdim=True, unbiased=False)
    return (x - m) / torch.sqrt(v + eps)
def _scatter_add(tgt, idx, src, axis=0):
    return tgt.clone().index_add_(axis, idx, src)
def _segment_sum(src, seg, n):
    out = torch.zeros((n,) + src.shape[1:], dtype=src.dtype)
    return out.index_add_(0, seg, src)
def _pad(x, pw):
    flat = tuple(v for pair in reversed(pw) for v in pair)
    return torch.nn.functional.pad(x, flat)

kernel_name = 'concat_heads__gqa_block_cached__gqa_block_cached__near_ridge'

def setup_inputs():

    _w = (lambda a: (lambda t: t.to(torch.bfloat16) if t.is_floating_point() else t)(torch.as_tensor(a)))
    def _A_setup():
        B, Sq, D = 8, 224, 640
        Hq, Hkv, Sk, Dh = 32, 32, 512, 192
        assert Hq % Hkv == 0, (Hq, Hkv)
        return {
            "x": _w((lambda *s: torch.randn(*s, dtype=torch.bfloat16) * 0.8)(B, Sq, D)),
            "k_cache": _w((lambda *s: torch.randn(*s, dtype=torch.bfloat16) * 0.8)(B, Hkv, Sk, Dh)),
            "v_cache": _w((lambda *s: torch.randn(*s, dtype=torch.bfloat16) * 0.05)(B, Hkv, Sk, Dh)),
            "wq": _w((lambda *s: torch.randn(*s, dtype=torch.bfloat16) * 0.8)(D, Hq * Dh) * (D ** -0.5)),
            "wo": _w((lambda *s: torch.randn(*s, dtype=torch.bfloat16) * 0.05)(Hq * Dh, D) * ((Hq * Dh) ** -0.5)),
        }
    _A_in = _A_setup()

    def _B_setup():
        B, Sq, D = 8, 224, 640
        Hq, Hkv, Sk, Dh = 32, 32, 512, 192
        assert Hq % Hkv == 0, (Hq, Hkv)
        return {
            "x": _w((lambda *s: torch.randn(*s, dtype=torch.bfloat16) * 0.8)(B, Sq, D)),
            "k_cache": _w((lambda *s: torch.randn(*s, dtype=torch.bfloat16) * 0.8)(B, Hkv, Sk, Dh)),
            "v_cache": _w((lambda *s: torch.randn(*s, dtype=torch.bfloat16) * 0.05)(B, Hkv, Sk, Dh)),
            "wq": _w((lambda *s: torch.randn(*s, dtype=torch.bfloat16) * 0.8)(D, Hq * Dh) * (D ** -0.5)),
            "wo": _w((lambda *s: torch.randn(*s, dtype=torch.bfloat16) * 0.05)(Hq * Dh, D) * ((Hq * Dh) ** -0.5)),
        }
    _B_in = _B_setup()

    return {
        "A_x": _A_in["x"],
        "A_k_cache": _A_in["k_cache"],
        "A_v_cache": _A_in["v_cache"],
        "A_wq": _A_in["wq"],
        "A_wo": _A_in["wo"],
        "B_x": _B_in["x"],
        "B_k_cache": _B_in["k_cache"],
        "B_v_cache": _B_in["v_cache"],
        "B_wq": _B_in["wq"],
        "B_wo": _B_in["wo"],
    }

def reference(A_x, A_k_cache, A_v_cache, A_wq, A_wo, B_x, B_k_cache, B_v_cache, B_wq, B_wo):
    def _A_ref(x, k_cache, v_cache, wq, wo):
        B, Sq, D = x.shape
        Hq, Dh = 32, 192
        Hkv = k_cache.shape[1]
        rep = Hq // Hkv
        q = (lambda x, *d: x.permute(*d))((x @ wq).reshape(B, Sq, Hq, Dh), 0, 2, 1, 3)
        k = (lambda x, n, axis: torch.repeat_interleave(x, n, dim=axis))(k_cache, rep, axis=1)
        v = (lambda x, n, axis: torch.repeat_interleave(x, n, dim=axis))(v_cache, rep, axis=1)
        scores = torch.einsum("bhqd,bhkd->bhqk", q, k) * (Dh ** -0.5)
        p = _softmax(scores, axis=-1)
        o = torch.einsum("bhqk,bhkd->bhqd", p, v)
        return (lambda x, *d: x.permute(*d))(o, 0, 2, 1, 3).reshape(B, Sq, Hq * Dh) @ wo

    def _B_ref(x, k_cache, v_cache, wq, wo):
        B, Sq, D = x.shape
        Hq, Dh = 32, 192
        Hkv = k_cache.shape[1]
        rep = Hq // Hkv
        q = (lambda x, *d: x.permute(*d))((x @ wq).reshape(B, Sq, Hq, Dh), 0, 2, 1, 3)
        k = (lambda x, n, axis: torch.repeat_interleave(x, n, dim=axis))(k_cache, rep, axis=1)
        v = (lambda x, n, axis: torch.repeat_interleave(x, n, dim=axis))(v_cache, rep, axis=1)
        scores = torch.einsum("bhqd,bhkd->bhqk", q, k) * (Dh ** -0.5)
        p = _softmax(scores, axis=-1)
        o = torch.einsum("bhqk,bhkd->bhqd", p, v)
        return (lambda x, *d: x.permute(*d))(o, 0, 2, 1, 3).reshape(B, Sq, Hq * Dh) @ wo

    a = _A_ref(A_x, A_k_cache, A_v_cache, A_wq, A_wo)
    b = _B_ref(B_x, B_k_cache, B_v_cache, B_wq, B_wo)
    return torch.concatenate([a, b], axis=-1)
```

```asm
; @launch grid=(256,1,1) block=(256,1,1) lds=163840
.amdgcn_target "amdgcn-amd-amdhsa--gfx950"
.text
.globl concat_heads__gqa_block_cached__gqa_block_cached__near_ridge_kernel
.p2align 8
.type concat_heads__gqa_block_cached__gqa_block_cached__near_ridge_kernel,@function
concat_heads__gqa_block_cached__gqa_block_cached__near_ridge_kernel:
 s_cmp_ge_u32 s2, 256
 s_cbranch_scc1 K1_exit
 s_load_dwordx8 s[56:63], s[0:1], 0
 s_load_dwordx8 s[64:71], s[0:1], 40
 s_load_dwordx2 s[72:73], s[0:1], 96
 s_load_dwordx2 s[88:89], s[0:1], 32
 s_load_dwordx2 s[90:91], s[0:1], 72
 s_load_dwordx4 s[84:87], s[0:1], 80
 s_getpc_b64 s[4:5]
K1_pc:
 s_lshr_b32 s6, s2, 3
 s_lshl_b32 s6, s6, 3
 v_and_b32 v1, 31, v0
 v_lshrrev_b32 v2, 5, v0
 v_add_u32 v2, s6, v2
 v_lshl_add_u32 v2, v1, 8, v2
 v_cmp_gt_u32 vcc, (CODE_END-K1_pc)/128, v2
 v_lshlrev_b32 v2, 7, v2
 v_mov_b32 v3, s5
 v_add_co_u32 v2, s[6:7], s4, v2
 s_nop 1
 v_addc_co_u32 v3, s[6:7], 0, v3, s[6:7]
 s_and_saveexec_b64 s[6:7], vcc
 s_cbranch_execz K1_nopf
 global_load_dword v200, v[2:3], off
 K1_nopf:
 s_mov_b64 exec, s[6:7]
 v_lshrrev_b32 v1, 6, v0
 v_and_b32 v0, 63, v0
 v_readfirstlane_b32 s28, v1
 s_and_b32 s74, s2, 7
 s_lshr_b32 s75, s2, 3
 s_lshr_b32 s76, s74, 2
 s_and_b32 s77, s74, 3
 s_and_b32 s78, s75, 7
 s_lshr_b32 s79, s75, 3
 s_lshl_b32 s80, s77, 3
 s_add_u32 s80, s80, s79
 s_and_b32 s29, s28, 1
 s_lshr_b32 s81, s28, 1
 s_mul_i32 s32, s28, 3072
 s_lshl_b32 s33, s28, 12
 s_mul_i32 s34, s28, 6144
 s_mul_i32 s35, s28, 30720
 s_mul_i32 s36, s28, 40960
 s_add_u32 s36, s36, 122880
 v_lshlrev_b32 v246, 4, v0
 v_lshrrev_b32 v2, 3, v0
 v_and_b32 v3, 6, v2
 v_and_b32 v4, 7, v0
 v_xor_b32 v4, v4, v3
 v_lshlrev_b32 v4, 4, v4
 v_mul_u32_u24 v2, 1280, v2
 v_add_u32 v242, v2, v4
 v_add_u32 v243, 9216, v242
 v_add_u32 v244, 18432, v242
 v_add_u32 v245, 27648, v242
 s_mul_i32 s82, s28, 98304
 s_lshl_b32 s83, s29, 2
 v_add_u32 v2, 0, v0
 v_mul_u32_u24 v3, 2731, v2
 v_lshrrev_b32 v3, 16, v3
 v_mul_u32_u24 v4, 24, v3
 v_sub_u32 v4, v2, v4
 v_bfe_u32 v5, v3, 1, 1
 v_or_b32 v5, s83, v5
 v_xor_b32 v5, v4, v5
 v_lshlrev_b32 v5, 4, v5
 v_mul_u32_u24 v6, 12288, v3
 v_add3_u32 v5, v5, v6, s82
 v_subrev_u32 v239, 0, v5
 v_lshlrev_b32 v12, 5, v3
 v_or_b32 v12, v12, v4
 v_add_u32 v2, 64, v0
 v_mul_u32_u24 v3, 2731, v2
 v_lshrrev_b32 v3, 16, v3
 v_mul_u32_u24 v4, 24, v3
 v_sub_u32 v4, v2, v4
 v_bfe_u32 v5, v3, 1, 1
 v_or_b32 v5, s83, v5
 v_xor_b32 v5, v4, v5
 v_lshlrev_b32 v5, 4, v5
 v_mul_u32_u24 v6, 12288, v3
 v_add3_u32 v5, v5, v6, s82
 v_subrev_u32 v240, 1024, v5
 v_lshlrev_b32 v13, 5, v3
 v_or_b32 v13, v13, v4
 v_add_u32 v2, 128, v0
 v_mul_u32_u24 v3, 2731, v2
 v_lshrrev_b32 v3, 16, v3
 v_mul_u32_u24 v4, 24, v3
 v_sub_u32 v4, v2, v4
 v_bfe_u32 v5, v3, 1, 1
 v_or_b32 v5, s83, v5
 v_xor_b32 v5, v4, v5
 v_lshlrev_b32 v5, 4, v5
 v_mul_u32_u24 v6, 12288, v3
 v_add3_u32 v5, v5, v6, s82
 v_subrev_u32 v241, 2048, v5
 v_lshlrev_b32 v14, 5, v3
 v_or_b32 v14, v14, v4
 s_waitcnt lgkmcnt(0)
 s_cmp_eq_u32 s76, 0
 s_cselect_b32 s56, s56, s64
 s_cselect_b32 s57, s57, s65
 s_cselect_b32 s58, s58, s66
 s_cselect_b32 s59, s59, s67
 s_cselect_b32 s60, s60, s68
 s_cselect_b32 s61, s61, s69
 s_cselect_b32 s62, s62, s70
 s_cselect_b32 s63, s63, s71
 s_mul_i32 s82, s78, 286720
 s_add_u32 s8, s56, s82
 s_addc_u32 s9, s57, 0
 s_mov_b32 s10, 286720
 s_mov_b32 s11, 0x20000
 s_mul_i32 s82, s80, 384
 s_add_u32 s12, s62, s82
 s_addc_u32 s13, s63, 0
 s_sub_u32 s14, 7864320, s82
 s_mov_b32 s15, 0x20000
 s_sub_u32 s54, s14, 1536
 s_lshl_b32 s82, s76, 3
 s_add_u32 s82, s82, s78
 s_lshl_b32 s82, s82, 2
 s_add_u32 s31, s82, s79
 s_or_b32 s30, s77, s28
 s_cmp_lg_u32 s30, 0
 s_cbranch_scc1 K1_noclr
 s_lshl_b32 s82, s31, 8
 s_add_u32 s82, s82, 524288
 s_add_u32 s20, s72, s82
 s_addc_u32 s21, s73, 0
 s_mov_b32 s22, 8
 s_mov_b32 s23, 0x20000
 v_mov_b32 v20, 0
 v_mov_b32 v21, 0
 buffer_store_dwordx2 v[20:21], v246, s[20:23], 0 offen sc1
 K1_noclr:
 s_add_u32 m0, s32, 36864
 s_mov_b32 s38, 0
 buffer_load_dwordx4 v239, s[12:15], s38 offen lds
 buffer_load_dwordx4 v240, s[12:15], s38 offen offset:1024 lds
 buffer_load_dwordx4 v241, s[12:15], s38 offen offset:2048 lds
 s_add_u32 m0, s32, 0
 s_add_u32 s37, s35, 0
 buffer_load_dwordx4 v242, s[8:11], s37 offen lds
 buffer_load_dwordx4 v243, s[8:11], s37 offen offset:1024 lds
 buffer_load_dwordx4 v244, s[8:11], s37 offen offset:2048 lds
 s_add_u32 m0, s33, 12288
 s_add_u32 s37, s36, 0
 buffer_load_dwordx4 v242, s[8:11], s37 offen lds
 buffer_load_dwordx4 v243, s[8:11], s37 offen offset:1024 lds
 buffer_load_dwordx4 v244, s[8:11], s37 offen offset:2048 lds
 buffer_load_dwordx4 v245, s[8:11], s37 offen offset:3072 lds
 v_lshrrev_b32 v3, 5, v12
 v_and_b32 v4, 31, v12
 v_and_b32 v5, 6, v3
 v_xor_b32 v5, v4, v5
 v_lshlrev_b32 v5, 4, v5
 v_mul_u32_u24 v6, 384, v3
 v_add3_u32 v5, v5, v6, s34
 v_subrev_u32 v226, 0, v5
 v_lshrrev_b32 v3, 5, v13
 v_and_b32 v4, 31, v13
 v_and_b32 v5, 6, v3
 v_xor_b32 v5, v4, v5
 v_lshlrev_b32 v5, 4, v5
 v_mul_u32_u24 v6, 384, v3
 v_add3_u32 v5, v5, v6, s34
 v_subrev_u32 v227, 1024, v5
 v_add_u32 v229, 4096, v227
 v_lshrrev_b32 v3, 5, v14
 v_and_b32 v4, 31, v14
 v_and_b32 v5, 6, v3
 v_xor_b32 v5, v4, v5
 v_lshlrev_b32 v5, 4, v5
 v_mul_u32_u24 v6, 384, v3
 v_add3_u32 v5, v5, v6, s34
 v_subrev_u32 v228, 2048, v5
 v_add_u32 v230, 4096, v228
 s_lshl_b32 s82, s78, 5
 s_add_u32 s82, s82, s80
 s_mul_i32 s82, s82, 196608
 s_add_u32 s16, s58, s82
 s_addc_u32 s17, s59, 0
 s_mov_b32 s18, 196608
 s_mov_b32 s19, 0x20000
 s_add_u32 s20, s60, s82
 s_addc_u32 s21, s61, 0
 s_mov_b32 s22, 196608
 s_mov_b32 s23, 0x20000
 s_mov_b32 s4, s86
 s_mov_b32 s5, s87
 s_mov_b32 s6, 0
 s_mov_b32 s7, 0x20000
 s_lshl_b32 s101, s74, 3
 s_add_u32 s101, s101, s78
 s_lshl_b32 s101, s101, 2
 s_cmp_eq_u32 s76, 0
 s_cselect_b32 s96, s88, s90
 s_cselect_b32 s97, s89, s91
 s_lshl_b32 s82, s77, 5
 s_add_u32 s82, s82, s75
 s_lshl_b32 s82, s82, 2
 s_add_u32 s82, s82, s28
 s_mul_i32 s82, s82, 15360
 s_add_u32 s56, s96, s82
 s_addc_u32 s57, s97, 0
 s_mov_b64 s[64:65], s[96:97]
 s_mov_b64 s[66:67], s[84:85]
 s_lshl_b32 s82, s75, 2
 s_add_u32 s82, s82, s28
 s_mul_i32 s82, s82, 61440
 s_add_u32 s82, s82, 1536
 s_mul_i32 s83, s79, 384
 s_sub_u32 s82, s82, s83
 s_add_u32 s96, s12, s82
 s_addc_u32 s97, s13, 0
 s_mov_b32 s98, 0
 s_mov_b32 s99, 0x20000
 s_lshl_b32 s100, s31, 2
 v_mul_u32_u24 v2, 342, v246
 v_lshrrev_b32 v2, 16, v2
 v_mul_u32_u24 v2, 10752, v2
 v_lshl_add_u32 v2, v246, 3, v2
 v_cmp_gt_u32 vcc, 384, v246
 v_mov_b32 v3, 0x7ff00000
 s_nop 1
 v_cndmask_b32 v251, v3, v2, vcc
 s_lshl_b32 s82, s76, 3
 s_add_u32 s82, s82, s78
 s_mul_i32 s82, s82, 2752512
 s_mul_i32 s83, s80, 86016
 s_add_u32 s82, s82, s83
 s_add_u32 s82, s82, 704512
 s_add_u32 s24, s72, s82
 s_addc_u32 s25, s73, 0
 s_mov_b32 s26, 0
 s_mov_b32 s27, 0x20000
 s_lshl_b32 s82, s29, 2
 s_mul_i32 s83, s81, 7
 s_add_u32 s82, s82, s83
 s_lshl_b32 s82, s82, 10
 s_add_u32 s83, s83, 3
 s_lshl_b32 s83, s83, 10
 s_xor_b32 s84, s29, 0
 s_mul_i32 s84, s84, 14336
 s_add_u32 s41, s84, s82
 s_add_u32 s47, s84, s83
 s_xor_b32 s84, s29, 1
 s_mul_i32 s84, s84, 14336
 s_add_u32 s42, s84, s82
 s_xor_b32 s84, s29, 2
 s_mul_i32 s84, s84, 14336
 s_add_u32 s43, s84, s82
 s_add_u32 s48, s84, s83
 s_xor_b32 s84, s29, 3
 s_mul_i32 s84, s84, 14336
 s_add_u32 s44, s84, s82
 s_xor_b32 s84, s29, 4
 s_mul_i32 s84, s84, 14336
 s_add_u32 s45, s84, s82
 s_add_u32 s49, s84, s83
 s_xor_b32 s84, s29, 5
 s_mul_i32 s84, s84, 14336
 s_add_u32 s46, s84, s82
 s_mov_b32 s50, 0
 s_mov_b32 s51, 0x3dd53b95
 s_mov_b32 s52, 0xffff0000
 s_mov_b32 s53, 0xffff0000
 s_mul_i32 s53, s79, 56
 s_mul_i32 s82, s28, 14
 s_add_u32 s53, s53, s82
 s_mul_i32 s53, s53, 1280
 v_and_b32 v2, 15, v0
 v_lshrrev_b32 v3, 4, v0
 v_bfe_u32 v4, v0, 2, 2
 v_and_b32 v5, 3, v0
 v_and_b32 v6, 6, v2
 s_lshl_b32 s82, s29, 2
 s_mul_i32 s83, s29, 12288
 s_sub_u32 s84, 12288, s83
 v_or_b32 v7, s82, v3
 v_xor_b32 v7, v7, v6
 v_lshlrev_b32 v7, 4, v7
 v_mul_u32_u24 v8, 384, v2
 v_add_u32 v7, v7, v8
 v_xor_b32 v8, 64, v7
 v_add_u32 v214, s83, v7
 v_add_u32 v215, s83, v8
 v_add_u32 v216, s84, v7
 v_add_u32 v217, s84, v8
 v_xor_b32 v7, v3, v6
 v_lshlrev_b32 v7, 4, v7
 v_lshlrev_b32 v8, 7, v2
 v_add_u32 v7, v7, v8
 v_xor_b32 v8, 64, v7
 s_mul_i32 s85, s81, 14336
 s_lshl_b32 s86, s29, 13
 s_add_u32 s86, s86, s85
 s_add_u32 s86, s86, 106496
 s_add_u32 s85, s85, 112640
 v_add_u32 v235, s86, v7
 v_add_u32 v236, s86, v8
 v_add_u32 v237, s85, v7
 v_add_u32 v238, s85, v8
 v_lshlrev_b32 v7, 2, v3
 v_add_u32 v7, v7, v4
 v_bfe_u32 v8, v7, 1, 2
 s_lshl_b32 s85, s29, 1
 v_xor_b32 v8, s85, v8
 v_mul_u32_u24 v7, 384, v7
 v_lshlrev_b32 v9, 3, v5
 v_add_u32 v7, v7, v9
 s_add_u32 s85, s83, 110592
 s_add_u32 s86, s84, 110592
 v_xor_b32 v9, 0, v8
 v_lshlrev_b32 v9, 5, v9
 v_add_u32 v9, v9, v7
 v_add_u32 v218, s85, v9
 v_add_u32 v222, s86, v9
 v_xor_b32 v9, 1, v8
 v_lshlrev_b32 v9, 5, v9
 v_add_u32 v9, v9, v7
 v_add_u32 v219, s85, v9
 v_add_u32 v223, s86, v9
 v_xor_b32 v9, 2, v8
 v_lshlrev_b32 v9, 5, v9
 v_add_u32 v9, v9, v7
 v_add_u32 v220, s85, v9
 v_add_u32 v224, s86, v9
 v_xor_b32 v9, 3, v8
 v_lshlrev_b32 v9, 5, v9
 v_add_u32 v9, v9, v7
 v_add_u32 v221, s85, v9
 v_add_u32 v225, s86, v9
 v_lshrrev_b32 v7, 1, v4
 v_and_b32 v8, 1, v3
 v_lshlrev_b32 v8, 2, v8
 v_or_b32 v7, v7, v8
 v_or_b32 v8, s82, v5
 v_xor_b32 v7, v7, v8
 v_lshlrev_b32 v7, 4, v7
 v_lshlrev_b32 v8, 3, v3
 v_add_u32 v8, v8, v4
 v_mul_u32_u24 v8, 384, v8
 v_add_u32 v7, v7, v8
 v_xor_b32 v8, 8, v7
 v_xor_b32 v9, 64, v7
 v_xor_b32 v10, 72, v7
 v_add_u32 v231, 24576, v7
 v_add_u32 v232, 24576, v8
 v_add_u32 v233, 24576, v9
 v_add_u32 v234, 24576, v10
 s_xor_b32 s85, s28, 1
 s_mul_i32 s86, s85, 3072
 s_add_u32 s86, s86, 73728
 s_mul_i32 s87, s28, 3072
 s_add_u32 s87, s87, 73728
 v_add_u32 v247, s87, v246
 v_add_u32 v248, s86, v246
 s_lshl_b32 s86, s85, 11
 s_add_u32 s86, s86, 28672
 s_lshl_b32 s87, s28, 11
 s_add_u32 s87, s87, 28672
 v_add_u32 v249, s87, v246
 v_add_u32 v250, s86, v246
 s_mov_b32 s77, 0
 s_mov_b64 s[78:79], s[64:65]
 s_mov_b64 s[80:81], s[66:67]
 s_mov_b64 s[82:83], s[72:73]
 s_add_u32 m0, s32, 49152
 s_mov_b32 s38, 393216
 buffer_load_dwordx4 v239, s[12:15], s38 offen lds
 buffer_load_dwordx4 v240, s[12:15], s38 offen offset:1024 lds
 buffer_load_dwordx4 v241, s[12:15], s38 offen offset:2048 lds
 s_add_u32 m0, s32, 135168
 s_add_u32 s37, s35, 128
 buffer_load_dwordx4 v242, s[8:11], s37 offen lds
 buffer_load_dwordx4 v243, s[8:11], s37 offen offset:1024 lds
 buffer_load_dwordx4 v244, s[8:11], s37 offen offset:2048 lds
 s_add_u32 m0, s33, 147456
 s_add_u32 s37, s36, 128
 buffer_load_dwordx4 v242, s[8:11], s37 offen lds
 buffer_load_dwordx4 v243, s[8:11], s37 offen offset:1024 lds
 buffer_load_dwordx4 v244, s[8:11], s37 offen offset:2048 lds
 buffer_load_dwordx4 v245, s[8:11], s37 offen offset:3072 lds
 s_add_u32 m0, s32, 61440
 s_mov_b32 s38, 786432
 buffer_load_dwordx4 v239, s[12:15], s38 offen lds
 buffer_load_dwordx4 v240, s[12:15], s38 offen offset:1024 lds
 buffer_load_dwordx4 v241, s[12:15], s38 offen offset:2048 lds
 v_subrev_u32 v207, 106496, v235
 v_subrev_u32 v212, 106496, v236
 v_subrev_u32 v213, 106496, v237
 v_subrev_u32 v171, 106496, v238
 s_waitcnt vmcnt(13) lgkmcnt(0)
 s_barrier
 s_cmp_lg_u32 s30, 0
 s_cbranch_scc1 K1_noann
 v_add_u32 v20, s100, v246
 v_lshl_add_u32 v20, v246, 8, v20
 v_mov_b32 v21, 0x1000000
 s_mov_b32 s6, 256
 buffer_atomic_add v21, v20, s[4:7], 0 offen
 s_mov_b32 s6, 0
 K1_noann:
 ds_read_b64_tr_b16 a[192:193], v231 offset:12288
 ds_read_b128 a[196:199], v207 offset:0
 ds_read_b64_tr_b16 a[194:195], v231 offset:13824
 ds_read_b128 a[200:203], v207 offset:2048
 ds_read_b128 a[204:207], v207 offset:4096
 ds_read_b128 a[208:211], v213 offset:0
 ds_read_b64_tr_b16 a[212:213], v232 offset:12288
 ds_read_b64_tr_b16 a[214:215], v232 offset:13824
 ds_read_b64_tr_b16 a[216:217], v233 offset:12288
 ds_read_b64_tr_b16 a[218:219], v233 offset:13824
 ds_read_b64_tr_b16 a[220:221], v234 offset:12288
 ds_read_b64_tr_b16 a[222:223], v234 offset:13824
 ds_read_b64_tr_b16 a[224:225], v231 offset:12416
 s_waitcnt lgkmcnt(7)
.p2align 3
K1_body:
 v_mfma_f32_16x16x32_bf16 v[0:3], a[192:195], a[196:199], 0
 ds_read_b64_tr_b16 a[226:227], v231 offset:13952
 v_add_u32 v170, 69632, v249
 v_mfma_f32_16x16x32_bf16 v[48:51], a[192:195], a[200:203], 0
 ds_read_b64_tr_b16 a[228:229], v232 offset:12416
 v_mfma_f32_16x16x32_bf16 v[96:99], a[192:195], a[204:207], 0
 ds_read_b64_tr_b16 a[230:231], v232 offset:13952
 v_mfma_f32_16x16x32_bf16 v[144:147], a[192:195], a[208:211], 0
 ds_read_b64_tr_b16 a[192:193], v233 offset:12416
 s_waitcnt lgkmcnt(7)
 v_mfma_f32_16x16x32_bf16 v[4:7], a[212:215], a[196:199], 0
 ds_read_b64_tr_b16 a[194:195], v233 offset:13952
 v_mfma_f32_16x16x32_bf16 v[52:55], a[212:215], a[200:203], 0
 ds_read_b64_tr_b16 a[232:233], v234 offset:12416
 s_mov_b32 s38, 1179648
 v_mfma_f32_16x16x32_bf16 v[100:103], a[212:215], a[204:207], 0
 ds_read_b64_tr_b16 a[234:235], v234 offset:13952
 s_add_u32 m0, s32, 86016
 v_mfma_f32_16x16x32_bf16 v[148:151], a[212:215], a[208:211], 0
 buffer_load_dwordx4 v239, s[12:15], s38 offen lds
 v_mfma_f32_16x16x32_bf16 v[8:11], a[216:219], a[196:199], 0
 ds_read_b128 a[212:215], v212 offset:0
 v_mfma_f32_16x16x32_bf16 v[56:59], a[216:219], a[200:203], 0
 ds_read_b64_tr_b16 a[236:237], v231 offset:12544
 v_mfma_f32_16x16x32_bf16 v[104:107], a[216:219], a[204:207], 0
 ds_read_b64_tr_b16 a[238:239], v231 offset:14080
 s_waitcnt lgkmcnt(7)
 v_mfma_f32_16x16x32_bf16 v[12:15], a[220:223], a[196:199], 0
 ds_read_b128 a[216:219], v212 offset:2048
 v_mfma_f32_16x16x32_bf16 v[60:63], a[220:223], a[200:203], 0
 ds_read_b64_tr_b16 a[240:241], v232 offset:12544
 v_mfma_f32_16x16x32_bf16 v[108:111], a[220:223], a[204:207], 0
 ds_read_b64_tr_b16 a[242:243], v232 offset:14080
 v_mfma_f32_16x16x32_bf16 v[16:19], a[224:227], a[196:199], 0
 buffer_load_dwordx4 v240, s[12:15], s38 offen offset:1024 lds
 v_mfma_f32_16x16x32_bf16 v[64:67], a[224:227], a[200:203], 0
 ds_read_b128 a[220:223], v212 offset:4096
 v_mfma_f32_16x16x32_bf16 v[112:115], a[224:227], a[204:207], 0
 ds_read_b64_tr_b16 a[244:245], v233 offset:12544
 v_mfma_f32_16x16x32_bf16 v[152:155], a[224:227], a[208:211], 0
 ds_read_b64_tr_b16 a[246:247], v233 offset:14080
 v_mfma_f32_16x16x32_bf16 v[20:23], a[228:231], a[196:199], 0
 ds_read_b128 a[224:227], v171 offset:0
 v_mfma_f32_16x16x32_bf16 v[68:71], a[228:231], a[200:203], 0
 ds_read_b64_tr_b16 a[248:249], v234 offset:12544
 v_mfma_f32_16x16x32_bf16 v[116:119], a[228:231], a[204:207], 0
 ds_read_b64_tr_b16 a[250:251], v234 offset:14080
 ds_write_b128 v170, a[184:187] offset:0
 ds_write_b128 v170, a[188:191] offset:1024
 v_mfma_f32_16x16x32_bf16 v[156:159], a[228:231], a[208:211], 0
 ds_read_b64 v[254:255], v248 offset:0
 s_waitcnt lgkmcnt(15)
 v_mfma_f32_16x16x32_bf16 v[24:27], a[192:195], a[196:199], 0
 buffer_load_dwordx4 v241, s[12:15], s38 offen offset:2048 lds
 v_mfma_f32_16x16x32_bf16 v[72:75], a[192:195], a[200:203], 0
 s_add_u32 m0, s32, 106496
 s_add_u32 s37, s35, 256
 v_mfma_f32_16x16x32_bf16 v[120:123], a[192:195], a[204:207], 0
 buffer_load_dwordx4 v242, s[8:11], s37 offen lds
 v_mfma_f32_16x16x32_bf16 v[28:31], a[232:235], a[196:199], 0
 ds_read_b128 v[208:211], v248 offset:1024
 s_waitcnt vmcnt(14) lgkmcnt(0)
 v_mfma_f32_16x16x32_bf16 v[76:79], a[232:235], a[200:203], 0
 ds_read_b128 v[196:199], v248 offset:2048
 s_barrier
 v_mfma_f32_16x16x32_bf16 v[124:127], a[232:235], a[204:207], 0
 ds_read_b64_tr_b16 a[192:193], v231 offset:24576
 v_accvgpr_read_b32 v172, a144
 v_mfma_f32_16x16x32_bf16 v[32:35], a[236:239], a[196:199], 0
 ds_read_b64_tr_b16 a[194:195], v231 offset:26112
 s_waitcnt lgkmcnt(4)
 v_mfma_f32_16x16x32_bf16 v[80:83], a[236:239], a[200:203], 0
 buffer_load_dwordx4 v243, s[8:11], s37 offen offset:1024 lds
 v_mfma_f32_16x16x32_bf16 v[128:131], a[236:239], a[204:207], 0
 ds_read_b64_tr_b16 a[228:229], v232 offset:24576
 v_min_f32 v168, v252, v254
 v_mfma_f32_16x16x32_bf16 v[160:163], a[236:239], a[208:211], 0
 ds_read_b64_tr_b16 a[230:231], v232 offset:26112
 v_sub_f32 v252, v168, v252
 v_mfma_f32_16x16x32_bf16 v[36:39], a[240:243], a[196:199], 0
 buffer_load_dwordx4 v244, s[8:11], s37 offen offset:2048 lds
 v_mfma_f32_16x16x32_bf16 v[84:87], a[240:243], a[200:203], 0
 ds_read_b64_tr_b16 a[232:233], v233 offset:24576
 s_add_u32 s37, s36, 256
 v_mfma_f32_16x16x32_bf16 v[132:135], a[240:243], a[204:207], 0
 ds_read_b64_tr_b16 a[234:235], v233 offset:26112
 s_add_u32 m0, s33, 118784
 v_mfma_f32_16x16x32_bf16 v[164:167], a[240:243], a[208:211], 0
 buffer_load_dwordx4 v242, s[8:11], s37 offen lds
 v_mfma_f32_16x16x32_bf16 v[40:43], a[244:247], a[196:199], 0
 ds_read_b64_tr_b16 a[208:209], v234 offset:24576
 v_sub_f32 v254, v168, v254
 v_mfma_f32_16x16x32_bf16 v[88:91], a[244:247], a[200:203], 0
 ds_read_b64_tr_b16 a[210:211], v234 offset:26112
 s_waitcnt lgkmcnt(8)
 v_mfma_f32_16x16x32_bf16 v[136:139], a[244:247], a[204:207], 0
 buffer_load_dwordx4 v243, s[8:11], s37 offen offset:1024 lds
 v_mfma_f32_16x16x32_bf16 v[44:47], a[248:251], a[196:199], 0
 ds_read_b64_tr_b16 a[196:197], v231 offset:24704
 v_accvgpr_read_b32 v173, a145
 v_mfma_f32_16x16x32_bf16 v[92:95], a[248:251], a[200:203], 0
 ds_read_b64_tr_b16 a[198:199], v231 offset:26240
 v_accvgpr_read_b32 v174, a146
 v_mfma_f32_16x16x32_bf16 v[140:143], a[248:251], a[204:207], 0
 v_accvgpr_read_b32 v175, a147
 s_waitcnt lgkmcnt(8)
 v_mfma_f32_16x16x32_bf16 v[0:3], a[192:195], a[212:215], v[0:3]
 ds_read_b64_tr_b16 a[200:201], v232 offset:24704
 v_accvgpr_read_b32 v176, a148
 v_mfma_f32_16x16x32_bf16 v[48:51], a[192:195], a[216:219], v[48:51]
 ds_read_b64_tr_b16 a[202:203], v232 offset:26240
 v_accvgpr_read_b32 v177, a149
 v_mfma_f32_16x16x32_bf16 v[96:99], a[192:195], a[220:223], v[96:99]
 buffer_load_dwordx4 v244, s[8:11], s37 offen offset:2048 lds
 v_mfma_f32_16x16x32_bf16 v[144:147], a[192:195], a[224:227], v[144:147]
 ds_read_b64_tr_b16 a[192:193], v233 offset:24704
 s_waitcnt lgkmcnt(7)
 v_mfma_f32_16x16x32_bf16 v[4:7], a[228:231], a[212:215], v[4:7]
 ds_read_b64_tr_b16 a[194:195], v233 offset:26240
 v_accvgpr_read_b32 v178, a150
 v_mfma_f32_16x16x32_bf16 v[52:55], a[228:231], a[216:219], v[52:55]
 buffer_load_dwordx4 v245, s[8:11], s37 offen offset:3072 lds
 v_mfma_f32_16x16x32_bf16 v[100:103], a[228:231], a[220:223], v[100:103]
 ds_read_b64_tr_b16 a[204:205], v234 offset:24704
 s_mov_b32 s38, 1572864
 v_mfma_f32_16x16x32_bf16 v[148:151], a[228:231], a[224:227], v[148:151]
 ds_read_b64_tr_b16 a[206:207], v234 offset:26240
 s_add_u32 m0, s32, 36864
 v_mfma_f32_16x16x32_bf16 v[8:11], a[232:235], a[212:215], v[8:11]
 buffer_load_dwordx4 v239, s[12:15], s38 offen lds
 v_mfma_f32_16x16x32_bf16 v[56:59], a[232:235], a[216:219], v[56:59]
 ds_read_b64_tr_b16 a[228:229], v231 offset:24832
 v_accvgpr_read_b32 v179, a151
 v_mfma_f32_16x16x32_bf16 v[104:107], a[232:235], a[220:223], v[104:107]
 ds_read_b64_tr_b16 a[230:231], v231 offset:26368
 s_waitcnt lgkmcnt(6)
 v_mfma_f32_16x16x32_bf16 v[12:15], a[208:211], a[212:215], v[12:15]
 buffer_load_dwordx4 v240, s[12:15], s38 offen offset:1024 lds
 v_mfma_f32_16x16x32_bf16 v[60:63], a[208:211], a[216:219], v[60:63]
 ds_read_b64_tr_b16 a[232:233], v232 offset:24832
 v_mfma_f32_16x16x32_bf16 v[108:111], a[208:211], a[220:223], v[108:111]
 ds_read_b64_tr_b16 a[234:235], v232 offset:26368
 v_mfma_f32_16x16x32_bf16 v[16:19], a[196:199], a[212:215], v[16:19]
 buffer_load_dwordx4 v241, s[12:15], s38 offen offset:2048 lds
 v_mfma_f32_16x16x32_bf16 v[64:67], a[196:199], a[216:219], v[64:67]
 ds_read_b64_tr_b16 a[208:209], v233 offset:24832
 s_add_u32 s37, s35, 384
 v_mfma_f32_16x16x32_bf16 v[112:115], a[196:199], a[220:223], v[112:115]
 ds_read_b64_tr_b16 a[210:211], v233 offset:26368
 s_add_u32 m0, s32, 0
 v_mfma_f32_16x16x32_bf16 v[152:155], a[196:199], a[224:227], v[152:155]
 buffer_load_dwordx4 v242, s[8:11], s37 offen lds
 v_mfma_f32_16x16x32_bf16 v[20:23], a[200:203], a[212:215], v[20:23]
 ds_read_b64_tr_b16 a[196:197], v234 offset:24832
 v_mfma_f32_16x16x32_bf16 v[68:71], a[200:203], a[216:219], v[68:71]
 ds_read_b64_tr_b16 a[198:199], v234 offset:26368
 v_mfma_f32_16x16x32_bf16 v[116:119], a[200:203], a[220:223], v[116:119]
 buffer_load_dwordx4 v243, s[8:11], s37 offen offset:1024 lds
 v_mfma_f32_16x16x32_bf16 v[156:159], a[200:203], a[224:227], v[156:159]
 s_waitcnt lgkmcnt(8)
 v_mfma_f32_16x16x32_bf16 v[24:27], a[192:195], a[212:215], v[24:27]
 buffer_load_dwordx4 v244, s[8:11], s37 offen offset:2048 lds
 v_mfma_f32_16x16x32_bf16 v[72:75], a[192:195], a[216:219], v[72:75]
 v_exp_f32 v252, v252
 v_mfma_f32_16x16x32_bf16 v[120:123], a[192:195], a[220:223], v[120:123]
 v_exp_f32 v254, v254
 v_mfma_f32_16x16x32_bf16 v[28:31], a[204:207], a[212:215], v[28:31]
 v_mul_f32 v169, v253, v252
 s_waitcnt vmcnt(16) lgkmcnt(0)
 v_mfma_f32_16x16x32_bf16 v[76:79], a[204:207], a[216:219], v[76:79]
 v_fmac_f32 v169, v255, v254
 s_barrier
 v_mfma_f32_16x16x32_bf16 v[124:127], a[204:207], a[220:223], v[124:127]
 ds_read_b64_tr_b16 a[192:193], v231 offset:36864
 v_mfma_f32_16x16x32_bf16 v[32:35], a[228:231], a[212:215], v[32:35]
 ds_read_b128 a[200:203], v235 offset:28672
 v_mfma_f32_16x16x32_bf16 v[80:83], a[228:231], a[216:219], v[80:83]
 ds_read_b64_tr_b16 a[194:195], v231 offset:38400
 v_mfma_f32_16x16x32_bf16 v[128:131], a[228:231], a[220:223], v[128:131]
 ds_read_b128 a[204:207], v235 offset:30720
 v_mfma_f32_16x16x32_bf16 v[160:163], a[228:231], a[224:227], v[160:163]
 ds_read_b128 a[228:231], v235 offset:32768
 v_mfma_f32_16x16x32_bf16 v[36:39], a[232:235], a[212:215], v[36:39]
 ds_read_b128 a[236:239], v237 offset:28672
 s_mov_b32 s38, 1966080
 v_mfma_f32_16x16x32_bf16 v[84:87], a[232:235], a[216:219], v[84:87]
 ds_read_b64_tr_b16 a[240:241], v232 offset:36864
 s_add_u32 m0, s32, 49152
 v_mfma_f32_16x16x32_bf16 v[132:135], a[232:235], a[220:223], v[132:135]
 buffer_load_dwordx4 v239, s[12:15], s38 offen lds
 v_mfma_f32_16x16x32_bf16 v[164:167], a[232:235], a[224:227], v[164:167]
 ds_read_b64_tr_b16 a[242:243], v232 offset:38400
 v_mfma_f32_16x16x32_bf16 v[40:43], a[208:211], a[212:215], v[40:43]
 ds_read_b64_tr_b16 a[224:225], v233 offset:36864
 v_mfma_f32_16x16x32_bf16 v[88:91], a[208:211], a[216:219], v[88:91]
 ds_read_b64_tr_b16 a[226:227], v233 offset:38400
 v_mfma_f32_16x16x32_bf16 v[136:139], a[208:211], a[220:223], v[136:139]
 ds_read_b64_tr_b16 a[208:209], v234 offset:36864
 v_mfma_f32_16x16x32_bf16 v[44:47], a[196:199], a[212:215], v[44:47]
 ds_read_b64_tr_b16 a[210:211], v234 offset:38400
 v_mfma_f32_16x16x32_bf16 v[92:95], a[196:199], a[216:219], v[92:95]
 ds_read_b64_tr_b16 a[212:213], v231 offset:36992
 v_mfma_f32_16x16x32_bf16 v[140:143], a[196:199], a[220:223], v[140:143]
 buffer_load_dwordx4 v240, s[12:15], s38 offen offset:1024 lds
 s_waitcnt lgkmcnt(7)
 v_mfma_f32_16x16x32_bf16 v[0:3], a[192:195], a[200:203], v[0:3]
 ds_read_b64_tr_b16 a[214:215], v231 offset:38528
 v_mfma_f32_16x16x32_bf16 v[48:51], a[192:195], a[204:207], v[48:51]
 ds_read_b64_tr_b16 a[196:197], v232 offset:36992
 v_mfma_f32_16x16x32_bf16 v[96:99], a[192:195], a[228:231], v[96:99]
 ds_read_b64_tr_b16 a[198:199], v232 offset:38528
 v_mfma_f32_16x16x32_bf16 v[144:147], a[192:195], a[236:239], v[144:147]
 ds_read_b64_tr_b16 a[192:193], v233 offset:36992
 s_waitcnt lgkmcnt(7)
 v_mfma_f32_16x16x32_bf16 v[4:7], a[240:243], a[200:203], v[4:7]
 ds_read_b64_tr_b16 a[194:195], v233 offset:38528
 v_mfma_f32_16x16x32_bf16 v[52:55], a[240:243], a[204:207], v[52:55]
 ds_read_b64_tr_b16 a[216:217], v234 offset:36992
 v_mfma_f32_16x16x32_bf16 v[100:103], a[240:243], a[228:231], v[100:103]
 ds_read_b64_tr_b16 a[218:219], v234 offset:38528
 v_mfma_f32_16x16x32_bf16 v[148:151], a[240:243], a[236:239], v[148:151]
 buffer_load_dwordx4 v241, s[12:15], s38 offen offset:2048 lds
 v_mfma_f32_16x16x32_bf16 v[8:11], a[224:227], a[200:203], v[8:11]
 ds_read_b128 a[220:223], v236 offset:28672
 v_mfma_f32_16x16x32_bf16 v[56:59], a[224:227], a[204:207], v[56:59]
 ds_read_b64_tr_b16 a[232:233], v231 offset:37120
 v_mfma_f32_16x16x32_bf16 v[104:107], a[224:227], a[228:231], v[104:107]
 ds_read_b64_tr_b16 a[234:235], v231 offset:38656
 s_waitcnt lgkmcnt(7)
 v_mfma_f32_16x16x32_bf16 v[12:15], a[208:211], a[200:203], v[12:15]
 ds_read_b128 a[224:227], v236 offset:30720
 v_mfma_f32_16x16x32_bf16 v[60:63], a[208:211], a[204:207], v[60:63]
 ds_read_b64_tr_b16 a[240:241], v232 offset:37120
 s_mov_b32 s38, 2359296
 v_mfma_f32_16x16x32_bf16 v[108:111], a[208:211], a[228:231], v[108:111]
 ds_read_b64_tr_b16 a[242:243], v232 offset:38656
 s_add_u32 m0, s32, 73728
 v_mfma_f32_16x16x32_bf16 v[16:19], a[212:215], a[200:203], v[16:19]
 buffer_load_dwordx4 v239, s[12:15], s38 offen lds
 v_mfma_f32_16x16x32_bf16 v[64:67], a[212:215], a[204:207], v[64:67]
 ds_read_b128 a[208:211], v236 offset:32768
 v_mfma_f32_16x16x32_bf16 v[112:115], a[212:215], a[228:231], v[112:115]
 ds_read_b64_tr_b16 a[244:245], v233 offset:37120
 v_mfma_f32_16x16x32_bf16 v[152:155], a[212:215], a[236:239], v[152:155]
 ds_read_b64_tr_b16 a[246:247], v233 offset:38656
 v_mfma_f32_16x16x32_bf16 v[20:23], a[196:199], a[200:203], v[20:23]
 ds_read_b128 a[212:215], v238 offset:28672
 v_mfma_f32_16x16x32_bf16 v[68:71], a[196:199], a[204:207], v[68:71]
 ds_read_b64_tr_b16 a[248:249], v234 offset:37120
 v_mfma_f32_16x16x32_bf16 v[116:119], a[196:199], a[228:231], v[116:119]
 ds_read_b64_tr_b16 a[250:251], v234 offset:38656
 v_mfma_f32_16x16x32_bf16 v[156:159], a[196:199], a[236:239], v[156:159]
 s_waitcnt lgkmcnt(12)
 v_mfma_f32_16x16x32_bf16 v[24:27], a[192:195], a[200:203], v[24:27]
 buffer_load_dwordx4 v240, s[12:15], s38 offen offset:1024 lds
 v_mfma_f32_16x16x32_bf16 v[72:75], a[192:195], a[204:207], v[72:75]
 buffer_load_dwordx4 v241, s[12:15], s38 offen offset:2048 lds
 v_mfma_f32_16x16x32_bf16 v[120:123], a[192:195], a[228:231], v[120:123]
 v_rcp_f32 v169, v169
 v_mfma_f32_16x16x32_bf16 v[28:31], a[216:219], a[200:203], v[28:31]
 v_mul_f32 v252, v252, v169
 s_waitcnt vmcnt(19) lgkmcnt(0)
 v_mfma_f32_16x16x32_bf16 v[76:79], a[216:219], a[204:207], v[76:79]
 v_mul_f32 v253, v254, v169
 s_barrier
 v_mfma_f32_16x16x32_bf16 v[124:127], a[216:219], a[228:231], v[124:127]
 ds_read_b64_tr_b16 a[192:193], v231 offset:61440
 s_add_u32 s37, s36, 384
 v_mfma_f32_16x16x32_bf16 v[32:35], a[232:235], a[200:203], v[32:35]
 ds_read_b64_tr_b16 a[194:195], v231 offset:62976
 s_add_u32 m0, s33, 12288
 v_mfma_f32_16x16x32_bf16 v[80:83], a[232:235], a[204:207], v[80:83]
 buffer_load_dwordx4 v242, s[8:11], s37 offen lds
 v_mfma_f32_16x16x32_bf16 v[128:131], a[232:235], a[228:231], v[128:131]
 ds_read_b64_tr_b16 a[196:197], v232 offset:61440
 v_mul_f32 v172, v172, v252
 v_mfma_f32_16x16x32_bf16 v[160:163], a[232:235], a[236:239], v[160:163]
 ds_read_b64_tr_b16 a[198:199], v232 offset:62976
 v_fmac_f32 v172, v208, v253
 v_mfma_f32_16x16x32_bf16 v[36:39], a[240:243], a[200:203], v[36:39]
 buffer_load_dwordx4 v243, s[8:11], s37 offen offset:1024 lds
 v_mfma_f32_16x16x32_bf16 v[84:87], a[240:243], a[204:207], v[84:87]
 ds_read_b64_tr_b16 a[216:217], v233 offset:61440
 v_mul_f32 v173, v173, v252
 v_mfma_f32_16x16x32_bf16 v[132:135], a[240:243], a[228:231], v[132:135]
 ds_read_b64_tr_b16 a[218:219], v233 offset:62976
 v_fmac_f32 v173, v209, v253
 v_mfma_f32_16x16x32_bf16 v[164:167], a[240:243], a[236:239], v[164:167]
 buffer_load_dwordx4 v244, s[8:11], s37 offen offset:2048 lds
 v_mfma_f32_16x16x32_bf16 v[40:43], a[244:247], a[200:203], v[40:43]
 ds_read_b64_tr_b16 a[232:233], v234 offset:61440
 v_mul_f32 v174, v174, v252
 v_mfma_f32_16x16x32_bf16 v[88:91], a[244:247], a[204:207], v[88:91]
 ds_read_b64_tr_b16 a[234:235], v234 offset:62976
 v_fmac_f32 v174, v210, v253
 v_mfma_f32_16x16x32_bf16 v[136:139], a[244:247], a[228:231], v[136:139]
 buffer_load_dwordx4 v245, s[8:11], s37 offen offset:3072 lds
 v_mfma_f32_16x16x32_bf16 v[44:47], a[248:251], a[200:203], v[44:47]
 ds_read_b64_tr_b16 a[200:201], v231 offset:61568
 v_mul_f32 v175, v175, v252
 v_mfma_f32_16x16x32_bf16 v[92:95], a[248:251], a[204:207], v[92:95]
 ds_read_b64_tr_b16 a[202:203], v231 offset:63104
 v_fmac_f32 v175, v211, v253
 v_mfma_f32_16x16x32_bf16 v[140:143], a[248:251], a[228:231], v[140:143]
 ds_read_b128 v[208:211], v250 offset:0
 s_waitcnt lgkmcnt(9)
 v_mfma_f32_16x16x32_bf16 v[0:3], a[192:195], a[220:223], v[0:3]
 ds_read_b64_tr_b16 a[204:205], v232 offset:61568
 s_mov_b32 s38, 2752512
 v_mfma_f32_16x16x32_bf16 v[48:51], a[192:195], a[224:227], v[48:51]
 ds_read_b64_tr_b16 a[206:207], v232 offset:63104
 s_add_u32 m0, s32, 61440
 v_mfma_f32_16x16x32_bf16 v[96:99], a[192:195], a[208:211], v[96:99]
 buffer_load_dwordx4 v239, s[12:15], s38 offen lds
 v_mfma_f32_16x16x32_bf16 v[144:147], a[192:195], a[212:215], v[144:147]
 ds_read_b64_tr_b16 a[192:193], v233 offset:61568
 s_waitcnt lgkmcnt(8)
 v_mfma_f32_16x16x32_bf16 v[4:7], a[196:199], a[220:223], v[4:7]
 ds_read_b64_tr_b16 a[194:195], v233 offset:63104
 v_mul_f32 v176, v176, v252
 v_mfma_f32_16x16x32_bf16 v[52:55], a[196:199], a[224:227], v[52:55]
 buffer_load_dwordx4 v240, s[12:15], s38 offen offset:1024 lds
 v_mfma_f32_16x16x32_bf16 v[100:103], a[196:199], a[208:211], v[100:103]
 ds_read_b64_tr_b16 a[228:229], v234 offset:61568
 v_fmac_f32 v176, v196, v253
 v_mfma_f32_16x16x32_bf16 v[148:151], a[196:199], a[212:215], v[148:151]
 ds_read_b64_tr_b16 a[230:231], v234 offset:63104
 v_mul_f32 v177, v177, v252
 v_mfma_f32_16x16x32_bf16 v[8:11], a[216:219], a[220:223], v[8:11]
 buffer_load_dwordx4 v241, s[12:15], s38 offen offset:2048 lds
 v_mfma_f32_16x16x32_bf16 v[56:59], a[216:219], a[224:227], v[56:59]
 ds_read_b64_tr_b16 a[196:197], v231 offset:61696
 v_fmac_f32 v177, v197, v253
 v_mfma_f32_16x16x32_bf16 v[104:107], a[216:219], a[208:211], v[104:107]
 ds_read_b64_tr_b16 a[198:199], v231 offset:63232
 s_waitcnt lgkmcnt(6)
 v_mfma_f32_16x16x32_bf16 v[12:15], a[232:235], a[220:223], v[12:15]
 v_mul_f32 v178, v178, v252
 v_fmac_f32 v178, v198, v253
 v_mfma_f32_16x16x32_bf16 v[60:63], a[232:235], a[224:227], v[60:63]
 ds_read_b64_tr_b16 a[216:217], v232 offset:61696
 s_add_u32 s37, s35, 512
 v_mfma_f32_16x16x32_bf16 v[108:111], a[232:235], a[208:211], v[108:111]
 ds_read_b64_tr_b16 a[218:219], v232 offset:63232
 s_add_u32 m0, s32, 135168
 v_mfma_f32_16x16x32_bf16 v[16:19], a[200:203], a[220:223], v[16:19]
 buffer_load_dwordx4 v242, s[8:11], s37 offen lds
 v_mfma_f32_16x16x32_bf16 v[64:67], a[200:203], a[224:227], v[64:67]
 ds_read_b64_tr_b16 a[232:233], v233 offset:61696
 v_mul_f32 v179, v179, v252
 v_mfma_f32_16x16x32_bf16 v[112:115], a[200:203], a[208:211], v[112:115]
 ds_read_b64_tr_b16 a[234:235], v233 offset:63232
 v_fmac_f32 v179, v199, v253
 v_mfma_f32_16x16x32_bf16 v[152:155], a[200:203], a[212:215], v[152:155]
 buffer_load_dwordx4 v243, s[8:11], s37 offen offset:1024 lds
 v_mfma_f32_16x16x32_bf16 v[20:23], a[204:207], a[220:223], v[20:23]
 ds_read_b64_tr_b16 a[200:201], v234 offset:61696
 v_cvt_pk_bf16_f32 v180, v172, v173
 v_mfma_f32_16x16x32_bf16 v[68:71], a[204:207], a[224:227], v[68:71]
 ds_read_b64_tr_b16 a[202:203], v234 offset:63232
 v_cvt_pk_bf16_f32 v181, v174, v175
 v_mfma_f32_16x16x32_bf16 v[116:119], a[204:207], a[208:211], v[116:119]
 ds_read_b128 v[196:199], v250 offset:1024
 v_cvt_pk_bf16_f32 v182, v176, v177
 v_mfma_f32_16x16x32_bf16 v[156:159], a[204:207], a[212:215], v[156:159]
 v_cvt_pk_bf16_f32 v183, v178, v179
 s_waitcnt lgkmcnt(9)
 v_mfma_f32_16x16x32_bf16 v[24:27], a[192:195], a[220:223], v[24:27]
 buffer_load_dwordx4 v244, s[8:11], s37 offen offset:2048 lds
 v_mfma_f32_16x16x32_bf16 v[72:75], a[192:195], a[224:227], v[72:75]
 buffer_store_dwordx4 v[180:183], v246, s[24:27], s47 offen sc1
 v_mfma_f32_16x16x32_bf16 v[120:123], a[192:195], a[208:211], v[120:123]
 v_accvgpr_read_b32 v184, a160
 v_accvgpr_read_b32 v185, a161
 v_mfma_f32_16x16x32_bf16 v[28:31], a[228:231], a[220:223], v[28:31]
 v_accvgpr_read_b32 v186, a162
 s_waitcnt vmcnt(20) lgkmcnt(0)
 v_mfma_f32_16x16x32_bf16 v[76:79], a[228:231], a[224:227], v[76:79]
 v_accvgpr_read_b32 v187, a163
 s_barrier
 v_mfma_f32_16x16x32_bf16 v[124:127], a[228:231], a[208:211], v[124:127]
 ds_read_b64_tr_b16 a[192:193], v231 offset:12288
 s_waitcnt lgkmcnt(1)
 v_mfma_f32_16x16x32_bf16 v[32:35], a[196:199], a[220:223], v[32:35]
 ds_read_b128 a[204:207], v235 offset:0
 v_accvgpr_read_b32 v188, a164
 v_mfma_f32_16x16x32_bf16 v[80:83], a[196:199], a[224:227], v[80:83]
 ds_read_b64_tr_b16 a[194:195], v231 offset:13824
 v_accvgpr_read_b32 v189, a165
 v_mfma_f32_16x16x32_bf16 v[128:131], a[196:199], a[208:211], v[128:131]
 ds_read_b128 a[228:231], v235 offset:2048
 v_accvgpr_read_b32 v190, a166
 v_mfma_f32_16x16x32_bf16 v[160:163], a[196:199], a[212:215], v[160:163]
 ds_read_b128 a[196:199], v235 offset:4096
 v_accvgpr_read_b32 v191, a167
 v_mfma_f32_16x16x32_bf16 v[36:39], a[216:219], a[220:223], v[36:39]
 ds_read_b128 a[236:239], v237 offset:0
 s_mov_b32 s38, 3145728
 v_mfma_f32_16x16x32_bf16 v[84:87], a[216:219], a[224:227], v[84:87]
 ds_read_b64_tr_b16 a[240:241], v232 offset:12288
 s_add_u32 m0, s32, 86016
 v_mfma_f32_16x16x32_bf16 v[132:135], a[216:219], a[208:211], v[132:135]
 buffer_load_dwordx4 v239, s[12:15], s38 offen lds
 v_mfma_f32_16x16x32_bf16 v[164:167], a[216:219], a[212:215], v[164:167]
 ds_read_b64_tr_b16 a[242:243], v232 offset:13824
 v_mul_f32 v184, v184, v252
 v_mfma_f32_16x16x32_bf16 v[40:43], a[232:235], a[220:223], v[40:43]
 ds_read_b64_tr_b16 a[212:213], v233 offset:12288
 v_fmac_f32 v184, v208, v253
 v_mfma_f32_16x16x32_bf16 v[88:91], a[232:235], a[224:227], v[88:91]
 ds_read_b64_tr_b16 a[214:215], v233 offset:13824
 v_mul_f32 v185, v185, v252
 v_mfma_f32_16x16x32_bf16 v[136:139], a[232:235], a[208:211], v[136:139]
 ds_read_b64_tr_b16 a[216:217], v234 offset:12288
 v_fmac_f32 v185, v209, v253
 v_mfma_f32_16x16x32_bf16 v[44:47], a[200:203], a[220:223], v[44:47]
 ds_read_b64_tr_b16 a[218:219], v234 offset:13824
 v_mul_f32 v186, v186, v252
 v_mfma_f32_16x16x32_bf16 v[92:95], a[200:203], a[224:227], v[92:95]
 ds_read_b64_tr_b16 a[220:221], v231 offset:12416
 v_fmac_f32 v186, v210, v253
 v_mfma_f32_16x16x32_bf16 v[140:143], a[200:203], a[208:211], v[140:143]
 buffer_load_dwordx4 v240, s[12:15], s38 offen offset:1024 lds
 s_waitcnt lgkmcnt(7)
 v_mfma_f32_16x16x32_bf16 v[0:3], a[192:195], a[204:207], v[0:3]
 ds_read_b64_tr_b16 a[222:223], v231 offset:13952
 v_mul_f32 v187, v187, v252
 v_mfma_f32_16x16x32_bf16 v[48:51], a[192:195], a[228:231], v[48:51]
 ds_read_b64_tr_b16 a[200:201], v232 offset:12416
 v_fmac_f32 v187, v211, v253
 v_mfma_f32_16x16x32_bf16 v[96:99], a[192:195], a[196:199], v[96:99]
 ds_read_b64_tr_b16 a[202:203], v232 offset:13952
 v_mul_f32 v188, v188, v252
 v_mfma_f32_16x16x32_bf16 v[144:147], a[192:195], a[236:239], v[144:147]
 ds_read_b64_tr_b16 a[192:193], v233 offset:12416
 s_waitcnt lgkmcnt(7)
 v_mfma_f32_16x16x32_bf16 v[4:7], a[240:243], a[204:207], v[4:7]
 ds_read_b64_tr_b16 a[194:195], v233 offset:13952
 v_fmac_f32 v188, v196, v253
 v_mfma_f32_16x16x32_bf16 v[52:55], a[240:243], a[228:231], v[52:55]
 ds_read_b64_tr_b16 a[208:209], v234 offset:12416
 v_mul_f32 v189, v189, v252
 v_mfma_f32_16x16x32_bf16 v[100:103], a[240:243], a[196:199], v[100:103]
 ds_read_b64_tr_b16 a[210:211], v234 offset:13952
 v_fmac_f32 v189, v197, v253
 v_mfma_f32_16x16x32_bf16 v[148:151], a[240:243], a[236:239], v[148:151]
 buffer_load_dwordx4 v241, s[12:15], s38 offen offset:2048 lds
 v_mfma_f32_16x16x32_bf16 v[8:11], a[212:215], a[204:207], v[8:11]
 ds_read_b128 a[224:227], v236 offset:0
 v_mul_f32 v190, v190, v252
 v_mfma_f32_16x16x32_bf16 v[56:59], a[212:215], a[228:231], v[56:59]
 ds_read_b64_tr_b16 a[232:233], v231 offset:12544
 v_fmac_f32 v190, v198, v253
 v_mfma_f32_16x16x32_bf16 v[104:107], a[212:215], a[196:199], v[104:107]
 ds_read_b64_tr_b16 a[234:235], v231 offset:14080
 s_waitcnt lgkmcnt(7)
 v_mfma_f32_16x16x32_bf16 v[12:15], a[216:219], a[204:207], v[12:15]
 ds_read_b128 a[212:215], v236 offset:2048
 v_mul_f32 v191, v191, v252
 v_mfma_f32_16x16x32_bf16 v[60:63], a[216:219], a[228:231], v[60:63]
 ds_read_b64_tr_b16 a[240:241], v232 offset:12544
 s_add_u32 s37, s36, 512
 v_mfma_f32_16x16x32_bf16 v[108:111], a[216:219], a[196:199], v[108:111]
 ds_read_b64_tr_b16 a[242:243], v232 offset:14080
 s_add_u32 m0, s33, 147456
 v_mfma_f32_16x16x32_bf16 v[16:19], a[220:223], a[204:207], v[16:19]
 buffer_load_dwordx4 v242, s[8:11], s37 offen lds
 v_mfma_f32_16x16x32_bf16 v[64:67], a[220:223], a[228:231], v[64:67]
 ds_read_b128 a[216:219], v236 offset:4096
 v_fmac_f32 v191, v199, v253
 v_mfma_f32_16x16x32_bf16 v[112:115], a[220:223], a[196:199], v[112:115]
 ds_read_b64_tr_b16 a[244:245], v233 offset:12544
 v_cvt_pk_bf16_f32 v192, v184, v185
 v_mfma_f32_16x16x32_bf16 v[152:155], a[220:223], a[236:239], v[152:155]
 ds_read_b64_tr_b16 a[246:247], v233 offset:14080
 v_cvt_pk_bf16_f32 v193, v186, v187
 v_mfma_f32_16x16x32_bf16 v[20:23], a[200:203], a[204:207], v[20:23]
 ds_read_b128 a[220:223], v238 offset:0
 v_cvt_pk_bf16_f32 v194, v188, v189
 v_mfma_f32_16x16x32_bf16 v[68:71], a[200:203], a[228:231], v[68:71]
 ds_read_b64_tr_b16 a[248:249], v234 offset:12544
 v_cvt_pk_bf16_f32 v195, v190, v191
 v_mfma_f32_16x16x32_bf16 v[116:119], a[200:203], a[196:199], v[116:119]
 ds_read_b64_tr_b16 a[250:251], v234 offset:14080
 v_add_u32 v170, 69632, v250
 v_mfma_f32_16x16x32_bf16 v[156:159], a[200:203], a[236:239], v[156:159]
 ds_read_b128 v[208:211], v170 offset:0
 s_waitcnt lgkmcnt(13)
 v_mfma_f32_16x16x32_bf16 v[24:27], a[192:195], a[204:207], v[24:27]
 buffer_load_dwordx4 v243, s[8:11], s37 offen offset:1024 lds
 ds_read_b128 v[196:199], v170 offset:1024
 s_waitcnt lgkmcnt(0)
 v_accvgpr_read_b32 v172, a176
 v_accvgpr_read_b32 v173, a177
 v_accvgpr_read_b32 v174, a178
 v_accvgpr_read_b32 v175, a179
 v_accvgpr_read_b32 v176, a180
 v_accvgpr_read_b32 v177, a181
 v_accvgpr_read_b32 v178, a182
 v_accvgpr_read_b32 v179, a183
 v_mul_f32 v172, v172, v252
 v_fmac_f32 v172, v208, v253
 v_mul_f32 v173, v173, v252
 v_fmac_f32 v173, v209, v253
 v_mul_f32 v174, v174, v252
 v_fmac_f32 v174, v210, v253
 v_mul_f32 v175, v175, v252
 v_fmac_f32 v175, v211, v253
 v_mul_f32 v176, v176, v252
 v_fmac_f32 v176, v196, v253
 v_mul_f32 v177, v177, v252
 v_fmac_f32 v177, v197, v253
 v_mul_f32 v178, v178, v252
 v_fmac_f32 v178, v198, v253
 v_mul_f32 v179, v179, v252
 v_fmac_f32 v179, v199, v253
 v_cvt_pk_bf16_f32 v180, v172, v173
 v_cvt_pk_bf16_f32 v181, v174, v175
 v_cvt_pk_bf16_f32 v182, v176, v177
 v_cvt_pk_bf16_f32 v183, v178, v179
 buffer_store_dwordx4 v[180:183], v246, s[24:27], s49 offen sc1
 v_accvgpr_read_b32 v172, a48
 v_accvgpr_read_b32 v173, a49
 v_accvgpr_read_b32 v174, a50
 v_accvgpr_read_b32 v175, a51
 v_accvgpr_read_b32 v176, a52
 v_accvgpr_read_b32 v177, a53
 v_accvgpr_read_b32 v178, a54
 v_accvgpr_read_b32 v179, a55
 v_mul_f32 v172, v172, v205
 v_mul_f32 v173, v173, v205
 v_mul_f32 v174, v174, v205
 v_mul_f32 v175, v175, v205
 v_mul_f32 v176, v176, v205
 v_mul_f32 v177, v177, v205
 v_mul_f32 v178, v178, v205
 v_mul_f32 v179, v179, v205
 v_cvt_pk_bf16_f32 v180, v172, v173
 v_cvt_pk_bf16_f32 v181, v174, v175
 v_cvt_pk_bf16_f32 v182, v176, v177
 v_cvt_pk_bf16_f32 v183, v178, v179
 buffer_store_dwordx4 v[180:183], v246, s[24:27], s41 offen offset:1024 sc1
 v_mfma_f32_16x16x32_bf16 v[72:75], a[192:195], a[228:231], v[72:75]
 buffer_load_dwordx4 v244, s[8:11], s37 offen offset:2048 lds
 v_mfma_f32_16x16x32_bf16 v[120:123], a[192:195], a[196:199], v[120:123]
 buffer_store_dwordx4 v[192:195], v246, s[24:27], s48 offen sc1
 v_mfma_f32_16x16x32_bf16 v[28:31], a[208:211], a[204:207], v[28:31]
 v_accvgpr_read_b32 v184, a56
 s_waitcnt vmcnt(23) lgkmcnt(0)
 v_mfma_f32_16x16x32_bf16 v[76:79], a[208:211], a[228:231], v[76:79]
 v_accvgpr_read_b32 v185, a57
 s_barrier
 v_mfma_f32_16x16x32_bf16 v[124:127], a[208:211], a[196:199], v[124:127]
 ds_read_b64_tr_b16 a[192:193], v231 offset:24576
 v_accvgpr_read_b32 v186, a58
 v_mfma_f32_16x16x32_bf16 v[32:35], a[232:235], a[204:207], v[32:35]
 ds_read_b64_tr_b16 a[194:195], v231 offset:26112
 v_accvgpr_read_b32 v187, a59
 v_mfma_f32_16x16x32_bf16 v[80:83], a[232:235], a[228:231], v[80:83]
 buffer_load_dwordx4 v245, s[8:11], s37 offen offset:3072 lds
 v_mfma_f32_16x16x32_bf16 v[128:131], a[232:235], a[196:199], v[128:131]
 ds_read_b64_tr_b16 a[200:201], v232 offset:24576
 s_mov_b32 s38, 3538944
 v_mfma_f32_16x16x32_bf16 v[160:163], a[232:235], a[236:239], v[160:163]
 ds_read_b64_tr_b16 a[202:203], v232 offset:26112
 s_add_u32 m0, s32, 36864
 v_mfma_f32_16x16x32_bf16 v[36:39], a[240:243], a[204:207], v[36:39]
 buffer_load_dwordx4 v239, s[12:15], s38 offen lds
 v_mfma_f32_16x16x32_bf16 v[84:87], a[240:243], a[228:231], v[84:87]
 ds_read_b64_tr_b16 a[208:209], v233 offset:24576
 v_accvgpr_read_b32 v188, a60
 v_mfma_f32_16x16x32_bf16 v[132:135], a[240:243], a[196:199], v[132:135]
 ds_read_b64_tr_b16 a[210:211], v233 offset:26112
 v_accvgpr_read_b32 v189, a61
 v_mfma_f32_16x16x32_bf16 v[164:167], a[240:243], a[236:239], v[164:167]
 v_accvgpr_read_b32 v190, a62
 v_accvgpr_read_b32 v191, a63
 v_mfma_f32_16x16x32_bf16 v[40:43], a[244:247], a[204:207], v[40:43]
 ds_read_b64_tr_b16 a[232:233], v234 offset:24576
 v_mul_f32 v184, v184, v205
 v_mfma_f32_16x16x32_bf16 v[88:91], a[244:247], a[228:231], v[88:91]
 ds_read_b64_tr_b16 a[234:235], v234 offset:26112
 v_mul_f32 v185, v185, v205
 v_mfma_f32_16x16x32_bf16 v[136:139], a[244:247], a[196:199], v[136:139]
 buffer_load_dwordx4 v240, s[12:15], s38 offen offset:1024 lds
 v_mfma_f32_16x16x32_bf16 v[44:47], a[248:251], a[204:207], v[44:47]
 ds_read_b64_tr_b16 a[204:205], v231 offset:24704
 v_mul_f32 v186, v186, v205
 v_mfma_f32_16x16x32_bf16 v[92:95], a[248:251], a[228:231], v[92:95]
 ds_read_b64_tr_b16 a[206:207], v231 offset:26240
 v_mul_f32 v187, v187, v205
 v_mfma_f32_16x16x32_bf16 v[140:143], a[248:251], a[196:199], v[140:143]
 v_mul_f32 v188, v188, v205
 s_waitcnt lgkmcnt(8)
 v_mfma_f32_16x16x32_bf16 v[0:3], a[192:195], a[224:227], v[0:3]
 ds_read_b64_tr_b16 a[196:197], v232 offset:24704
 v_mul_f32 v189, v189, v205
 v_mfma_f32_16x16x32_bf16 v[48:51], a[192:195], a[212:215], v[48:51]
 ds_read_b64_tr_b16 a[198:199], v232 offset:26240
 v_mul_f32 v190, v190, v205
 v_mul_f32 v191, v191, v205
 v_cvt_pk_bf16_f32 v192, v184, v185
 v_cvt_pk_bf16_f32 v193, v186, v187
 v_cvt_pk_bf16_f32 v194, v188, v189
 v_cvt_pk_bf16_f32 v195, v190, v191
 buffer_store_dwordx4 v[192:195], v246, s[24:27], s42 offen offset:1024 sc1
 v_mfma_f32_16x16x32_bf16 v[96:99], a[192:195], a[216:219], v[96:99]
 buffer_load_dwordx4 v241, s[12:15], s38 offen offset:2048 lds
 v_mfma_f32_16x16x32_bf16 v[144:147], a[192:195], a[220:223], v[144:147]
 ds_read_b64_tr_b16 a[192:193], v233 offset:24704
 s_waitcnt lgkmcnt(7)
 v_mfma_f32_16x16x32_bf16 v[4:7], a[200:203], a[224:227], v[4:7]
 ds_read_b64_tr_b16 a[194:195], v233 offset:26240
 v_accvgpr_read_b32 v172, a64
 v_mfma_f32_16x16x32_bf16 v[52:55], a[200:203], a[212:215], v[52:55]
 v_accvgpr_read_b32 v173, a65
 v_accvgpr_read_b32 v174, a66
 v_mfma_f32_16x16x32_bf16 v[100:103], a[200:203], a[216:219], v[100:103]
 ds_read_b64_tr_b16 a[228:229], v234 offset:24704
 s_add_u32 s37, s35, 640
 v_mfma_f32_16x16x32_bf16 v[148:151], a[200:203], a[220:223], v[148:151]
 ds_read_b64_tr_b16 a[230:231], v234 offset:26240
 s_add_u32 m0, s32, 106496
 v_mfma_f32_16x16x32_bf16 v[8:11], a[208:211], a[224:227], v[8:11]
 buffer_load_dwordx4 v242, s[8:11], s37 offen lds
 v_mfma_f32_16x16x32_bf16 v[56:59], a[208:211], a[212:215], v[56:59]
 ds_read_b64_tr_b16 a[200:201], v231 offset:24832
 v_accvgpr_read_b32 v175, a67
 v_mfma_f32_16x16x32_bf16 v[104:107], a[208:211], a[216:219], v[104:107]
 ds_read_b64_tr_b16 a[202:203], v231 offset:26368
 s_waitcnt lgkmcnt(6)
 v_mfma_f32_16x16x32_bf16 v[12:15], a[232:235], a[224:227], v[12:15]
 v_accvgpr_read_b32 v176, a68
 v_accvgpr_read_b32 v177, a69
 v_mfma_f32_16x16x32_bf16 v[60:63], a[232:235], a[212:215], v[60:63]
 ds_read_b64_tr_b16 a[208:209], v232 offset:24832
 v_accvgpr_read_b32 v178, a70
 v_mfma_f32_16x16x32_bf16 v[108:111], a[232:235], a[216:219], v[108:111]
 ds_read_b64_tr_b16 a[210:211], v232 offset:26368
 v_accvgpr_read_b32 v179, a71
 v_mfma_f32_16x16x32_bf16 v[16:19], a[204:207], a[224:227], v[16:19]
 buffer_load_dwordx4 v243, s[8:11], s37 offen offset:1024 lds
 v_mfma_f32_16x16x32_bf16 v[64:67], a[204:207], a[212:215], v[64:67]
 ds_read_b64_tr_b16 a[232:233], v233 offset:24832
 v_mul_f32 v172, v172, v205
 v_mfma_f32_16x16x32_bf16 v[112:115], a[204:207], a[216:219], v[112:115]
 ds_read_b64_tr_b16 a[234:235], v233 offset:26368
 v_mul_f32 v173, v173, v205
 v_mfma_f32_16x16x32_bf16 v[152:155], a[204:207], a[220:223], v[152:155]
 v_mul_f32 v174, v174, v205
 v_mul_f32 v175, v175, v205
 v_mfma_f32_16x16x32_bf16 v[20:23], a[196:199], a[224:227], v[20:23]
 ds_read_b64_tr_b16 a[204:205], v234 offset:24832
 v_mul_f32 v176, v176, v205
 v_mfma_f32_16x16x32_bf16 v[68:71], a[196:199], a[212:215], v[68:71]
 ds_read_b64_tr_b16 a[206:207], v234 offset:26368
 v_mul_f32 v177, v177, v205
 v_mfma_f32_16x16x32_bf16 v[116:119], a[196:199], a[216:219], v[116:119]
 buffer_load_dwordx4 v244, s[8:11], s37 offen offset:2048 lds
 v_mfma_f32_16x16x32_bf16 v[156:159], a[196:199], a[220:223], v[156:159]
 v_mul_f32 v178, v178, v205
 s_waitcnt lgkmcnt(8)
 v_mfma_f32_16x16x32_bf16 v[24:27], a[192:195], a[224:227], v[24:27]
 v_mul_f32 v179, v179, v205
 v_cvt_pk_bf16_f32 v180, v172, v173
 v_cvt_pk_bf16_f32 v181, v174, v175
 v_cvt_pk_bf16_f32 v182, v176, v177
 v_cvt_pk_bf16_f32 v183, v178, v179
 buffer_store_dwordx4 v[180:183], v246, s[24:27], s43 offen offset:1024 sc1
 v_mfma_f32_16x16x32_bf16 v[72:75], a[192:195], a[212:215], v[72:75]
 v_accvgpr_read_b32 v184, a72
 v_accvgpr_read_b32 v185, a73
 v_mfma_f32_16x16x32_bf16 v[120:123], a[192:195], a[216:219], v[120:123]
 v_accvgpr_read_b32 v186, a74
 v_accvgpr_read_b32 v187, a75
 v_mfma_f32_16x16x32_bf16 v[28:31], a[228:231], a[224:227], v[28:31]
 v_accvgpr_read_b32 v188, a76
 s_waitcnt vmcnt(25) lgkmcnt(0)
 v_mfma_f32_16x16x32_bf16 v[76:79], a[228:231], a[212:215], v[76:79]
 v_accvgpr_read_b32 v189, a77
 s_barrier
 v_mfma_f32_16x16x32_bf16 v[124:127], a[228:231], a[216:219], v[124:127]
 ds_read_b64_tr_b16 a[192:193], v231 offset:49152
 v_accvgpr_read_b32 v190, a78
 v_mfma_f32_16x16x32_bf16 v[32:35], a[200:203], a[224:227], v[32:35]
 ds_read_b128 a[196:199], v207 offset:0
 v_accvgpr_read_b32 v191, a79
 v_mfma_f32_16x16x32_bf16 v[80:83], a[200:203], a[212:215], v[80:83]
 ds_read_b64_tr_b16 a[194:195], v231 offset:50688
 v_mul_f32 v184, v184, v205
 v_mfma_f32_16x16x32_bf16 v[128:131], a[200:203], a[216:219], v[128:131]
 ds_read_b128 a[228:231], v207 offset:2048
 v_mul_f32 v185, v185, v205
 v_mfma_f32_16x16x32_bf16 v[160:163], a[200:203], a[220:223], v[160:163]
 ds_read_b128 a[200:203], v207 offset:4096
 v_mul_f32 v186, v186, v205
 v_mfma_f32_16x16x32_bf16 v[36:39], a[208:211], a[224:227], v[36:39]
 ds_read_b128 a[236:239], v213 offset:0
 s_mov_b32 s38, 3932160
 v_mfma_f32_16x16x32_bf16 v[84:87], a[208:211], a[212:215], v[84:87]
 ds_read_b64_tr_b16 a[240:241], v232 offset:49152
 s_add_u32 m0, s32, 49152
 v_mfma_f32_16x16x32_bf16 v[132:135], a[208:211], a[216:219], v[132:135]
 buffer_load_dwordx4 v239, s[12:15], s38 offen lds
 v_mfma_f32_16x16x32_bf16 v[164:167], a[208:211], a[220:223], v[164:167]
 ds_read_b64_tr_b16 a[242:243], v232 offset:50688
 v_mul_f32 v187, v187, v205
 v_mfma_f32_16x16x32_bf16 v[40:43], a[232:235], a[224:227], v[40:43]
 ds_read_b64_tr_b16 a[208:209], v233 offset:49152
 v_mul_f32 v188, v188, v205
 v_mfma_f32_16x16x32_bf16 v[88:91], a[232:235], a[212:215], v[88:91]
 ds_read_b64_tr_b16 a[210:211], v233 offset:50688
 v_mul_f32 v189, v189, v205
 v_mfma_f32_16x16x32_bf16 v[136:139], a[232:235], a[216:219], v[136:139]
 ds_read_b64_tr_b16 a[220:221], v234 offset:49152
 v_mul_f32 v190, v190, v205
 v_mfma_f32_16x16x32_bf16 v[44:47], a[204:207], a[224:227], v[44:47]
 ds_read_b64_tr_b16 a[222:223], v234 offset:50688
 v_mul_f32 v191, v191, v205
 v_mfma_f32_16x16x32_bf16 v[92:95], a[204:207], a[212:215], v[92:95]
 ds_read_b64_tr_b16 a[212:213], v231 offset:49280
 v_cvt_pk_bf16_f32 v192, v184, v185
 v_mfma_f32_16x16x32_bf16 v[140:143], a[204:207], a[216:219], v[140:143]
 buffer_load_dwordx4 v240, s[12:15], s38 offen offset:1024 lds
 s_waitcnt lgkmcnt(7)
 v_mfma_f32_16x16x32_bf16 v[0:3], a[192:195], a[196:199], v[0:3]
 ds_read_b64_tr_b16 a[214:215], v231 offset:50816
 v_cvt_pk_bf16_f32 v193, v186, v187
 v_mfma_f32_16x16x32_bf16 v[48:51], a[192:195], a[228:231], v[48:51]
 ds_read_b64_tr_b16 a[204:205], v232 offset:49280
 v_cvt_pk_bf16_f32 v194, v188, v189
 v_cvt_pk_bf16_f32 v195, v190, v191
 buffer_store_dwordx4 v[192:195], v246, s[24:27], s44 offen offset:1024 sc1
 v_mfma_f32_16x16x32_bf16 v[96:99], a[192:195], a[200:203], v[96:99]
 ds_read_b64_tr_b16 a[206:207], v232 offset:50816
 v_accvgpr_read_b32 v172, a80
 v_mfma_f32_16x16x32_bf16 v[144:147], a[192:195], a[236:239], v[144:147]
 ds_read_b64_tr_b16 a[192:193], v233 offset:49280
 s_waitcnt lgkmcnt(7)
 v_mfma_f32_16x16x32_bf16 v[4:7], a[240:243], a[196:199], v[4:7]
 ds_read_b64_tr_b16 a[194:195], v233 offset:50816
 v_accvgpr_read_b32 v173, a81
 v_mfma_f32_16x16x32_bf16 v[52:55], a[240:243], a[228:231], v[52:55]
 ds_read_b64_tr_b16 a[216:217], v234 offset:49280
 v_accvgpr_read_b32 v174, a82
 v_mfma_f32_16x16x32_bf16 v[100:103], a[240:243], a[200:203], v[100:103]
 ds_read_b64_tr_b16 a[218:219], v234 offset:50816
 v_accvgpr_read_b32 v175, a83
 v_mfma_f32_16x16x32_bf16 v[148:151], a[240:243], a[236:239], v[148:151]
 buffer_load_dwordx4 v241, s[12:15], s38 offen offset:2048 lds
 v_mfma_f32_16x16x32_bf16 v[8:11], a[208:211], a[196:199], v[8:11]
 ds_read_b128 a[224:227], v212 offset:0
 v_accvgpr_read_b32 v176, a84
 v_mfma_f32_16x16x32_bf16 v[56:59], a[208:211], a[228:231], v[56:59]
 ds_read_b64_tr_b16 a[232:233], v231 offset:49408
 v_accvgpr_read_b32 v177, a85
 v_mfma_f32_16x16x32_bf16 v[104:107], a[208:211], a[200:203], v[104:107]
 ds_read_b64_tr_b16 a[234:235], v231 offset:50944
 s_waitcnt lgkmcnt(7)
 v_mfma_f32_16x16x32_bf16 v[12:15], a[220:223], a[196:199], v[12:15]
 ds_read_b128 a[208:211], v212 offset:2048
 v_accvgpr_read_b32 v178, a86
 v_mfma_f32_16x16x32_bf16 v[60:63], a[220:223], a[228:231], v[60:63]
 ds_read_b64_tr_b16 a[240:241], v232 offset:49408
 s_add_u32 s37, s36, 640
 v_mfma_f32_16x16x32_bf16 v[108:111], a[220:223], a[200:203], v[108:111]
 ds_read_b64_tr_b16 a[242:243], v232 offset:50944
 s_add_u32 m0, s33, 118784
 v_mfma_f32_16x16x32_bf16 v[16:19], a[212:215], a[196:199], v[16:19]
 buffer_load_dwordx4 v242, s[8:11], s37 offen lds
 v_mfma_f32_16x16x32_bf16 v[64:67], a[212:215], a[228:231], v[64:67]
 ds_read_b128 a[220:223], v212 offset:4096
 v_accvgpr_read_b32 v179, a87
 v_mfma_f32_16x16x32_bf16 v[112:115], a[212:215], a[200:203], v[112:115]
 ds_read_b64_tr_b16 a[244:245], v233 offset:49408
 v_mul_f32 v172, v172, v205
 v_mfma_f32_16x16x32_bf16 v[152:155], a[212:215], a[236:239], v[152:155]
 ds_read_b64_tr_b16 a[246:247], v233 offset:50944
 v_mul_f32 v173, v173, v205
 v_mfma_f32_16x16x32_bf16 v[20:23], a[204:207], a[196:199], v[20:23]
 ds_read_b128 a[212:215], v171 offset:0
 v_mul_f32 v174, v174, v205
 v_mfma_f32_16x16x32_bf16 v[68:71], a[204:207], a[228:231], v[68:71]
 ds_read_b64_tr_b16 a[248:249], v234 offset:49408
 v_mul_f32 v175, v175, v205
 v_mfma_f32_16x16x32_bf16 v[116:119], a[204:207], a[200:203], v[116:119]
 ds_read_b64_tr_b16 a[250:251], v234 offset:50944
 v_mul_f32 v176, v176, v205
 v_mfma_f32_16x16x32_bf16 v[156:159], a[204:207], a[236:239], v[156:159]
 v_mul_f32 v177, v177, v205
 s_waitcnt lgkmcnt(12)
 v_mfma_f32_16x16x32_bf16 v[24:27], a[192:195], a[196:199], v[24:27]
 buffer_load_dwordx4 v243, s[8:11], s37 offen offset:1024 lds
 v_mul_f32 v178, v178, v205
 v_mul_f32 v179, v179, v205
 v_cvt_pk_bf16_f32 v180, v172, v173
 v_cvt_pk_bf16_f32 v181, v174, v175
 v_cvt_pk_bf16_f32 v182, v176, v177
 v_cvt_pk_bf16_f32 v183, v178, v179
 buffer_store_dwordx4 v[180:183], v246, s[24:27], s45 offen offset:1024 sc1
 v_mfma_f32_16x16x32_bf16 v[72:75], a[192:195], a[228:231], v[72:75]
 buffer_load_dwordx4 v244, s[8:11], s37 offen offset:2048 lds
 v_mfma_f32_16x16x32_bf16 v[120:123], a[192:195], a[200:203], v[120:123]
 v_accvgpr_read_b32 v184, a88
 v_accvgpr_read_b32 v185, a89
 v_mfma_f32_16x16x32_bf16 v[28:31], a[216:219], a[196:199], v[28:31]
 v_accvgpr_read_b32 v186, a90
 s_waitcnt vmcnt(30) lgkmcnt(0)
 v_mfma_f32_16x16x32_bf16 v[76:79], a[216:219], a[228:231], v[76:79]
 v_accvgpr_read_b32 v187, a91
 s_barrier
 v_mfma_f32_16x16x32_bf16 v[124:127], a[216:219], a[200:203], v[124:127]
 ds_read_b64_tr_b16 a[192:193], v231 offset:36864
 v_accvgpr_read_b32 v188, a92
 v_mfma_f32_16x16x32_bf16 v[32:35], a[232:235], a[196:199], v[32:35]
 ds_read_b64_tr_b16 a[194:195], v231 offset:38400
 v_accvgpr_read_b32 v189, a93
 v_mfma_f32_16x16x32_bf16 v[80:83], a[232:235], a[228:231], v[80:83]
 buffer_load_dwordx4 v245, s[8:11], s37 offen offset:3072 lds
 v_mfma_f32_16x16x32_bf16 v[128:131], a[232:235], a[200:203], v[128:131]
 ds_read_b64_tr_b16 a[204:205], v232 offset:36864
 s_mov_b32 s38, 4325376
 v_mfma_f32_16x16x32_bf16 v[160:163], a[232:235], a[236:239], v[160:163]
 ds_read_b64_tr_b16 a[206:207], v232 offset:38400
 s_add_u32 m0, s32, 73728
 v_mfma_f32_16x16x32_bf16 v[36:39], a[240:243], a[196:199], v[36:39]
 buffer_load_dwordx4 v239, s[12:15], s38 offen lds
 v_mfma_f32_16x16x32_bf16 v[84:87], a[240:243], a[228:231], v[84:87]
 ds_read_b64_tr_b16 a[216:217], v233 offset:36864
 v_accvgpr_read_b32 v190, a94
 v_mfma_f32_16x16x32_bf16 v[132:135], a[240:243], a[200:203], v[132:135]
 ds_read_b64_tr_b16 a[218:219], v233 offset:38400
 v_accvgpr_read_b32 v191, a95
 v_mfma_f32_16x16x32_bf16 v[164:167], a[240:243], a[236:239], v[164:167]
 v_mul_f32 v184, v184, v205
 v_mul_f32 v185, v185, v205
 v_mfma_f32_16x16x32_bf16 v[40:43], a[244:247], a[196:199], v[40:43]
 ds_read_b64_tr_b16 a[232:233], v234 offset:36864
 v_mul_f32 v186, v186, v205
 v_mfma_f32_16x16x32_bf16 v[88:91], a[244:247], a[228:231], v[88:91]
 ds_read_b64_tr_b16 a[234:235], v234 offset:38400
 v_mul_f32 v187, v187, v205
 v_mfma_f32_16x16x32_bf16 v[136:139], a[244:247], a[200:203], v[136:139]
 buffer_load_dwordx4 v240, s[12:15], s38 offen offset:1024 lds
 v_mfma_f32_16x16x32_bf16 v[44:47], a[248:251], a[196:199], v[44:47]
 ds_read_b64_tr_b16 a[196:197], v231 offset:36992
 v_mul_f32 v188, v188, v205
 v_mfma_f32_16x16x32_bf16 v[92:95], a[248:251], a[228:231], v[92:95]
 ds_read_b64_tr_b16 a[198:199], v231 offset:38528
 v_mul_f32 v189, v189, v205
 v_mfma_f32_16x16x32_bf16 v[140:143], a[248:251], a[200:203], v[140:143]
 v_mul_f32 v190, v190, v205
 s_waitcnt lgkmcnt(8)
 v_mfma_f32_16x16x32_bf16 v[0:3], a[192:195], a[224:227], v[0:3]
 ds_read_b64_tr_b16 a[200:201], v232 offset:36992
 v_mul_f32 v191, v191, v205
 v_mfma_f32_16x16x32_bf16 v[48:51], a[192:195], a[208:211], v[48:51]
 ds_read_b64_tr_b16 a[202:203], v232 offset:38528
 v_cvt_pk_bf16_f32 v192, v184, v185
 v_cvt_pk_bf16_f32 v193, v186, v187
 v_cvt_pk_bf16_f32 v194, v188, v189
 v_cvt_pk_bf16_f32 v195, v190, v191
 buffer_store_dwordx4 v[192:195], v246, s[24:27], s46 offen offset:1024 sc1
 v_mfma_f32_16x16x32_bf16 v[96:99], a[192:195], a[220:223], v[96:99]
 buffer_load_dwordx4 v241, s[12:15], s38 offen offset:2048 lds
 v_mfma_f32_16x16x32_bf16 v[144:147], a[192:195], a[212:215], v[144:147]
 ds_read_b64_tr_b16 a[192:193], v233 offset:36992
 s_waitcnt lgkmcnt(7)
 v_mfma_f32_16x16x32_bf16 v[4:7], a[204:207], a[224:227], v[4:7]
 ds_read_b64_tr_b16 a[194:195], v233 offset:38528
 v_accvgpr_read_b32 v172, a96
 v_mfma_f32_16x16x32_bf16 v[52:55], a[204:207], a[208:211], v[52:55]
 v_accvgpr_read_b32 v173, a97
 v_accvgpr_read_b32 v174, a98
 v_mfma_f32_16x16x32_bf16 v[100:103], a[204:207], a[220:223], v[100:103]
 ds_read_b64_tr_b16 a[228:229], v234 offset:36992
 s_add_u32 s37, s35, 768
 v_mfma_f32_16x16x32_bf16 v[148:151], a[204:207], a[212:215], v[148:151]
 ds_read_b64_tr_b16 a[230:231], v234 offset:38528
 s_add_u32 m0, s32, 0
 v_mfma_f32_16x16x32_bf16 v[8:11], a[216:219], a[224:227], v[8:11]
 buffer_load_dwordx4 v242, s[8:11], s37 offen lds
 v_mfma_f32_16x16x32_bf16 v[56:59], a[216:219], a[208:211], v[56:59]
 ds_read_b64_tr_b16 a[204:205], v231 offset:37120
 v_accvgpr_read_b32 v175, a99
 v_mfma_f32_16x16x32_bf16 v[104:107], a[216:219], a[220:223], v[104:107]
 ds_read_b64_tr_b16 a[206:207], v231 offset:38656
 s_waitcnt lgkmcnt(6)
 v_mfma_f32_16x16x32_bf16 v[12:15], a[232:235], a[224:227], v[12:15]
 v_accvgpr_read_b32 v176, a100
 v_accvgpr_read_b32 v177, a101
 v_mfma_f32_16x16x32_bf16 v[60:63], a[232:235], a[208:211], v[60:63]
 ds_read_b64_tr_b16 a[216:217], v232 offset:37120
 v_accvgpr_read_b32 v178, a102
 v_mfma_f32_16x16x32_bf16 v[108:111], a[232:235], a[220:223], v[108:111]
 ds_read_b64_tr_b16 a[218:219], v232 offset:38656
 v_accvgpr_read_b32 v179, a103
 v_mfma_f32_16x16x32_bf16 v[16:19], a[196:199], a[224:227], v[16:19]
 buffer_load_dwordx4 v243, s[8:11], s37 offen offset:1024 lds
 v_mfma_f32_16x16x32_bf16 v[64:67], a[196:199], a[208:211], v[64:67]
 ds_read_b64_tr_b16 a[232:233], v233 offset:37120
 v_mul_f32 v172, v172, v206
 v_mfma_f32_16x16x32_bf16 v[112:115], a[196:199], a[220:223], v[112:115]
 ds_read_b64_tr_b16 a[234:235], v233 offset:38656
 v_mul_f32 v173, v173, v206
 v_mfma_f32_16x16x32_bf16 v[152:155], a[196:199], a[212:215], v[152:155]
 v_mul_f32 v174, v174, v206
 v_mul_f32 v175, v175, v206
 v_mfma_f32_16x16x32_bf16 v[20:23], a[200:203], a[224:227], v[20:23]
 ds_read_b64_tr_b16 a[196:197], v234 offset:37120
 v_mul_f32 v176, v176, v206
 v_mfma_f32_16x16x32_bf16 v[68:71], a[200:203], a[208:211], v[68:71]
 ds_read_b64_tr_b16 a[198:199], v234 offset:38656
 v_mul_f32 v177, v177, v206
 v_mfma_f32_16x16x32_bf16 v[116:119], a[200:203], a[220:223], v[116:119]
 buffer_load_dwordx4 v244, s[8:11], s37 offen offset:2048 lds
 v_mfma_f32_16x16x32_bf16 v[156:159], a[200:203], a[212:215], v[156:159]
 v_mul_f32 v178, v178, v206
 v_mul_f32 v179, v179, v206
 v_cvt_pk_bf16_f32 v180, v172, v173
 v_cvt_pk_bf16_f32 v181, v174, v175
 v_cvt_pk_bf16_f32 v182, v176, v177
 v_cvt_pk_bf16_f32 v183, v178, v179
 buffer_store_dwordx4 v[180:183], v246, s[24:27], s41 offen offset:2048 sc1
 s_waitcnt lgkmcnt(8)
 v_mfma_f32_16x16x32_bf16 v[24:27], a[192:195], a[224:227], v[24:27]
 v_accvgpr_read_b32 v184, a104
 v_accvgpr_read_b32 v185, a105
 v_mfma_f32_16x16x32_bf16 v[72:75], a[192:195], a[208:211], v[72:75]
 v_accvgpr_read_b32 v186, a106
 v_accvgpr_read_b32 v187, a107
 v_mfma_f32_16x16x32_bf16 v[120:123], a[192:195], a[220:223], v[120:123]
 v_accvgpr_read_b32 v188, a108
 v_accvgpr_read_b32 v189, a109
 v_mfma_f32_16x16x32_bf16 v[28:31], a[228:231], a[224:227], v[28:31]
 v_accvgpr_read_b32 v190, a110
 s_waitcnt vmcnt(25) lgkmcnt(0)
 v_mfma_f32_16x16x32_bf16 v[76:79], a[228:231], a[208:211], v[76:79]
 v_accvgpr_read_b32 v191, a111
 s_barrier
 v_mfma_f32_16x16x32_bf16 v[124:127], a[228:231], a[220:223], v[124:127]
 ds_read_b64_tr_b16 a[192:193], v231 offset:61440
 v_mul_f32 v184, v184, v206
 v_mfma_f32_16x16x32_bf16 v[32:35], a[204:207], a[224:227], v[32:35]
 ds_read_b128 a[200:203], v235 offset:28672
 v_mul_f32 v185, v185, v206
 v_mfma_f32_16x16x32_bf16 v[80:83], a[204:207], a[208:211], v[80:83]
 ds_read_b64_tr_b16 a[194:195], v231 offset:62976
 v_mul_f32 v186, v186, v206
 v_mfma_f32_16x16x32_bf16 v[128:131], a[204:207], a[220:223], v[128:131]
 ds_read_b128 a[228:231], v235 offset:30720
 v_mul_f32 v187, v187, v206
 v_mfma_f32_16x16x32_bf16 v[160:163], a[204:207], a[212:215], v[160:163]
 ds_read_b128 a[204:207], v235 offset:32768
 v_mul_f32 v188, v188, v206
 v_mfma_f32_16x16x32_bf16 v[36:39], a[216:219], a[224:227], v[36:39]
 ds_read_b128 a[236:239], v237 offset:28672
 s_mov_b32 s38, 4718592
 v_mfma_f32_16x16x32_bf16 v[84:87], a[216:219], a[208:211], v[84:87]
 ds_read_b64_tr_b16 a[240:241], v232 offset:61440
 s_add_u32 m0, s32, 61440
 v_mfma_f32_16x16x32_bf16 v[132:135], a[216:219], a[220:223], v[132:135]
 buffer_load_dwordx4 v239, s[12:15], s38 offen lds
 v_mfma_f32_16x16x32_bf16 v[164:167], a[216:219], a[212:215], v[164:167]
 ds_read_b64_tr_b16 a[242:243], v232 offset:62976
 v_mul_f32 v189, v189, v206
 v_mfma_f32_16x16x32_bf16 v[40:43], a[232:235], a[224:227], v[40:43]
 ds_read_b64_tr_b16 a[212:213], v233 offset:61440
 v_mul_f32 v190, v190, v206
 v_mfma_f32_16x16x32_bf16 v[88:91], a[232:235], a[208:211], v[88:91]
 ds_read_b64_tr_b16 a[214:215], v233 offset:62976
 v_mul_f32 v191, v191, v206
 v_mfma_f32_16x16x32_bf16 v[136:139], a[232:235], a[220:223], v[136:139]
 ds_read_b64_tr_b16 a[216:217], v234 offset:61440
 v_cvt_pk_bf16_f32 v192, v184, v185
 v_mfma_f32_16x16x32_bf16 v[44:47], a[196:199], a[224:227], v[44:47]
 ds_read_b64_tr_b16 a[218:219], v234 offset:62976
 v_cvt_pk_bf16_f32 v193, v186, v187
 v_mfma_f32_16x16x32_bf16 v[92:95], a[196:199], a[208:211], v[92:95]
 ds_read_b64_tr_b16 a[208:209], v231 offset:61568
 v_cvt_pk_bf16_f32 v194, v188, v189
 v_mfma_f32_16x16x32_bf16 v[140:143], a[196:199], a[220:223], v[140:143]
 buffer_load_dwordx4 v240, s[12:15], s38 offen offset:1024 lds
 s_waitcnt lgkmcnt(7)
 v_mfma_f32_16x16x32_bf16 v[0:3], a[192:195], a[200:203], v[0:3]
 ds_read_b64_tr_b16 a[210:211], v231 offset:63104
 v_cvt_pk_bf16_f32 v195, v190, v191
 buffer_store_dwordx4 v[192:195], v246, s[24:27], s42 offen offset:2048 sc1
 v_mfma_f32_16x16x32_bf16 v[48:51], a[192:195], a[228:231], v[48:51]
 ds_read_b64_tr_b16 a[196:197], v232 offset:61568
 v_accvgpr_read_b32 v172, a112
 v_mfma_f32_16x16x32_bf16 v[96:99], a[192:195], a[204:207], v[96:99]
 ds_read_b64_tr_b16 a[198:199], v232 offset:63104
 v_accvgpr_read_b32 v173, a113
 v_mfma_f32_16x16x32_bf16 v[144:147], a[192:195], a[236:239], v[144:147]
 ds_read_b64_tr_b16 a[192:193], v233 offset:61568
 s_waitcnt lgkmcnt(7)
 v_mfma_f32_16x16x32_bf16 v[4:7], a[240:243], a[200:203], v[4:7]
 ds_read_b64_tr_b16 a[194:195], v233 offset:63104
 v_accvgpr_read_b32 v174, a114
 v_mfma_f32_16x16x32_bf16 v[52:55], a[240:243], a[228:231], v[52:55]
 ds_read_b64_tr_b16 a[220:221], v234 offset:61568
 v_accvgpr_read_b32 v175, a115
 v_mfma_f32_16x16x32_bf16 v[100:103], a[240:243], a[204:207], v[100:103]
 ds_read_b64_tr_b16 a[222:223], v234 offset:63104
 v_accvgpr_read_b32 v176, a116
 v_mfma_f32_16x16x32_bf16 v[148:151], a[240:243], a[236:239], v[148:151]
 buffer_load_dwordx4 v241, s[12:15], s38 offen offset:2048 lds
 v_mfma_f32_16x16x32_bf16 v[8:11], a[212:215], a[200:203], v[8:11]
 ds_read_b128 a[224:227], v236 offset:28672
 v_accvgpr_read_b32 v177, a117
 v_mfma_f32_16x16x32_bf16 v[56:59], a[212:215], a[228:231], v[56:59]
 ds_read_b64_tr_b16 a[232:233], v231 offset:61696
 v_accvgpr_read_b32 v178, a118
 v_mfma_f32_16x16x32_bf16 v[104:107], a[212:215], a[204:207], v[104:107]
 ds_read_b64_tr_b16 a[234:235], v231 offset:63232
 s_waitcnt lgkmcnt(7)
 v_mfma_f32_16x16x32_bf16 v[12:15], a[216:219], a[200:203], v[12:15]
 ds_read_b128 a[212:215], v236 offset:30720
 v_accvgpr_read_b32 v179, a119
 v_mfma_f32_16x16x32_bf16 v[60:63], a[216:219], a[228:231], v[60:63]
 ds_read_b64_tr_b16 a[240:241], v232 offset:61696
 s_add_u32 s37, s36, 768
 v_mfma_f32_16x16x32_bf16 v[108:111], a[216:219], a[204:207], v[108:111]
 ds_read_b64_tr_b16 a[242:243], v232 offset:63232
 s_add_u32 m0, s33, 12288
 v_mfma_f32_16x16x32_bf16 v[16:19], a[208:211], a[200:203], v[16:19]
 buffer_load_dwordx4 v242, s[8:11], s37 offen lds
 v_mfma_f32_16x16x32_bf16 v[64:67], a[208:211], a[228:231], v[64:67]
 ds_read_b128 a[216:219], v236 offset:32768
 v_mul_f32 v172, v172, v206
 v_mfma_f32_16x16x32_bf16 v[112:115], a[208:211], a[204:207], v[112:115]
 ds_read_b64_tr_b16 a[244:245], v233 offset:61696
 v_mul_f32 v173, v173, v206
 v_mfma_f32_16x16x32_bf16 v[152:155], a[208:211], a[236:239], v[152:155]
 ds_read_b64_tr_b16 a[246:247], v233 offset:63232
 v_mul_f32 v174, v174, v206
 v_mfma_f32_16x16x32_bf16 v[20:23], a[196:199], a[200:203], v[20:23]
 ds_read_b128 a[208:211], v238 offset:28672
 v_mul_f32 v175, v175, v206
 v_mfma_f32_16x16x32_bf16 v[68:71], a[196:199], a[228:231], v[68:71]
 ds_read_b64_tr_b16 a[248:249], v234 offset:61696
 v_mul_f32 v176, v176, v206
 v_mfma_f32_16x16x32_bf16 v[116:119], a[196:199], a[204:207], v[116:119]
 ds_read_b64_tr_b16 a[250:251], v234 offset:63232
 v_mul_f32 v177, v177, v206
 v_mfma_f32_16x16x32_bf16 v[156:159], a[196:199], a[236:239], v[156:159]
 v_mul_f32 v178, v178, v206
 v_mul_f32 v179, v179, v206
 v_cvt_pk_bf16_f32 v180, v172, v173
 v_cvt_pk_bf16_f32 v181, v174, v175
 v_cvt_pk_bf16_f32 v182, v176, v177
 v_cvt_pk_bf16_f32 v183, v178, v179
 buffer_store_dwordx4 v[180:183], v246, s[24:27], s43 offen offset:2048 sc1
 s_waitcnt lgkmcnt(12)
 v_mfma_f32_16x16x32_bf16 v[24:27], a[192:195], a[200:203], v[24:27]
 buffer_load_dwordx4 v243, s[8:11], s37 offen offset:1024 lds
 v_mfma_f32_16x16x32_bf16 v[72:75], a[192:195], a[228:231], v[72:75]
 buffer_load_dwordx4 v244, s[8:11], s37 offen offset:2048 lds
 v_mfma_f32_16x16x32_bf16 v[120:123], a[192:195], a[204:207], v[120:123]
 v_accvgpr_read_b32 v184, a120
 v_accvgpr_read_b32 v185, a121
 v_mfma_f32_16x16x32_bf16 v[28:31], a[220:223], a[200:203], v[28:31]
 v_accvgpr_read_b32 v186, a122
 s_waitcnt vmcnt(29) lgkmcnt(0)
 v_mfma_f32_16x16x32_bf16 v[76:79], a[220:223], a[228:231], v[76:79]
 v_accvgpr_read_b32 v187, a123
 s_barrier
 v_mfma_f32_16x16x32_bf16 v[124:127], a[220:223], a[204:207], v[124:127]
 ds_read_b64_tr_b16 a[192:193], v231 offset:12288
 v_accvgpr_read_b32 v188, a124
 v_mfma_f32_16x16x32_bf16 v[32:35], a[232:235], a[200:203], v[32:35]
 ds_read_b64_tr_b16 a[194:195], v231 offset:13824
 v_accvgpr_read_b32 v189, a125
 v_mfma_f32_16x16x32_bf16 v[80:83], a[232:235], a[228:231], v[80:83]
 buffer_load_dwordx4 v245, s[8:11], s37 offen offset:3072 lds
 v_mfma_f32_16x16x32_bf16 v[128:131], a[232:235], a[204:207], v[128:131]
 ds_read_b64_tr_b16 a[196:197], v232 offset:12288
 s_mov_b32 s38, 5111808
 v_mfma_f32_16x16x32_bf16 v[160:163], a[232:235], a[236:239], v[160:163]
 ds_read_b64_tr_b16 a[198:199], v232 offset:13824
 s_add_u32 m0, s32, 86016
 v_mfma_f32_16x16x32_bf16 v[36:39], a[240:243], a[200:203], v[36:39]
 buffer_load_dwordx4 v239, s[12:15], s38 offen lds
 v_mfma_f32_16x16x32_bf16 v[84:87], a[240:243], a[228:231], v[84:87]
 ds_read_b64_tr_b16 a[220:221], v233 offset:12288
 v_accvgpr_read_b32 v190, a126
 v_mfma_f32_16x16x32_bf16 v[132:135], a[240:243], a[204:207], v[132:135]
 ds_read_b64_tr_b16 a[222:223], v233 offset:13824
 v_accvgpr_read_b32 v191, a127
 v_mfma_f32_16x16x32_bf16 v[164:167], a[240:243], a[236:239], v[164:167]
 v_mul_f32 v184, v184, v206
 v_mul_f32 v185, v185, v206
 v_mfma_f32_16x16x32_bf16 v[40:43], a[244:247], a[200:203], v[40:43]
 ds_read_b64_tr_b16 a[232:233], v234 offset:12288
 v_mul_f32 v186, v186, v206
 v_mfma_f32_16x16x32_bf16 v[88:91], a[244:247], a[228:231], v[88:91]
 ds_read_b64_tr_b16 a[234:235], v234 offset:13824
 v_mul_f32 v187, v187, v206
 v_mfma_f32_16x16x32_bf16 v[136:139], a[244:247], a[204:207], v[136:139]
 buffer_load_dwordx4 v240, s[12:15], s38 offen offset:1024 lds
 v_mfma_f32_16x16x32_bf16 v[44:47], a[248:251], a[200:203], v[44:47]
 ds_read_b64_tr_b16 a[200:201], v231 offset:12416
 v_mul_f32 v188, v188, v206
 v_mfma_f32_16x16x32_bf16 v[92:95], a[248:251], a[228:231], v[92:95]
 ds_read_b64_tr_b16 a[202:203], v231 offset:13952
 v_mul_f32 v189, v189, v206
 v_mfma_f32_16x16x32_bf16 v[140:143], a[248:251], a[204:207], v[140:143]
 v_mul_f32 v190, v190, v206
 s_waitcnt lgkmcnt(8)
 v_mfma_f32_16x16x32_bf16 v[0:3], a[192:195], a[224:227], v[0:3]
 ds_read_b64_tr_b16 a[204:205], v232 offset:12416
 v_mul_f32 v191, v191, v206
 v_cvt_pk_bf16_f32 v192, v184, v185
 v_cvt_pk_bf16_f32 v193, v186, v187
 v_cvt_pk_bf16_f32 v194, v188, v189
 v_cvt_pk_bf16_f32 v195, v190, v191
 buffer_store_dwordx4 v[192:195], v246, s[24:27], s44 offen offset:2048 sc1
 v_mfma_f32_16x16x32_bf16 v[48:51], a[192:195], a[212:215], v[48:51]
 ds_read_b64_tr_b16 a[206:207], v232 offset:13952
 v_accvgpr_read_b32 v172, a128
 v_mfma_f32_16x16x32_bf16 v[96:99], a[192:195], a[216:219], v[96:99]
 buffer_load_dwordx4 v241, s[12:15], s38 offen offset:2048 lds
 v_mfma_f32_16x16x32_bf16 v[144:147], a[192:195], a[208:211], v[144:147]
 ds_read_b64_tr_b16 a[192:193], v233 offset:12416
 s_waitcnt lgkmcnt(7)
 v_mfma_f32_16x16x32_bf16 v[4:7], a[196:199], a[224:227], v[4:7]
 ds_read_b64_tr_b16 a[194:195], v233 offset:13952
 v_accvgpr_read_b32 v173, a129
 v_mfma_f32_16x16x32_bf16 v[52:55], a[196:199], a[212:215], v[52:55]
 v_accvgpr_read_b32 v174, a130
 v_accvgpr_read_b32 v175, a131
 v_mfma_f32_16x16x32_bf16 v[100:103], a[196:199], a[216:219], v[100:103]
 ds_read_b64_tr_b16 a[228:229], v234 offset:12416
 s_add_u32 s37, s35, 896
 v_mfma_f32_16x16x32_bf16 v[148:151], a[196:199], a[208:211], v[148:151]
 ds_read_b64_tr_b16 a[230:231], v234 offset:13952
 s_add_u32 m0, s32, 135168
 v_mfma_f32_16x16x32_bf16 v[8:11], a[220:223], a[224:227], v[8:11]
 buffer_load_dwordx4 v242, s[8:11], s37 offen lds
 v_mfma_f32_16x16x32_bf16 v[56:59], a[220:223], a[212:215], v[56:59]
 ds_read_b64_tr_b16 a[196:197], v231 offset:12544
 v_accvgpr_read_b32 v176, a132
 v_mfma_f32_16x16x32_bf16 v[104:107], a[220:223], a[216:219], v[104:107]
 ds_read_b64_tr_b16 a[198:199], v231 offset:14080
 s_waitcnt lgkmcnt(6)
 v_mfma_f32_16x16x32_bf16 v[12:15], a[232:235], a[224:227], v[12:15]
 v_accvgpr_read_b32 v177, a133
 v_accvgpr_read_b32 v178, a134
 v_mfma_f32_16x16x32_bf16 v[60:63], a[232:235], a[212:215], v[60:63]
 ds_read_b64_tr_b16 a[220:221], v232 offset:12544
 v_accvgpr_read_b32 v179, a135
 v_mfma_f32_16x16x32_bf16 v[108:111], a[232:235], a[216:219], v[108:111]
 ds_read_b64_tr_b16 a[222:223], v232 offset:14080
 v_mul_f32 v172, v172, v206
 v_mfma_f32_16x16x32_bf16 v[16:19], a[200:203], a[224:227], v[16:19]
 buffer_load_dwordx4 v243, s[8:11], s37 offen offset:1024 lds
 v_mfma_f32_16x16x32_bf16 v[64:67], a[200:203], a[212:215], v[64:67]
 ds_read_b64_tr_b16 a[232:233], v233 offset:12544
 v_mul_f32 v173, v173, v206
 v_mfma_f32_16x16x32_bf16 v[112:115], a[200:203], a[216:219], v[112:115]
 ds_read_b64_tr_b16 a[234:235], v233 offset:14080
 v_mul_f32 v174, v174, v206
 v_mfma_f32_16x16x32_bf16 v[152:155], a[200:203], a[208:211], v[152:155]
 v_mul_f32 v175, v175, v206
 v_mul_f32 v176, v176, v206
 v_mfma_f32_16x16x32_bf16 v[20:23], a[204:207], a[224:227], v[20:23]
 ds_read_b64_tr_b16 a[200:201], v234 offset:12544
 v_mul_f32 v177, v177, v206
 v_mfma_f32_16x16x32_bf16 v[68:71], a[204:207], a[212:215], v[68:71]
 ds_read_b64_tr_b16 a[202:203], v234 offset:14080
 v_mul_f32 v178, v178, v206
 v_mfma_f32_16x16x32_bf16 v[116:119], a[204:207], a[216:219], v[116:119]
 buffer_load_dwordx4 v244, s[8:11], s37 offen offset:2048 lds
 v_mfma_f32_16x16x32_bf16 v[156:159], a[204:207], a[208:211], v[156:159]
 v_mul_f32 v179, v179, v206
 v_cvt_pk_bf16_f32 v180, v172, v173
 v_cvt_pk_bf16_f32 v181, v174, v175
 v_cvt_pk_bf16_f32 v182, v176, v177
 v_cvt_pk_bf16_f32 v183, v178, v179
 buffer_store_dwordx4 v[180:183], v246, s[24:27], s45 offen offset:2048 sc1
 s_waitcnt lgkmcnt(8)
 v_mfma_f32_16x16x32_bf16 v[24:27], a[192:195], a[224:227], v[24:27]
 v_accvgpr_read_b32 v184, a136
 v_accvgpr_read_b32 v185, a137
 v_mfma_f32_16x16x32_bf16 v[72:75], a[192:195], a[212:215], v[72:75]
 v_accvgpr_read_b32 v186, a138
 v_accvgpr_read_b32 v187, a139
 v_mfma_f32_16x16x32_bf16 v[120:123], a[192:195], a[216:219], v[120:123]
 v_accvgpr_read_b32 v188, a140
 v_accvgpr_read_b32 v189, a141
 v_mfma_f32_16x16x32_bf16 v[28:31], a[228:231], a[224:227], v[28:31]
 v_accvgpr_read_b32 v190, a142
 s_waitcnt vmcnt(25) lgkmcnt(0)
 v_mfma_f32_16x16x32_bf16 v[76:79], a[228:231], a[212:215], v[76:79]
 v_accvgpr_read_b32 v191, a143
 s_barrier
 v_mfma_f32_16x16x32_bf16 v[124:127], a[228:231], a[216:219], v[124:127]
 ds_read_b64_tr_b16 a[192:193], v231 offset:24576
 v_mul_f32 v184, v184, v206
 v_mfma_f32_16x16x32_bf16 v[32:35], a[196:199], a[224:227], v[32:35]
 ds_read_b128 a[204:207], v235 offset:0
 v_mul_f32 v185, v185, v206
 v_mfma_f32_16x16x32_bf16 v[80:83], a[196:199], a[212:215], v[80:83]
 ds_read_b64_tr_b16 a[194:195], v231 offset:26112
 v_mul_f32 v186, v186, v206
 v_mfma_f32_16x16x32_bf16 v[128:131], a[196:199], a[216:219], v[128:131]
 ds_read_b128 a[228:231], v235 offset:2048
 v_mul_f32 v187, v187, v206
 v_mfma_f32_16x16x32_bf16 v[160:163], a[196:199], a[208:211], v[160:163]
 ds_read_b128 a[196:199], v235 offset:4096
 v_mul_f32 v188, v188, v206
 v_mfma_f32_16x16x32_bf16 v[36:39], a[220:223], a[224:227], v[36:39]
 ds_read_b128 a[236:239], v237 offset:0
 s_mov_b32 s38, 5505024
 v_mfma_f32_16x16x32_bf16 v[84:87], a[220:223], a[212:215], v[84:87]
 ds_read_b64_tr_b16 a[240:241], v232 offset:24576
 s_add_u32 m0, s32, 36864
 v_mfma_f32_16x16x32_bf16 v[132:135], a[220:223], a[216:219], v[132:135]
 buffer_load_dwordx4 v239, s[12:15], s38 offen lds
 v_mfma_f32_16x16x32_bf16 v[164:167], a[220:223], a[208:211], v[164:167]
 ds_read_b64_tr_b16 a[242:243], v232 offset:26112
 v_mul_f32 v189, v189, v206
 v_mfma_f32_16x16x32_bf16 v[40:43], a[232:235], a[224:227], v[40:43]
 ds_read_b64_tr_b16 a[208:209], v233 offset:24576
 v_mul_f32 v190, v190, v206
 v_mfma_f32_16x16x32_bf16 v[88:91], a[232:235], a[212:215], v[88:91]
 ds_read_b64_tr_b16 a[210:211], v233 offset:26112
 v_mul_f32 v191, v191, v206
 v_mfma_f32_16x16x32_bf16 v[136:139], a[232:235], a[216:219], v[136:139]
 ds_read_b64_tr_b16 a[220:221], v234 offset:24576
 v_cvt_pk_bf16_f32 v192, v184, v185
 v_mfma_f32_16x16x32_bf16 v[44:47], a[200:203], a[224:227], v[44:47]
 ds_read_b64_tr_b16 a[222:223], v234 offset:26112
 v_cvt_pk_bf16_f32 v193, v186, v187
 v_mfma_f32_16x16x32_bf16 v[92:95], a[200:203], a[212:215], v[92:95]
 ds_read_b64_tr_b16 a[212:213], v231 offset:24704
 v_cvt_pk_bf16_f32 v194, v188, v189
 v_mfma_f32_16x16x32_bf16 v[140:143], a[200:203], a[216:219], v[140:143]
 buffer_load_dwordx4 v240, s[12:15], s38 offen offset:1024 lds
 s_waitcnt lgkmcnt(7)
 v_mfma_f32_16x16x32_bf16 v[0:3], a[192:195], a[204:207], v[0:3]
 ds_read_b64_tr_b16 a[214:215], v231 offset:26240
 v_cvt_pk_bf16_f32 v195, v190, v191
 buffer_store_dwordx4 v[192:195], v246, s[24:27], s46 offen offset:2048 sc1
 v_mfma_f32_16x16x32_bf16 v[48:51], a[192:195], a[228:231], v[48:51]
 ds_read_b64_tr_b16 a[200:201], v232 offset:24704
 v_mfma_f32_16x16x32_bf16 v[96:99], a[192:195], a[196:199], v[96:99]
 ds_read_b64_tr_b16 a[202:203], v232 offset:26240
 v_mfma_f32_16x16x32_bf16 v[144:147], a[192:195], a[236:239], v[144:147]
 ds_read_b64_tr_b16 a[192:193], v233 offset:24704
 s_waitcnt lgkmcnt(7)
 v_mfma_f32_16x16x32_bf16 v[4:7], a[240:243], a[204:207], v[4:7]
 ds_read_b64_tr_b16 a[194:195], v233 offset:26240
 v_mfma_f32_16x16x32_bf16 v[52:55], a[240:243], a[228:231], v[52:55]
 ds_read_b64_tr_b16 a[216:217], v234 offset:24704
 v_mfma_f32_16x16x32_bf16 v[100:103], a[240:243], a[196:199], v[100:103]
 ds_read_b64_tr_b16 a[218:219], v234 offset:26240
 v_mfma_f32_16x16x32_bf16 v[148:151], a[240:243], a[236:239], v[148:151]
 buffer_load_dwordx4 v241, s[12:15], s38 offen offset:2048 lds
 v_mfma_f32_16x16x32_bf16 v[8:11], a[208:211], a[204:207], v[8:11]
 ds_read_b128 a[224:227], v236 offset:0
 v_mfma_f32_16x16x32_bf16 v[56:59], a[208:211], a[228:231], v[56:59]
 ds_read_b64_tr_b16 a[232:233], v231 offset:24832
 v_mfma_f32_16x16x32_bf16 v[104:107], a[208:211], a[196:199], v[104:107]
 ds_read_b64_tr_b16 a[234:235], v231 offset:26368
 s_waitcnt lgkmcnt(7)
 v_mfma_f32_16x16x32_bf16 v[12:15], a[220:223], a[204:207], v[12:15]
 ds_read_b128 a[208:211], v236 offset:2048
 v_mfma_f32_16x16x32_bf16 v[60:63], a[220:223], a[228:231], v[60:63]
 ds_read_b64_tr_b16 a[240:241], v232 offset:24832
 s_add_u32 s37, s36, 896
 v_mfma_f32_16x16x32_bf16 v[108:111], a[220:223], a[196:199], v[108:111]
 ds_read_b64_tr_b16 a[242:243], v232 offset:26368
 s_add_u32 m0, s33, 147456
 v_mfma_f32_16x16x32_bf16 v[16:19], a[212:215], a[204:207], v[16:19]
 buffer_load_dwordx4 v242, s[8:11], s37 offen lds
 v_mfma_f32_16x16x32_bf16 v[64:67], a[212:215], a[228:231], v[64:67]
 ds_read_b128 a[220:223], v236 offset:4096
 v_mfma_f32_16x16x32_bf16 v[112:115], a[212:215], a[196:199], v[112:115]
 ds_read_b64_tr_b16 a[244:245], v233 offset:24832
 v_mfma_f32_16x16x32_bf16 v[152:155], a[212:215], a[236:239], v[152:155]
 ds_read_b64_tr_b16 a[246:247], v233 offset:26368
 v_mfma_f32_16x16x32_bf16 v[20:23], a[200:203], a[204:207], v[20:23]
 ds_read_b128 a[212:215], v238 offset:0
 v_mfma_f32_16x16x32_bf16 v[68:71], a[200:203], a[228:231], v[68:71]
 ds_read_b64_tr_b16 a[248:249], v234 offset:24832
 v_mfma_f32_16x16x32_bf16 v[116:119], a[200:203], a[196:199], v[116:119]
 ds_read_b64_tr_b16 a[250:251], v234 offset:26368
 v_mfma_f32_16x16x32_bf16 v[156:159], a[200:203], a[236:239], v[156:159]
 s_waitcnt lgkmcnt(12)
 v_mfma_f32_16x16x32_bf16 v[24:27], a[192:195], a[204:207], v[24:27]
 buffer_load_dwordx4 v243, s[8:11], s37 offen offset:1024 lds
 v_mfma_f32_16x16x32_bf16 v[72:75], a[192:195], a[228:231], v[72:75]
 buffer_load_dwordx4 v244, s[8:11], s37 offen offset:2048 lds
 v_mfma_f32_16x16x32_bf16 v[120:123], a[192:195], a[196:199], v[120:123]
 v_mfma_f32_16x16x32_bf16 v[28:31], a[216:219], a[204:207], v[28:31]
 s_waitcnt vmcnt(28) lgkmcnt(0)
 v_mfma_f32_16x16x32_bf16 v[76:79], a[216:219], a[228:231], v[76:79]
 s_barrier
 v_mfma_f32_16x16x32_bf16 v[124:127], a[216:219], a[196:199], v[124:127]
 ds_read_b64_tr_b16 a[192:193], v231 offset:49152
 v_mfma_f32_16x16x32_bf16 v[32:35], a[232:235], a[204:207], v[32:35]
 ds_read_b64_tr_b16 a[194:195], v231 offset:50688
 v_mfma_f32_16x16x32_bf16 v[80:83], a[232:235], a[228:231], v[80:83]
 buffer_load_dwordx4 v245, s[8:11], s37 offen offset:3072 lds
 v_mfma_f32_16x16x32_bf16 v[128:131], a[232:235], a[196:199], v[128:131]
 ds_read_b64_tr_b16 a[200:201], v232 offset:49152
 s_add_u32 s37, s35, 1024
 v_mfma_f32_16x16x32_bf16 v[160:163], a[232:235], a[236:239], v[160:163]
 ds_read_b64_tr_b16 a[202:203], v232 offset:50688
 s_add_u32 m0, s32, 106496
 v_mfma_f32_16x16x32_bf16 v[36:39], a[240:243], a[204:207], v[36:39]
 buffer_load_dwordx4 v242, s[8:11], s37 offen lds
 v_mfma_f32_16x16x32_bf16 v[84:87], a[240:243], a[228:231], v[84:87]
 ds_read_b64_tr_b16 a[216:217], v233 offset:49152
 v_mfma_f32_16x16x32_bf16 v[132:135], a[240:243], a[196:199], v[132:135]
 ds_read_b64_tr_b16 a[218:219], v233 offset:50688
 v_mfma_f32_16x16x32_bf16 v[164:167], a[240:243], a[236:239], v[164:167]
 v_mfma_f32_16x16x32_bf16 v[40:43], a[244:247], a[204:207], v[40:43]
 ds_read_b64_tr_b16 a[232:233], v234 offset:49152
 v_mfma_f32_16x16x32_bf16 v[88:91], a[244:247], a[228:231], v[88:91]
 ds_read_b64_tr_b16 a[234:235], v234 offset:50688
 v_mfma_f32_16x16x32_bf16 v[136:139], a[244:247], a[196:199], v[136:139]
 v_mfma_f32_16x16x32_bf16 v[44:47], a[248:251], a[204:207], v[44:47]
 ds_read_b64_tr_b16 a[204:205], v231 offset:49280
 v_mfma_f32_16x16x32_bf16 v[92:95], a[248:251], a[228:231], v[92:95]
 ds_read_b64_tr_b16 a[206:207], v231 offset:50816
 v_mfma_f32_16x16x32_bf16 v[140:143], a[248:251], a[196:199], v[140:143]
 s_waitcnt lgkmcnt(8)
 v_mfma_f32_16x16x32_bf16 v[0:3], a[192:195], a[224:227], v[0:3]
 ds_read_b64_tr_b16 a[196:197], v232 offset:49280
 v_mfma_f32_16x16x32_bf16 v[48:51], a[192:195], a[208:211], v[48:51]
 ds_read_b64_tr_b16 a[198:199], v232 offset:50816
 v_mfma_f32_16x16x32_bf16 v[96:99], a[192:195], a[220:223], v[96:99]
 buffer_load_dwordx4 v243, s[8:11], s37 offen offset:1024 lds
 v_mfma_f32_16x16x32_bf16 v[144:147], a[192:195], a[212:215], v[144:147]
 ds_read_b64_tr_b16 a[192:193], v233 offset:49280
 s_waitcnt lgkmcnt(7)
 v_mfma_f32_16x16x32_bf16 v[4:7], a[200:203], a[224:227], v[4:7]
 ds_read_b64_tr_b16 a[194:195], v233 offset:50816
 v_mfma_f32_16x16x32_bf16 v[52:55], a[200:203], a[208:211], v[52:55]
 v_mfma_f32_16x16x32_bf16 v[100:103], a[200:203], a[220:223], v[100:103]
 ds_read_b64_tr_b16 a[228:229], v234 offset:49280
 v_mfma_f32_16x16x32_bf16 v[148:151], a[200:203], a[212:215], v[148:151]
 ds_read_b64_tr_b16 a[230:231], v234 offset:50816
 v_mfma_f32_16x16x32_bf16 v[8:11], a[216:219], a[224:227], v[8:11]
 v_mfma_f32_16x16x32_bf16 v[56:59], a[216:219], a[208:211], v[56:59]
 ds_read_b64_tr_b16 a[200:201], v231 offset:49408
 v_mfma_f32_16x16x32_bf16 v[104:107], a[216:219], a[220:223], v[104:107]
 ds_read_b64_tr_b16 a[202:203], v231 offset:50944
 s_waitcnt lgkmcnt(6)
 v_mfma_f32_16x16x32_bf16 v[12:15], a[232:235], a[224:227], v[12:15]
 v_mfma_f32_16x16x32_bf16 v[60:63], a[232:235], a[208:211], v[60:63]
 ds_read_b64_tr_b16 a[216:217], v232 offset:49408
 v_mfma_f32_16x16x32_bf16 v[108:111], a[232:235], a[220:223], v[108:111]
 ds_read_b64_tr_b16 a[218:219], v232 offset:50944
 v_mfma_f32_16x16x32_bf16 v[16:19], a[204:207], a[224:227], v[16:19]
 buffer_load_dwordx4 v244, s[8:11], s37 offen offset:2048 lds
 v_mfma_f32_16x16x32_bf16 v[64:67], a[204:207], a[208:211], v[64:67]
 ds_read_b64_tr_b16 a[232:233], v233 offset:49408
 v_mfma_f32_16x16x32_bf16 v[112:115], a[204:207], a[220:223], v[112:115]
 ds_read_b64_tr_b16 a[234:235], v233 offset:50944
 v_mfma_f32_16x16x32_bf16 v[152:155], a[204:207], a[212:215], v[152:155]
 v_mfma_f32_16x16x32_bf16 v[20:23], a[196:199], a[224:227], v[20:23]
 ds_read_b64_tr_b16 a[204:205], v234 offset:49408
 v_mfma_f32_16x16x32_bf16 v[68:71], a[196:199], a[208:211], v[68:71]
 ds_read_b64_tr_b16 a[206:207], v234 offset:50944
 v_mfma_f32_16x16x32_bf16 v[116:119], a[196:199], a[220:223], v[116:119]
 v_mfma_f32_16x16x32_bf16 v[156:159], a[196:199], a[212:215], v[156:159]
 s_waitcnt lgkmcnt(8)
 v_mfma_f32_16x16x32_bf16 v[24:27], a[192:195], a[224:227], v[24:27]
 v_mfma_f32_16x16x32_bf16 v[72:75], a[192:195], a[208:211], v[72:75]
 v_mfma_f32_16x16x32_bf16 v[120:123], a[192:195], a[220:223], v[120:123]
 v_mfma_f32_16x16x32_bf16 v[28:31], a[228:231], a[224:227], v[28:31]
 s_waitcnt vmcnt(19) lgkmcnt(0)
 v_mfma_f32_16x16x32_bf16 v[76:79], a[228:231], a[208:211], v[76:79]
 s_barrier
 v_mfma_f32_16x16x32_bf16 v[124:127], a[228:231], a[220:223], v[124:127]
 ds_read_b64_tr_b16 a[192:193], v231 offset:36864
 v_mfma_f32_16x16x32_bf16 v[32:35], a[200:203], a[224:227], v[32:35]
 ds_read_b128 a[196:199], v207 offset:0
 v_mfma_f32_16x16x32_bf16 v[80:83], a[200:203], a[208:211], v[80:83]
 ds_read_b64_tr_b16 a[194:195], v231 offset:38400
 v_mfma_f32_16x16x32_bf16 v[128:131], a[200:203], a[220:223], v[128:131]
 ds_read_b128 a[228:231], v207 offset:2048
 v_mfma_f32_16x16x32_bf16 v[160:163], a[200:203], a[212:215], v[160:163]
 ds_read_b128 a[200:203], v207 offset:4096
 v_mfma_f32_16x16x32_bf16 v[36:39], a[216:219], a[224:227], v[36:39]
 ds_read_b128 a[236:239], v213 offset:0
 s_mov_b32 s38, 6291456
 v_mfma_f32_16x16x32_bf16 v[84:87], a[216:219], a[208:211], v[84:87]
 ds_read_b64_tr_b16 a[240:241], v232 offset:36864
 s_add_u32 m0, s32, 73728
 v_mfma_f32_16x16x32_bf16 v[132:135], a[216:219], a[220:223], v[132:135]
 buffer_load_dwordx4 v239, s[12:15], s38 offen lds
 v_mfma_f32_16x16x32_bf16 v[164:167], a[216:219], a[212:215], v[164:167]
 ds_read_b64_tr_b16 a[242:243], v232 offset:38400
 v_mfma_f32_16x16x32_bf16 v[40:43], a[232:235], a[224:227], v[40:43]
 ds_read_b64_tr_b16 a[212:213], v233 offset:36864
 v_mfma_f32_16x16x32_bf16 v[88:91], a[232:235], a[208:211], v[88:91]
 ds_read_b64_tr_b16 a[214:215], v233 offset:38400
 v_mfma_f32_16x16x32_bf16 v[136:139], a[232:235], a[220:223], v[136:139]
 ds_read_b64_tr_b16 a[216:217], v234 offset:36864
 v_mfma_f32_16x16x32_bf16 v[44:47], a[204:207], a[224:227], v[44:47]
 ds_read_b64_tr_b16 a[218:219], v234 offset:38400
 v_mfma_f32_16x16x32_bf16 v[92:95], a[204:207], a[208:211], v[92:95]
 ds_read_b64_tr_b16 a[208:209], v231 offset:36992
 v_mfma_f32_16x16x32_bf16 v[140:143], a[204:207], a[220:223], v[140:143]
 buffer_load_dwordx4 v240, s[12:15], s38 offen offset:1024 lds
 s_waitcnt lgkmcnt(7)
 v_mfma_f32_16x16x32_bf16 v[0:3], a[192:195], a[196:199], v[0:3]
 ds_read_b64_tr_b16 a[210:211], v231 offset:38528
 v_mfma_f32_16x16x32_bf16 v[48:51], a[192:195], a[228:231], v[48:51]
 ds_read_b64_tr_b16 a[204:205], v232 offset:36992
 v_mfma_f32_16x16x32_bf16 v[96:99], a[192:195], a[200:203], v[96:99]
 ds_read_b64_tr_b16 a[206:207], v232 offset:38528
 v_mfma_f32_16x16x32_bf16 v[144:147], a[192:195], a[236:239], v[144:147]
 ds_read_b64_tr_b16 a[192:193], v233 offset:36992
 s_waitcnt lgkmcnt(7)
 v_mfma_f32_16x16x32_bf16 v[4:7], a[240:243], a[196:199], v[4:7]
 ds_read_b64_tr_b16 a[194:195], v233 offset:38528
 v_mfma_f32_16x16x32_bf16 v[52:55], a[240:243], a[228:231], v[52:55]
 ds_read_b64_tr_b16 a[220:221], v234 offset:36992
 v_mfma_f32_16x16x32_bf16 v[100:103], a[240:243], a[200:203], v[100:103]
 ds_read_b64_tr_b16 a[222:223], v234 offset:38528
 v_mfma_f32_16x16x32_bf16 v[148:151], a[240:243], a[236:239], v[148:151]
 buffer_load_dwordx4 v241, s[12:15], s38 offen offset:2048 lds
 v_mfma_f32_16x16x32_bf16 v[8:11], a[212:215], a[196:199], v[8:11]
 ds_read_b128 a[224:227], v212 offset:0
 v_mfma_f32_16x16x32_bf16 v[56:59], a[212:215], a[228:231], v[56:59]
 ds_read_b64_tr_b16 a[232:233], v231 offset:37120
 v_mfma_f32_16x16x32_bf16 v[104:107], a[212:215], a[200:203], v[104:107]
 ds_read_b64_tr_b16 a[234:235], v231 offset:38656
 s_waitcnt lgkmcnt(7)
 v_mfma_f32_16x16x32_bf16 v[12:15], a[216:219], a[196:199], v[12:15]
 ds_read_b128 a[212:215], v212 offset:2048
 v_mfma_f32_16x16x32_bf16 v[60:63], a[216:219], a[228:231], v[60:63]
 ds_read_b64_tr_b16 a[240:241], v232 offset:37120
 s_add_u32 s37, s36, 1024
 v_mfma_f32_16x16x32_bf16 v[108:111], a[216:219], a[200:203], v[108:111]
 ds_read_b64_tr_b16 a[242:243], v232 offset:38656
 s_add_u32 m0, s33, 118784
 v_mfma_f32_16x16x32_bf16 v[16:19], a[208:211], a[196:199], v[16:19]
 buffer_load_dwordx4 v242, s[8:11], s37 offen lds
 v_mfma_f32_16x16x32_bf16 v[64:67], a[208:211], a[228:231], v[64:67]
 ds_read_b128 a[216:219], v212 offset:4096
 v_mfma_f32_16x16x32_bf16 v[112:115], a[208:211], a[200:203], v[112:115]
 ds_read_b64_tr_b16 a[244:245], v233 offset:37120
 v_mfma_f32_16x16x32_bf16 v[152:155], a[208:211], a[236:239], v[152:155]
 ds_read_b64_tr_b16 a[246:247], v233 offset:38656
 v_mfma_f32_16x16x32_bf16 v[20:23], a[204:207], a[196:199], v[20:23]
 ds_read_b128 a[208:211], v171 offset:0
 v_mfma_f32_16x16x32_bf16 v[68:71], a[204:207], a[228:231], v[68:71]
 ds_read_b64_tr_b16 a[248:249], v234 offset:37120
 v_mfma_f32_16x16x32_bf16 v[116:119], a[204:207], a[200:203], v[116:119]
 ds_read_b64_tr_b16 a[250:251], v234 offset:38656
 v_mfma_f32_16x16x32_bf16 v[156:159], a[204:207], a[236:239], v[156:159]
 s_waitcnt lgkmcnt(12)
 v_mfma_f32_16x16x32_bf16 v[24:27], a[192:195], a[196:199], v[24:27]
 buffer_load_dwordx4 v243, s[8:11], s37 offen offset:1024 lds
 v_mfma_f32_16x16x32_bf16 v[72:75], a[192:195], a[228:231], v[72:75]
 buffer_load_dwordx4 v244, s[8:11], s37 offen offset:2048 lds
 v_mfma_f32_16x16x32_bf16 v[120:123], a[192:195], a[200:203], v[120:123]
 v_mfma_f32_16x16x32_bf16 v[28:31], a[220:223], a[196:199], v[28:31]
 s_waitcnt vmcnt(21) lgkmcnt(0)
 v_mfma_f32_16x16x32_bf16 v[76:79], a[220:223], a[228:231], v[76:79]
 s_barrier
 v_mfma_f32_16x16x32_bf16 v[124:127], a[220:223], a[200:203], v[124:127]
 ds_read_b64_tr_b16 a[192:193], v231 offset:61440
 v_mfma_f32_16x16x32_bf16 v[32:35], a[232:235], a[196:199], v[32:35]
 ds_read_b64_tr_b16 a[194:195], v231 offset:62976
 v_mfma_f32_16x16x32_bf16 v[80:83], a[232:235], a[228:231], v[80:83]
 buffer_load_dwordx4 v245, s[8:11], s37 offen offset:3072 lds
 v_mfma_f32_16x16x32_bf16 v[128:131], a[232:235], a[200:203], v[128:131]
 ds_read_b64_tr_b16 a[204:205], v232 offset:61440
 s_mov_b32 s38, 5898240
 v_mfma_f32_16x16x32_bf16 v[160:163], a[232:235], a[236:239], v[160:163]
 ds_read_b64_tr_b16 a[206:207], v232 offset:62976
 s_add_u32 m0, s32, 24576
 v_mfma_f32_16x16x32_bf16 v[36:39], a[240:243], a[196:199], v[36:39]
 buffer_load_dwordx4 v239, s[12:15], s38 offen lds
 v_mfma_f32_16x16x32_bf16 v[84:87], a[240:243], a[228:231], v[84:87]
 ds_read_b64_tr_b16 a[220:221], v233 offset:61440
 v_mfma_f32_16x16x32_bf16 v[132:135], a[240:243], a[200:203], v[132:135]
 ds_read_b64_tr_b16 a[222:223], v233 offset:62976
 v_mfma_f32_16x16x32_bf16 v[164:167], a[240:243], a[236:239], v[164:167]
 buffer_load_dwordx4 v240, s[12:15], s38 offen offset:1024 lds
 v_mfma_f32_16x16x32_bf16 v[40:43], a[244:247], a[196:199], v[40:43]
 ds_read_b64_tr_b16 a[232:233], v234 offset:61440
 v_mfma_f32_16x16x32_bf16 v[88:91], a[244:247], a[228:231], v[88:91]
 ds_read_b64_tr_b16 a[234:235], v234 offset:62976
 v_mfma_f32_16x16x32_bf16 v[136:139], a[244:247], a[200:203], v[136:139]
 buffer_load_dwordx4 v241, s[12:15], s38 offen offset:2048 lds
 v_mfma_f32_16x16x32_bf16 v[44:47], a[248:251], a[196:199], v[44:47]
 ds_read_b64_tr_b16 a[196:197], v231 offset:61568
 v_mfma_f32_16x16x32_bf16 v[92:95], a[248:251], a[228:231], v[92:95]
 ds_read_b64_tr_b16 a[198:199], v231 offset:63104
 v_mfma_f32_16x16x32_bf16 v[140:143], a[248:251], a[200:203], v[140:143]
 s_waitcnt lgkmcnt(8)
 v_mfma_f32_16x16x32_bf16 v[0:3], a[192:195], a[224:227], v[0:3]
 ds_read_b64_tr_b16 a[200:201], v232 offset:61568
 v_mfma_f32_16x16x32_bf16 v[48:51], a[192:195], a[212:215], v[48:51]
 ds_read_b64_tr_b16 a[202:203], v232 offset:63104
 s_add_u32 m0, s34, 0
 s_xor_b32 s39, s77, 0
 s_mul_i32 s39, s39, 24576
 v_mfma_f32_16x16x32_bf16 v[96:99], a[192:195], a[216:219], v[96:99]
 buffer_load_dwordx4 v226, s[16:19], s39 offen nt lds
 v_mfma_f32_16x16x32_bf16 v[144:147], a[192:195], a[208:211], v[144:147]
 ds_read_b64_tr_b16 a[192:193], v233 offset:61568
 s_waitcnt lgkmcnt(7)
 v_mfma_f32_16x16x32_bf16 v[4:7], a[204:207], a[224:227], v[4:7]
 ds_read_b64_tr_b16 a[194:195], v233 offset:63104
 v_mfma_f32_16x16x32_bf16 v[52:55], a[204:207], a[212:215], v[52:55]
 buffer_load_dwordx4 v227, s[16:19], s39 offen offset:1024 nt lds
 v_mfma_f32_16x16x32_bf16 v[100:103], a[204:207], a[216:219], v[100:103]
 ds_read_b64_tr_b16 a[228:229], v234 offset:61568
 v_mfma_f32_16x16x32_bf16 v[148:151], a[204:207], a[208:211], v[148:151]
 ds_read_b64_tr_b16 a[230:231], v234 offset:63104
 v_mfma_f32_16x16x32_bf16 v[8:11], a[220:223], a[224:227], v[8:11]
 buffer_load_dwordx4 v228, s[16:19], s39 offen offset:2048 nt lds
 v_mfma_f32_16x16x32_bf16 v[56:59], a[220:223], a[212:215], v[56:59]
 ds_read_b64_tr_b16 a[204:205], v231 offset:61696
 v_mfma_f32_16x16x32_bf16 v[104:107], a[220:223], a[216:219], v[104:107]
 ds_read_b64_tr_b16 a[206:207], v231 offset:63232
 s_waitcnt lgkmcnt(6)
 v_mfma_f32_16x16x32_bf16 v[12:15], a[232:235], a[224:227], v[12:15]
 v_mfma_f32_16x16x32_bf16 v[60:63], a[232:235], a[212:215], v[60:63]
 ds_read_b64_tr_b16 a[220:221], v232 offset:61696
 v_mfma_f32_16x16x32_bf16 v[108:111], a[232:235], a[216:219], v[108:111]
 ds_read_b64_tr_b16 a[222:223], v232 offset:63232
 v_mfma_f32_16x16x32_bf16 v[16:19], a[196:199], a[224:227], v[16:19]
 buffer_load_dwordx4 v226, s[16:19], s39 offen offset:3072 nt lds
 v_mfma_f32_16x16x32_bf16 v[64:67], a[196:199], a[212:215], v[64:67]
 ds_read_b64_tr_b16 a[232:233], v233 offset:61696
 v_mfma_f32_16x16x32_bf16 v[112:115], a[196:199], a[216:219], v[112:115]
 ds_read_b64_tr_b16 a[234:235], v233 offset:63232
 s_add_u32 m0, s34, 4096
 v_mfma_f32_16x16x32_bf16 v[152:155], a[196:199], a[208:211], v[152:155]
 buffer_load_dwordx4 v229, s[16:19], s39 offen nt lds
 v_mfma_f32_16x16x32_bf16 v[20:23], a[200:203], a[224:227], v[20:23]
 ds_read_b64_tr_b16 a[196:197], v234 offset:61696
 v_mfma_f32_16x16x32_bf16 v[68:71], a[200:203], a[212:215], v[68:71]
 ds_read_b64_tr_b16 a[198:199], v234 offset:63232
 v_mfma_f32_16x16x32_bf16 v[116:119], a[200:203], a[216:219], v[116:119]
 buffer_load_dwordx4 v230, s[16:19], s39 offen offset:1024 nt lds
 v_mfma_f32_16x16x32_bf16 v[156:159], a[200:203], a[208:211], v[156:159]
 s_waitcnt lgkmcnt(8)
 v_mfma_f32_16x16x32_bf16 v[24:27], a[192:195], a[224:227], v[24:27]
 v_mfma_f32_16x16x32_bf16 v[72:75], a[192:195], a[212:215], v[72:75]
 v_mfma_f32_16x16x32_bf16 v[120:123], a[192:195], a[216:219], v[120:123]
 v_mfma_f32_16x16x32_bf16 v[28:31], a[228:231], a[224:227], v[28:31]
 s_waitcnt vmcnt(19) lgkmcnt(0)
 v_mfma_f32_16x16x32_bf16 v[76:79], a[228:231], a[212:215], v[76:79]
 s_barrier
 v_mfma_f32_16x16x32_bf16 v[124:127], a[228:231], a[216:219], v[124:127]
 ds_read_b64_tr_b16 a[192:193], v231 offset:12288
 v_mfma_f32_16x16x32_bf16 v[32:35], a[204:207], a[224:227], v[32:35]
 ds_read_b128 a[200:203], v235 offset:28672
 v_mfma_f32_16x16x32_bf16 v[80:83], a[204:207], a[212:215], v[80:83]
 ds_read_b64_tr_b16 a[194:195], v231 offset:13824
 v_mfma_f32_16x16x32_bf16 v[128:131], a[204:207], a[216:219], v[128:131]
 ds_read_b128 a[228:231], v235 offset:30720
 v_mfma_f32_16x16x32_bf16 v[160:163], a[204:207], a[208:211], v[160:163]
 ds_read_b128 a[204:207], v235 offset:32768
 v_mfma_f32_16x16x32_bf16 v[36:39], a[220:223], a[224:227], v[36:39]
 ds_read_b128 a[236:239], v237 offset:28672
 s_mov_b32 s38, 6684672
 v_mfma_f32_16x16x32_bf16 v[84:87], a[220:223], a[212:215], v[84:87]
 ds_read_b64_tr_b16 a[240:241], v232 offset:12288
 s_add_u32 m0, s32, 86016
 v_mfma_f32_16x16x32_bf16 v[132:135], a[220:223], a[216:219], v[132:135]
 buffer_load_dwordx4 v239, s[12:15], s38 offen lds
 v_mfma_f32_16x16x32_bf16 v[164:167], a[220:223], a[208:211], v[164:167]
 ds_read_b64_tr_b16 a[242:243], v232 offset:13824
 v_mfma_f32_16x16x32_bf16 v[40:43], a[232:235], a[224:227], v[40:43]
 ds_read_b64_tr_b16 a[208:209], v233 offset:12288
 v_mfma_f32_16x16x32_bf16 v[88:91], a[232:235], a[212:215], v[88:91]
 ds_read_b64_tr_b16 a[210:211], v233 offset:13824
 v_mfma_f32_16x16x32_bf16 v[136:139], a[232:235], a[216:219], v[136:139]
 ds_read_b64_tr_b16 a[220:221], v234 offset:12288
 v_mfma_f32_16x16x32_bf16 v[44:47], a[196:199], a[224:227], v[44:47]
 ds_read_b64_tr_b16 a[222:223], v234 offset:13824
 v_mfma_f32_16x16x32_bf16 v[92:95], a[196:199], a[212:215], v[92:95]
 ds_read_b64_tr_b16 a[212:213], v231 offset:12416
 v_mfma_f32_16x16x32_bf16 v[140:143], a[196:199], a[216:219], v[140:143]
 buffer_load_dwordx4 v240, s[12:15], s38 offen offset:1024 lds
 s_waitcnt lgkmcnt(7)
 v_mfma_f32_16x16x32_bf16 v[0:3], a[192:195], a[200:203], v[0:3]
 ds_read_b64_tr_b16 a[214:215], v231 offset:13952
 v_mfma_f32_16x16x32_bf16 v[48:51], a[192:195], a[228:231], v[48:51]
 ds_read_b64_tr_b16 a[196:197], v232 offset:12416
 v_mfma_f32_16x16x32_bf16 v[96:99], a[192:195], a[204:207], v[96:99]
 ds_read_b64_tr_b16 a[198:199], v232 offset:13952
 v_mfma_f32_16x16x32_bf16 v[144:147], a[192:195], a[236:239], v[144:147]
 ds_read_b64_tr_b16 a[192:193], v233 offset:12416
 s_waitcnt lgkmcnt(7)
 v_mfma_f32_16x16x32_bf16 v[4:7], a[240:243], a[200:203], v[4:7]
 ds_read_b64_tr_b16 a[194:195], v233 offset:13952
 v_mfma_f32_16x16x32_bf16 v[52:55], a[240:243], a[228:231], v[52:55]
 ds_read_b64_tr_b16 a[216:217], v234 offset:12416
 v_mfma_f32_16x16x32_bf16 v[100:103], a[240:243], a[204:207], v[100:103]
 ds_read_b64_tr_b16 a[218:219], v234 offset:13952
 v_mfma_f32_16x16x32_bf16 v[148:151], a[240:243], a[236:239], v[148:151]
 buffer_load_dwordx4 v241, s[12:15], s38 offen offset:2048 lds
 v_mfma_f32_16x16x32_bf16 v[8:11], a[208:211], a[200:203], v[8:11]
 ds_read_b128 a[224:227], v236 offset:28672
 v_mfma_f32_16x16x32_bf16 v[56:59], a[208:211], a[228:231], v[56:59]
 ds_read_b64_tr_b16 a[232:233], v231 offset:12544
 v_mfma_f32_16x16x32_bf16 v[104:107], a[208:211], a[204:207], v[104:107]
 ds_read_b64_tr_b16 a[234:235], v231 offset:14080
 s_waitcnt lgkmcnt(7)
 v_mfma_f32_16x16x32_bf16 v[12:15], a[220:223], a[200:203], v[12:15]
 ds_read_b128 a[208:211], v236 offset:30720
 v_mfma_f32_16x16x32_bf16 v[60:63], a[220:223], a[228:231], v[60:63]
 ds_read_b64_tr_b16 a[240:241], v232 offset:12544
 v_mfma_f32_16x16x32_bf16 v[108:111], a[220:223], a[204:207], v[108:111]
 ds_read_b64_tr_b16 a[242:243], v232 offset:14080
 s_add_u32 m0, s34, 49152
 s_xor_b32 s39, s77, 1
 s_mul_i32 s39, s39, 24576
 v_mfma_f32_16x16x32_bf16 v[16:19], a[212:215], a[200:203], v[16:19]
 buffer_load_dwordx4 v226, s[16:19], s39 offen nt lds
 v_mfma_f32_16x16x32_bf16 v[64:67], a[212:215], a[228:231], v[64:67]
 ds_read_b128 a[220:223], v236 offset:32768
 v_mfma_f32_16x16x32_bf16 v[112:115], a[212:215], a[204:207], v[112:115]
 ds_read_b64_tr_b16 a[244:245], v233 offset:12544
 v_mfma_f32_16x16x32_bf16 v[152:155], a[212:215], a[236:239], v[152:155]
 ds_read_b64_tr_b16 a[246:247], v233 offset:14080
 v_mfma_f32_16x16x32_bf16 v[20:23], a[196:199], a[200:203], v[20:23]
 ds_read_b128 a[212:215], v238 offset:28672
 v_mfma_f32_16x16x32_bf16 v[68:71], a[196:199], a[228:231], v[68:71]
 ds_read_b64_tr_b16 a[248:249], v234 offset:12544
 v_mfma_f32_16x16x32_bf16 v[116:119], a[196:199], a[204:207], v[116:119]
 ds_read_b64_tr_b16 a[250:251], v234 offset:14080
 v_mfma_f32_16x16x32_bf16 v[156:159], a[196:199], a[236:239], v[156:159]
 s_waitcnt lgkmcnt(12)
 v_mfma_f32_16x16x32_bf16 v[24:27], a[192:195], a[200:203], v[24:27]
 buffer_load_dwordx4 v227, s[16:19], s39 offen offset:1024 nt lds
 v_mfma_f32_16x16x32_bf16 v[72:75], a[192:195], a[228:231], v[72:75]
 buffer_load_dwordx4 v228, s[16:19], s39 offen offset:2048 nt lds
 v_mfma_f32_16x16x32_bf16 v[120:123], a[192:195], a[204:207], v[120:123]
 v_mfma_f32_16x16x32_bf16 v[28:31], a[216:219], a[200:203], v[28:31]
 s_waitcnt vmcnt(12) lgkmcnt(0)
 v_mfma_f32_16x16x32_bf16 v[76:79], a[216:219], a[228:231], v[76:79]
 s_barrier
 v_mfma_f32_16x16x32_bf16 v[124:127], a[216:219], a[204:207], v[124:127]
 ds_read_b64_tr_b16 a[192:193], v231 offset:0
 v_mfma_f32_16x16x32_bf16 v[32:35], a[232:235], a[200:203], v[32:35]
 ds_read_b64_tr_b16 a[194:195], v231 offset:1536
 v_mfma_f32_16x16x32_bf16 v[80:83], a[232:235], a[228:231], v[80:83]
 buffer_load_dwordx4 v226, s[16:19], s39 offen offset:3072 nt lds
 v_mfma_f32_16x16x32_bf16 v[128:131], a[232:235], a[204:207], v[128:131]
 ds_read_b64_tr_b16 a[196:197], v232 offset:0
 v_mfma_f32_16x16x32_bf16 v[160:163], a[232:235], a[236:239], v[160:163]
 ds_read_b64_tr_b16 a[198:199], v232 offset:1536
 s_add_u32 m0, s34, 53248
 v_mfma_f32_16x16x32_bf16 v[36:39], a[240:243], a[200:203], v[36:39]
 buffer_load_dwordx4 v229, s[16:19], s39 offen nt lds
 v_mfma_f32_16x16x32_bf16 v[84:87], a[240:243], a[228:231], v[84:87]
 ds_read_b64_tr_b16 a[216:217], v233 offset:0
 v_mfma_f32_16x16x32_bf16 v[132:135], a[240:243], a[204:207], v[132:135]
 ds_read_b64_tr_b16 a[218:219], v233 offset:1536
 v_mfma_f32_16x16x32_bf16 v[164:167], a[240:243], a[236:239], v[164:167]
 v_mfma_f32_16x16x32_bf16 v[40:43], a[244:247], a[200:203], v[40:43]
 ds_read_b64_tr_b16 a[232:233], v234 offset:0
 v_mfma_f32_16x16x32_bf16 v[88:91], a[244:247], a[228:231], v[88:91]
 ds_read_b64_tr_b16 a[234:235], v234 offset:1536
 v_mfma_f32_16x16x32_bf16 v[136:139], a[244:247], a[204:207], v[136:139]
 buffer_load_dwordx4 v230, s[16:19], s39 offen offset:1024 nt lds
 v_mfma_f32_16x16x32_bf16 v[44:47], a[248:251], a[200:203], v[44:47]
 ds_read_b64_tr_b16 a[200:201], v231 offset:128
 v_mfma_f32_16x16x32_bf16 v[92:95], a[248:251], a[228:231], v[92:95]
 ds_read_b64_tr_b16 a[202:203], v231 offset:1664
 v_mfma_f32_16x16x32_bf16 v[140:143], a[248:251], a[204:207], v[140:143]
 s_waitcnt lgkmcnt(8)
 v_mfma_f32_16x16x32_bf16 v[0:3], a[192:195], a[224:227], v[0:3]
 ds_read_b64_tr_b16 a[204:205], v232 offset:128
 s_mov_b32 s38, 7077888
 v_mfma_f32_16x16x32_bf16 v[48:51], a[192:195], a[208:211], v[48:51]
 ds_read_b64_tr_b16 a[206:207], v232 offset:1664
 s_add_u32 m0, s32, 36864
 v_mfma_f32_16x16x32_bf16 v[96:99], a[192:195], a[220:223], v[96:99]
 buffer_load_dwordx4 v239, s[12:15], s38 offen lds
 v_mfma_f32_16x16x32_bf16 v[144:147], a[192:195], a[212:215], v[144:147]
 ds_read_b64_tr_b16 a[192:193], v233 offset:128
 s_waitcnt lgkmcnt(7)
 v_mfma_f32_16x16x32_bf16 v[4:7], a[196:199], a[224:227], v[4:7]
 ds_read_b64_tr_b16 a[194:195], v233 offset:1664
 v_mfma_f32_16x16x32_bf16 v[52:55], a[196:199], a[208:211], v[52:55]
 buffer_load_dwordx4 v240, s[12:15], s38 offen offset:1024 lds
 v_mfma_f32_16x16x32_bf16 v[100:103], a[196:199], a[220:223], v[100:103]
 ds_read_b64_tr_b16 a[228:229], v234 offset:128
 v_mfma_f32_16x16x32_bf16 v[148:151], a[196:199], a[212:215], v[148:151]
 ds_read_b64_tr_b16 a[230:231], v234 offset:1664
 v_mfma_f32_16x16x32_bf16 v[8:11], a[216:219], a[224:227], v[8:11]
 buffer_load_dwordx4 v241, s[12:15], s38 offen offset:2048 lds
 v_mfma_f32_16x16x32_bf16 v[56:59], a[216:219], a[208:211], v[56:59]
 ds_read_b64_tr_b16 a[196:197], v231 offset:256
 s_add_u32 m0, s32, 135168
 v_mfma_f32_16x16x32_bf16 v[104:107], a[216:219], a[220:223], v[104:107]
 ds_read_b64_tr_b16 a[198:199], v231 offset:1792
 s_add_u32 s37, s35, 1152
 s_waitcnt lgkmcnt(6)
 v_mfma_f32_16x16x32_bf16 v[12:15], a[232:235], a[224:227], v[12:15]
 buffer_load_dwordx4 v242, s[8:11], s37 offen lds
 v_mfma_f32_16x16x32_bf16 v[60:63], a[232:235], a[208:211], v[60:63]
 ds_read_b64_tr_b16 a[216:217], v232 offset:256
 v_mfma_f32_16x16x32_bf16 v[108:111], a[232:235], a[220:223], v[108:111]
 ds_read_b64_tr_b16 a[218:219], v232 offset:1792
 v_mfma_f32_16x16x32_bf16 v[16:19], a[200:203], a[224:227], v[16:19]
 buffer_load_dwordx4 v243, s[8:11], s37 offen offset:1024 lds
 v_mfma_f32_16x16x32_bf16 v[64:67], a[200:203], a[208:211], v[64:67]
 ds_read_b64_tr_b16 a[232:233], v233 offset:256
 v_mfma_f32_16x16x32_bf16 v[112:115], a[200:203], a[220:223], v[112:115]
 ds_read_b64_tr_b16 a[234:235], v233 offset:1792
 v_mfma_f32_16x16x32_bf16 v[152:155], a[200:203], a[212:215], v[152:155]
 buffer_load_dwordx4 v244, s[8:11], s37 offen offset:2048 lds
 v_mfma_f32_16x16x32_bf16 v[20:23], a[204:207], a[224:227], v[20:23]
 ds_read_b64_tr_b16 a[200:201], v234 offset:256
 s_add_u32 s37, s36, 1152
 v_mfma_f32_16x16x32_bf16 v[68:71], a[204:207], a[208:211], v[68:71]
 ds_read_b64_tr_b16 a[202:203], v234 offset:1792
 s_add_u32 m0, s33, 147456
 v_mfma_f32_16x16x32_bf16 v[116:119], a[204:207], a[220:223], v[116:119]
 buffer_load_dwordx4 v242, s[8:11], s37 offen lds
 v_mfma_f32_16x16x32_bf16 v[156:159], a[204:207], a[212:215], v[156:159]
 s_waitcnt lgkmcnt(8)
 v_mfma_f32_16x16x32_bf16 v[24:27], a[192:195], a[224:227], v[24:27]
 buffer_load_dwordx4 v243, s[8:11], s37 offen offset:1024 lds
 v_mfma_f32_16x16x32_bf16 v[72:75], a[192:195], a[208:211], v[72:75]
 buffer_load_dwordx4 v244, s[8:11], s37 offen offset:2048 lds
 v_mfma_f32_16x16x32_bf16 v[120:123], a[192:195], a[220:223], v[120:123]
 v_mfma_f32_16x16x32_bf16 v[28:31], a[228:231], a[224:227], v[28:31]
 s_waitcnt vmcnt(27) lgkmcnt(0)
 v_mfma_f32_16x16x32_bf16 v[76:79], a[228:231], a[208:211], v[76:79]
 s_barrier
 v_mfma_f32_16x16x32_bf16 v[124:127], a[228:231], a[220:223], v[124:127]
 ds_read_b64_tr_b16 a[192:193], v231 offset:49152
 v_mfma_f32_16x16x32_bf16 v[32:35], a[196:199], a[224:227], v[32:35]
 ds_read_b128 a[204:207], v235 offset:0
 v_mfma_f32_16x16x32_bf16 v[80:83], a[196:199], a[208:211], v[80:83]
 ds_read_b64_tr_b16 a[194:195], v231 offset:50688
 v_mfma_f32_16x16x32_bf16 v[128:131], a[196:199], a[220:223], v[128:131]
 ds_read_b128 a[228:231], v235 offset:2048
 v_mfma_f32_16x16x32_bf16 v[160:163], a[196:199], a[212:215], v[160:163]
 ds_read_b128 a[196:199], v235 offset:4096
 v_mfma_f32_16x16x32_bf16 v[36:39], a[216:219], a[224:227], v[36:39]
 ds_read_b128 a[236:239], v237 offset:0
 v_mfma_f32_16x16x32_bf16 v[84:87], a[216:219], a[208:211], v[84:87]
 ds_read_b64_tr_b16 a[240:241], v232 offset:49152
 v_mfma_f32_16x16x32_bf16 v[132:135], a[216:219], a[220:223], v[132:135]
 buffer_load_dwordx4 v245, s[8:11], s37 offen offset:3072 lds
 v_mfma_f32_16x16x32_bf16 v[164:167], a[216:219], a[212:215], v[164:167]
 ds_read_b64_tr_b16 a[242:243], v232 offset:50688
 v_mfma_f32_16x16x32_bf16 v[40:43], a[232:235], a[224:227], v[40:43]
 ds_read_b64_tr_b16 a[212:213], v233 offset:49152
 v_mfma_f32_16x16x32_bf16 v[88:91], a[232:235], a[208:211], v[88:91]
 ds_read_b64_tr_b16 a[214:215], v233 offset:50688
 v_mfma_f32_16x16x32_bf16 v[136:139], a[232:235], a[220:223], v[136:139]
 ds_read_b64_tr_b16 a[216:217], v234 offset:49152
 v_mfma_f32_16x16x32_bf16 v[44:47], a[200:203], a[224:227], v[44:47]
 ds_read_b64_tr_b16 a[218:219], v234 offset:50688
 s_mov_b32 s38, 7471104
 v_mfma_f32_16x16x32_bf16 v[92:95], a[200:203], a[208:211], v[92:95]
 ds_read_b64_tr_b16 a[208:209], v231 offset:49280
 s_add_u32 m0, s32, 24576
 v_mfma_f32_16x16x32_bf16 v[140:143], a[200:203], a[220:223], v[140:143]
 buffer_load_dwordx4 v239, s[12:15], s38 offen lds
 s_waitcnt lgkmcnt(7)
 v_mfma_f32_16x16x32_bf16 v[0:3], a[192:195], a[204:207], v[0:3]
 ds_read_b64_tr_b16 a[210:211], v231 offset:50816
 v_mfma_f32_16x16x32_bf16 v[48:51], a[192:195], a[228:231], v[48:51]
 ds_read_b64_tr_b16 a[200:201], v232 offset:49280
 v_mfma_f32_16x16x32_bf16 v[96:99], a[192:195], a[196:199], v[96:99]
 ds_read_b64_tr_b16 a[202:203], v232 offset:50816
 v_mfma_f32_16x16x32_bf16 v[144:147], a[192:195], a[236:239], v[144:147]
 ds_read_b64_tr_b16 a[192:193], v233 offset:49280
 s_waitcnt lgkmcnt(7)
 v_mfma_f32_16x16x32_bf16 v[4:7], a[240:243], a[204:207], v[4:7]
 ds_read_b64_tr_b16 a[194:195], v233 offset:50816
 v_mfma_f32_16x16x32_bf16 v[52:55], a[240:243], a[228:231], v[52:55]
 ds_read_b64_tr_b16 a[220:221], v234 offset:49280
 v_mfma_f32_16x16x32_bf16 v[100:103], a[240:243], a[196:199], v[100:103]
 ds_read_b64_tr_b16 a[222:223], v234 offset:50816
 v_mfma_f32_16x16x32_bf16 v[148:151], a[240:243], a[236:239], v[148:151]
 buffer_load_dwordx4 v240, s[12:15], s38 offen offset:1024 lds
 v_mfma_f32_16x16x32_bf16 v[8:11], a[212:215], a[204:207], v[8:11]
 ds_read_b128 a[224:227], v236 offset:0
 v_mfma_f32_16x16x32_bf16 v[56:59], a[212:215], a[228:231], v[56:59]
 ds_read_b64_tr_b16 a[232:233], v231 offset:49408
 v_mfma_f32_16x16x32_bf16 v[104:107], a[212:215], a[196:199], v[104:107]
 ds_read_b64_tr_b16 a[234:235], v231 offset:50944
 s_waitcnt lgkmcnt(7)
 v_mfma_f32_16x16x32_bf16 v[12:15], a[216:219], a[204:207], v[12:15]
 ds_read_b128 a[212:215], v236 offset:2048
 v_mfma_f32_16x16x32_bf16 v[60:63], a[216:219], a[228:231], v[60:63]
 ds_read_b64_tr_b16 a[240:241], v232 offset:49408
 v_mfma_f32_16x16x32_bf16 v[108:111], a[216:219], a[196:199], v[108:111]
 ds_read_b64_tr_b16 a[242:243], v232 offset:50944
 v_mfma_f32_16x16x32_bf16 v[16:19], a[208:211], a[204:207], v[16:19]
 buffer_load_dwordx4 v241, s[12:15], s38 offen offset:2048 lds
 v_mfma_f32_16x16x32_bf16 v[64:67], a[208:211], a[228:231], v[64:67]
 ds_read_b128 a[216:219], v236 offset:4096
 v_mfma_f32_16x16x32_bf16 v[112:115], a[208:211], a[196:199], v[112:115]
 ds_read_b64_tr_b16 a[244:245], v233 offset:49408
 v_mfma_f32_16x16x32_bf16 v[152:155], a[208:211], a[236:239], v[152:155]
 ds_read_b64_tr_b16 a[246:247], v233 offset:50944
 v_mfma_f32_16x16x32_bf16 v[20:23], a[200:203], a[204:207], v[20:23]
 ds_read_b128 a[208:211], v238 offset:0
 v_mfma_f32_16x16x32_bf16 v[68:71], a[200:203], a[228:231], v[68:71]
 ds_read_b64_tr_b16 a[248:249], v234 offset:49408
 v_mfma_f32_16x16x32_bf16 v[116:119], a[200:203], a[196:199], v[116:119]
 ds_read_b64_tr_b16 a[250:251], v234 offset:50944
 v_mfma_f32_16x16x32_bf16 v[156:159], a[200:203], a[236:239], v[156:159]
 s_waitcnt lgkmcnt(12)
 v_mfma_f32_16x16x32_bf16 v[24:27], a[192:195], a[204:207], v[24:27]
 v_mfma_f32_16x16x32_bf16 v[72:75], a[192:195], a[228:231], v[72:75]
 v_mfma_f32_16x16x32_bf16 v[120:123], a[192:195], a[196:199], v[120:123]
 s_xor_b32 s40, s77, 0
 s_mul_i32 s40, s40, 24576
 v_mfma_f32_16x16x32_bf16 v[28:31], a[220:223], a[204:207], v[28:31]
 s_waitcnt vmcnt(19) lgkmcnt(0)
 v_mfma_f32_16x16x32_bf16 v[76:79], a[220:223], a[228:231], v[76:79]
 s_barrier
 v_mfma_f32_16x16x32_bf16 v[124:127], a[220:223], a[196:199], v[124:127]
 ds_read_b64_tr_b16 a[192:193], v231 offset:61440
 v_mfma_f32_16x16x32_bf16 v[32:35], a[232:235], a[204:207], v[32:35]
 ds_read_b64_tr_b16 a[194:195], v231 offset:62976
 s_add_u32 m0, s34, 110592
 v_mfma_f32_16x16x32_bf16 v[80:83], a[232:235], a[228:231], v[80:83]
 buffer_load_dwordx4 v226, s[20:23], s40 offen nt lds
 v_mfma_f32_16x16x32_bf16 v[128:131], a[232:235], a[196:199], v[128:131]
 ds_read_b64_tr_b16 a[200:201], v232 offset:61440
 v_mfma_f32_16x16x32_bf16 v[160:163], a[232:235], a[236:239], v[160:163]
 ds_read_b64_tr_b16 a[202:203], v232 offset:62976
 v_mfma_f32_16x16x32_bf16 v[36:39], a[240:243], a[204:207], v[36:39]
 v_mfma_f32_16x16x32_bf16 v[84:87], a[240:243], a[228:231], v[84:87]
 ds_read_b64_tr_b16 a[220:221], v233 offset:61440
 v_mfma_f32_16x16x32_bf16 v[132:135], a[240:243], a[196:199], v[132:135]
 ds_read_b64_tr_b16 a[222:223], v233 offset:62976
 v_mfma_f32_16x16x32_bf16 v[164:167], a[240:243], a[236:239], v[164:167]
 buffer_load_dwordx4 v227, s[20:23], s40 offen offset:1024 nt lds
 v_mfma_f32_16x16x32_bf16 v[40:43], a[244:247], a[204:207], v[40:43]
 ds_read_b64_tr_b16 a[232:233], v234 offset:61440
 v_mfma_f32_16x16x32_bf16 v[88:91], a[244:247], a[228:231], v[88:91]
 ds_read_b64_tr_b16 a[234:235], v234 offset:62976
 v_mfma_f32_16x16x32_bf16 v[136:139], a[244:247], a[196:199], v[136:139]
 v_mfma_f32_16x16x32_bf16 v[44:47], a[248:251], a[204:207], v[44:47]
 ds_read_b64_tr_b16 a[204:205], v231 offset:61568
 v_mfma_f32_16x16x32_bf16 v[92:95], a[248:251], a[228:231], v[92:95]
 ds_read_b64_tr_b16 a[206:207], v231 offset:63104
 v_mfma_f32_16x16x32_bf16 v[140:143], a[248:251], a[196:199], v[140:143]
 s_waitcnt lgkmcnt(8)
 v_mfma_f32_16x16x32_bf16 v[0:3], a[192:195], a[224:227], v[0:3]
 ds_read_b64_tr_b16 a[196:197], v232 offset:61568
 v_mfma_f32_16x16x32_bf16 v[48:51], a[192:195], a[212:215], v[48:51]
 ds_read_b64_tr_b16 a[198:199], v232 offset:63104
 v_mfma_f32_16x16x32_bf16 v[96:99], a[192:195], a[216:219], v[96:99]
 buffer_load_dwordx4 v228, s[20:23], s40 offen offset:2048 nt lds
 v_mfma_f32_16x16x32_bf16 v[144:147], a[192:195], a[208:211], v[144:147]
 ds_read_b64_tr_b16 a[192:193], v233 offset:61568
 s_waitcnt lgkmcnt(7)
 v_mfma_f32_16x16x32_bf16 v[4:7], a[200:203], a[224:227], v[4:7]
 ds_read_b64_tr_b16 a[194:195], v233 offset:63104
 v_mfma_f32_16x16x32_bf16 v[52:55], a[200:203], a[212:215], v[52:55]
 buffer_load_dwordx4 v226, s[20:23], s40 offen offset:3072 nt lds
 v_mfma_f32_16x16x32_bf16 v[100:103], a[200:203], a[216:219], v[100:103]
 ds_read_b64_tr_b16 a[228:229], v234 offset:61568
 v_mfma_f32_16x16x32_bf16 v[148:151], a[200:203], a[208:211], v[148:151]
 ds_read_b64_tr_b16 a[230:231], v234 offset:63104
 v_mfma_f32_16x16x32_bf16 v[8:11], a[220:223], a[224:227], v[8:11]
 v_mfma_f32_16x16x32_bf16 v[56:59], a[220:223], a[212:215], v[56:59]
 ds_read_b64_tr_b16 a[200:201], v231 offset:61696
 v_mfma_f32_16x16x32_bf16 v[104:107], a[220:223], a[216:219], v[104:107]
 ds_read_b64_tr_b16 a[202:203], v231 offset:63232
 s_waitcnt lgkmcnt(6)
 v_mfma_f32_16x16x32_bf16 v[12:15], a[232:235], a[224:227], v[12:15]
 v_mfma_f32_16x16x32_bf16 v[60:63], a[232:235], a[212:215], v[60:63]
 ds_read_b64_tr_b16 a[220:221], v232 offset:61696
 v_mfma_f32_16x16x32_bf16 v[108:111], a[232:235], a[216:219], v[108:111]
 ds_read_b64_tr_b16 a[222:223], v232 offset:63232
 s_add_u32 m0, s34, 114688
 v_mfma_f32_16x16x32_bf16 v[16:19], a[204:207], a[224:227], v[16:19]
 buffer_load_dwordx4 v229, s[20:23], s40 offen nt lds
 v_mfma_f32_16x16x32_bf16 v[64:67], a[204:207], a[212:215], v[64:67]
 ds_read_b64_tr_b16 a[232:233], v233 offset:61696
 v_mfma_f32_16x16x32_bf16 v[112:115], a[204:207], a[216:219], v[112:115]
 ds_read_b64_tr_b16 a[234:235], v233 offset:63232
 v_mfma_f32_16x16x32_bf16 v[152:155], a[204:207], a[208:211], v[152:155]
 buffer_load_dwordx4 v230, s[20:23], s40 offen offset:1024 nt lds
 v_mfma_f32_16x16x32_bf16 v[20:23], a[196:199], a[224:227], v[20:23]
 ds_read_b64_tr_b16 a[204:205], v234 offset:61696
 v_mfma_f32_16x16x32_bf16 v[68:71], a[196:199], a[212:215], v[68:71]
 ds_read_b64_tr_b16 a[206:207], v234 offset:63232
 v_mfma_f32_16x16x32_bf16 v[116:119], a[196:199], a[216:219], v[116:119]
 v_mfma_f32_16x16x32_bf16 v[156:159], a[196:199], a[208:211], v[156:159]
 s_waitcnt lgkmcnt(8)
 v_mfma_f32_16x16x32_bf16 v[24:27], a[192:195], a[224:227], v[24:27]
 v_mfma_f32_16x16x32_bf16 v[72:75], a[192:195], a[212:215], v[72:75]
 v_mfma_f32_16x16x32_bf16 v[120:123], a[192:195], a[216:219], v[120:123]
 v_mfma_f32_16x16x32_bf16 v[28:31], a[228:231], a[224:227], v[28:31]
 s_waitcnt vmcnt(9) lgkmcnt(0)
 v_mfma_f32_16x16x32_bf16 v[76:79], a[228:231], a[212:215], v[76:79]
 v_mov_b32 v255, 0x7ff00000
 s_barrier
 v_mfma_f32_16x16x32_bf16 v[124:127], a[228:231], a[216:219], v[124:127]
 ds_read_b64_tr_b16 a[192:193], v231 offset:12288
 v_mov_b32 v254, s101
 v_mfma_f32_16x16x32_bf16 v[32:35], a[200:203], a[224:227], v[32:35]
 ds_read_b128 a[196:199], v235 offset:28672
 v_or_b32 v253, s28, v246
 v_mfma_f32_16x16x32_bf16 v[80:83], a[200:203], a[212:215], v[80:83]
 ds_read_b64_tr_b16 a[194:195], v231 offset:13824
 v_cmp_eq_u32 vcc, 0, v253
 v_mfma_f32_16x16x32_bf16 v[128:131], a[200:203], a[216:219], v[128:131]
 ds_read_b128 a[228:231], v235 offset:30720
 v_mov_b32 v253, 1
 v_mfma_f32_16x16x32_bf16 v[160:163], a[200:203], a[208:211], v[160:163]
 ds_read_b128 a[200:203], v235 offset:32768
 v_cndmask_b32 v254, v255, v254, vcc
 v_mfma_f32_16x16x32_bf16 v[36:39], a[220:223], a[224:227], v[36:39]
 ds_read_b128 a[236:239], v237 offset:28672
 v_mfma_f32_16x16x32_bf16 v[84:87], a[220:223], a[212:215], v[84:87]
 ds_read_b64_tr_b16 a[240:241], v232 offset:12288
 v_mfma_f32_16x16x32_bf16 v[132:135], a[220:223], a[216:219], v[132:135]
 v_mfma_f32_16x16x32_bf16 v[164:167], a[220:223], a[208:211], v[164:167]
 ds_read_b64_tr_b16 a[242:243], v232 offset:13824
 v_mfma_f32_16x16x32_bf16 v[40:43], a[232:235], a[224:227], v[40:43]
 ds_read_b64_tr_b16 a[208:209], v233 offset:12288
 v_mfma_f32_16x16x32_bf16 v[88:91], a[232:235], a[212:215], v[88:91]
 ds_read_b64_tr_b16 a[210:211], v233 offset:13824
 v_mfma_f32_16x16x32_bf16 v[136:139], a[232:235], a[216:219], v[136:139]
 ds_read_b64_tr_b16 a[220:221], v234 offset:12288
 v_mfma_f32_16x16x32_bf16 v[44:47], a[204:207], a[224:227], v[44:47]
 ds_read_b64_tr_b16 a[222:223], v234 offset:13824
 v_mfma_f32_16x16x32_bf16 v[92:95], a[204:207], a[212:215], v[92:95]
 ds_read_b64_tr_b16 a[212:213], v231 offset:12416
 v_mfma_f32_16x16x32_bf16 v[140:143], a[204:207], a[216:219], v[140:143]
 s_waitcnt lgkmcnt(7)
 v_mfma_f32_16x16x32_bf16 v[0:3], a[192:195], a[196:199], v[0:3]
 ds_read_b64_tr_b16 a[214:215], v231 offset:13952
 v_mfma_f32_16x16x32_bf16 v[48:51], a[192:195], a[228:231], v[48:51]
 ds_read_b64_tr_b16 a[204:205], v232 offset:12416
 v_mfma_f32_16x16x32_bf16 v[96:99], a[192:195], a[200:203], v[96:99]
 ds_read_b64_tr_b16 a[206:207], v232 offset:13952
 v_mfma_f32_16x16x32_bf16 v[144:147], a[192:195], a[236:239], v[144:147]
 ds_read_b64_tr_b16 a[192:193], v233 offset:12416
 s_waitcnt lgkmcnt(7)
 v_mfma_f32_16x16x32_bf16 v[4:7], a[240:243], a[196:199], v[4:7]
 ds_read_b64_tr_b16 a[194:195], v233 offset:13952
 s_add_u32 s55, s34, 0
 v_mfma_f32_16x16x32_bf16 v[52:55], a[240:243], a[228:231], v[52:55]
 ds_read_b64_tr_b16 a[216:217], v234 offset:12416
 s_add_u32 s3, s34, 139264
 v_mfma_f32_16x16x32_bf16 v[100:103], a[240:243], a[200:203], v[100:103]
 ds_read_b64_tr_b16 a[218:219], v234 offset:13952
 s_mov_b32 s87, 196608
 v_mfma_f32_16x16x32_bf16 v[148:151], a[240:243], a[236:239], v[148:151]
 s_mov_b32 s58, 49152
 s_mov_b32 s59, 4294942720
 v_mfma_f32_16x16x32_bf16 v[8:11], a[208:211], a[196:199], v[8:11]
 ds_read_b128 a[224:227], v236 offset:28672
 v_mfma_f32_16x16x32_bf16 v[56:59], a[208:211], a[228:231], v[56:59]
 ds_read_b64_tr_b16 a[232:233], v231 offset:12544
 v_mfma_f32_16x16x32_bf16 v[104:107], a[208:211], a[200:203], v[104:107]
 ds_read_b64_tr_b16 a[234:235], v231 offset:14080
 s_waitcnt lgkmcnt(7)
 v_mfma_f32_16x16x32_bf16 v[12:15], a[220:223], a[196:199], v[12:15]
 ds_read_b128 a[240:243], v236 offset:30720
 v_mfma_f32_16x16x32_bf16 v[60:63], a[220:223], a[228:231], v[60:63]
 ds_read_b64_tr_b16 a[208:209], v232 offset:12544
 v_mfma_f32_16x16x32_bf16 v[108:111], a[220:223], a[200:203], v[108:111]
 ds_read_b64_tr_b16 a[210:211], v232 offset:14080
 v_mfma_f32_16x16x32_bf16 v[16:19], a[212:215], a[196:199], v[16:19]
 s_mov_b32 s60, 4294942720
 s_mov_b32 s61, 53248
 v_mfma_f32_16x16x32_bf16 v[64:67], a[212:215], a[228:231], v[64:67]
 ds_read_b128 a[220:223], v236 offset:32768
 v_mfma_f32_16x16x32_bf16 v[112:115], a[212:215], a[200:203], v[112:115]
 ds_read_b64_tr_b16 a[244:245], v233 offset:12544
 v_mfma_f32_16x16x32_bf16 v[152:155], a[212:215], a[236:239], v[152:155]
 ds_read_b64_tr_b16 a[246:247], v233 offset:14080
 v_mfma_f32_16x16x32_bf16 v[20:23], a[204:207], a[196:199], v[20:23]
 ds_read_b128 a[212:215], v238 offset:28672
 v_mfma_f32_16x16x32_bf16 v[68:71], a[204:207], a[228:231], v[68:71]
 ds_read_b64_tr_b16 a[248:249], v234 offset:12544
 v_mfma_f32_16x16x32_bf16 v[116:119], a[204:207], a[200:203], v[116:119]
 ds_read_b64_tr_b16 a[250:251], v234 offset:14080
 v_mfma_f32_16x16x32_bf16 v[156:159], a[204:207], a[236:239], v[156:159]
 s_waitcnt lgkmcnt(12)
 v_mfma_f32_16x16x32_bf16 v[24:27], a[192:195], a[196:199], v[24:27]
 s_mov_b32 s62, 4294942720
 s_mov_b32 s63, 4294938624
 v_mfma_f32_16x16x32_bf16 v[72:75], a[192:195], a[228:231], v[72:75]
 v_mfma_f32_16x16x32_bf16 v[120:123], a[192:195], a[200:203], v[120:123]
 s_xor_b32 s40, s77, 1
 s_mul_i32 s40, s40, 24576
 v_mfma_f32_16x16x32_bf16 v[28:31], a[216:219], a[196:199], v[28:31]
 s_waitcnt vmcnt(6) lgkmcnt(0)
 v_mfma_f32_16x16x32_bf16 v[76:79], a[216:219], a[228:231], v[76:79]
 s_barrier
 v_mfma_f32_16x16x32_bf16 v[124:127], a[216:219], a[200:203], v[124:127]
 ds_read_b64_tr_b16 a[192:193], v231 offset:0
 v_mfma_f32_16x16x32_bf16 v[32:35], a[232:235], a[196:199], v[32:35]
 ds_read_b64_tr_b16 a[194:195], v231 offset:1536
 s_add_u32 m0, s34, 86016
 v_mfma_f32_16x16x32_bf16 v[80:83], a[232:235], a[228:231], v[80:83]
 buffer_load_dwordx4 v226, s[20:23], s40 offen nt lds
 v_mfma_f32_16x16x32_bf16 v[128:131], a[232:235], a[200:203], v[128:131]
 ds_read_b64_tr_b16 a[204:205], v232 offset:0
 v_mfma_f32_16x16x32_bf16 v[160:163], a[232:235], a[236:239], v[160:163]
 ds_read_b64_tr_b16 a[206:207], v232 offset:1536
 v_mfma_f32_16x16x32_bf16 v[36:39], a[208:211], a[196:199], v[36:39]
 buffer_load_dwordx4 v227, s[20:23], s40 offen offset:1024 nt lds
 v_mfma_f32_16x16x32_bf16 v[84:87], a[208:211], a[228:231], v[84:87]
 ds_read_b64_tr_b16 a[216:217], v233 offset:0
 v_mfma_f32_16x16x32_bf16 v[132:135], a[208:211], a[200:203], v[132:135]
 ds_read_b64_tr_b16 a[218:219], v233 offset:1536
 v_mfma_f32_16x16x32_bf16 v[164:167], a[208:211], a[236:239], v[164:167]
 buffer_load_dwordx4 v228, s[20:23], s40 offen offset:2048 nt lds
 v_mfma_f32_16x16x32_bf16 v[40:43], a[244:247], a[196:199], v[40:43]
 ds_read_b64_tr_b16 a[208:209], v234 offset:0
 v_mfma_f32_16x16x32_bf16 v[88:91], a[244:247], a[228:231], v[88:91]
 ds_read_b64_tr_b16 a[210:211], v234 offset:1536
 v_mfma_f32_16x16x32_bf16 v[136:139], a[244:247], a[200:203], v[136:139]
 buffer_load_dwordx4 v226, s[20:23], s40 offen offset:3072 nt lds
 v_mfma_f32_16x16x32_bf16 v[44:47], a[248:251], a[196:199], v[44:47]
 ds_read_b64_tr_b16 a[196:197], v231 offset:128
 v_mfma_f32_16x16x32_bf16 v[92:95], a[248:251], a[228:231], v[92:95]
 ds_read_b64_tr_b16 a[198:199], v231 offset:1664
 v_mfma_f32_16x16x32_bf16 v[140:143], a[248:251], a[200:203], v[140:143]
 s_waitcnt lgkmcnt(8)
 v_mfma_f32_16x16x32_bf16 v[0:3], a[192:195], a[224:227], v[0:3]
 ds_read_b64_tr_b16 a[200:201], v232 offset:128
 v_mfma_f32_16x16x32_bf16 v[48:51], a[192:195], a[240:243], v[48:51]
 ds_read_b64_tr_b16 a[202:203], v232 offset:1664
 s_add_u32 m0, s34, 90112
 v_mfma_f32_16x16x32_bf16 v[96:99], a[192:195], a[220:223], v[96:99]
 buffer_load_dwordx4 v229, s[20:23], s40 offen nt lds
 v_mfma_f32_16x16x32_bf16 v[144:147], a[192:195], a[212:215], v[144:147]
 ds_read_b64_tr_b16 a[192:193], v233 offset:128
 s_waitcnt lgkmcnt(7)
 v_mfma_f32_16x16x32_bf16 v[4:7], a[204:207], a[224:227], v[4:7]
 ds_read_b64_tr_b16 a[194:195], v233 offset:1664
 v_mfma_f32_16x16x32_bf16 v[52:55], a[204:207], a[240:243], v[52:55]
 buffer_load_dwordx4 v230, s[20:23], s40 offen offset:1024 nt lds
 v_mfma_f32_16x16x32_bf16 v[100:103], a[204:207], a[220:223], v[100:103]
 ds_read_b64_tr_b16 a[228:229], v234 offset:128
 v_mfma_f32_16x16x32_bf16 v[148:151], a[204:207], a[212:215], v[148:151]
 ds_read_b64_tr_b16 a[230:231], v234 offset:1664
 s_add_u32 m0, s34, 139264
 s_xor_b32 s40, s77, 2
 s_mul_i32 s40, s40, 24576
 v_mfma_f32_16x16x32_bf16 v[8:11], a[216:219], a[224:227], v[8:11]
 buffer_load_dwordx4 v226, s[20:23], s40 offen nt lds
 v_mfma_f32_16x16x32_bf16 v[56:59], a[216:219], a[240:243], v[56:59]
 ds_read_b64_tr_b16 a[204:205], v231 offset:256
 v_mul_f32 v0, s51, v0
 v_mfma_f32_16x16x32_bf16 v[104:107], a[216:219], a[220:223], v[104:107]
 ds_read_b64_tr_b16 a[206:207], v231 offset:1792
 s_waitcnt lgkmcnt(6)
 v_mfma_f32_16x16x32_bf16 v[12:15], a[208:211], a[224:227], v[12:15]
 buffer_load_dwordx4 v227, s[20:23], s40 offen offset:1024 nt lds
 v_mfma_f32_16x16x32_bf16 v[60:63], a[208:211], a[240:243], v[60:63]
 ds_read_b64_tr_b16 a[216:217], v232 offset:256
 v_mul_f32 v1, s51, v1
 v_mfma_f32_16x16x32_bf16 v[108:111], a[208:211], a[220:223], v[108:111]
 ds_read_b64_tr_b16 a[218:219], v232 offset:1792
 v_mul_f32 v2, s51, v2
 v_mfma_f32_16x16x32_bf16 v[16:19], a[196:199], a[224:227], v[16:19]
 buffer_load_dwordx4 v228, s[20:23], s40 offen offset:2048 nt lds
 v_mfma_f32_16x16x32_bf16 v[64:67], a[196:199], a[240:243], v[64:67]
 ds_read_b64_tr_b16 a[232:233], v233 offset:256
 v_mul_f32 v3, s51, v3
 v_mfma_f32_16x16x32_bf16 v[112:115], a[196:199], a[220:223], v[112:115]
 ds_read_b64_tr_b16 a[234:235], v233 offset:1792
 v_mul_f32 v4, s51, v4
 v_mfma_f32_16x16x32_bf16 v[152:155], a[196:199], a[212:215], v[152:155]
 buffer_load_dwordx4 v226, s[20:23], s40 offen offset:3072 nt lds
 v_mfma_f32_16x16x32_bf16 v[20:23], a[200:203], a[224:227], v[20:23]
 ds_read_b64_tr_b16 a[236:237], v234 offset:256
 v_mul_f32 v5, s51, v5
 v_mfma_f32_16x16x32_bf16 v[68:71], a[200:203], a[240:243], v[68:71]
 ds_read_b64_tr_b16 a[238:239], v234 offset:1792
 v_mul_f32 v6, s51, v6
 v_mfma_f32_16x16x32_bf16 v[116:119], a[200:203], a[220:223], v[116:119]
 v_mul_f32 v7, s51, v7
 v_cvt_pk_bf16_f32 v0, v0, v1
 v_mfma_f32_16x16x32_bf16 v[156:159], a[200:203], a[212:215], v[156:159]
 s_add_u32 m0, s34, 143360
 s_waitcnt lgkmcnt(8)
 v_mfma_f32_16x16x32_bf16 v[24:27], a[192:195], a[224:227], v[24:27]
 buffer_load_dwordx4 v229, s[20:23], s40 offen nt lds
 v_mfma_f32_16x16x32_bf16 v[72:75], a[192:195], a[240:243], v[72:75]
 v_cvt_pk_bf16_f32 v1, v2, v3
 v_cvt_pk_bf16_f32 v2, v4, v5
 v_mfma_f32_16x16x32_bf16 v[120:123], a[192:195], a[220:223], v[120:123]
 buffer_load_dwordx4 v230, s[20:23], s40 offen offset:1024 nt lds
 v_mfma_f32_16x16x32_bf16 v[28:31], a[228:231], a[224:227], v[28:31]
 v_cvt_pk_bf16_f32 v3, v6, v7
 v_mul_f32 v8, s51, v8
 v_mfma_f32_16x16x32_bf16 v[76:79], a[228:231], a[240:243], v[76:79]
 v_mul_f32 v9, s51, v9
 v_mul_f32 v10, s51, v10
 v_mfma_f32_16x16x32_bf16 v[124:127], a[228:231], a[220:223], v[124:127]
 v_mul_f32 v11, s51, v11
 s_waitcnt lgkmcnt(0)
 v_mfma_f32_16x16x32_bf16 v[32:35], a[204:207], a[224:227], v[32:35]
 ds_read_b128 a[192:195], v214 offset:0
 v_mul_f32 v12, s51, v12
 v_mfma_f32_16x16x32_bf16 v[80:83], a[204:207], a[240:243], v[80:83]
 ds_read_b128 a[196:199], v215 offset:0
 v_mul_f32 v13, s51, v13
 v_mfma_f32_16x16x32_bf16 v[128:131], a[204:207], a[220:223], v[128:131]
 v_mul_f32 v14, s51, v14
 v_mul_f32 v15, s51, v15
 v_mfma_f32_16x16x32_bf16 v[160:163], a[204:207], a[212:215], v[160:163]
 ds_read_b128 a[200:203], v214 offset:128
 v_cvt_pk_bf16_f32 v4, v8, v9
 v_mfma_f32_16x16x32_bf16 v[36:39], a[216:219], a[224:227], v[36:39]
 ds_read_b128 a[204:207], v215 offset:128
 v_cvt_pk_bf16_f32 v5, v10, v11
 v_mfma_f32_16x16x32_bf16 v[84:87], a[216:219], a[240:243], v[84:87]
 v_cvt_pk_bf16_f32 v6, v12, v13
 v_cvt_pk_bf16_f32 v7, v14, v15
 v_mfma_f32_16x16x32_bf16 v[132:135], a[216:219], a[220:223], v[132:135]
 ds_read_b128 a[208:211], v214 offset:256
 v_mul_f32 v16, s51, v16
 v_mfma_f32_16x16x32_bf16 v[164:167], a[216:219], a[212:215], v[164:167]
 ds_read_b128 a[212:215], v215 offset:256
 v_mul_f32 v17, s51, v17
 v_mfma_f32_16x16x32_bf16 v[40:43], a[232:235], a[224:227], v[40:43]
 v_mul_f32 v18, s51, v18
 v_mul_f32 v19, s51, v19
 v_mfma_f32_16x16x32_bf16 v[88:91], a[232:235], a[240:243], v[88:91]
 v_mul_f32 v20, s51, v20
 v_mul_f32 v21, s51, v21
 v_mfma_f32_16x16x32_bf16 v[136:139], a[232:235], a[220:223], v[136:139]
 v_mul_f32 v22, s51, v22
 v_mul_f32 v23, s51, v23
 v_mfma_f32_16x16x32_bf16 v[44:47], a[236:239], a[224:227], v[44:47]
 v_cvt_pk_bf16_f32 v8, v16, v17
 v_cvt_pk_bf16_f32 v9, v18, v19
 v_mfma_f32_16x16x32_bf16 v[92:95], a[236:239], a[240:243], v[92:95]
 v_cvt_pk_bf16_f32 v10, v20, v21
 v_cvt_pk_bf16_f32 v11, v22, v23
 v_mfma_f32_16x16x32_bf16 v[140:143], a[236:239], a[220:223], v[140:143]
 v_mul_f32 v24, s51, v24
 v_mul_f32 v25, s51, v25
 v_mul_f32 v26, s51, v26
 v_mul_f32 v27, s51, v27
 v_mul_f32 v28, s51, v28
 v_mul_f32 v29, s51, v29
 v_mul_f32 v30, s51, v30
 v_mul_f32 v31, s51, v31
 v_cvt_pk_bf16_f32 v12, v24, v25
 v_cvt_pk_bf16_f32 v13, v26, v27
 v_cvt_pk_bf16_f32 v14, v28, v29
 v_cvt_pk_bf16_f32 v15, v30, v31
 v_mul_f32 v32, s51, v32
 v_mul_f32 v33, s51, v33
 v_mul_f32 v34, s51, v34
 v_mul_f32 v35, s51, v35
 v_mul_f32 v36, s51, v36
 v_mul_f32 v37, s51, v37
 v_mul_f32 v38, s51, v38
 v_mul_f32 v39, s51, v39
 v_cvt_pk_bf16_f32 v16, v32, v33
 v_cvt_pk_bf16_f32 v17, v34, v35
 v_cvt_pk_bf16_f32 v18, v36, v37
 v_cvt_pk_bf16_f32 v19, v38, v39
 v_mul_f32 v40, s51, v40
 v_mul_f32 v41, s51, v41
 v_mul_f32 v42, s51, v42
 v_mul_f32 v43, s51, v43
 v_mul_f32 v44, s51, v44
 v_mul_f32 v45, s51, v45
 v_mul_f32 v46, s51, v46
 v_mul_f32 v47, s51, v47
 v_cvt_pk_bf16_f32 v20, v40, v41
 v_cvt_pk_bf16_f32 v21, v42, v43
 v_cvt_pk_bf16_f32 v22, v44, v45
 v_cvt_pk_bf16_f32 v23, v46, v47
 s_waitcnt lgkmcnt(0)
 v_mfma_f32_16x16x32_bf16 v[168:171], a[192:195], v[0:3], 0
 v_mul_f32 v144, s51, v144
 v_mul_f32 v145, s51, v145
 v_mfma_f32_16x16x32_bf16 v[168:171], a[196:199], v[4:7], v[168:171]
 ds_read_b128 a[216:219], v214 offset:6144
 v_mul_f32 v146, s51, v146
 v_mul_f32 v147, s51, v147
 v_mul_f32 v148, s51, v148
 v_mul_f32 v149, s51, v149
 v_mul_f32 v150, s51, v150
 v_mul_f32 v151, s51, v151
 v_cvt_pk_bf16_f32 v144, v144, v145
 v_cvt_pk_bf16_f32 v145, v146, v147
 v_cvt_pk_bf16_f32 v146, v148, v149
 v_cvt_pk_bf16_f32 v147, v150, v151
 v_mul_f32 v152, s51, v152
 v_mul_f32 v153, s51, v153
 v_mul_f32 v154, s51, v154
 v_mul_f32 v155, s51, v155
 v_mul_f32 v156, s51, v156
 v_mul_f32 v157, s51, v157
 v_mul_f32 v158, s51, v158
 v_mul_f32 v159, s51, v159
 v_cvt_pk_bf16_f32 v152, v152, v153
 v_cvt_pk_bf16_f32 v153, v154, v155
 v_cvt_pk_bf16_f32 v154, v156, v157
 v_cvt_pk_bf16_f32 v155, v158, v159
 v_mul_f32 v160, s51, v160
 v_mul_f32 v161, s51, v161
 v_mul_f32 v162, s51, v162
 v_mul_f32 v163, s51, v163
 v_mul_f32 v164, s51, v164
 v_mul_f32 v165, s51, v165
 v_mul_f32 v166, s51, v166
 v_mul_f32 v167, s51, v167
 v_cvt_pk_bf16_f32 v160, v160, v161
 v_cvt_pk_bf16_f32 v161, v162, v163
 v_cvt_pk_bf16_f32 v162, v164, v165
 v_cvt_pk_bf16_f32 v163, v166, v167
 v_mfma_f32_16x16x32_bf16 v[168:171], a[200:203], v[8:11], v[168:171]
 ds_write_b128 v247, v[144:147] offset:0
 ds_write_b128 v247, v[152:155] offset:1024
 ds_write_b128 v247, v[160:163] offset:2048
 v_mfma_f32_16x16x32_bf16 v[168:171], a[204:207], v[12:15], v[168:171]
 ds_read_b128 a[220:223], v215 offset:6144
 v_mul_f32 v48, s51, v48
 v_mfma_f32_16x16x32_bf16 v[168:171], a[208:211], v[16:19], v[168:171]
 v_mul_f32 v49, s51, v49
 s_waitcnt lgkmcnt(1)
 v_mfma_f32_16x16x32_bf16 v[168:171], a[212:215], v[20:23], v[168:171]
 ds_read_b128 a[224:227], v214 offset:6272
 v_mul_f32 v50, s51, v50
 v_mul_f32 v51, s51, v51
 v_mul_f32 v52, s51, v52
 v_mul_f32 v53, s51, v53
 v_mul_f32 v54, s51, v54
 v_mul_f32 v55, s51, v55
 v_cvt_pk_bf16_f32 v24, v48, v49
 v_cvt_pk_bf16_f32 v25, v50, v51
 v_cvt_pk_bf16_f32 v26, v52, v53
 v_cvt_pk_bf16_f32 v27, v54, v55
 v_mul_f32 v56, s51, v56
 v_mul_f32 v57, s51, v57
 v_mul_f32 v58, s51, v58
 v_mul_f32 v59, s51, v59
 v_mul_f32 v60, s51, v60
 v_mul_f32 v61, s51, v61
 v_mul_f32 v62, s51, v62
 v_mul_f32 v63, s51, v63
 v_cvt_pk_bf16_f32 v28, v56, v57
 v_cvt_pk_bf16_f32 v29, v58, v59
 v_cvt_pk_bf16_f32 v30, v60, v61
 v_cvt_pk_bf16_f32 v31, v62, v63
 v_mul_f32 v64, s51, v64
 v_mul_f32 v65, s51, v65
 v_mul_f32 v66, s51, v66
 v_mul_f32 v67, s51, v67
 v_mul_f32 v68, s51, v68
 v_mul_f32 v69, s51, v69
 v_mul_f32 v70, s51, v70
 v_mul_f32 v71, s51, v71
 v_cvt_pk_bf16_f32 v32, v64, v65
 v_cvt_pk_bf16_f32 v33, v66, v67
 v_cvt_pk_bf16_f32 v34, v68, v69
 v_cvt_pk_bf16_f32 v35, v70, v71
 v_mul_f32 v72, s51, v72
 v_mul_f32 v73, s51, v73
 v_mul_f32 v74, s51, v74
 v_mul_f32 v75, s51, v75
 v_mul_f32 v76, s51, v76
 v_mul_f32 v77, s51, v77
 v_mul_f32 v78, s51, v78
 v_mul_f32 v79, s51, v79
 v_cvt_pk_bf16_f32 v36, v72, v73
 v_cvt_pk_bf16_f32 v37, v74, v75
 v_cvt_pk_bf16_f32 v38, v76, v77
 v_cvt_pk_bf16_f32 v39, v78, v79
 v_mul_f32 v80, s51, v80
 v_mul_f32 v81, s51, v81
 v_mul_f32 v82, s51, v82
 v_mul_f32 v83, s51, v83
 v_mul_f32 v84, s51, v84
 v_mul_f32 v85, s51, v85
 v_mul_f32 v86, s51, v86
 v_mul_f32 v87, s51, v87
 v_cvt_pk_bf16_f32 v40, v80, v81
 v_cvt_pk_bf16_f32 v41, v82, v83
 v_cvt_pk_bf16_f32 v42, v84, v85
 v_cvt_pk_bf16_f32 v43, v86, v87
 v_mul_f32 v88, s51, v88
 v_mul_f32 v89, s51, v89
 v_mul_f32 v90, s51, v90
 v_mul_f32 v91, s51, v91
 v_mul_f32 v92, s51, v92
 v_mul_f32 v93, s51, v93
 v_mul_f32 v94, s51, v94
 v_mul_f32 v95, s51, v95
 v_cvt_pk_bf16_f32 v44, v88, v89
 v_cvt_pk_bf16_f32 v45, v90, v91
 v_cvt_pk_bf16_f32 v46, v92, v93
 v_cvt_pk_bf16_f32 v47, v94, v95
 s_barrier
 v_mfma_f32_16x16x32_bf16 v[172:175], a[192:195], v[24:27], 0
 s_xor_b32 s39, s77, 2
 s_mul_i32 s39, s39, 24576
 v_mfma_f32_16x16x32_bf16 v[172:175], a[196:199], v[28:31], v[172:175]
 ds_read_b128 a[228:231], v215 offset:6272
 s_add_u32 m0, s34, 24576
 v_mfma_f32_16x16x32_bf16 v[172:175], a[200:203], v[32:35], v[172:175]
 buffer_load_dwordx4 v226, s[16:19], s39 offen nt lds
 v_mfma_f32_16x16x32_bf16 v[172:175], a[204:207], v[36:39], v[172:175]
 ds_read_b128 a[232:235], v214 offset:6400
 v_mul_f32 v96, s51, v96
 v_mfma_f32_16x16x32_bf16 v[172:175], a[208:211], v[40:43], v[172:175]
 v_mul_f32 v97, s51, v97
 v_mul_f32 v98, s51, v98
 v_mfma_f32_16x16x32_bf16 v[172:175], a[212:215], v[44:47], v[172:175]
 ds_read_b128 a[236:239], v215 offset:6400
 v_mul_f32 v99, s51, v99
 v_mul_f32 v100, s51, v100
 v_mul_f32 v101, s51, v101
 v_mul_f32 v102, s51, v102
 v_mul_f32 v103, s51, v103
 v_cvt_pk_bf16_f32 v48, v96, v97
 v_cvt_pk_bf16_f32 v49, v98, v99
 v_cvt_pk_bf16_f32 v50, v100, v101
 v_cvt_pk_bf16_f32 v51, v102, v103
 v_mul_f32 v104, s51, v104
 v_mul_f32 v105, s51, v105
 v_mul_f32 v106, s51, v106
 v_mul_f32 v107, s51, v107
 v_mul_f32 v108, s51, v108
 v_mul_f32 v109, s51, v109
 v_mul_f32 v110, s51, v110
 v_mul_f32 v111, s51, v111
 v_cvt_pk_bf16_f32 v52, v104, v105
 v_cvt_pk_bf16_f32 v53, v106, v107
 v_cvt_pk_bf16_f32 v54, v108, v109
 v_cvt_pk_bf16_f32 v55, v110, v111
 v_mul_f32 v112, s51, v112
 v_mul_f32 v113, s51, v113
 v_mul_f32 v114, s51, v114
 v_mul_f32 v115, s51, v115
 v_mul_f32 v116, s51, v116
 v_mul_f32 v117, s51, v117
 v_mul_f32 v118, s51, v118
 v_mul_f32 v119, s51, v119
 v_cvt_pk_bf16_f32 v56, v112, v113
 v_cvt_pk_bf16_f32 v57, v114, v115
 v_cvt_pk_bf16_f32 v58, v116, v117
 v_cvt_pk_bf16_f32 v59, v118, v119
 v_mul_f32 v120, s51, v120
 v_mul_f32 v121, s51, v121
 v_mul_f32 v122, s51, v122
 v_mul_f32 v123, s51, v123
 v_mul_f32 v124, s51, v124
 v_mul_f32 v125, s51, v125
 v_mul_f32 v126, s51, v126
 v_mul_f32 v127, s51, v127
 v_cvt_pk_bf16_f32 v60, v120, v121
 v_cvt_pk_bf16_f32 v61, v122, v123
 v_cvt_pk_bf16_f32 v62, v124, v125
 v_cvt_pk_bf16_f32 v63, v126, v127
 v_mul_f32 v128, s51, v128
 v_mul_f32 v129, s51, v129
 v_mul_f32 v130, s51, v130
 v_mul_f32 v131, s51, v131
 v_mul_f32 v132, s51, v132
 v_mul_f32 v133, s51, v133
 v_mul_f32 v134, s51, v134
 v_mul_f32 v135, s51, v135
 v_cvt_pk_bf16_f32 v64, v128, v129
 v_cvt_pk_bf16_f32 v65, v130, v131
 v_cvt_pk_bf16_f32 v66, v132, v133
 v_cvt_pk_bf16_f32 v67, v134, v135
 v_mul_f32 v136, s51, v136
 v_mul_f32 v137, s51, v137
 v_mul_f32 v138, s51, v138
 v_mul_f32 v139, s51, v139
 v_mul_f32 v140, s51, v140
 v_mul_f32 v141, s51, v141
 v_mul_f32 v142, s51, v142
 v_mul_f32 v143, s51, v143
 v_cvt_pk_bf16_f32 v68, v136, v137
 v_cvt_pk_bf16_f32 v69, v138, v139
 v_cvt_pk_bf16_f32 v70, v140, v141
 v_cvt_pk_bf16_f32 v71, v142, v143
 v_mfma_f32_16x16x32_bf16 v[176:179], a[192:195], v[48:51], 0
 buffer_load_dwordx4 v227, s[16:19], s39 offen offset:1024 nt lds
 ds_read_b128 v[72:75], v247 offset:0
 ds_read_b128 v[76:79], v248 offset:0
 ds_read_b128 v[80:83], v247 offset:1024
 ds_read_b128 v[84:87], v248 offset:1024
 ds_read_b128 v[88:91], v247 offset:2048
 ds_read_b128 v[92:95], v248 offset:2048
 v_mfma_f32_16x16x32_bf16 v[176:179], a[196:199], v[52:55], v[176:179]
 v_max3_f32 v208, v168, v169, v170
 v_max_f32 v208, v208, v171
 v_mfma_f32_16x16x32_bf16 v[176:179], a[200:203], v[56:59], v[176:179]
 v_mov_b32 v209, v208
 v_mfma_f32_16x16x32_bf16 v[176:179], a[204:207], v[60:63], v[176:179]
 s_nop 0
 v_permlane16_swap_b32 v209, v208
 v_max_f32 v208, v208, v209
 v_mfma_f32_16x16x32_bf16 v[176:179], a[208:211], v[64:67], v[176:179]
 v_mov_b32 v209, v208
 v_max3_f32 v210, v172, v173, v174
 v_mfma_f32_16x16x32_bf16 v[176:179], a[212:215], v[68:71], v[176:179]
 s_waitcnt lgkmcnt(0)
 v_permlane32_swap_b32 v209, v208
 v_mfma_f32_16x16x32_bf16 v[180:183], a[192:195], v[72:75], 0
 v_max_f32 v208, v208, v209
 v_sub_f32 v148, 0, v208
 v_mfma_f32_16x16x32_bf16 v[180:183], a[196:199], v[76:79], v[180:183]
 buffer_load_dwordx4 v228, s[16:19], s39 offen offset:2048 nt lds
 v_mfma_f32_16x16x32_bf16 v[180:183], a[200:203], v[80:83], v[180:183]
 v_add_u32 v214, 0xc000, v214
 v_add_u32 v215, 0xc000, v215
 v_mfma_f32_16x16x32_bf16 v[180:183], a[204:207], v[84:87], v[180:183]
 v_sub_f32 v149, 0, v208
 v_sub_f32 v150, 0, v208
 v_mfma_f32_16x16x32_bf16 v[180:183], a[208:211], v[88:91], v[180:183]
 v_sub_f32 v151, 0, v208
 v_sub_f32 v168, v168, v208
 v_mfma_f32_16x16x32_bf16 v[180:183], a[212:215], v[92:95], v[180:183]
 v_sub_f32 v169, v169, v208
 s_waitcnt lgkmcnt(6)
 v_mfma_f32_16x16x32_bf16 v[184:187], a[216:219], v[0:3], v[148:151]
 v_sub_f32 v170, v170, v208
 v_sub_f32 v171, v171, v208
 v_mfma_f32_16x16x32_bf16 v[184:187], a[220:223], v[4:7], v[184:187]
 buffer_load_dwordx4 v226, s[16:19], s39 offen offset:3072 nt lds
 v_mfma_f32_16x16x32_bf16 v[184:187], a[224:227], v[8:11], v[184:187]
 v_max_f32 v210, v210, v175
 v_mov_b32 v211, v210
 v_mfma_f32_16x16x32_bf16 v[184:187], a[228:231], v[12:15], v[184:187]
 s_nop 0
 v_permlane16_swap_b32 v211, v210
 v_max_f32 v210, v210, v211
 v_mfma_f32_16x16x32_bf16 v[184:187], a[232:235], v[16:19], v[184:187]
 ds_read_b128 a[192:195], v216 offset:0
 v_mov_b32 v211, v210
 s_nop 1
 v_permlane32_swap_b32 v211, v210
 v_max_f32 v210, v210, v211
 v_sub_f32 v152, 0, v210
 v_sub_f32 v153, 0, v210
 v_sub_f32 v154, 0, v210
 v_sub_f32 v155, 0, v210
 v_mfma_f32_16x16x32_bf16 v[184:187], a[236:239], v[20:23], v[184:187]
 v_sub_f32 v172, v172, v210
 v_sub_f32 v173, v173, v210
 v_mfma_f32_16x16x32_bf16 v[188:191], a[216:219], v[24:27], v[152:155]
 ds_read_b128 a[196:199], v217 offset:0
 v_sub_f32 v174, v174, v210
 v_mfma_f32_16x16x32_bf16 v[188:191], a[220:223], v[28:31], v[188:191]
 v_sub_f32 v175, v175, v210
 v_max3_f32 v208, v176, v177, v178
 v_mfma_f32_16x16x32_bf16 v[188:191], a[224:227], v[32:35], v[188:191]
 ds_read_b128 a[200:203], v216 offset:128
 s_add_u32 m0, s34, 28672
 v_mfma_f32_16x16x32_bf16 v[188:191], a[228:231], v[36:39], v[188:191]
 buffer_load_dwordx4 v229, s[16:19], s39 offen nt lds
 v_mfma_f32_16x16x32_bf16 v[188:191], a[232:235], v[40:43], v[188:191]
 ds_read_b128 a[204:207], v217 offset:128
 v_max_f32 v208, v208, v179
 v_mov_b32 v209, v208
 s_nop 1
 v_permlane16_swap_b32 v209, v208
 v_max_f32 v208, v208, v209
 v_mov_b32 v209, v208
 s_nop 1
 v_permlane32_swap_b32 v209, v208
 v_max_f32 v208, v208, v209
 v_sub_f32 v156, 0, v208
 v_sub_f32 v157, 0, v208
 v_sub_f32 v158, 0, v208
 v_sub_f32 v159, 0, v208
 v_mfma_f32_16x16x32_bf16 v[188:191], a[236:239], v[44:47], v[188:191]
 v_sub_f32 v176, v176, v208
 v_sub_f32 v177, v177, v208
 v_mfma_f32_16x16x32_bf16 v[192:195], a[216:219], v[48:51], v[156:159]
 ds_read_b128 a[208:211], v216 offset:256
 v_sub_f32 v178, v178, v208
 v_mfma_f32_16x16x32_bf16 v[192:195], a[220:223], v[52:55], v[192:195]
 v_sub_f32 v179, v179, v208
 v_max3_f32 v210, v180, v181, v182
 v_mfma_f32_16x16x32_bf16 v[192:195], a[224:227], v[56:59], v[192:195]
 ds_read_b128 a[212:215], v217 offset:256
 v_max_f32 v210, v210, v183
 v_mfma_f32_16x16x32_bf16 v[192:195], a[228:231], v[60:63], v[192:195]
 buffer_load_dwordx4 v230, s[16:19], s39 offen offset:1024 nt lds
 v_mfma_f32_16x16x32_bf16 v[192:195], a[232:235], v[64:67], v[192:195]
 v_mov_b32 v211, v210
 s_nop 1
 v_permlane16_swap_b32 v211, v210
 v_max_f32 v210, v210, v211
 v_mov_b32 v211, v210
 s_nop 1
 v_permlane32_swap_b32 v211, v210
 v_max_f32 v210, v210, v211
 v_sub_f32 v160, 0, v210
 v_sub_f32 v161, 0, v210
 v_sub_f32 v162, 0, v210
 v_sub_f32 v163, 0, v210
 v_mfma_f32_16x16x32_bf16 v[192:195], a[236:239], v[68:71], v[192:195]
 v_exp_f32 v208, v168
 v_mfma_f32_16x16x32_bf16 v[196:199], a[216:219], v[72:75], v[160:163]
 v_exp_f32 v209, v169
 v_mfma_f32_16x16x32_bf16 v[196:199], a[220:223], v[76:79], v[196:199]
 v_exp_f32 v211, v171
 v_mfma_f32_16x16x32_bf16 v[196:199], a[224:227], v[80:83], v[196:199]
 v_exp_f32 v212, v172
 v_mfma_f32_16x16x32_bf16 v[196:199], a[228:231], v[84:87], v[196:199]
 v_exp_f32 v213, v173
 v_mfma_f32_16x16x32_bf16 v[196:199], a[232:235], v[88:91], v[196:199]
 v_exp_f32 v164, v174
 v_mfma_f32_16x16x32_bf16 v[196:199], a[236:239], v[92:95], v[196:199]
 v_sub_f32 v180, v180, v210
 s_waitcnt lgkmcnt(0)
 v_mfma_f32_16x16x32_bf16 v[124:127], a[192:195], v[0:3], v[148:151]
 ds_read_b128 a[216:219], v216 offset:6144
 v_sub_f32 v181, v181, v210
 v_mfma_f32_16x16x32_bf16 v[124:127], a[196:199], v[4:7], v[124:127]
 ds_read_b128 a[220:223], v217 offset:6144
 v_sub_f32 v182, v182, v210
 v_mfma_f32_16x16x32_bf16 v[124:127], a[200:203], v[8:11], v[124:127]
 s_cmp_eq_u32 s50, 1
 s_cselect_b32 s96, s56, s96
 s_cselect_b32 s97, s57, s97
 s_mov_b32 s98, 50688
 s_mov_b32 s52, 24576
 s_cmp_eq_u32 s50, 1
 s_cselect_b32 s98, 15360, s98
 s_cselect_b32 s52, 5120, s52
 v_mfma_f32_16x16x32_bf16 v[124:127], a[204:207], v[12:15], v[124:127]
 ds_read_b128 a[224:227], v216 offset:6272
 s_mov_b32 s76, 4
 v_mfma_f32_16x16x32_bf16 v[124:127], a[208:211], v[16:19], v[124:127]
 ds_read_b128 a[228:231], v217 offset:6272
 v_sub_f32 v183, v183, v210
 v_mfma_f32_16x16x32_bf16 v[124:127], a[212:215], v[20:23], v[124:127]
 s_xor_b32 s39, s77, 3
 s_mul_i32 s39, s39, 24576
 v_mfma_f32_16x16x32_bf16 v[128:131], a[192:195], v[24:27], v[152:155]
 ds_read_b128 a[232:235], v216 offset:6400
 v_add_f32 v204, v208, v209
 v_mfma_f32_16x16x32_bf16 v[128:131], a[196:199], v[28:31], v[128:131]
 ds_read_b128 a[236:239], v217 offset:6400
 v_cvt_pk_bf16_f32 v96, v208, v209
 v_mfma_f32_16x16x32_bf16 v[128:131], a[200:203], v[32:35], v[128:131]
 s_xor_b32 s40, s77, 2
 s_mul_i32 s40, s40, 24576
 v_mfma_f32_16x16x32_bf16 v[128:131], a[204:207], v[36:39], v[128:131]
 v_exp_f32 v210, v170
 v_mfma_f32_16x16x32_bf16 v[128:131], a[208:211], v[40:43], v[128:131]
 v_exp_f32 v165, v175
 v_mfma_f32_16x16x32_bf16 v[128:131], a[212:215], v[44:47], v[128:131]
 v_exp_f32 v166, v176
 v_mfma_f32_16x16x32_bf16 v[132:135], a[192:195], v[48:51], v[156:159]
 v_exp_f32 v167, v177
 v_mfma_f32_16x16x32_bf16 v[132:135], a[196:199], v[52:55], v[132:135]
 v_exp_f32 v208, v178
 v_mfma_f32_16x16x32_bf16 v[132:135], a[200:203], v[56:59], v[132:135]
 v_add_u32 v216, 0xc000, v216
 v_add_u32 v217, 0xc000, v217
 v_mfma_f32_16x16x32_bf16 v[132:135], a[204:207], v[60:63], v[132:135]
 v_exp_f32 v209, v179
 v_mfma_f32_16x16x32_bf16 v[132:135], a[208:211], v[64:67], v[132:135]
 v_add_f32 v204, v204, v210
 v_add_f32 v204, v204, v211
 v_mfma_f32_16x16x32_bf16 v[132:135], a[212:215], v[68:71], v[132:135]
 v_cvt_pk_bf16_f32 v97, v210, v211
 s_waitcnt vmcnt(18) lgkmcnt(0)
 v_mfma_f32_16x16x32_bf16 v[136:139], a[216:219], v[0:3], v[148:151]
 v_add_f32 v205, v212, v213
 s_barrier
 v_mfma_f32_16x16x32_bf16 v[136:139], a[220:223], v[4:7], v[136:139]
 ds_read_b64_tr_b16 a[192:193], v218 offset:0
 v_cvt_pk_bf16_f32 v100, v212, v213
 v_mfma_f32_16x16x32_bf16 v[136:139], a[224:227], v[8:11], v[136:139]
 ds_read_b64_tr_b16 a[194:195], v218 offset:6144
 v_add_f32 v205, v205, v164
 v_mfma_f32_16x16x32_bf16 v[136:139], a[228:231], v[12:15], v[136:139]
 s_nop 1
 v_mfma_f32_16x16x32_bf16 v[136:139], a[232:235], v[16:19], v[136:139]
 ds_read_b64_tr_b16 a[196:197], v219 offset:0
 v_add_f32 v205, v205, v165
 v_mfma_f32_16x16x32_bf16 v[136:139], a[236:239], v[20:23], v[136:139]
 buffer_atomic_add v253, v254, s[4:7], 0 offen
 v_mfma_f32_16x16x32_bf16 v[140:143], a[216:219], v[24:27], v[152:155]
 ds_read_b64_tr_b16 a[198:199], v219 offset:6144
 v_cvt_pk_bf16_f32 v101, v164, v165
 v_mfma_f32_16x16x32_bf16 v[140:143], a[220:223], v[28:31], v[140:143]
 v_exp_f32 v210, v180
 v_mfma_f32_16x16x32_bf16 v[140:143], a[224:227], v[32:35], v[140:143]
 ds_read_b64_tr_b16 a[200:201], v220 offset:0
 v_add_f32 v206, v166, v167
 v_mfma_f32_16x16x32_bf16 v[140:143], a[228:231], v[36:39], v[140:143]
 s_cmp_lt_u32 s39, s87
 s_cselect_b32 m0, s55, 196608
 v_lshrrev_b32 v254, 4, v246
 v_mfma_f32_16x16x32_bf16 v[140:143], a[232:235], v[40:43], v[140:143]
 ds_read_b64_tr_b16 a[202:203], v220 offset:6144
 v_cmp_gt_u32 s[84:85], 40, v254
 v_lshlrev_b32 v254, 3, v246
 v_mov_b32 v255, 0x7ff00000
 v_cndmask_b32 v254, v255, v254, s[84:85]
 s_cmp_eq_u32 s50, 0
 s_cselect_b64 s[84:85], -1, 0
 v_cndmask_b32 v254, v254, v251, s[84:85]
 v_min_u32 v251, 752, v246
 v_lshlrev_b32 v251, 3, v251
 s_cmp_eq_u32 s50, 0
 s_cselect_b32 s10, s10, 0
 v_mfma_f32_16x16x32_bf16 v[140:143], a[236:239], v[44:47], v[140:143]
 buffer_load_dwordx4 v226, s[16:19], s39 offen nt lds
 v_mfma_f32_16x16x32_bf16 v[144:147], a[216:219], v[48:51], v[156:159]
 ds_read_b64_tr_b16 a[204:205], v221 offset:0
 v_cvt_pk_bf16_f32 v104, v166, v167
 v_mfma_f32_16x16x32_bf16 v[144:147], a[220:223], v[52:55], v[144:147]
 v_exp_f32 v211, v181
 v_mfma_f32_16x16x32_bf16 v[144:147], a[224:227], v[56:59], v[144:147]
 ds_read_b64_tr_b16 a[206:207], v221 offset:6144
 v_add_f32 v206, v206, v208
 v_mfma_f32_16x16x32_bf16 v[144:147], a[228:231], v[60:63], v[144:147]
 v_exp_f32 v212, v182
 v_mfma_f32_16x16x32_bf16 v[144:147], a[232:235], v[64:67], v[144:147]
 ds_read_b64_tr_b16 a[208:209], v218 offset:128
 v_add_f32 v206, v206, v209
 v_cvt_pk_bf16_f32 v105, v208, v209
 v_add_f32 v207, v210, v211
 v_cvt_pk_bf16_f32 v108, v210, v211
 v_exp_f32 v213, v183
 v_add_f32 v207, v207, v212
 v_add_f32 v207, v207, v213
 v_cvt_pk_bf16_f32 v109, v212, v213
 v_exp_f32 v164, v184
 v_exp_f32 v165, v185
 v_add_f32 v204, v204, v164
 v_add_f32 v204, v204, v165
 v_cvt_pk_bf16_f32 v98, v164, v165
 v_exp_f32 v166, v186
 v_exp_f32 v167, v187
 v_add_f32 v204, v204, v166
 v_add_f32 v204, v204, v167
 v_cvt_pk_bf16_f32 v99, v166, v167
 v_exp_f32 v208, v188
 v_exp_f32 v209, v189
 v_add_f32 v205, v205, v208
 v_add_f32 v205, v205, v209
 v_cvt_pk_bf16_f32 v102, v208, v209
 v_exp_f32 v210, v190
 v_exp_f32 v211, v191
 v_add_f32 v205, v205, v210
 v_add_f32 v205, v205, v211
 v_cvt_pk_bf16_f32 v103, v210, v211
 v_exp_f32 v212, v192
 v_exp_f32 v213, v193
 v_add_f32 v206, v206, v212
 v_add_f32 v206, v206, v213
 v_cvt_pk_bf16_f32 v106, v212, v213
 v_exp_f32 v164, v194
 v_exp_f32 v165, v195
 v_add_f32 v206, v206, v164
 v_add_f32 v206, v206, v165
 v_cvt_pk_bf16_f32 v107, v164, v165
 v_exp_f32 v166, v196
 v_exp_f32 v167, v197
 v_add_f32 v207, v207, v166
 v_add_f32 v207, v207, v167
 v_cvt_pk_bf16_f32 v110, v166, v167
 v_exp_f32 v208, v198
 v_exp_f32 v209, v199
 v_add_f32 v207, v207, v208
 v_add_f32 v207, v207, v209
 v_cvt_pk_bf16_f32 v111, v208, v209
 v_max3_f32 v208, v204, v205, v206
 v_max_f32 v208, v208, v207
 v_cmp_lt_f32 vcc, 0x45800000, v208
 v_mfma_f32_16x16x32_bf16 v[144:147], a[236:239], v[68:71], v[144:147]
 ds_read_b64_tr_b16 a[210:211], v218 offset:6272
 s_waitcnt lgkmcnt(4)
 s_cbranch_vccnz K1_stub0
K1_back0:
 v_mfma_f32_16x16x32_bf16 a[0:3], a[192:195], v[96:99], 0
 v_exp_f32 v208, v124
 v_mfma_f32_16x16x32_bf16 a[48:51], a[192:195], v[100:103], 0
 ds_read_b64_tr_b16 a[212:213], v219 offset:128
 v_mov_b32 v200, v204
 v_mfma_f32_16x16x32_bf16 a[96:99], a[192:195], v[104:107], 0
 buffer_load_dwordx4 v227, s[16:19], s39 offen offset:1024 nt lds
 v_mfma_f32_16x16x32_bf16 a[144:147], a[192:195], v[108:111], 0
 ds_read_b64_tr_b16 a[214:215], v219 offset:6272
 v_mov_b32 v201, v205
 v_mfma_f32_16x16x32_bf16 a[4:7], a[196:199], v[96:99], 0
 v_exp_f32 v209, v125
 v_mfma_f32_16x16x32_bf16 a[52:55], a[196:199], v[100:103], 0
 ds_read_b64_tr_b16 a[192:193], v220 offset:128
 v_mov_b32 v202, v206
 v_mfma_f32_16x16x32_bf16 a[100:103], a[196:199], v[104:107], 0
 v_exp_f32 v210, v126
 v_mfma_f32_16x16x32_bf16 a[148:151], a[196:199], v[108:111], 0
 ds_read_b64_tr_b16 a[194:195], v220 offset:6272
 v_mov_b32 v203, v207
 v_mfma_f32_16x16x32_bf16 a[8:11], a[200:203], v[96:99], 0
 v_exp_f32 v211, v127
 v_mfma_f32_16x16x32_bf16 a[56:59], a[200:203], v[100:103], 0
 ds_read_b64_tr_b16 a[216:217], v221 offset:128
 v_add_f32 v204, v208, v209
 v_mfma_f32_16x16x32_bf16 a[104:107], a[200:203], v[104:107], 0
 buffer_load_dwordx4 v228, s[16:19], s39 offen offset:2048 nt lds
 v_mfma_f32_16x16x32_bf16 a[152:155], a[200:203], v[108:111], 0
 ds_read_b64_tr_b16 a[218:219], v221 offset:6272
 s_waitcnt lgkmcnt(4)
 v_mfma_f32_16x16x32_bf16 a[12:15], a[204:207], v[96:99], 0
 v_exp_f32 v212, v128
 v_mfma_f32_16x16x32_bf16 a[60:63], a[204:207], v[100:103], 0
 ds_read_b64_tr_b16 a[220:221], v218 offset:256
 v_cvt_pk_bf16_f32 v112, v208, v209
 v_mfma_f32_16x16x32_bf16 a[108:111], a[204:207], v[104:107], 0
 ds_read_b64_tr_b16 a[222:223], v218 offset:6400
 v_add_f32 v204, v204, v210
 v_mfma_f32_16x16x32_bf16 a[156:159], a[204:207], v[108:111], 0
 v_exp_f32 v213, v129
 v_mfma_f32_16x16x32_bf16 a[16:19], a[208:211], v[96:99], 0
 ds_read_b64_tr_b16 a[224:225], v219 offset:256
 v_add_f32 v204, v204, v211
 v_mfma_f32_16x16x32_bf16 a[64:67], a[208:211], v[100:103], 0
 v_exp_f32 v164, v130
 v_mfma_f32_16x16x32_bf16 a[112:115], a[208:211], v[104:107], 0
 ds_read_b64_tr_b16 a[226:227], v219 offset:6400
 v_cvt_pk_bf16_f32 v113, v210, v211
 v_mfma_f32_16x16x32_bf16 a[160:163], a[208:211], v[108:111], 0
 buffer_load_dwordx4 v226, s[16:19], s39 offen offset:3072 nt lds
 v_mfma_f32_16x16x32_bf16 a[20:23], a[212:215], v[96:99], 0
 ds_read_b64_tr_b16 a[228:229], v220 offset:256
 v_add_f32 v205, v212, v213
 v_mfma_f32_16x16x32_bf16 a[68:71], a[212:215], v[100:103], 0
 v_exp_f32 v165, v131
 v_mfma_f32_16x16x32_bf16 a[116:119], a[212:215], v[104:107], 0
 ds_read_b64_tr_b16 a[230:231], v220 offset:6400
 v_cvt_pk_bf16_f32 v116, v212, v213
 v_mfma_f32_16x16x32_bf16 a[164:167], a[212:215], v[108:111], 0
 v_add_f32 v205, v205, v164
 s_waitcnt lgkmcnt(4)
 v_mfma_f32_16x16x32_bf16 a[24:27], a[192:195], v[96:99], 0
 ds_read_b64_tr_b16 a[232:233], v221 offset:256
 v_add_f32 v205, v205, v165
 v_mfma_f32_16x16x32_bf16 a[72:75], a[192:195], v[100:103], 0
 v_exp_f32 v166, v132
 v_mfma_f32_16x16x32_bf16 a[120:123], a[192:195], v[104:107], 0
 ds_read_b64_tr_b16 a[234:235], v221 offset:6400
 v_cvt_pk_bf16_f32 v117, v164, v165
 v_mfma_f32_16x16x32_bf16 a[168:171], a[192:195], v[108:111], 0
 v_exp_f32 v167, v133
 v_mfma_f32_16x16x32_bf16 a[28:31], a[216:219], v[96:99], 0
 v_exp_f32 v208, v134
 v_mfma_f32_16x16x32_bf16 a[76:79], a[216:219], v[100:103], 0
 ds_read_b128 a[192:195], v214 offset:0
 v_add_f32 v206, v166, v167
 v_mfma_f32_16x16x32_bf16 a[124:127], a[216:219], v[104:107], 0
 ds_read_b128 a[196:199], v215 offset:0
 s_add_u32 m0, m0, 4096
 v_mfma_f32_16x16x32_bf16 a[172:175], a[216:219], v[108:111], 0
 buffer_load_dwordx4 v229, s[16:19], s39 offen nt lds
 v_mfma_f32_16x16x32_bf16 a[32:35], a[220:223], v[96:99], 0
 ds_read_b128 a[200:203], v214 offset:128
 v_cvt_pk_bf16_f32 v120, v166, v167
 v_mfma_f32_16x16x32_bf16 a[80:83], a[220:223], v[100:103], 0
 v_add_u32 v218, 0xffffa000, v218
 v_add_u32 v219, 0xffffa000, v219
 v_mfma_f32_16x16x32_bf16 a[128:131], a[220:223], v[104:107], 0
 ds_read_b128 a[204:207], v215 offset:128
 v_add_u32 v220, 0xffffa000, v220
 v_mfma_f32_16x16x32_bf16 a[176:179], a[220:223], v[108:111], 0
 v_add_u32 v221, 0xffffa000, v221
 s_waitcnt lgkmcnt(4)
 v_mfma_f32_16x16x32_bf16 a[36:39], a[224:227], v[96:99], 0
 ds_read_b128 a[208:211], v214 offset:256
 v_add_f32 v206, v206, v208
 v_mfma_f32_16x16x32_bf16 a[84:87], a[224:227], v[100:103], 0
 buffer_load_dwordx4 v230, s[16:19], s39 offen offset:1024 nt lds
 v_mfma_f32_16x16x32_bf16 a[132:135], a[224:227], v[104:107], 0
 ds_read_b128 a[212:215], v215 offset:256
 v_mfma_f32_16x16x32_bf16 a[180:183], a[224:227], v[108:111], 0
 s_mov_b64 s[84:85], s[58:59]
 s_mov_b64 s[58:59], s[60:61]
 v_mfma_f32_16x16x32_bf16 a[40:43], a[228:231], v[96:99], 0
 s_mov_b64 s[60:61], s[62:63]
 s_mov_b64 s[62:63], s[84:85]
 v_mfma_f32_16x16x32_bf16 a[88:91], a[228:231], v[100:103], 0
 v_exp_f32 v209, v135
 v_mfma_f32_16x16x32_bf16 a[136:139], a[228:231], v[104:107], 0
 v_exp_f32 v210, v136
 v_mfma_f32_16x16x32_bf16 a[184:187], a[228:231], v[108:111], 0
 v_exp_f32 v211, v137
 v_mfma_f32_16x16x32_bf16 a[44:47], a[232:235], v[96:99], 0
 v_exp_f32 v212, v138
 v_mfma_f32_16x16x32_bf16 a[92:95], a[232:235], v[100:103], 0
 v_exp_f32 v213, v139
 v_mfma_f32_16x16x32_bf16 a[140:143], a[232:235], v[104:107], 0
 s_mov_b32 s22, 0
 s_mov_b32 m0, 196608
 v_mfma_f32_16x16x32_bf16 a[188:191], a[232:235], v[108:111], 0
 s_mov_b32 s86, 5
 s_waitcnt lgkmcnt(0)
.p2align 3
K1_att:
 v_mfma_f32_16x16x32_bf16 v[168:171], a[192:195], v[0:3], v[148:151]
 buffer_load_dwordx4 v226, s[20:23], s40 offen nt lds
 v_mfma_f32_16x16x32_bf16 v[168:171], a[196:199], v[4:7], v[168:171]
 ds_read_b128 a[216:219], v214 offset:6144
 v_add_f32 v206, v206, v209
 v_mfma_f32_16x16x32_bf16 v[168:171], a[200:203], v[8:11], v[168:171]
 v_exp_f32 v164, v140
 v_mfma_f32_16x16x32_bf16 v[168:171], a[204:207], v[12:15], v[168:171]
 ds_read_b128 a[220:223], v215 offset:6144
 v_cvt_pk_bf16_f32 v121, v208, v209
 v_mfma_f32_16x16x32_bf16 v[168:171], a[208:211], v[16:19], v[168:171]
 v_exp_f32 v165, v141
 v_mfma_f32_16x16x32_bf16 v[168:171], a[212:215], v[20:23], v[168:171]
 ds_read_b128 a[224:227], v214 offset:6272
 v_add_f32 v204, v204, v210
 v_mfma_f32_16x16x32_bf16 v[172:175], a[192:195], v[24:27], v[152:155]
 v_exp_f32 v166, v142
 v_mfma_f32_16x16x32_bf16 v[172:175], a[196:199], v[28:31], v[172:175]
 ds_read_b128 a[228:231], v215 offset:6272
 v_add_f32 v204, v204, v211
 v_mfma_f32_16x16x32_bf16 v[172:175], a[200:203], v[32:35], v[172:175]
 buffer_load_dwordx4 v227, s[20:23], s40 offen offset:1024 nt lds
 v_mfma_f32_16x16x32_bf16 v[172:175], a[204:207], v[36:39], v[172:175]
 ds_read_b128 a[232:235], v214 offset:6400
 v_cvt_pk_bf16_f32 v114, v210, v211
 v_mfma_f32_16x16x32_bf16 v[172:175], a[208:211], v[40:43], v[172:175]
 v_exp_f32 v167, v143
 v_mfma_f32_16x16x32_bf16 v[172:175], a[212:215], v[44:47], v[172:175]
 ds_read_b128 a[236:239], v215 offset:6400
 v_add_f32 v204, v204, v212
 v_mfma_f32_16x16x32_bf16 v[176:179], a[192:195], v[48:51], v[156:159]
 v_exp_f32 v208, v144
 v_mfma_f32_16x16x32_bf16 v[176:179], a[196:199], v[52:55], v[176:179]
 v_exp_f32 v209, v145
 v_mfma_f32_16x16x32_bf16 v[176:179], a[200:203], v[56:59], v[176:179]
 v_exp_f32 v210, v146
 v_mfma_f32_16x16x32_bf16 v[176:179], a[204:207], v[60:63], v[176:179]
 v_exp_f32 v211, v147
 v_mfma_f32_16x16x32_bf16 v[176:179], a[208:211], v[64:67], v[176:179]
 ds_read_b64_tr_b16 a[240:241], v222 offset:0
 v_add_f32 v204, v204, v213
 v_mfma_f32_16x16x32_bf16 v[176:179], a[212:215], v[68:71], v[176:179]
 buffer_load_dwordx4 v228, s[20:23], s40 offen offset:2048 nt lds
 v_mfma_f32_16x16x32_bf16 v[180:183], a[192:195], v[72:75], v[160:163]
 ds_read_b64_tr_b16 a[242:243], v222 offset:6144
 v_cvt_pk_bf16_f32 v115, v212, v213
 v_mfma_f32_16x16x32_bf16 v[180:183], a[196:199], v[76:79], v[180:183]
 v_add_f32 v205, v205, v164
 v_add_f32 v205, v205, v165
 v_mfma_f32_16x16x32_bf16 v[180:183], a[200:203], v[80:83], v[180:183]
 ds_read_b64_tr_b16 a[192:193], v223 offset:0
 v_add_u32 v214, s58, v214
 v_mfma_f32_16x16x32_bf16 v[180:183], a[204:207], v[84:87], v[180:183]
 v_add_u32 v215, s58, v215
 v_cvt_pk_bf16_f32 v118, v164, v165
 v_mfma_f32_16x16x32_bf16 v[180:183], a[208:211], v[88:91], v[180:183]
 ds_read_b64_tr_b16 a[194:195], v223 offset:6144
 v_add_f32 v205, v205, v166
 v_add_f32 v205, v205, v167
 v_cvt_pk_bf16_f32 v119, v166, v167
 v_add_f32 v206, v206, v208
 v_add_f32 v206, v206, v209
 v_cvt_pk_bf16_f32 v122, v208, v209
 v_add_f32 v206, v206, v210
 v_add_f32 v206, v206, v211
 v_cvt_pk_bf16_f32 v123, v210, v211
 v_max3_f32 v208, v204, v205, v206
 v_cmp_lt_f32 vcc, 0x45800000, v208
 v_mfma_f32_16x16x32_bf16 v[180:183], a[212:215], v[92:95], v[180:183]
 s_waitcnt lgkmcnt(4)
 s_cbranch_vccnz K1_stub1
K1_back1:
 v_mfma_f32_16x16x32_bf16 v[184:187], a[216:219], v[0:3], v[148:151]
 ds_read_b64_tr_b16 a[196:197], v224 offset:0
 v_add_f32 v200, v200, v204
 v_mfma_f32_16x16x32_bf16 v[184:187], a[220:223], v[4:7], v[184:187]
 v_exp_f32 v208, v168
 v_mfma_f32_16x16x32_bf16 v[184:187], a[224:227], v[8:11], v[184:187]
 ds_read_b64_tr_b16 a[198:199], v224 offset:6144
 v_add_f32 v201, v201, v205
 v_mfma_f32_16x16x32_bf16 v[184:187], a[228:231], v[12:15], v[184:187]
 buffer_load_dwordx4 v226, s[20:23], s40 offen offset:3072 nt lds
 v_mfma_f32_16x16x32_bf16 v[184:187], a[232:235], v[16:19], v[184:187]
 ds_read_b64_tr_b16 a[200:201], v225 offset:0
 v_add_f32 v202, v202, v206
 v_mfma_f32_16x16x32_bf16 v[184:187], a[236:239], v[20:23], v[184:187]
 v_exp_f32 v209, v169
 v_mfma_f32_16x16x32_bf16 v[188:191], a[216:219], v[24:27], v[152:155]
 ds_read_b64_tr_b16 a[202:203], v225 offset:6144
 v_add_f32 v204, v208, v209
 v_mfma_f32_16x16x32_bf16 v[188:191], a[220:223], v[28:31], v[188:191]
 v_exp_f32 v210, v170
 v_mfma_f32_16x16x32_bf16 v[188:191], a[224:227], v[32:35], v[188:191]
 v_exp_f32 v211, v171
 v_mfma_f32_16x16x32_bf16 v[188:191], a[228:231], v[36:39], v[188:191]
 ds_read_b64_tr_b16 a[204:205], v222 offset:128
 v_cvt_pk_bf16_f32 v96, v208, v209
 v_mfma_f32_16x16x32_bf16 v[188:191], a[232:235], v[40:43], v[188:191]
 v_exp_f32 v212, v172
 v_mfma_f32_16x16x32_bf16 v[188:191], a[236:239], v[44:47], v[188:191]
 ds_read_b64_tr_b16 a[206:207], v222 offset:6272
 s_add_u32 m0, m0, 4096
 v_mfma_f32_16x16x32_bf16 v[192:195], a[216:219], v[48:51], v[156:159]
 buffer_load_dwordx4 v229, s[20:23], s40 offen nt lds
 v_mfma_f32_16x16x32_bf16 v[192:195], a[220:223], v[52:55], v[192:195]
 ds_read_b64_tr_b16 a[208:209], v223 offset:128
 v_add_f32 v204, v204, v210
 v_mfma_f32_16x16x32_bf16 v[192:195], a[224:227], v[56:59], v[192:195]
 v_exp_f32 v213, v173
 v_mfma_f32_16x16x32_bf16 v[192:195], a[228:231], v[60:63], v[192:195]
 ds_read_b64_tr_b16 a[210:211], v223 offset:6272
 v_add_f32 v204, v204, v211
 v_mfma_f32_16x16x32_bf16 v[192:195], a[232:235], v[64:67], v[192:195]
 v_exp_f32 v164, v174
 v_mfma_f32_16x16x32_bf16 v[192:195], a[236:239], v[68:71], v[192:195]
 ds_read_b64_tr_b16 a[212:213], v224 offset:128
 v_cvt_pk_bf16_f32 v97, v210, v211
 v_mfma_f32_16x16x32_bf16 v[196:199], a[216:219], v[72:75], v[160:163]
 v_exp_f32 v165, v175
 v_mfma_f32_16x16x32_bf16 v[196:199], a[220:223], v[76:79], v[196:199]
 ds_read_b64_tr_b16 a[214:215], v224 offset:6272
 v_add_f32 v205, v212, v213
 v_mfma_f32_16x16x32_bf16 v[196:199], a[224:227], v[80:83], v[196:199]
 buffer_load_dwordx4 v230, s[20:23], s40 offen offset:1024 nt lds
 v_mfma_f32_16x16x32_bf16 v[196:199], a[228:231], v[84:87], v[196:199]
 ds_read_b64_tr_b16 a[216:217], v225 offset:128
 v_cvt_pk_bf16_f32 v100, v212, v213
 v_mfma_f32_16x16x32_bf16 v[196:199], a[232:235], v[88:91], v[196:199]
 v_exp_f32 v166, v176
 v_mfma_f32_16x16x32_bf16 v[196:199], a[236:239], v[92:95], v[196:199]
 ds_read_b64_tr_b16 a[218:219], v225 offset:6272
 s_waitcnt lgkmcnt(10)
 v_mfma_f32_16x16x32_bf16 a[0:3], a[240:243], v[112:115], a[0:3]
 v_exp_f32 v167, v177
 v_mfma_f32_16x16x32_bf16 a[48:51], a[240:243], v[116:119], a[48:51]
 v_exp_f32 v208, v178
 v_mfma_f32_16x16x32_bf16 a[96:99], a[240:243], v[120:123], a[96:99]
 ds_read_b64_tr_b16 a[220:221], v222 offset:256
 v_add_f32 v205, v205, v164
 v_mfma_f32_16x16x32_bf16 a[4:7], a[192:195], v[112:115], a[4:7]
 v_exp_f32 v209, v179
 v_mfma_f32_16x16x32_bf16 a[52:55], a[192:195], v[116:119], a[52:55]
 ds_read_b64_tr_b16 a[222:223], v222 offset:6400
 v_add_f32 v205, v205, v165
 v_mfma_f32_16x16x32_bf16 a[100:103], a[192:195], v[120:123], a[100:103]
 v_exp_f32 v210, v180
 v_mfma_f32_16x16x32_bf16 a[8:11], a[196:199], v[112:115], a[8:11]
 ds_read_b64_tr_b16 a[224:225], v223 offset:256
 v_cvt_pk_bf16_f32 v101, v164, v165
 v_mfma_f32_16x16x32_bf16 a[56:59], a[196:199], v[116:119], a[56:59]
 v_exp_f32 v211, v181
 v_mfma_f32_16x16x32_bf16 a[104:107], a[196:199], v[120:123], a[104:107]
 ds_read_b64_tr_b16 a[226:227], v223 offset:6400
 s_waitcnt lgkmcnt(8)
 v_mfma_f32_16x16x32_bf16 a[12:15], a[200:203], v[112:115], a[12:15]
 s_sub_u32 s85, s86, 3
 s_cselect_b32 s85, s86, s85
 v_mfma_f32_16x16x32_bf16 a[60:63], a[200:203], v[116:119], a[60:63]
 ds_read_b64_tr_b16 a[228:229], v224 offset:256
 v_add_f32 v206, v166, v167
 v_mfma_f32_16x16x32_bf16 a[108:111], a[200:203], v[120:123], a[108:111]
 s_mul_i32 s85, s85, 6144
 s_add_u32 s85, s85, s53
 v_mfma_f32_16x16x32_bf16 a[16:19], a[204:207], v[112:115], a[16:19]
 ds_read_b64_tr_b16 a[230:231], v224 offset:6400
 v_cvt_pk_bf16_f32 v104, v166, v167
 v_mfma_f32_16x16x32_bf16 a[64:67], a[204:207], v[116:119], a[64:67]
 buffer_load_dword v255, v251, s[8:11], s85 offen
 v_mfma_f32_16x16x32_bf16 a[112:115], a[204:207], v[120:123], a[112:115]
 ds_read_b64_tr_b16 a[232:233], v225 offset:256
 s_add_u32 s55, s55, s62
 v_mfma_f32_16x16x32_bf16 a[20:23], a[208:211], v[112:115], a[20:23]
 s_add_u32 s3, s3, s61
 s_mov_b32 s22, 196608
 v_mfma_f32_16x16x32_bf16 a[68:71], a[208:211], v[116:119], a[68:71]
 ds_read_b64_tr_b16 a[234:235], v225 offset:6400
 v_add_f32 v206, v206, v208
 v_mfma_f32_16x16x32_bf16 a[116:119], a[208:211], v[120:123], a[116:119]
 v_add_f32 v206, v206, v209
 s_waitcnt lgkmcnt(6)
 v_mfma_f32_16x16x32_bf16 a[24:27], a[212:215], v[112:115], a[24:27]
 s_mov_b32 s40, s39
 s_xor_b32 s39, s77, s76
 v_mfma_f32_16x16x32_bf16 a[72:75], a[212:215], v[116:119], a[72:75]
 ds_read_b128 a[192:195], v216 offset:0
 v_cvt_pk_bf16_f32 v105, v208, v209
 v_mfma_f32_16x16x32_bf16 a[120:123], a[212:215], v[120:123], a[120:123]
 ds_read_b128 a[196:199], v217 offset:0
 v_add_f32 v207, v210, v211
 v_mfma_f32_16x16x32_bf16 a[28:31], a[216:219], v[112:115], a[28:31]
 s_mul_i32 s39, s39, 24576
 s_add_u32 s76, s76, 1
 v_mfma_f32_16x16x32_bf16 a[76:79], a[216:219], v[116:119], a[76:79]
 ds_read_b128 a[200:203], v216 offset:128
 v_cvt_pk_bf16_f32 v108, v210, v211
 v_mfma_f32_16x16x32_bf16 a[124:127], a[216:219], v[120:123], a[124:127]
 v_exp_f32 v212, v182
 v_mfma_f32_16x16x32_bf16 a[32:35], a[220:223], v[112:115], a[32:35]
 ds_read_b128 a[204:207], v217 offset:128
 v_add_u32 v222, s63, v222
 v_mfma_f32_16x16x32_bf16 a[80:83], a[220:223], v[116:119], a[80:83]
 ds_read_b128 a[208:211], v216 offset:256
 v_add_u32 v223, s63, v223
 v_mfma_f32_16x16x32_bf16 a[128:131], a[220:223], v[120:123], a[128:131]
 v_add_u32 v224, s63, v224
 s_waitcnt lgkmcnt(5)
 v_mfma_f32_16x16x32_bf16 a[36:39], a[224:227], v[112:115], a[36:39]
 ds_read_b128 a[212:215], v217 offset:256
 v_add_u32 v225, s63, v225
 v_mfma_f32_16x16x32_bf16 a[84:87], a[224:227], v[116:119], a[84:87]
 v_exp_f32 v213, v183
 v_mfma_f32_16x16x32_bf16 a[132:135], a[224:227], v[120:123], a[132:135]
 v_exp_f32 v164, v184
 v_mfma_f32_16x16x32_bf16 a[40:43], a[228:231], v[112:115], a[40:43]
 v_exp_f32 v165, v185
 v_mfma_f32_16x16x32_bf16 a[88:91], a[228:231], v[116:119], a[88:91]
 v_exp_f32 v166, v186
 v_mfma_f32_16x16x32_bf16 a[136:139], a[228:231], v[120:123], a[136:139]
 v_exp_f32 v167, v187
 v_mfma_f32_16x16x32_bf16 a[44:47], a[232:235], v[112:115], a[44:47]
 v_exp_f32 v208, v188
 v_mfma_f32_16x16x32_bf16 a[92:95], a[232:235], v[116:119], a[92:95]
 v_exp_f32 v209, v189
 v_mfma_f32_16x16x32_bf16 a[140:143], a[232:235], v[120:123], a[140:143]
 v_add_f32 v207, v207, v212
 s_waitcnt lgkmcnt(0)
 v_mfma_f32_16x16x32_bf16 v[124:127], a[192:195], v[0:3], v[148:151]
 ds_read_b128 a[216:219], v216 offset:6144
 v_add_f32 v207, v207, v213
 v_mfma_f32_16x16x32_bf16 v[124:127], a[196:199], v[4:7], v[124:127]
 ds_read_b128 a[220:223], v217 offset:6144
 v_cvt_pk_bf16_f32 v109, v212, v213
 v_mfma_f32_16x16x32_bf16 v[124:127], a[200:203], v[8:11], v[124:127]
 v_exp_f32 v210, v190
 v_mfma_f32_16x16x32_bf16 v[124:127], a[204:207], v[12:15], v[124:127]
 ds_read_b128 a[224:227], v216 offset:6272
 v_add_f32 v204, v204, v164
 v_mfma_f32_16x16x32_bf16 v[124:127], a[208:211], v[16:19], v[124:127]
 ds_read_b128 a[228:231], v217 offset:6272
 v_add_f32 v204, v204, v165
 v_mfma_f32_16x16x32_bf16 v[124:127], a[212:215], v[20:23], v[124:127]
 v_exp_f32 v211, v191
 v_mfma_f32_16x16x32_bf16 v[128:131], a[192:195], v[24:27], v[152:155]
 ds_read_b128 a[232:235], v216 offset:6400
 v_cvt_pk_bf16_f32 v98, v164, v165
 v_mfma_f32_16x16x32_bf16 v[128:131], a[196:199], v[28:31], v[128:131]
 ds_read_b128 a[236:239], v217 offset:6400
 v_add_f32 v204, v204, v166
 v_mfma_f32_16x16x32_bf16 v[128:131], a[200:203], v[32:35], v[128:131]
 v_exp_f32 v212, v192
 v_mfma_f32_16x16x32_bf16 v[128:131], a[204:207], v[36:39], v[128:131]
 v_exp_f32 v213, v193
 v_mfma_f32_16x16x32_bf16 v[128:131], a[208:211], v[40:43], v[128:131]
 v_exp_f32 v164, v194
 v_mfma_f32_16x16x32_bf16 v[128:131], a[212:215], v[44:47], v[128:131]
 v_exp_f32 v165, v195
 v_mfma_f32_16x16x32_bf16 v[132:135], a[192:195], v[48:51], v[156:159]
 v_add_f32 v204, v204, v167
 v_cvt_pk_bf16_f32 v99, v166, v167
 v_mfma_f32_16x16x32_bf16 v[132:135], a[196:199], v[52:55], v[132:135]
 v_exp_f32 v166, v196
 v_mfma_f32_16x16x32_bf16 v[132:135], a[200:203], v[56:59], v[132:135]
 v_add_u32 v216, s58, v216
 v_add_u32 v217, s58, v217
 v_mfma_f32_16x16x32_bf16 v[132:135], a[204:207], v[60:63], v[132:135]
 v_exp_f32 v167, v197
 v_mfma_f32_16x16x32_bf16 v[132:135], a[208:211], v[64:67], v[132:135]
 v_add_f32 v205, v205, v208
 v_add_f32 v205, v205, v209
 v_mfma_f32_16x16x32_bf16 v[132:135], a[212:215], v[68:71], v[132:135]
 v_cvt_pk_bf16_f32 v102, v208, v209
 s_waitcnt vmcnt(14) lgkmcnt(0)
 v_mfma_f32_16x16x32_bf16 v[136:139], a[216:219], v[0:3], v[148:151]
 v_add_f32 v205, v205, v210
 s_barrier
 v_mfma_f32_16x16x32_bf16 v[136:139], a[220:223], v[4:7], v[136:139]
 ds_read_b64_tr_b16 a[192:193], v218 offset:0
 v_add_f32 v205, v205, v211
 v_mfma_f32_16x16x32_bf16 v[136:139], a[224:227], v[8:11], v[136:139]
 ds_read_b64_tr_b16 a[194:195], v218 offset:6144
 s_mul_i32 s84, s86, s52
 v_mfma_f32_16x16x32_bf16 v[136:139], a[228:231], v[12:15], v[136:139]
 buffer_load_dword v255, v254, s[96:99], s84 offen
 v_mfma_f32_16x16x32_bf16 v[136:139], a[232:235], v[16:19], v[136:139]
 ds_read_b64_tr_b16 a[196:197], v219 offset:0
 v_cvt_pk_bf16_f32 v103, v210, v211
 v_mfma_f32_16x16x32_bf16 v[136:139], a[236:239], v[20:23], v[136:139]
 v_exp_f32 v208, v198
 v_mfma_f32_16x16x32_bf16 v[140:143], a[216:219], v[24:27], v[152:155]
 ds_read_b64_tr_b16 a[198:199], v219 offset:6144
 v_add_f32 v206, v206, v212
 v_mfma_f32_16x16x32_bf16 v[140:143], a[220:223], v[28:31], v[140:143]
 v_exp_f32 v209, v199
 v_mfma_f32_16x16x32_bf16 v[140:143], a[224:227], v[32:35], v[140:143]
 ds_read_b64_tr_b16 a[200:201], v220 offset:0
 v_add_f32 v206, v206, v213
 v_mfma_f32_16x16x32_bf16 v[140:143], a[228:231], v[36:39], v[140:143]
 s_cmp_lt_u32 s39, s87
 s_cselect_b32 m0, s55, 196608
 v_mfma_f32_16x16x32_bf16 v[140:143], a[232:235], v[40:43], v[140:143]
 ds_read_b64_tr_b16 a[202:203], v220 offset:6144
 v_cvt_pk_bf16_f32 v106, v212, v213
 v_mfma_f32_16x16x32_bf16 v[140:143], a[236:239], v[44:47], v[140:143]
 buffer_load_dwordx4 v226, s[16:19], s39 offen nt lds
 v_mfma_f32_16x16x32_bf16 v[144:147], a[216:219], v[48:51], v[156:159]
 ds_read_b64_tr_b16 a[204:205], v221 offset:0
 v_add_f32 v206, v206, v164
 v_mfma_f32_16x16x32_bf16 v[144:147], a[220:223], v[52:55], v[144:147]
 v_add_f32 v206, v206, v165
 v_cvt_pk_bf16_f32 v107, v164, v165
 v_mfma_f32_16x16x32_bf16 v[144:147], a[224:227], v[56:59], v[144:147]
 ds_read_b64_tr_b16 a[206:207], v221 offset:6144
 v_add_f32 v207, v207, v166
 v_mfma_f32_16x16x32_bf16 v[144:147], a[228:231], v[60:63], v[144:147]
 v_add_f32 v207, v207, v167
 v_cvt_pk_bf16_f32 v110, v166, v167
 v_mfma_f32_16x16x32_bf16 v[144:147], a[232:235], v[64:67], v[144:147]
 ds_read_b64_tr_b16 a[208:209], v218 offset:128
 v_add_f32 v207, v207, v208
 v_add_f32 v207, v207, v209
 v_cvt_pk_bf16_f32 v111, v208, v209
 v_max3_f32 v208, v204, v205, v206
 v_max_f32 v208, v208, v207
 v_cmp_lt_f32 vcc, 0x45800000, v208
 v_mfma_f32_16x16x32_bf16 v[144:147], a[236:239], v[68:71], v[144:147]
 ds_read_b64_tr_b16 a[210:211], v218 offset:6272
 s_waitcnt lgkmcnt(4)
 s_cbranch_vccnz K1_stub2
K1_back2:
 v_mfma_f32_16x16x32_bf16 a[0:3], a[192:195], v[96:99], a[0:3]
 v_exp_f32 v208, v124
 v_mfma_f32_16x16x32_bf16 a[48:51], a[192:195], v[100:103], a[48:51]
 ds_read_b64_tr_b16 a[212:213], v219 offset:128
 v_add_f32 v200, v200, v204
 v_mfma_f32_16x16x32_bf16 a[96:99], a[192:195], v[104:107], a[96:99]
 buffer_load_dwordx4 v227, s[16:19], s39 offen offset:1024 nt lds
 v_mfma_f32_16x16x32_bf16 a[144:147], a[192:195], v[108:111], a[144:147]
 ds_read_b64_tr_b16 a[214:215], v219 offset:6272
 v_add_f32 v201, v201, v205
 v_mfma_f32_16x16x32_bf16 a[4:7], a[196:199], v[96:99], a[4:7]
 v_exp_f32 v209, v125
 v_mfma_f32_16x16x32_bf16 a[52:55], a[196:199], v[100:103], a[52:55]
 ds_read_b64_tr_b16 a[192:193], v220 offset:128
 v_add_f32 v202, v202, v206
 v_mfma_f32_16x16x32_bf16 a[100:103], a[196:199], v[104:107], a[100:103]
 v_exp_f32 v210, v126
 v_mfma_f32_16x16x32_bf16 a[148:151], a[196:199], v[108:111], a[148:151]
 ds_read_b64_tr_b16 a[194:195], v220 offset:6272
 v_add_f32 v203, v203, v207
 v_mfma_f32_16x16x32_bf16 a[8:11], a[200:203], v[96:99], a[8:11]
 v_exp_f32 v211, v127
 v_mfma_f32_16x16x32_bf16 a[56:59], a[200:203], v[100:103], a[56:59]
 ds_read_b64_tr_b16 a[216:217], v221 offset:128
 v_add_f32 v204, v208, v209
 v_mfma_f32_16x16x32_bf16 a[104:107], a[200:203], v[104:107], a[104:107]
 buffer_load_dwordx4 v228, s[16:19], s39 offen offset:2048 nt lds
 v_mfma_f32_16x16x32_bf16 a[152:155], a[200:203], v[108:111], a[152:155]
 ds_read_b64_tr_b16 a[218:219], v221 offset:6272
 s_waitcnt lgkmcnt(4)
 v_mfma_f32_16x16x32_bf16 a[12:15], a[204:207], v[96:99], a[12:15]
 v_exp_f32 v212, v128
 v_mfma_f32_16x16x32_bf16 a[60:63], a[204:207], v[100:103], a[60:63]
 ds_read_b64_tr_b16 a[220:221], v218 offset:256
 v_cvt_pk_bf16_f32 v112, v208, v209
 v_mfma_f32_16x16x32_bf16 a[108:111], a[204:207], v[104:107], a[108:111]
 ds_read_b64_tr_b16 a[222:223], v218 offset:6400
 v_add_f32 v204, v204, v210
 v_mfma_f32_16x16x32_bf16 a[156:159], a[204:207], v[108:111], a[156:159]
 v_exp_f32 v213, v129
 v_mfma_f32_16x16x32_bf16 a[16:19], a[208:211], v[96:99], a[16:19]
 ds_read_b64_tr_b16 a[224:225], v219 offset:256
 v_add_f32 v204, v204, v211
 v_mfma_f32_16x16x32_bf16 a[64:67], a[208:211], v[100:103], a[64:67]
 v_exp_f32 v164, v130
 v_mfma_f32_16x16x32_bf16 a[112:115], a[208:211], v[104:107], a[112:115]
 ds_read_b64_tr_b16 a[226:227], v219 offset:6400
 v_cvt_pk_bf16_f32 v113, v210, v211
 v_mfma_f32_16x16x32_bf16 a[160:163], a[208:211], v[108:111], a[160:163]
 buffer_load_dwordx4 v226, s[16:19], s39 offen offset:3072 nt lds
 v_mfma_f32_16x16x32_bf16 a[20:23], a[212:215], v[96:99], a[20:23]
 ds_read_b64_tr_b16 a[228:229], v220 offset:256
 v_add_f32 v205, v212, v213
 v_mfma_f32_16x16x32_bf16 a[68:71], a[212:215], v[100:103], a[68:71]
 v_exp_f32 v165, v131
 v_mfma_f32_16x16x32_bf16 a[116:119], a[212:215], v[104:107], a[116:119]
 ds_read_b64_tr_b16 a[230:231], v220 offset:6400
 v_cvt_pk_bf16_f32 v116, v212, v213
 v_mfma_f32_16x16x32_bf16 a[164:167], a[212:215], v[108:111], a[164:167]
 v_add_f32 v205, v205, v164
 s_waitcnt lgkmcnt(4)
 v_mfma_f32_16x16x32_bf16 a[24:27], a[192:195], v[96:99], a[24:27]
 ds_read_b64_tr_b16 a[232:233], v221 offset:256
 v_add_f32 v205, v205, v165
 v_mfma_f32_16x16x32_bf16 a[72:75], a[192:195], v[100:103], a[72:75]
 v_exp_f32 v166, v132
 v_mfma_f32_16x16x32_bf16 a[120:123], a[192:195], v[104:107], a[120:123]
 ds_read_b64_tr_b16 a[234:235], v221 offset:6400
 v_cvt_pk_bf16_f32 v117, v164, v165
 v_mfma_f32_16x16x32_bf16 a[168:171], a[192:195], v[108:111], a[168:171]
 v_exp_f32 v167, v133
 v_mfma_f32_16x16x32_bf16 a[28:31], a[216:219], v[96:99], a[28:31]
 v_exp_f32 v208, v134
 v_mfma_f32_16x16x32_bf16 a[76:79], a[216:219], v[100:103], a[76:79]
 ds_read_b128 a[192:195], v214 offset:0
 v_add_f32 v206, v166, v167
 v_mfma_f32_16x16x32_bf16 a[124:127], a[216:219], v[104:107], a[124:127]
 ds_read_b128 a[196:199], v215 offset:0
 s_add_u32 m0, m0, 4096
 v_mfma_f32_16x16x32_bf16 a[172:175], a[216:219], v[108:111], a[172:175]
 buffer_load_dwordx4 v229, s[16:19], s39 offen nt lds
 v_mfma_f32_16x16x32_bf16 a[32:35], a[220:223], v[96:99], a[32:35]
 ds_read_b128 a[200:203], v214 offset:128
 v_cvt_pk_bf16_f32 v120, v166, v167
 v_mfma_f32_16x16x32_bf16 a[80:83], a[220:223], v[100:103], a[80:83]
 v_add_u32 v218, s59, v218
 v_add_u32 v219, s59, v219
 v_mfma_f32_16x16x32_bf16 a[128:131], a[220:223], v[104:107], a[128:131]
 ds_read_b128 a[204:207], v215 offset:128
 v_add_u32 v220, s59, v220
 v_mfma_f32_16x16x32_bf16 a[176:179], a[220:223], v[108:111], a[176:179]
 v_add_u32 v221, s59, v221
 s_waitcnt lgkmcnt(4)
 v_mfma_f32_16x16x32_bf16 a[36:39], a[224:227], v[96:99], a[36:39]
 ds_read_b128 a[208:211], v214 offset:256
 v_add_f32 v206, v206, v208
 v_mfma_f32_16x16x32_bf16 a[84:87], a[224:227], v[100:103], a[84:87]
 buffer_load_dwordx4 v230, s[16:19], s39 offen offset:1024 nt lds
 v_mfma_f32_16x16x32_bf16 a[132:135], a[224:227], v[104:107], a[132:135]
 ds_read_b128 a[212:215], v215 offset:256
 v_mfma_f32_16x16x32_bf16 a[180:183], a[224:227], v[108:111], a[180:183]
 s_mov_b64 s[84:85], s[58:59]
 s_mov_b64 s[58:59], s[60:61]
 v_mfma_f32_16x16x32_bf16 a[40:43], a[228:231], v[96:99], a[40:43]
 s_mov_b64 s[60:61], s[62:63]
 s_mov_b64 s[62:63], s[84:85]
 v_mfma_f32_16x16x32_bf16 a[88:91], a[228:231], v[100:103], a[88:91]
 v_exp_f32 v209, v135
 v_mfma_f32_16x16x32_bf16 a[136:139], a[228:231], v[104:107], a[136:139]
 v_exp_f32 v210, v136
 v_mfma_f32_16x16x32_bf16 a[184:187], a[228:231], v[108:111], a[184:187]
 v_exp_f32 v211, v137
 v_mfma_f32_16x16x32_bf16 a[44:47], a[232:235], v[96:99], a[44:47]
 v_exp_f32 v212, v138
 v_mfma_f32_16x16x32_bf16 a[92:95], a[232:235], v[100:103], a[92:95]
 v_exp_f32 v213, v139
 v_mfma_f32_16x16x32_bf16 a[140:143], a[232:235], v[104:107], a[140:143]
 s_cmp_lt_u32 s40, s87
 s_cselect_b32 m0, s3, 196608
 v_mfma_f32_16x16x32_bf16 a[188:191], a[232:235], v[108:111], a[188:191]
 s_waitcnt lgkmcnt(0)
 s_sub_u32 s86, s86, 1
 s_cbranch_scc0 K1_att
 v_mfma_f32_16x16x32_bf16 v[168:171], a[192:195], v[0:3], v[148:151]
 v_exp_f32 v164, v140
 v_mfma_f32_16x16x32_bf16 v[168:171], a[196:199], v[4:7], v[168:171]
 ds_read_b128 a[216:219], v214 offset:6144
 v_add_f32 v206, v206, v209
 v_mfma_f32_16x16x32_bf16 v[168:171], a[200:203], v[8:11], v[168:171]
 s_add_u32 s12, s12, 1536
 s_addc_u32 s13, s13, 0
 v_mfma_f32_16x16x32_bf16 v[168:171], a[204:207], v[12:15], v[168:171]
 ds_read_b128 a[220:223], v215 offset:6144
 s_mov_b32 s98, 0
 v_mfma_f32_16x16x32_bf16 v[168:171], a[208:211], v[16:19], v[168:171]
 s_cmp_eq_u32 s50, 0
 s_cselect_b32 s14, s54, 0
 v_mfma_f32_16x16x32_bf16 v[168:171], a[212:215], v[20:23], v[168:171]
 ds_read_b128 a[224:227], v214 offset:6272
 v_cvt_pk_bf16_f32 v121, v208, v209
 v_mfma_f32_16x16x32_bf16 v[172:175], a[192:195], v[24:27], v[152:155]
 s_cmp_eq_u32 s50, 0
 s_cselect_b32 s10, s10, 0
 v_mfma_f32_16x16x32_bf16 v[172:175], a[196:199], v[28:31], v[172:175]
 ds_read_b128 a[228:231], v215 offset:6272
 s_cmp_eq_u32 s50, 0
 s_cselect_b32 s32, s32, 163840
 s_cselect_b32 s33, s33, 163840
 v_mfma_f32_16x16x32_bf16 v[172:175], a[200:203], v[32:35], v[172:175]
 s_add_u32 s16, s16, 786432
 s_addc_u32 s17, s17, 0
 v_mfma_f32_16x16x32_bf16 v[172:175], a[204:207], v[36:39], v[172:175]
 ds_read_b128 a[232:235], v214 offset:6400
 v_add_f32 v204, v204, v210
 v_mfma_f32_16x16x32_bf16 v[172:175], a[208:211], v[40:43], v[172:175]
 s_add_u32 s20, s20, 786432
 s_addc_u32 s21, s21, 0
 v_mfma_f32_16x16x32_bf16 v[172:175], a[212:215], v[44:47], v[172:175]
 ds_read_b128 a[236:239], v215 offset:6400
 v_add_f32 v204, v204, v211
 v_mfma_f32_16x16x32_bf16 v[176:179], a[192:195], v[48:51], v[156:159]
 s_add_u32 m0, s32, 36864
 s_mov_b32 s38, 0
 v_mfma_f32_16x16x32_bf16 v[176:179], a[196:199], v[52:55], v[176:179]
 buffer_load_dwordx4 v239, s[12:15], s38 offen lds
 v_mfma_f32_16x16x32_bf16 v[176:179], a[200:203], v[56:59], v[176:179]
 v_exp_f32 v165, v141
 v_mfma_f32_16x16x32_bf16 v[176:179], a[204:207], v[60:63], v[176:179]
 v_exp_f32 v166, v142
 v_mfma_f32_16x16x32_bf16 v[176:179], a[208:211], v[64:67], v[176:179]
 ds_read_b64_tr_b16 a[240:241], v222 offset:0
 v_cvt_pk_bf16_f32 v114, v210, v211
 v_mfma_f32_16x16x32_bf16 v[176:179], a[212:215], v[68:71], v[176:179]
 v_exp_f32 v167, v143
 v_mfma_f32_16x16x32_bf16 v[180:183], a[192:195], v[72:75], v[160:163]
 ds_read_b64_tr_b16 a[242:243], v222 offset:6144
 v_add_f32 v204, v204, v212
 v_mfma_f32_16x16x32_bf16 v[180:183], a[196:199], v[76:79], v[180:183]
 v_exp_f32 v208, v144
 v_mfma_f32_16x16x32_bf16 v[180:183], a[200:203], v[80:83], v[180:183]
 ds_read_b64_tr_b16 a[192:193], v223 offset:0
 v_add_u32 v214, 0xffff4000, v214
 v_mfma_f32_16x16x32_bf16 v[180:183], a[204:207], v[84:87], v[180:183]
 buffer_load_dwordx4 v240, s[12:15], s38 offen offset:1024 lds
 v_mfma_f32_16x16x32_bf16 v[180:183], a[208:211], v[88:91], v[180:183]
 ds_read_b64_tr_b16 a[194:195], v223 offset:6144
 v_add_u32 v215, 0xffff4000, v215
 v_add_f32 v204, v204, v213
 v_cvt_pk_bf16_f32 v115, v212, v213
 v_add_f32 v205, v205, v164
 v_add_f32 v205, v205, v165
 v_cvt_pk_bf16_f32 v118, v164, v165
 v_add_f32 v205, v205, v166
 v_add_f32 v205, v205, v167
 v_cvt_pk_bf16_f32 v119, v166, v167
 v_exp_f32 v209, v145
 v_add_f32 v206, v206, v208
 v_add_f32 v206, v206, v209
 v_cvt_pk_bf16_f32 v122, v208, v209
 v_exp_f32 v210, v146
 v_exp_f32 v211, v147
 v_add_f32 v206, v206, v210
 v_add_f32 v206, v206, v211
 v_cvt_pk_bf16_f32 v123, v210, v211
 v_max3_f32 v208, v204, v205, v206
 v_cmp_lt_f32 vcc, 0x45800000, v208
 v_mfma_f32_16x16x32_bf16 v[180:183], a[212:215], v[92:95], v[180:183]
 s_waitcnt lgkmcnt(4)
 s_cbranch_vccnz K1_stub13
K1_back13:
 v_mfma_f32_16x16x32_bf16 v[184:187], a[216:219], v[0:3], v[148:151]
 ds_read_b64_tr_b16 a[196:197], v224 offset:0
 v_add_f32 v200, v200, v204
 v_mfma_f32_16x16x32_bf16 v[184:187], a[220:223], v[4:7], v[184:187]
 v_exp_f32 v208, v168
 v_mfma_f32_16x16x32_bf16 v[184:187], a[224:227], v[8:11], v[184:187]
 ds_read_b64_tr_b16 a[198:199], v224 offset:6144
 v_add_f32 v201, v201, v205
 v_mfma_f32_16x16x32_bf16 v[184:187], a[228:231], v[12:15], v[184:187]
 v_exp_f32 v209, v169
 v_mfma_f32_16x16x32_bf16 v[184:187], a[232:235], v[16:19], v[184:187]
 ds_read_b64_tr_b16 a[200:201], v225 offset:0
 v_add_f32 v202, v202, v206
 v_mfma_f32_16x16x32_bf16 v[184:187], a[236:239], v[20:23], v[184:187]
 buffer_load_dwordx4 v241, s[12:15], s38 offen offset:2048 lds
 v_mfma_f32_16x16x32_bf16 v[188:191], a[216:219], v[24:27], v[152:155]
 ds_read_b64_tr_b16 a[202:203], v225 offset:6144
 v_add_f32 v204, v208, v209
 v_mfma_f32_16x16x32_bf16 v[188:191], a[220:223], v[28:31], v[188:191]
 v_exp_f32 v210, v170
 v_mfma_f32_16x16x32_bf16 v[188:191], a[224:227], v[32:35], v[188:191]
 v_exp_f32 v211, v171
 v_mfma_f32_16x16x32_bf16 v[188:191], a[228:231], v[36:39], v[188:191]
 ds_read_b64_tr_b16 a[204:205], v222 offset:128
 v_cvt_pk_bf16_f32 v96, v208, v209
 v_mfma_f32_16x16x32_bf16 v[188:191], a[232:235], v[40:43], v[188:191]
 v_exp_f32 v212, v172
 v_mfma_f32_16x16x32_bf16 v[188:191], a[236:239], v[44:47], v[188:191]
 ds_read_b64_tr_b16 a[206:207], v222 offset:6272
 v_add_f32 v204, v204, v210
 v_mfma_f32_16x16x32_bf16 v[192:195], a[216:219], v[48:51], v[156:159]
 v_exp_f32 v213, v173
 v_mfma_f32_16x16x32_bf16 v[192:195], a[220:223], v[52:55], v[192:195]
 ds_read_b64_tr_b16 a[208:209], v223 offset:128
 v_add_f32 v204, v204, v211
 v_mfma_f32_16x16x32_bf16 v[192:195], a[224:227], v[56:59], v[192:195]
 s_add_u32 s37, s35, 0
 v_cvt_pk_bf16_f32 v97, v210, v211
 v_mfma_f32_16x16x32_bf16 v[192:195], a[228:231], v[60:63], v[192:195]
 ds_read_b64_tr_b16 a[210:211], v223 offset:6272
 s_add_u32 m0, s32, 0
 v_mfma_f32_16x16x32_bf16 v[192:195], a[232:235], v[64:67], v[192:195]
 buffer_load_dwordx4 v242, s[8:11], s37 offen lds
 v_mfma_f32_16x16x32_bf16 v[192:195], a[236:239], v[68:71], v[192:195]
 ds_read_b64_tr_b16 a[212:213], v224 offset:128
 v_add_f32 v205, v212, v213
 v_mfma_f32_16x16x32_bf16 v[196:199], a[216:219], v[72:75], v[160:163]
 v_exp_f32 v164, v174
 v_mfma_f32_16x16x32_bf16 v[196:199], a[220:223], v[76:79], v[196:199]
 ds_read_b64_tr_b16 a[214:215], v224 offset:6272
 v_cvt_pk_bf16_f32 v100, v212, v213
 v_mfma_f32_16x16x32_bf16 v[196:199], a[224:227], v[80:83], v[196:199]
 v_exp_f32 v165, v175
 v_mfma_f32_16x16x32_bf16 v[196:199], a[228:231], v[84:87], v[196:199]
 ds_read_b64_tr_b16 a[216:217], v225 offset:128
 v_add_f32 v205, v205, v164
 v_mfma_f32_16x16x32_bf16 v[196:199], a[232:235], v[88:91], v[196:199]
 v_exp_f32 v166, v176
 v_mfma_f32_16x16x32_bf16 v[196:199], a[236:239], v[92:95], v[196:199]
 ds_read_b64_tr_b16 a[218:219], v225 offset:6272
 s_waitcnt lgkmcnt(10)
 v_mfma_f32_16x16x32_bf16 a[0:3], a[240:243], v[112:115], a[0:3]
 buffer_load_dwordx4 v243, s[8:11], s37 offen offset:1024 lds
 v_mfma_f32_16x16x32_bf16 a[48:51], a[240:243], v[116:119], a[48:51]
 v_exp_f32 v167, v177
 v_mfma_f32_16x16x32_bf16 a[96:99], a[240:243], v[120:123], a[96:99]
 ds_read_b64_tr_b16 a[220:221], v222 offset:256
 v_add_f32 v205, v205, v165
 v_mfma_f32_16x16x32_bf16 a[4:7], a[192:195], v[112:115], a[4:7]
 v_exp_f32 v208, v178
 v_mfma_f32_16x16x32_bf16 a[52:55], a[192:195], v[116:119], a[52:55]
 ds_read_b64_tr_b16 a[222:223], v222 offset:6400
 v_cvt_pk_bf16_f32 v101, v164, v165
 v_mfma_f32_16x16x32_bf16 a[100:103], a[192:195], v[120:123], a[100:103]
 v_exp_f32 v209, v179
 v_mfma_f32_16x16x32_bf16 a[8:11], a[196:199], v[112:115], a[8:11]
 ds_read_b64_tr_b16 a[224:225], v223 offset:256
 v_add_f32 v206, v166, v167
 v_mfma_f32_16x16x32_bf16 a[56:59], a[196:199], v[116:119], a[56:59]
 buffer_load_dwordx4 v244, s[8:11], s37 offen offset:2048 lds
 v_mfma_f32_16x16x32_bf16 a[104:107], a[196:199], v[120:123], a[104:107]
 ds_read_b64_tr_b16 a[226:227], v223 offset:6400
 s_waitcnt lgkmcnt(8)
 v_mfma_f32_16x16x32_bf16 a[12:15], a[200:203], v[112:115], a[12:15]
 v_exp_f32 v210, v180
 v_mfma_f32_16x16x32_bf16 a[60:63], a[200:203], v[116:119], a[60:63]
 ds_read_b64_tr_b16 a[228:229], v224 offset:256
 v_cvt_pk_bf16_f32 v104, v166, v167
 v_mfma_f32_16x16x32_bf16 a[108:111], a[200:203], v[120:123], a[108:111]
 v_exp_f32 v211, v181
 v_mfma_f32_16x16x32_bf16 a[16:19], a[204:207], v[112:115], a[16:19]
 ds_read_b64_tr_b16 a[230:231], v224 offset:6400
 v_add_f32 v206, v206, v208
 v_mfma_f32_16x16x32_bf16 a[64:67], a[204:207], v[116:119], a[64:67]
 v_exp_f32 v212, v182
 v_mfma_f32_16x16x32_bf16 a[112:115], a[204:207], v[120:123], a[112:115]
 ds_read_b64_tr_b16 a[232:233], v225 offset:256
 v_add_f32 v206, v206, v209
 v_mfma_f32_16x16x32_bf16 a[20:23], a[208:211], v[112:115], a[20:23]
 v_exp_f32 v213, v183
 v_mfma_f32_16x16x32_bf16 a[68:71], a[208:211], v[116:119], a[68:71]
 ds_read_b64_tr_b16 a[234:235], v225 offset:6400
 s_add_u32 s37, s36, 0
 v_mfma_f32_16x16x32_bf16 a[116:119], a[208:211], v[120:123], a[116:119]
 s_add_u32 m0, s33, 12288
 s_waitcnt lgkmcnt(6)
 v_mfma_f32_16x16x32_bf16 a[24:27], a[212:215], v[112:115], a[24:27]
 buffer_load_dwordx4 v242, s[8:11], s37 offen lds
 v_mfma_f32_16x16x32_bf16 a[72:75], a[212:215], v[116:119], a[72:75]
 ds_read_b128 a[192:195], v216 offset:0
 v_cvt_pk_bf16_f32 v105, v208, v209
 v_mfma_f32_16x16x32_bf16 a[120:123], a[212:215], v[120:123], a[120:123]
 ds_read_b128 a[196:199], v217 offset:0
 v_add_f32 v207, v210, v211
 v_mfma_f32_16x16x32_bf16 a[28:31], a[216:219], v[112:115], a[28:31]
 v_exp_f32 v164, v184
 v_mfma_f32_16x16x32_bf16 a[76:79], a[216:219], v[116:119], a[76:79]
 ds_read_b128 a[200:203], v216 offset:128
 v_cvt_pk_bf16_f32 v108, v210, v211
 v_mfma_f32_16x16x32_bf16 a[124:127], a[216:219], v[120:123], a[124:127]
 v_exp_f32 v165, v185
 v_mfma_f32_16x16x32_bf16 a[32:35], a[220:223], v[112:115], a[32:35]
 ds_read_b128 a[204:207], v217 offset:128
 v_add_u32 v222, 0xffffa000, v222
 v_mfma_f32_16x16x32_bf16 a[80:83], a[220:223], v[116:119], a[80:83]
 ds_read_b128 a[208:211], v216 offset:256
 v_add_u32 v223, 0xffffa000, v223
 v_mfma_f32_16x16x32_bf16 a[128:131], a[220:223], v[120:123], a[128:131]
 v_add_u32 v224, 0xffffa000, v224
 s_waitcnt lgkmcnt(5)
 v_mfma_f32_16x16x32_bf16 a[36:39], a[224:227], v[112:115], a[36:39]
 ds_read_b128 a[212:215], v217 offset:256
 v_add_u32 v225, 0xffffa000, v225
 v_mfma_f32_16x16x32_bf16 a[84:87], a[224:227], v[116:119], a[84:87]
 buffer_load_dwordx4 v243, s[8:11], s37 offen offset:1024 lds
 v_mfma_f32_16x16x32_bf16 a[132:135], a[224:227], v[120:123], a[132:135]
 v_exp_f32 v166, v186
 v_mfma_f32_16x16x32_bf16 a[40:43], a[228:231], v[112:115], a[40:43]
 v_exp_f32 v167, v187
 v_mfma_f32_16x16x32_bf16 a[88:91], a[228:231], v[116:119], a[88:91]
 v_exp_f32 v208, v188
 v_mfma_f32_16x16x32_bf16 a[136:139], a[228:231], v[120:123], a[136:139]
 v_exp_f32 v209, v189
 v_mfma_f32_16x16x32_bf16 a[44:47], a[232:235], v[112:115], a[44:47]
 v_exp_f32 v210, v190
 v_mfma_f32_16x16x32_bf16 a[92:95], a[232:235], v[116:119], a[92:95]
 buffer_load_dwordx4 v244, s[8:11], s37 offen offset:2048 lds
 v_mfma_f32_16x16x32_bf16 a[140:143], a[232:235], v[120:123], a[140:143]
 v_add_f32 v207, v207, v212
 s_waitcnt lgkmcnt(0)
 v_mfma_f32_16x16x32_bf16 v[124:127], a[192:195], v[0:3], v[148:151]
 ds_read_b128 a[216:219], v216 offset:6144
 v_add_f32 v207, v207, v213
 v_mfma_f32_16x16x32_bf16 v[124:127], a[196:199], v[4:7], v[124:127]
 ds_read_b128 a[220:223], v217 offset:6144
 v_cvt_pk_bf16_f32 v109, v212, v213
 v_mfma_f32_16x16x32_bf16 v[124:127], a[200:203], v[8:11], v[124:127]
 v_exp_f32 v211, v191
 v_mfma_f32_16x16x32_bf16 v[124:127], a[204:207], v[12:15], v[124:127]
 ds_read_b128 a[224:227], v216 offset:6272
 v_add_f32 v204, v204, v164
 v_mfma_f32_16x16x32_bf16 v[124:127], a[208:211], v[16:19], v[124:127]
 ds_read_b128 a[228:231], v217 offset:6272
 v_add_f32 v204, v204, v165
 v_mfma_f32_16x16x32_bf16 v[124:127], a[212:215], v[20:23], v[124:127]
 v_exp_f32 v212, v192
 v_mfma_f32_16x16x32_bf16 v[128:131], a[192:195], v[24:27], v[152:155]
 ds_read_b128 a[232:235], v216 offset:6400
 v_cvt_pk_bf16_f32 v98, v164, v165
 v_mfma_f32_16x16x32_bf16 v[128:131], a[196:199], v[28:31], v[128:131]
 ds_read_b128 a[236:239], v217 offset:6400
 v_add_f32 v204, v204, v166
 v_mfma_f32_16x16x32_bf16 v[128:131], a[200:203], v[32:35], v[128:131]
 buffer_load_dwordx4 v245, s[8:11], s37 offen offset:3072 lds
 v_mfma_f32_16x16x32_bf16 v[128:131], a[204:207], v[36:39], v[128:131]
 v_exp_f32 v213, v193
 v_mfma_f32_16x16x32_bf16 v[128:131], a[208:211], v[40:43], v[128:131]
 v_exp_f32 v164, v194
 v_mfma_f32_16x16x32_bf16 v[128:131], a[212:215], v[44:47], v[128:131]
 v_exp_f32 v165, v195
 v_mfma_f32_16x16x32_bf16 v[132:135], a[192:195], v[48:51], v[156:159]
 v_add_f32 v204, v204, v167
 v_cvt_pk_bf16_f32 v99, v166, v167
 v_mfma_f32_16x16x32_bf16 v[132:135], a[196:199], v[52:55], v[132:135]
 v_exp_f32 v166, v196
 v_mfma_f32_16x16x32_bf16 v[132:135], a[200:203], v[56:59], v[132:135]
 v_add_u32 v216, 0xffff4000, v216
 v_add_u32 v217, 0xffff4000, v217
 v_mfma_f32_16x16x32_bf16 v[132:135], a[204:207], v[60:63], v[132:135]
 v_exp_f32 v167, v197
 v_mfma_f32_16x16x32_bf16 v[132:135], a[208:211], v[64:67], v[132:135]
 v_add_f32 v205, v205, v208
 v_add_f32 v205, v205, v209
 v_mfma_f32_16x16x32_bf16 v[132:135], a[212:215], v[68:71], v[132:135]
 v_cvt_pk_bf16_f32 v102, v208, v209
 s_waitcnt vmcnt(18) lgkmcnt(0)
 v_mfma_f32_16x16x32_bf16 v[136:139], a[216:219], v[0:3], v[148:151]
 v_add_f32 v205, v205, v210
 s_barrier
 v_mfma_f32_16x16x32_bf16 v[136:139], a[220:223], v[4:7], v[136:139]
 ds_read_b64_tr_b16 a[192:193], v218 offset:0
 v_add_f32 v205, v205, v211
 v_mfma_f32_16x16x32_bf16 v[136:139], a[224:227], v[8:11], v[136:139]
 ds_read_b64_tr_b16 a[194:195], v218 offset:6144
 v_cvt_pk_bf16_f32 v103, v210, v211
 v_mfma_f32_16x16x32_bf16 v[136:139], a[228:231], v[12:15], v[136:139]
 v_exp_f32 v208, v198
 v_mfma_f32_16x16x32_bf16 v[136:139], a[232:235], v[16:19], v[136:139]
 ds_read_b64_tr_b16 a[196:197], v219 offset:0
 v_add_f32 v206, v206, v212
 v_mfma_f32_16x16x32_bf16 v[136:139], a[236:239], v[20:23], v[136:139]
 v_exp_f32 v209, v199
 v_mfma_f32_16x16x32_bf16 v[140:143], a[216:219], v[24:27], v[152:155]
 ds_read_b64_tr_b16 a[198:199], v219 offset:6144
 v_add_f32 v206, v206, v213
 v_mfma_f32_16x16x32_bf16 v[140:143], a[220:223], v[28:31], v[140:143]
 v_cvt_pk_bf16_f32 v106, v212, v213
 v_add_f32 v206, v206, v164
 v_mfma_f32_16x16x32_bf16 v[140:143], a[224:227], v[32:35], v[140:143]
 ds_read_b64_tr_b16 a[200:201], v220 offset:0
 v_add_f32 v206, v206, v165
 v_mfma_f32_16x16x32_bf16 v[140:143], a[228:231], v[36:39], v[140:143]
 v_cvt_pk_bf16_f32 v107, v164, v165
 v_add_f32 v207, v207, v166
 v_mfma_f32_16x16x32_bf16 v[140:143], a[232:235], v[40:43], v[140:143]
 ds_read_b64_tr_b16 a[202:203], v220 offset:6144
 v_add_f32 v207, v207, v167
 v_mfma_f32_16x16x32_bf16 v[140:143], a[236:239], v[44:47], v[140:143]
 v_cvt_pk_bf16_f32 v110, v166, v167
 v_add_f32 v207, v207, v208
 v_mfma_f32_16x16x32_bf16 v[144:147], a[216:219], v[48:51], v[156:159]
 ds_read_b64_tr_b16 a[204:205], v221 offset:0
 v_add_f32 v207, v207, v209
 v_mfma_f32_16x16x32_bf16 v[144:147], a[220:223], v[52:55], v[144:147]
 v_cvt_pk_bf16_f32 v111, v208, v209
 v_max3_f32 v208, v204, v205, v206
 v_mfma_f32_16x16x32_bf16 v[144:147], a[224:227], v[56:59], v[144:147]
 ds_read_b64_tr_b16 a[206:207], v221 offset:6144
 v_max_f32 v208, v208, v207
 v_mfma_f32_16x16x32_bf16 v[144:147], a[228:231], v[60:63], v[144:147]
 v_cmp_lt_f32 vcc, 0x45800000, v208
 v_mfma_f32_16x16x32_bf16 v[144:147], a[232:235], v[64:67], v[144:147]
 ds_read_b64_tr_b16 a[208:209], v218 offset:128
 v_mfma_f32_16x16x32_bf16 v[144:147], a[236:239], v[68:71], v[144:147]
 ds_read_b64_tr_b16 a[210:211], v218 offset:6272
 s_waitcnt lgkmcnt(4)
 s_cbranch_vccnz K1_stub14
K1_back14:
 v_mfma_f32_16x16x32_bf16 a[0:3], a[192:195], v[96:99], a[0:3]
 v_mov_b32 v251, 0x7ff00000
 v_add_f32 v200, v200, v204
 v_mfma_f32_16x16x32_bf16 a[48:51], a[192:195], v[100:103], a[48:51]
 ds_read_b64_tr_b16 a[212:213], v219 offset:128
 v_or_b32 v34, s28, v246
 v_cmp_eq_u32 s[84:85], 0, v34
 v_mov_b32 v34, s101
 v_mov_b32 v35, s100
 v_cndmask_b32 v34, v251, v34, s[84:85]
 v_cndmask_b32 v35, v251, v35, s[84:85]
 v_mfma_f32_16x16x32_bf16 a[96:99], a[192:195], v[104:107], a[96:99]
 buffer_load_dword v32, v34, s[4:7], 0 offen sc1
 v_mfma_f32_16x16x32_bf16 a[144:147], a[192:195], v[108:111], a[144:147]
 ds_read_b64_tr_b16 a[214:215], v219 offset:6272
 v_add_f32 v201, v201, v205
 v_mfma_f32_16x16x32_bf16 a[4:7], a[196:199], v[96:99], a[4:7]
 buffer_load_dword v33, v35, s[4:7], 0 offen sc1
 v_mfma_f32_16x16x32_bf16 a[52:55], a[196:199], v[100:103], a[52:55]
 ds_read_b64_tr_b16 a[192:193], v220 offset:128
 s_add_u32 m0, s32, 49152
 s_mov_b32 s38, 393216
 v_mfma_f32_16x16x32_bf16 a[100:103], a[196:199], v[104:107], a[100:103]
 buffer_load_dwordx4 v239, s[12:15], s38 offen lds
 v_mfma_f32_16x16x32_bf16 a[148:151], a[196:199], v[108:111], a[148:151]
 ds_read_b64_tr_b16 a[194:195], v220 offset:6272
 v_add_f32 v202, v202, v206
 v_mfma_f32_16x16x32_bf16 a[8:11], a[200:203], v[96:99], a[8:11]
 v_exp_f32 v208, v124
 v_mfma_f32_16x16x32_bf16 a[56:59], a[200:203], v[100:103], a[56:59]
 ds_read_b64_tr_b16 a[216:217], v221 offset:128
 v_add_f32 v203, v203, v207
 v_mfma_f32_16x16x32_bf16 a[104:107], a[200:203], v[104:107], a[104:107]
 buffer_load_dwordx4 v240, s[12:15], s38 offen offset:1024 lds
 v_mfma_f32_16x16x32_bf16 a[152:155], a[200:203], v[108:111], a[152:155]
 ds_read_b64_tr_b16 a[218:219], v221 offset:6272
 s_waitcnt lgkmcnt(4)
 v_mfma_f32_16x16x32_bf16 a[12:15], a[204:207], v[96:99], a[12:15]
 v_exp_f32 v209, v125
 v_mfma_f32_16x16x32_bf16 a[60:63], a[204:207], v[100:103], a[60:63]
 ds_read_b64_tr_b16 a[220:221], v218 offset:256
 v_mov_b32 v252, v160
 v_mfma_f32_16x16x32_bf16 a[108:111], a[204:207], v[104:107], a[108:111]
 ds_read_b64_tr_b16 a[222:223], v218 offset:6400
 v_add_f32 v204, v208, v209
 v_mfma_f32_16x16x32_bf16 a[156:159], a[204:207], v[108:111], a[156:159]
 buffer_load_dwordx4 v241, s[12:15], s38 offen offset:2048 lds
 v_mfma_f32_16x16x32_bf16 a[16:19], a[208:211], v[96:99], a[16:19]
 ds_read_b64_tr_b16 a[224:225], v219 offset:256
 v_cvt_pk_bf16_f32 v112, v208, v209
 v_mfma_f32_16x16x32_bf16 a[64:67], a[208:211], v[100:103], a[64:67]
 s_mov_b32 s38, 786432
 v_mfma_f32_16x16x32_bf16 a[112:115], a[208:211], v[104:107], a[112:115]
 ds_read_b64_tr_b16 a[226:227], v219 offset:6400
 s_add_u32 m0, s32, 61440
 v_mfma_f32_16x16x32_bf16 a[160:163], a[208:211], v[108:111], a[160:163]
 buffer_load_dwordx4 v239, s[12:15], s38 offen lds
 v_mfma_f32_16x16x32_bf16 a[20:23], a[212:215], v[96:99], a[20:23]
 ds_read_b64_tr_b16 a[228:229], v220 offset:256
 v_mfma_f32_16x16x32_bf16 a[68:71], a[212:215], v[100:103], a[68:71]
 v_exp_f32 v210, v126
 v_mfma_f32_16x16x32_bf16 a[116:119], a[212:215], v[104:107], a[116:119]
 ds_read_b64_tr_b16 a[230:231], v220 offset:6400
 v_add_f32 v204, v204, v210
 v_mfma_f32_16x16x32_bf16 a[164:167], a[212:215], v[108:111], a[164:167]
 s_waitcnt lgkmcnt(4)
 v_mfma_f32_16x16x32_bf16 a[24:27], a[192:195], v[96:99], a[24:27]
 ds_read_b64_tr_b16 a[232:233], v221 offset:256
 v_mfma_f32_16x16x32_bf16 a[72:75], a[192:195], v[100:103], a[72:75]
 buffer_load_dwordx4 v240, s[12:15], s38 offen offset:1024 lds
 v_mfma_f32_16x16x32_bf16 a[120:123], a[192:195], v[104:107], a[120:123]
 ds_read_b64_tr_b16 a[234:235], v221 offset:6400
 v_mfma_f32_16x16x32_bf16 a[168:171], a[192:195], v[108:111], a[168:171]
 buffer_load_dwordx4 v241, s[12:15], s38 offen offset:2048 lds
 v_mfma_f32_16x16x32_bf16 a[28:31], a[216:219], v[96:99], a[28:31]
 ds_read_b64_tr_b16 a[240:241], v222 offset:0
 s_cmp_eq_u32 s50, 0
 s_cselect_b32 s32, s32, 49152
 s_cselect_b32 s33, s33, 49152
 v_mfma_f32_16x16x32_bf16 a[76:79], a[216:219], v[100:103], a[76:79]
 ds_read_b64_tr_b16 a[242:243], v222 offset:6144
 s_add_u32 s37, s35, 128
 v_mfma_f32_16x16x32_bf16 a[124:127], a[216:219], v[104:107], a[124:127]
 ds_read_b64_tr_b16 a[192:193], v223 offset:0
 s_add_u32 m0, s32, 135168
 v_mfma_f32_16x16x32_bf16 a[172:175], a[216:219], v[108:111], a[172:175]
 buffer_load_dwordx4 v242, s[8:11], s37 offen lds
 v_mfma_f32_16x16x32_bf16 a[32:35], a[220:223], v[96:99], a[32:35]
 ds_read_b64_tr_b16 a[194:195], v223 offset:6144
 v_mfma_f32_16x16x32_bf16 a[80:83], a[220:223], v[100:103], a[80:83]
 ds_read_b64_tr_b16 a[196:197], v224 offset:0
 v_add_u32 v218, 0x6000, v218
 v_mfma_f32_16x16x32_bf16 a[128:131], a[220:223], v[104:107], a[128:131]
 buffer_load_dwordx4 v243, s[8:11], s37 offen offset:1024 lds
 v_mfma_f32_16x16x32_bf16 a[176:179], a[220:223], v[108:111], a[176:179]
 ds_read_b64_tr_b16 a[198:199], v224 offset:6144
 s_waitcnt lgkmcnt(6)
 v_mfma_f32_16x16x32_bf16 a[36:39], a[224:227], v[96:99], a[36:39]
 ds_read_b64_tr_b16 a[200:201], v225 offset:0
 v_add_u32 v219, 0x6000, v219
 v_mfma_f32_16x16x32_bf16 a[84:87], a[224:227], v[100:103], a[84:87]
 v_add_u32 v220, 0x6000, v220
 v_add_u32 v221, 0x6000, v221
 v_mfma_f32_16x16x32_bf16 a[132:135], a[224:227], v[104:107], a[132:135]
 ds_read_b64_tr_b16 a[202:203], v225 offset:6144
 v_mfma_f32_16x16x32_bf16 a[180:183], a[224:227], v[108:111], a[180:183]
 ds_read_b64_tr_b16 a[204:205], v222 offset:128
 v_mfma_f32_16x16x32_bf16 a[40:43], a[228:231], v[96:99], a[40:43]
 buffer_load_dwordx4 v244, s[8:11], s37 offen offset:2048 lds
 v_mfma_f32_16x16x32_bf16 a[88:91], a[228:231], v[100:103], a[88:91]
 ds_read_b64_tr_b16 a[206:207], v222 offset:6272
 v_mfma_f32_16x16x32_bf16 a[136:139], a[228:231], v[104:107], a[136:139]
 ds_read_b64_tr_b16 a[208:209], v223 offset:128
 v_mfma_f32_16x16x32_bf16 a[184:187], a[228:231], v[108:111], a[184:187]
 v_exp_f32 v211, v127
 v_mfma_f32_16x16x32_bf16 a[44:47], a[232:235], v[96:99], a[44:47]
 ds_read_b64_tr_b16 a[210:211], v223 offset:6272
 v_add_f32 v204, v204, v211
 v_mfma_f32_16x16x32_bf16 a[92:95], a[232:235], v[100:103], a[92:95]
 ds_read_b64_tr_b16 a[212:213], v224 offset:128
 v_cvt_pk_bf16_f32 v113, v210, v211
 v_mfma_f32_16x16x32_bf16 a[140:143], a[232:235], v[104:107], a[140:143]
 ds_read_b64_tr_b16 a[214:215], v224 offset:6272
 v_exp_f32 v212, v128
 v_exp_f32 v213, v129
 s_nop 0
 v_add_f32 v205, v212, v213
 v_cvt_pk_bf16_f32 v116, v212, v213
 v_exp_f32 v164, v130
 v_exp_f32 v165, v131
 v_add_f32 v205, v205, v164
 v_add_f32 v205, v205, v165
 v_cvt_pk_bf16_f32 v117, v164, v165
 v_exp_f32 v166, v132
 v_exp_f32 v167, v133
 s_nop 0
 v_add_f32 v206, v166, v167
 v_cvt_pk_bf16_f32 v120, v166, v167
 v_exp_f32 v208, v134
 v_exp_f32 v209, v135
 v_add_f32 v206, v206, v208
 v_add_f32 v206, v206, v209
 v_cvt_pk_bf16_f32 v121, v208, v209
 v_exp_f32 v210, v136
 v_exp_f32 v211, v137
 v_add_f32 v204, v204, v210
 v_add_f32 v204, v204, v211
 v_cvt_pk_bf16_f32 v114, v210, v211
 v_exp_f32 v212, v138
 v_exp_f32 v213, v139
 v_add_f32 v204, v204, v212
 v_add_f32 v204, v204, v213
 v_cvt_pk_bf16_f32 v115, v212, v213
 v_exp_f32 v164, v140
 v_exp_f32 v165, v141
 v_add_f32 v205, v205, v164
 v_add_f32 v205, v205, v165
 v_cvt_pk_bf16_f32 v118, v164, v165
 v_exp_f32 v166, v142
 v_exp_f32 v167, v143
 v_add_f32 v205, v205, v166
 v_add_f32 v205, v205, v167
 v_cvt_pk_bf16_f32 v119, v166, v167
 v_exp_f32 v208, v144
 v_exp_f32 v209, v145
 v_add_f32 v206, v206, v208
 v_add_f32 v206, v206, v209
 v_cvt_pk_bf16_f32 v122, v208, v209
 v_exp_f32 v210, v146
 v_exp_f32 v211, v147
 v_add_f32 v206, v206, v210
 v_add_f32 v206, v206, v211
 v_cvt_pk_bf16_f32 v123, v210, v211
 v_max3_f32 v208, v204, v205, v206
 v_cmp_lt_f32 vcc, 0x45800000, v208
 v_mfma_f32_16x16x32_bf16 a[188:191], a[232:235], v[108:111], a[188:191]
 s_waitcnt lgkmcnt(8)
 s_cbranch_vccnz K1_stub15
K1_back15:
 v_mfma_f32_16x16x32_bf16 a[0:3], a[240:243], v[112:115], a[0:3]
 ds_read_b64_tr_b16 a[216:217], v225 offset:128
 s_add_u32 s37, s36, 128
 v_mfma_f32_16x16x32_bf16 a[48:51], a[240:243], v[116:119], a[48:51]
 ds_read_b64_tr_b16 a[218:219], v225 offset:6272
 s_add_u32 m0, s33, 147456
 v_mfma_f32_16x16x32_bf16 a[96:99], a[240:243], v[120:123], a[96:99]
 buffer_load_dwordx4 v242, s[8:11], s37 offen lds
 v_mfma_f32_16x16x32_bf16 a[4:7], a[192:195], v[112:115], a[4:7]
 ds_read_b64_tr_b16 a[220:221], v222 offset:256
 v_add_f32 v200, v200, v204
 v_mfma_f32_16x16x32_bf16 a[52:55], a[192:195], v[116:119], a[52:55]
 ds_read_b64_tr_b16 a[222:223], v222 offset:6400
 v_add_f32 v201, v201, v205
 v_mfma_f32_16x16x32_bf16 a[100:103], a[192:195], v[120:123], a[100:103]
 buffer_load_dwordx4 v243, s[8:11], s37 offen offset:1024 lds
 v_mfma_f32_16x16x32_bf16 a[8:11], a[196:199], v[112:115], a[8:11]
 ds_read_b64_tr_b16 a[224:225], v223 offset:256
 v_add_f32 v202, v202, v206
 v_mfma_f32_16x16x32_bf16 a[56:59], a[196:199], v[116:119], a[56:59]
 ds_read_b64_tr_b16 a[226:227], v223 offset:6400
 v_mov_b32 v254, v203
 v_mfma_f32_16x16x32_bf16 a[104:107], a[196:199], v[120:123], a[104:107]
 s_nop 0
 v_permlane16_swap_b32 v254, v203
 s_waitcnt lgkmcnt(8)
 v_mfma_f32_16x16x32_bf16 a[12:15], a[200:203], v[112:115], a[12:15]
 ds_read_b64_tr_b16 a[228:229], v224 offset:256
 v_add_f32 v203, v203, v254
 v_mfma_f32_16x16x32_bf16 a[60:63], a[200:203], v[116:119], a[60:63]
 ds_read_b64_tr_b16 a[230:231], v224 offset:6400
 v_mov_b32 v254, v203
 v_mfma_f32_16x16x32_bf16 a[108:111], a[200:203], v[120:123], a[108:111]
 buffer_load_dwordx4 v244, s[8:11], s37 offen offset:2048 lds
 v_mfma_f32_16x16x32_bf16 a[16:19], a[204:207], v[112:115], a[16:19]
 ds_read_b64_tr_b16 a[232:233], v225 offset:256
 v_permlane32_swap_b32 v254, v203
 v_mfma_f32_16x16x32_bf16 a[64:67], a[204:207], v[116:119], a[64:67]
 ds_read_b64_tr_b16 a[234:235], v225 offset:6400
 v_add_f32 v203, v203, v254
 v_mfma_f32_16x16x32_bf16 a[112:115], a[204:207], v[120:123], a[112:115]
 buffer_load_dwordx4 v245, s[8:11], s37 offen offset:3072 lds
 v_mov_b32 v253, v203
 ds_write_b64 v247, v[252:253] offset:0
 ds_write_b128 v247, a[152:155] offset:1024
 ds_write_b128 v247, a[156:159] offset:2048
 ds_write_b128 v249, a[168:171] offset:0
 ds_write_b128 v249, a[172:175] offset:1024
 v_mfma_f32_16x16x32_bf16 a[20:23], a[208:211], v[112:115], a[20:23]
 v_subrev_u32 v207, 106496, v235
 v_subrev_u32 v212, 106496, v236
 v_mfma_f32_16x16x32_bf16 a[68:71], a[208:211], v[116:119], a[68:71]
 v_subrev_u32 v213, 106496, v237
 v_subrev_u32 v171, 106496, v238
 v_mfma_f32_16x16x32_bf16 a[116:119], a[208:211], v[120:123], a[116:119]
 s_mov_b32 s26, 86016
 s_waitcnt lgkmcnt(11)
 v_mfma_f32_16x16x32_bf16 a[24:27], a[212:215], v[112:115], a[24:27]
 s_add_u32 s24, s24, 344064
 s_addc_u32 s25, s25, 0
 v_mfma_f32_16x16x32_bf16 a[72:75], a[212:215], v[116:119], a[72:75]
 s_mov_b32 s6, 256
 s_waitcnt vmcnt(15) lgkmcnt(0)
 v_mfma_f32_16x16x32_bf16 a[120:123], a[212:215], v[120:123], a[120:123]
 s_barrier
 v_mfma_f32_16x16x32_bf16 a[28:31], a[216:219], v[112:115], a[28:31]
 ds_read_b64_tr_b16 a[192:193], v231 offset:12288
 v_mfma_f32_16x16x32_bf16 a[76:79], a[216:219], v[116:119], a[76:79]
 ds_read_b128 a[196:199], v207 offset:0
 v_add_u32 v222, 0x6000, v222
 v_mfma_f32_16x16x32_bf16 a[124:127], a[216:219], v[120:123], a[124:127]
 ds_read_b64_tr_b16 a[194:195], v231 offset:13824
 v_add_u32 v223, 0x6000, v223
 v_mfma_f32_16x16x32_bf16 a[32:35], a[220:223], v[112:115], a[32:35]
 ds_read_b128 a[200:203], v207 offset:2048
 v_add_u32 v224, 0x6000, v224
 v_mfma_f32_16x16x32_bf16 a[80:83], a[220:223], v[116:119], a[80:83]
 ds_read_b128 a[204:207], v207 offset:4096
 v_add_u32 v225, 0x6000, v225
 v_mfma_f32_16x16x32_bf16 a[128:131], a[220:223], v[120:123], a[128:131]
 ds_read_b128 a[208:211], v213 offset:0
 v_mfma_f32_16x16x32_bf16 a[36:39], a[224:227], v[112:115], a[36:39]
 ds_read_b64_tr_b16 a[212:213], v232 offset:12288
 v_mfma_f32_16x16x32_bf16 a[84:87], a[224:227], v[116:119], a[84:87]
 v_mfma_f32_16x16x32_bf16 a[132:135], a[224:227], v[120:123], a[132:135]
 ds_read_b64_tr_b16 a[214:215], v232 offset:13824
 v_mfma_f32_16x16x32_bf16 a[40:43], a[228:231], v[112:115], a[40:43]
 ds_read_b64_tr_b16 a[216:217], v233 offset:12288
 v_mfma_f32_16x16x32_bf16 a[88:91], a[228:231], v[116:119], a[88:91]
 ds_read_b64_tr_b16 a[218:219], v233 offset:13824
 v_mfma_f32_16x16x32_bf16 a[136:139], a[228:231], v[120:123], a[136:139]
 ds_read_b64_tr_b16 a[220:221], v234 offset:12288
 v_mfma_f32_16x16x32_bf16 a[44:47], a[232:235], v[112:115], a[44:47]
 ds_read_b64_tr_b16 a[222:223], v234 offset:13824
 v_mfma_f32_16x16x32_bf16 a[92:95], a[232:235], v[116:119], a[92:95]
 ds_read_b64_tr_b16 a[224:225], v231 offset:12416
 v_mfma_f32_16x16x32_bf16 a[140:143], a[232:235], v[120:123], a[140:143]
 s_waitcnt lgkmcnt(7)
 s_add_u32 s50, s50, 1
 s_cmp_lt_u32 s50, 2
 s_cbranch_scc1 K1_pre
K1_fin:
 s_nop 7
 v_add_u32 v170, 69632, v249
 ds_write_b128 v170, a[184:187] offset:0
 ds_write_b128 v170, a[188:191] offset:1024
 ds_read_b64 v[254:255], v248 offset:0
 ds_read_b128 v[40:43], v248 offset:1024
 ds_read_b128 v[44:47], v248 offset:2048
 ds_read_b128 v[48:51], v250 offset:0
 ds_read_b128 v[52:55], v250 offset:1024
 v_lshrrev_b32 v0, 4, v246
 v_mov_b32 v1, 0x7ff00000
 v_mov_b32 v158, s101
 v_or_b32 v163, s28, v0
 v_cmp_eq_u32 vcc, 0, v163
 v_mov_b32 v160, 1
 s_and_b32 s65, s2, 7
 v_cndmask_b32 v158, v1, v158, vcc
 s_cmp_eq_u32 s28, 0
 s_cselect_b32 s64, 4, 0
 s_lshr_b32 s63, s2, 3
 s_lshr_b32 s60, s65, 2
 s_and_b32 s61, s65, 3
 s_and_b32 s62, s63, 7
 s_lshr_b32 s63, s63, 3
 s_lshl_b32 s68, s60, 3
 s_add_u32 s68, s68, s62
 s_lshl_b32 s70, s68, 2
 s_add_u32 s70, s70, s63
 s_lshl_b32 s76, s70, 2
 v_mov_b32 v161, s76
 v_cndmask_b32 v161, v1, v161, vcc
 s_mul_i32 s29, s28, 7168
 s_mul_i32 s30, s28, 5120
 s_mov_b32 s31, s29
 s_mul_i32 s32, s28, 20480
 s_mov_b32 s40, s32
 v_add_u32 v16, 0, v0
 v_mul_u32_u24 v17, 3277, v16
 v_lshrrev_b32 v17, 16, v17
 v_mul_u32_u24 v18, 20, v17
 v_sub_u32 v18, v16, v18
 v_bfe_u32 v19, v17, 2, 1
 v_lshlrev_b32 v19, 1, v19
 v_xor_b32 v18, v18, v19
 v_lshlrev_b32 v18, 4, v18
 v_mul_u32_u24 v17, 1280, v17
 v_add_u32 v18, v18, v17
 v_subrev_u32 v11, 0, v18
 v_add_u32 v16, 64, v0
 v_mul_u32_u24 v17, 3277, v16
 v_lshrrev_b32 v17, 16, v17
 v_mul_u32_u24 v18, 20, v17
 v_sub_u32 v18, v16, v18
 v_bfe_u32 v19, v17, 2, 1
 v_lshlrev_b32 v19, 1, v19
 v_xor_b32 v18, v18, v19
 v_lshlrev_b32 v18, 4, v18
 v_mul_u32_u24 v17, 1280, v17
 v_add_u32 v18, v18, v17
 v_subrev_u32 v12, 1024, v18
 v_add_u32 v16, 128, v0
 v_mul_u32_u24 v17, 3277, v16
 v_lshrrev_b32 v17, 16, v17
 v_mul_u32_u24 v18, 20, v17
 v_sub_u32 v18, v16, v18
 v_bfe_u32 v19, v17, 2, 1
 v_lshlrev_b32 v19, 1, v19
 v_xor_b32 v18, v18, v19
 v_lshlrev_b32 v18, 4, v18
 v_mul_u32_u24 v17, 1280, v17
 v_add_u32 v18, v18, v17
 v_subrev_u32 v13, 2048, v18
 v_add_u32 v16, 192, v0
 v_mul_u32_u24 v17, 3277, v16
 v_lshrrev_b32 v17, 16, v17
 v_mul_u32_u24 v18, 20, v17
 v_sub_u32 v18, v16, v18
 v_bfe_u32 v19, v17, 2, 1
 v_lshlrev_b32 v19, 1, v19
 v_xor_b32 v18, v18, v19
 v_lshlrev_b32 v18, 4, v18
 v_mul_u32_u24 v17, 1280, v17
 v_add_u32 v18, v18, v17
 v_subrev_u32 v14, 3072, v18
 v_add_u32 v16, 256, v0
 v_mul_u32_u24 v17, 3277, v16
 v_lshrrev_b32 v17, 16, v17
 v_mul_u32_u24 v18, 20, v17
 v_sub_u32 v18, v16, v18
 v_bfe_u32 v19, v17, 2, 1
 v_lshlrev_b32 v19, 1, v19
 v_xor_b32 v18, v18, v19
 v_lshlrev_b32 v18, 4, v18
 v_mul_u32_u24 v17, 1280, v17
 v_add_u32 v18, v18, v17
 v_subrev_u32 v15, 0, v18
 s_mul_i32 s76, s68, 2752512
 s_mul_i32 s77, s61, 688128
 s_add_u32 s76, s76, s77
 s_add_u32 s76, s76, 1048576
 s_mul_i32 s69, s61, 1966080
 s_mul_i32 s77, s63, 320
 s_add_u32 s69, s69, s77
 s_add_u32 s8, s82, s76
 s_addc_u32 s9, s83, 0
 s_mov_b32 s10, 688128
 s_mov_b32 s11, 0x20000
 s_add_u32 s12, s78, s69
 s_addc_u32 s13, s79, 0
 s_sub_u32 s14, 1966080, s77
 s_mov_b32 s15, 0x20000
 s_waitcnt vmcnt(13)
 v_readfirstlane_b32 s35, v32
 s_and_b32 s35, s35, 0x10000ff
 s_mul_i32 s71, s64, 0x400001
 s_cmp_lt_u32 s35, s71
 s_cbranch_scc1 P_spin1
P_back1:
 v_mov_b32 v159, 4
 v_readfirstlane_b32 s35, v33
 s_lshr_b32 s35, s35, 22
 s_cmp_lt_u32 s35, s64
 s_cbranch_scc1 P_spin3
P_back3:
 s_waitcnt lgkmcnt(0)
 s_barrier
 s_add_u32 m0, s29, 0
 s_nop 0
 buffer_load_dwordx4 v246, s[8:11], s31 offen sc1 lds
 buffer_load_dwordx4 v246, s[8:11], s31 offen offset:1024 sc1 lds
 buffer_load_dwordx4 v246, s[8:11], s31 offen offset:2048 sc1 lds
 buffer_load_dwordx4 v246, s[8:11], s31 offen offset:3072 sc1 lds
 s_add_u32 m0, s29, 4096
 s_add_u32 s34, s31, 4096
 buffer_load_dwordx4 v246, s[8:11], s34 offen sc1 lds
 buffer_load_dwordx4 v246, s[8:11], s34 offen offset:1024 sc1 lds
 buffer_load_dwordx4 v246, s[8:11], s34 offen offset:2048 sc1 lds
 s_add_u32 m0, s30, 28672
 s_nop 0
 buffer_load_dwordx4 v11, s[12:15], s32 offen lds
 buffer_load_dwordx4 v12, s[12:15], s32 offen offset:1024 lds
 buffer_load_dwordx4 v13, s[12:15], s32 offen offset:2048 lds
 buffer_load_dwordx4 v14, s[12:15], s32 offen offset:3072 lds
 s_add_u32 m0, s30, 32768
 s_nop 0
 buffer_load_dwordx4 v15, s[12:15], s32 offen lds
 s_add_u32 s31, s31, 28672
 s_add_u32 s32, s32, 81920
 v_add_u32 v170, 69632, v250
 ds_read_b128 v[56:59], v170 offset:0
 ds_read_b128 v[60:63], v170 offset:1024
 s_add_u32 m0, s29, 49152
 s_nop 0
 buffer_load_dwordx4 v246, s[8:11], s31 offen sc1 lds
 s_add_u32 s36, s29, 344064
 s_mul_i32 s38, s63, 86016
 s_add_u32 s38, s38, s36
 s_add_u32 s37, s40, 983040
 s_mul_i32 s39, s63, 245760
 s_add_u32 s39, s39, s37
 s_lshr_b32 s74, s28, 1
 s_and_b32 s75, s28, 1
 s_mul_i32 s76, s74, 7168
 s_add_u32 s77, s76, 0
 v_add_u32 v2, s77, v246
 s_add_u32 s77, s76, 49152
 v_add_u32 v3, s77, v246
 buffer_load_dwordx4 v246, s[8:11], s31 offen offset:1024 sc1 lds
 s_add_u32 s77, s76, 98304
 v_add_u32 v4, s77, v246
 v_lshrrev_b32 v17, 4, v0
 v_bfe_u32 v18, v0, 2, 2
 v_and_b32 v19, 3, v0
 v_lshlrev_b32 v20, 2, v17
 v_add_u32 v20, v20, v18
 v_mul_u32_u24 v20, 320, v20
 v_lshlrev_b32 v19, 3, v19
 v_add_u32 v20, v20, v19
 v_and_b32 v21, 1, v17
 v_lshlrev_b32 v21, 5, v21
 v_add_u32 v22, v20, v21
 v_sub_u32 v23, v20, v21
 buffer_load_dwordx4 v246, s[8:11], s31 offen offset:2048 sc1 lds
 s_cmp_eq_u32 s75, 0
 s_cselect_b64 vcc, -1, 0
 v_cndmask_b32 v24, v23, v22, vcc
 v_cndmask_b32 v25, v22, v23, vcc
 s_mul_i32 s76, s75, 160
 s_add_u32 s77, s76, 28672
 v_add_u32 v5, s77, v24
 v_add_u32 v6, s77, v25
 s_add_u32 s77, s76, 77824
 v_add_u32 v7, s77, v24
 v_add_u32 v8, s77, v25
 s_add_u32 s77, s76, 126976
 v_add_u32 v9, s77, v24
 v_add_u32 v10, s77, v25
 buffer_load_dwordx4 v246, s[8:11], s31 offen offset:3072 sc1 lds
 v_and_b32 v16, 15, v0
 v_mul_u32_u24 v16, 2560, v16
 v_lshlrev_b32 v18, 3, v17
 v_add_u32 v156, v16, v18
 v_lshrrev_b32 v17, 1, v17
 v_lshlrev_b32 v17, 4, v17
 v_add3_u32 v157, v16, v17, v21
 s_add_u32 s96, s82, 524288
 s_addc_u32 s97, s83, 0
 s_mov_b32 s98, 16384
 s_mov_b32 s99, 0x20000
 v_cmp_gt_u32 vcc, 256, v158
 v_lshl_add_u32 v158, v158, 6, 4
 v_lshlrev_b32 v161, 6, v161
 v_cndmask_b32 v158, v1, v158, vcc
 v_cndmask_b32 v161, v1, v161, vcc
 s_add_u32 m0, s29, 53248
 s_add_u32 s34, s31, 4096
 buffer_load_dwordx4 v246, s[8:11], s34 offen sc1 lds
 v_mov_b32 v163, v158
 v_add_u32 v162, 4096, v246
 s_mov_b32 s76, s70
 s_lshl_b32 s76, s76, 2
 s_add_u32 s76, s76, s28
 s_mul_i32 s76, s76, 81920
 s_add_u32 s76, s76, 67108864
 s_add_u32 s16, s82, s76
 s_addc_u32 s17, s83, 0
 s_mov_b32 s18, 81920
 s_mov_b32 s19, 0x20000
 s_mul_i32 s76, s62, 224
 buffer_load_dwordx4 v246, s[8:11], s34 offen offset:1024 sc1 lds
 s_mul_i32 s77, s74, 112
 s_add_u32 s76, s76, s77
 s_mul_i32 s76, s76, 2560
 s_mul_i32 s77, s60, 1280
 s_add_u32 s76, s76, s77
 s_mul_i32 s77, s63, 320
 s_add_u32 s76, s76, s77
 s_mul_i32 s77, s75, 160
 s_add_u32 s76, s76, s77
 s_add_u32 s20, s80, s76
 s_addc_u32 s21, s81, 0
 s_sub_u32 s22, 4587520, s76
 s_mov_b32 s23, 0x20000
 s_sub_u32 s65, s61, s28
 buffer_load_dwordx4 v246, s[8:11], s34 offen offset:2048 sc1 lds
 s_and_b32 s65, s65, 3
 s_mul_i32 s77, s61, 5120
 s_add_u32 s76, s77, 0
 s_cmp_eq_u32 s65, 0
 s_cselect_b32 s52, 0x7ff00000, s76
 s_add_u32 s76, s77, 20480
 s_cmp_eq_u32 s65, 1
 s_cselect_b32 s53, 0x7ff00000, s76
 s_add_u32 s76, s77, 40960
 s_cmp_eq_u32 s65, 2
 s_cselect_b32 s54, 0x7ff00000, s76
 s_add_u32 s76, s77, 61440
 s_cmp_eq_u32 s65, 3
 s_cselect_b32 s55, 0x7ff00000, s76
 s_add_u32 m0, s30, 77824
 s_nop 0
 buffer_load_dwordx4 v11, s[12:15], s32 offen lds
 s_mov_b32 s33, 1
 v_min_f32 v168, v252, v254
 v_sub_f32 v252, v168, v252
 v_sub_f32 v254, v168, v254
 v_exp_f32 v252, v252
 v_exp_f32 v254, v254
 v_mul_f32 v169, v253, v252
 v_fmac_f32 v169, v255, v254
 v_rcp_f32 v169, v169
 s_nop 0
 v_mul_f32 v252, v252, v169
 v_mul_f32 v253, v254, v169
 v_accvgpr_read_b32 v172, a144
 v_accvgpr_read_b32 v173, a145
 buffer_load_dwordx4 v12, s[12:15], s32 offen offset:1024 lds
 v_accvgpr_read_b32 v174, a146
 v_accvgpr_read_b32 v175, a147
 v_accvgpr_read_b32 v176, a148
 v_accvgpr_read_b32 v177, a149
 v_accvgpr_read_b32 v178, a150
 v_accvgpr_read_b32 v179, a151
 v_mul_f32 v172, v172, v252
 v_fmac_f32 v172, v40, v253
 v_mul_f32 v173, v173, v252
 v_fmac_f32 v173, v41, v253
 v_mul_f32 v174, v174, v252
 v_fmac_f32 v174, v42, v253
 v_mul_f32 v175, v175, v252
 v_fmac_f32 v175, v43, v253
 buffer_load_dwordx4 v13, s[12:15], s32 offen offset:2048 lds
 v_mul_f32 v176, v176, v252
 v_fmac_f32 v176, v44, v253
 v_mul_f32 v177, v177, v252
 v_fmac_f32 v177, v45, v253
 v_mul_f32 v178, v178, v252
 v_fmac_f32 v178, v46, v253
 v_mul_f32 v179, v179, v252
 v_fmac_f32 v179, v47, v253
 v_cvt_pk_bf16_f32 v180, v172, v173
 v_cvt_pk_bf16_f32 v181, v174, v175
 v_cvt_pk_bf16_f32 v182, v176, v177
 v_cvt_pk_bf16_f32 v183, v178, v179
 buffer_store_dwordx4 v[180:183], v246, s[24:27], s47 offen sc1
 v_accvgpr_read_b32 v184, a160
 buffer_load_dwordx4 v14, s[12:15], s32 offen offset:3072 lds
 v_accvgpr_read_b32 v185, a161
 v_accvgpr_read_b32 v186, a162
 v_accvgpr_read_b32 v187, a163
 v_accvgpr_read_b32 v188, a164
 v_accvgpr_read_b32 v189, a165
 v_accvgpr_read_b32 v190, a166
 v_accvgpr_read_b32 v191, a167
 v_mul_f32 v184, v184, v252
 v_fmac_f32 v184, v48, v253
 v_mul_f32 v185, v185, v252
 v_fmac_f32 v185, v49, v253
 v_mul_f32 v186, v186, v252
 v_fmac_f32 v186, v50, v253
 v_mul_f32 v187, v187, v252
 s_add_u32 m0, s30, 81920
 s_nop 0
 buffer_load_dwordx4 v15, s[12:15], s32 offen lds
 s_add_u32 s31, s31, 28672
 s_add_u32 s32, s32, 81920
 v_fmac_f32 v187, v51, v253
 v_mul_f32 v188, v188, v252
 v_fmac_f32 v188, v52, v253
 v_mul_f32 v189, v189, v252
 v_fmac_f32 v189, v53, v253
 v_mul_f32 v190, v190, v252
 v_fmac_f32 v190, v54, v253
 v_mul_f32 v191, v191, v252
 v_fmac_f32 v191, v55, v253
 v_cvt_pk_bf16_f32 v192, v184, v185
 v_cvt_pk_bf16_f32 v193, v186, v187
 v_cvt_pk_bf16_f32 v194, v188, v189
 v_cvt_pk_bf16_f32 v195, v190, v191
 buffer_store_dwordx4 v[192:195], v246, s[24:27], s48 offen sc1
 s_waitcnt lgkmcnt(0)
 s_barrier
 s_add_u32 m0, s29, 98304
 s_nop 0
 buffer_load_dwordx4 v246, s[8:11], s31 offen sc1 lds
 v_accvgpr_read_b32 v172, a176
 v_accvgpr_read_b32 v173, a177
 v_accvgpr_read_b32 v174, a178
 v_accvgpr_read_b32 v175, a179
 v_accvgpr_read_b32 v176, a180
 v_accvgpr_read_b32 v177, a181
 v_accvgpr_read_b32 v178, a182
 v_accvgpr_read_b32 v179, a183
 v_mul_f32 v172, v172, v252
 buffer_load_dwordx4 v246, s[8:11], s31 offen offset:1024 sc1 lds
 v_fmac_f32 v172, v56, v253
 v_mul_f32 v173, v173, v252
 v_fmac_f32 v173, v57, v253
 v_mul_f32 v174, v174, v252
 v_fmac_f32 v174, v58, v253
 v_mul_f32 v175, v175, v252
 v_fmac_f32 v175, v59, v253
 v_mul_f32 v176, v176, v252
 v_fmac_f32 v176, v60, v253
 buffer_load_dwordx4 v246, s[8:11], s31 offen offset:2048 sc1 lds
 v_mul_f32 v177, v177, v252
 v_fmac_f32 v177, v61, v253
 v_mul_f32 v178, v178, v252
 v_fmac_f32 v178, v62, v253
 v_mul_f32 v179, v179, v252
 v_fmac_f32 v179, v63, v253
 v_cvt_pk_bf16_f32 v180, v172, v173
 v_cvt_pk_bf16_f32 v181, v174, v175
 v_cvt_pk_bf16_f32 v182, v176, v177
 v_cvt_pk_bf16_f32 v183, v178, v179
 buffer_load_dwordx4 v246, s[8:11], s31 offen offset:3072 sc1 lds
 buffer_store_dwordx4 v[180:183], v246, s[24:27], s49 offen sc1
 v_mov_b32 v168, v200
 s_nop 1
 v_permlane16_swap_b32 v168, v200
 v_add_f32 v200, v200, v168
 v_mov_b32 v168, v200
 s_nop 1
 v_permlane32_swap_b32 v168, v200
 v_add_f32 v200, v200, v168
 v_rcp_f32 v204, v200
 v_mov_b32 v169, v201
 s_add_u32 m0, s29, 102400
 s_add_u32 s34, s31, 4096
 buffer_load_dwordx4 v246, s[8:11], s34 offen sc1 lds
 v_permlane16_swap_b32 v169, v201
 v_add_f32 v201, v201, v169
 v_mov_b32 v169, v201
 s_nop 1
 v_permlane32_swap_b32 v169, v201
 v_add_f32 v201, v201, v169
 v_rcp_f32 v205, v201
 v_mov_b32 v170, v202
 s_nop 1
 v_permlane16_swap_b32 v170, v202
 v_add_f32 v202, v202, v170
 v_mov_b32 v170, v202
 buffer_load_dwordx4 v246, s[8:11], s34 offen offset:1024 sc1 lds
 s_nop 0
 v_permlane32_swap_b32 v170, v202
 v_add_f32 v202, v202, v170
 v_rcp_f32 v206, v202
 v_accvgpr_read_b32 v172, a0
 v_accvgpr_read_b32 v173, a1
 v_accvgpr_read_b32 v174, a2
 v_accvgpr_read_b32 v175, a3
 v_accvgpr_read_b32 v176, a4
 v_accvgpr_read_b32 v177, a5
 buffer_load_dwordx4 v246, s[8:11], s34 offen offset:2048 sc1 lds
 v_accvgpr_read_b32 v178, a6
 v_accvgpr_read_b32 v179, a7
 v_mul_f32 v172, v172, v204
 v_mul_f32 v173, v173, v204
 v_mul_f32 v174, v174, v204
 v_mul_f32 v175, v175, v204
 v_mul_f32 v176, v176, v204
 v_mul_f32 v177, v177, v204
 v_mul_f32 v178, v178, v204
 s_add_u32 m0, s30, 126976
 s_nop 0
 buffer_load_dwordx4 v11, s[12:15], s32 offen lds
 v_mul_f32 v179, v179, v204
 v_cvt_pk_bf16_f32 v180, v172, v173
 v_cvt_pk_bf16_f32 v181, v174, v175
 v_cvt_pk_bf16_f32 v182, v176, v177
 v_cvt_pk_bf16_f32 v183, v178, v179
 buffer_store_dwordx4 v[180:183], v246, s[24:27], s41 offen sc1
 v_accvgpr_read_b32 v184, a8
 v_accvgpr_read_b32 v185, a9
 v_accvgpr_read_b32 v186, a10
 v_accvgpr_read_b32 v187, a11
 buffer_load_dwordx4 v12, s[12:15], s32 offen offset:1024 lds
 v_accvgpr_read_b32 v188, a12
 v_accvgpr_read_b32 v189, a13
 v_accvgpr_read_b32 v190, a14
 v_accvgpr_read_b32 v191, a15
 v_mul_f32 v184, v184, v204
 v_mul_f32 v185, v185, v204
 v_mul_f32 v186, v186, v204
 v_mul_f32 v187, v187, v204
 v_mul_f32 v188, v188, v204
 buffer_load_dwordx4 v13, s[12:15], s32 offen offset:2048 lds
 v_mul_f32 v189, v189, v204
 v_mul_f32 v190, v190, v204
 v_mul_f32 v191, v191, v204
 v_cvt_pk_bf16_f32 v192, v184, v185
 v_cvt_pk_bf16_f32 v193, v186, v187
 v_cvt_pk_bf16_f32 v194, v188, v189
 v_cvt_pk_bf16_f32 v195, v190, v191
 buffer_store_dwordx4 v[192:195], v246, s[24:27], s42 offen sc1
 v_accvgpr_read_b32 v172, a16
 v_accvgpr_read_b32 v173, a17
 buffer_load_dwordx4 v14, s[12:15], s32 offen offset:3072 lds
 v_accvgpr_read_b32 v174, a18
 v_accvgpr_read_b32 v175, a19
 v_accvgpr_read_b32 v176, a20
 v_accvgpr_read_b32 v177, a21
 v_accvgpr_read_b32 v178, a22
 v_accvgpr_read_b32 v179, a23
 v_mul_f32 v172, v172, v204
 v_mul_f32 v173, v173, v204
 v_mul_f32 v174, v174, v204
 s_add_u32 m0, s30, 131072
 s_nop 0
 buffer_load_dwordx4 v15, s[12:15], s32 offen lds
 s_add_u32 s31, s31, 28672
 s_add_u32 s32, s32, 81920
 s_cmp_eq_u32 s31, s36
 s_cselect_b32 s31, s38, s31
 s_cmp_eq_u32 s32, s37
 s_cselect_b32 s32, s39, s32
 v_mul_f32 v175, v175, v204
 v_mul_f32 v176, v176, v204
 v_mul_f32 v177, v177, v204
 v_mul_f32 v178, v178, v204
 v_mul_f32 v179, v179, v204
 v_cvt_pk_bf16_f32 v180, v172, v173
 v_cvt_pk_bf16_f32 v181, v174, v175
 v_cvt_pk_bf16_f32 v182, v176, v177
 v_cvt_pk_bf16_f32 v183, v178, v179
 buffer_store_dwordx4 v[180:183], v246, s[24:27], s43 offen sc1
 s_waitcnt vmcnt(30)
 s_barrier
 ds_read_b64_tr_b16 a[248:249], v5 offset:0
 ds_read_b64_tr_b16 a[250:251], v5 offset:5120
 ds_read_b128 a[192:195], v2 offset:0
 ds_read_b64_tr_b16 a[252:253], v5 offset:10240
 ds_read_b64_tr_b16 a[254:255], v5 offset:15360
 ds_read_b128 a[196:199], v2 offset:14336
 ds_read_b128 a[200:203], v2 offset:1024
 ds_read_b128 a[204:207], v2 offset:15360
 ds_read_b128 a[208:211], v2 offset:2048
 ds_read_b128 a[212:215], v2 offset:16384
 ds_read_b128 a[216:219], v2 offset:3072
 ds_read_b128 a[220:223], v2 offset:17408
 ds_read_b128 a[224:227], v2 offset:4096
 ds_read_b128 a[228:231], v2 offset:18432
 ds_read_b128 a[232:235], v2 offset:5120
 ds_read_b128 a[236:239], v2 offset:19456
 ds_read_b128 a[240:243], v2 offset:6144
 ds_read_b128 a[244:247], v2 offset:20480
 s_waitcnt lgkmcnt(8)
 v_mfma_f32_16x16x32_bf16 v[16:19], a[248:251], a[192:195], 0
 ds_read_b64_tr_b16 a[144:145], v6 offset:32
 v_accvgpr_read_b32 v184, a24
 v_mfma_f32_16x16x32_bf16 v[16:19], a[252:255], a[196:199], v[16:19]
 ds_read_b64_tr_b16 a[146:147], v6 offset:5152
 v_accvgpr_read_b32 v185, a25
 v_mfma_f32_16x16x32_bf16 v[20:23], a[248:251], a[200:203], 0
 v_accvgpr_read_b32 v186, a26
 v_accvgpr_read_b32 v187, a27
 v_mfma_f32_16x16x32_bf16 v[20:23], a[252:255], a[204:207], v[20:23]
 ds_read_b64_tr_b16 a[148:149], v6 offset:10272
 v_accvgpr_read_b32 v188, a28
 v_mfma_f32_16x16x32_bf16 v[24:27], a[248:251], a[208:211], 0
 ds_read_b64_tr_b16 a[150:151], v6 offset:15392
 v_accvgpr_read_b32 v189, a29
 v_mfma_f32_16x16x32_bf16 v[24:27], a[252:255], a[212:215], v[24:27]
 v_accvgpr_read_b32 v190, a30
 s_waitcnt lgkmcnt(4)
 v_mfma_f32_16x16x32_bf16 v[28:31], a[248:251], a[216:219], 0
 ds_read_b64_tr_b16 a[152:153], v5 offset:64
 v_accvgpr_read_b32 v191, a31
 v_mfma_f32_16x16x32_bf16 v[28:31], a[252:255], a[220:223], v[28:31]
 ds_read_b64_tr_b16 a[154:155], v5 offset:5184
 v_mul_f32 v184, v184, v204
 v_mfma_f32_16x16x32_bf16 v[32:35], a[248:251], a[224:227], 0
 v_mul_f32 v185, v185, v204
 v_mul_f32 v186, v186, v204
 v_mfma_f32_16x16x32_bf16 v[32:35], a[252:255], a[228:231], v[32:35]
 ds_read_b64_tr_b16 a[156:157], v5 offset:10304
 v_mul_f32 v187, v187, v204
 v_mfma_f32_16x16x32_bf16 v[36:39], a[248:251], a[232:235], 0
 ds_read_b64_tr_b16 a[158:159], v5 offset:15424
 v_mul_f32 v188, v188, v204
 v_mfma_f32_16x16x32_bf16 v[36:39], a[252:255], a[236:239], v[36:39]
 v_mul_f32 v189, v189, v204
 v_mul_f32 v190, v190, v204
 v_mfma_f32_16x16x32_bf16 v[40:43], a[248:251], a[240:243], 0
 v_mul_f32 v191, v191, v204
 v_cvt_pk_bf16_f32 v192, v184, v185
 v_mfma_f32_16x16x32_bf16 v[40:43], a[252:255], a[244:247], v[40:43]
 v_cvt_pk_bf16_f32 v193, v186, v187
 s_waitcnt lgkmcnt(4)
 v_mfma_f32_16x16x32_bf16 v[44:47], a[144:147], a[192:195], 0
 v_cvt_pk_bf16_f32 v194, v188, v189
 v_cvt_pk_bf16_f32 v195, v190, v191
 v_mfma_f32_16x16x32_bf16 v[44:47], a[148:151], a[196:199], v[44:47]
 ds_read_b64_tr_b16 a[248:249], v6 offset:96
 v_accvgpr_read_b32 v172, a32
 v_mfma_f32_16x16x32_bf16 v[48:51], a[144:147], a[200:203], 0
 ds_read_b64_tr_b16 a[250:251], v6 offset:5216
 v_accvgpr_read_b32 v173, a33
 v_mfma_f32_16x16x32_bf16 v[48:51], a[148:151], a[204:207], v[48:51]
 buffer_store_dwordx4 v[192:195], v246, s[24:27], s44 offen sc1
 v_mfma_f32_16x16x32_bf16 v[52:55], a[144:147], a[208:211], 0
 ds_read_b64_tr_b16 a[252:253], v6 offset:10336
 v_accvgpr_read_b32 v174, a34
 v_mfma_f32_16x16x32_bf16 v[52:55], a[148:151], a[212:215], v[52:55]
 ds_read_b64_tr_b16 a[254:255], v6 offset:15456
 v_accvgpr_read_b32 v175, a35
 v_mfma_f32_16x16x32_bf16 v[56:59], a[144:147], a[216:219], 0
 v_accvgpr_read_b32 v176, a36
 v_accvgpr_read_b32 v177, a37
 v_mfma_f32_16x16x32_bf16 v[56:59], a[148:151], a[220:223], v[56:59]
 v_accvgpr_read_b32 v178, a38
 v_accvgpr_read_b32 v179, a39
 v_mfma_f32_16x16x32_bf16 v[60:63], a[144:147], a[224:227], 0
 v_mul_f32 v172, v172, v204
 v_mul_f32 v173, v173, v204
 v_mfma_f32_16x16x32_bf16 v[60:63], a[148:151], a[228:231], v[60:63]
 v_mul_f32 v174, v174, v204
 v_mul_f32 v175, v175, v204
 v_mfma_f32_16x16x32_bf16 v[64:67], a[144:147], a[232:235], 0
 v_mul_f32 v176, v176, v204
 v_mul_f32 v177, v177, v204
 v_mfma_f32_16x16x32_bf16 v[64:67], a[148:151], a[236:239], v[64:67]
 v_mul_f32 v178, v178, v204
 v_mul_f32 v179, v179, v204
 v_mfma_f32_16x16x32_bf16 v[68:71], a[144:147], a[240:243], 0
 v_cvt_pk_bf16_f32 v180, v172, v173
 v_cvt_pk_bf16_f32 v181, v174, v175
 v_mfma_f32_16x16x32_bf16 v[68:71], a[148:151], a[244:247], v[68:71]
 v_cvt_pk_bf16_f32 v182, v176, v177
 s_waitcnt lgkmcnt(4)
 v_mfma_f32_16x16x32_bf16 v[72:75], a[152:155], a[192:195], 0
 v_cvt_pk_bf16_f32 v183, v178, v179
 v_accvgpr_read_b32 v184, a40
 v_mfma_f32_16x16x32_bf16 v[72:75], a[156:159], a[196:199], v[72:75]
 ds_read_b64_tr_b16 a[144:145], v5 offset:128
 v_accvgpr_read_b32 v185, a41
 v_mfma_f32_16x16x32_bf16 v[76:79], a[152:155], a[200:203], 0
 ds_read_b64_tr_b16 a[146:147], v5 offset:5248
 v_accvgpr_read_b32 v186, a42
 v_mfma_f32_16x16x32_bf16 v[76:79], a[156:159], a[204:207], v[76:79]
 buffer_store_dwordx4 v[180:183], v246, s[24:27], s45 offen sc1
 v_mfma_f32_16x16x32_bf16 v[80:83], a[152:155], a[208:211], 0
 ds_read_b64_tr_b16 a[148:149], v5 offset:10368
 v_accvgpr_read_b32 v187, a43
 v_mfma_f32_16x16x32_bf16 v[80:83], a[156:159], a[212:215], v[80:83]
 ds_read_b64_tr_b16 a[150:151], v5 offset:15488
 v_accvgpr_read_b32 v188, a44
 v_mfma_f32_16x16x32_bf16 v[84:87], a[152:155], a[216:219], 0
 v_accvgpr_read_b32 v189, a45
 v_accvgpr_read_b32 v190, a46
 v_mfma_f32_16x16x32_bf16 v[84:87], a[156:159], a[220:223], v[84:87]
 v_accvgpr_read_b32 v191, a47
 v_mul_f32 v184, v184, v204
 v_mfma_f32_16x16x32_bf16 v[88:91], a[152:155], a[224:227], 0
 v_mul_f32 v185, v185, v204
 v_mul_f32 v186, v186, v204
 v_mfma_f32_16x16x32_bf16 v[88:91], a[156:159], a[228:231], v[88:91]
 v_mul_f32 v187, v187, v204
 v_mul_f32 v188, v188, v204
 v_mfma_f32_16x16x32_bf16 v[92:95], a[152:155], a[232:235], 0
 v_mul_f32 v189, v189, v204
 v_mul_f32 v190, v190, v204
 v_mfma_f32_16x16x32_bf16 v[92:95], a[156:159], a[236:239], v[92:95]
 v_mul_f32 v191, v191, v204
 v_cvt_pk_bf16_f32 v192, v184, v185
 v_mfma_f32_16x16x32_bf16 v[96:99], a[152:155], a[240:243], 0
 v_cvt_pk_bf16_f32 v193, v186, v187
 v_cvt_pk_bf16_f32 v194, v188, v189
 v_mfma_f32_16x16x32_bf16 v[96:99], a[156:159], a[244:247], v[96:99]
 v_cvt_pk_bf16_f32 v195, v190, v191
 s_waitcnt lgkmcnt(4)
 v_mfma_f32_16x16x32_bf16 v[100:103], a[248:251], a[192:195], 0
 buffer_store_dwordx4 v[192:195], v246, s[24:27], s46 offen sc1
 v_mfma_f32_16x16x32_bf16 v[100:103], a[252:255], a[196:199], v[100:103]
 v_accvgpr_read_b32 v172, a48
 s_waitcnt vmcnt(20) lgkmcnt(0)
 v_mfma_f32_16x16x32_bf16 v[104:107], a[248:251], a[200:203], 0
 v_accvgpr_read_b32 v173, a49
 s_barrier
 v_mfma_f32_16x16x32_bf16 v[104:107], a[252:255], a[204:207], v[104:107]
 ds_read_b64_tr_b16 a[152:153], v7 offset:0
 v_accvgpr_read_b32 v174, a50
 v_mfma_f32_16x16x32_bf16 v[108:111], a[248:251], a[208:211], 0
 ds_read_b64_tr_b16 a[154:155], v7 offset:5120
 v_accvgpr_read_b32 v175, a51
 v_mfma_f32_16x16x32_bf16 v[108:111], a[252:255], a[212:215], v[108:111]
 ds_read_b128 a[160:163], v3 offset:0
 s_add_u32 m0, s29, 0
 v_mfma_f32_16x16x32_bf16 v[112:115], a[248:251], a[216:219], 0
 buffer_load_dwordx4 v246, s[8:11], s31 offen sc1 lds
 v_mfma_f32_16x16x32_bf16 v[112:115], a[252:255], a[220:223], v[112:115]
 ds_read_b64_tr_b16 a[156:157], v7 offset:10240
 v_accvgpr_read_b32 v176, a52
 v_mfma_f32_16x16x32_bf16 v[116:119], a[248:251], a[224:227], 0
 ds_read_b64_tr_b16 a[158:159], v7 offset:15360
 v_accvgpr_read_b32 v177, a53
 v_mfma_f32_16x16x32_bf16 v[116:119], a[252:255], a[228:231], v[116:119]
 ds_read_b128 a[164:167], v3 offset:14336
 v_accvgpr_read_b32 v178, a54
 v_mfma_f32_16x16x32_bf16 v[120:123], a[248:251], a[232:235], 0
 buffer_load_dwordx4 v246, s[8:11], s31 offen offset:1024 sc1 lds
 v_mfma_f32_16x16x32_bf16 v[120:123], a[252:255], a[236:239], v[120:123]
 ds_read_b128 a[168:171], v3 offset:1024
 v_accvgpr_read_b32 v179, a55
 v_mfma_f32_16x16x32_bf16 v[124:127], a[248:251], a[240:243], 0
 ds_read_b128 a[172:175], v3 offset:15360
 v_mul_f32 v172, v172, v205
 v_mfma_f32_16x16x32_bf16 v[124:127], a[252:255], a[244:247], v[124:127]
 ds_read_b128 a[176:179], v3 offset:2048
 v_mul_f32 v173, v173, v205
 v_mfma_f32_16x16x32_bf16 v[128:131], a[144:147], a[192:195], 0
 buffer_load_dwordx4 v246, s[8:11], s31 offen offset:2048 sc1 lds
 v_mfma_f32_16x16x32_bf16 v[128:131], a[148:151], a[196:199], v[128:131]
 ds_read_b128 a[180:183], v3 offset:16384
 v_mul_f32 v174, v174, v205
 v_mfma_f32_16x16x32_bf16 v[132:135], a[144:147], a[200:203], 0
 ds_read_b128 a[184:187], v3 offset:3072
 v_mul_f32 v175, v175, v205
 v_mfma_f32_16x16x32_bf16 v[132:135], a[148:151], a[204:207], v[132:135]
 ds_read_b128 a[188:191], v3 offset:17408
 v_mul_f32 v176, v176, v205
 v_mfma_f32_16x16x32_bf16 v[136:139], a[144:147], a[208:211], 0
 buffer_load_dwordx4 v246, s[8:11], s31 offen offset:3072 sc1 lds
 v_mfma_f32_16x16x32_bf16 v[136:139], a[148:151], a[212:215], v[136:139]
 ds_read_b128 a[0:3], v3 offset:4096
 v_mul_f32 v177, v177, v205
 v_mfma_f32_16x16x32_bf16 v[140:143], a[144:147], a[216:219], 0
 ds_read_b128 a[4:7], v3 offset:18432
 s_add_u32 s34, s31, 4096
 v_mfma_f32_16x16x32_bf16 v[140:143], a[148:151], a[220:223], v[140:143]
 ds_read_b128 a[8:11], v3 offset:5120
 s_add_u32 m0, s29, 4096
 v_mfma_f32_16x16x32_bf16 v[144:147], a[144:147], a[224:227], 0
 buffer_load_dwordx4 v246, s[8:11], s34 offen sc1 lds
 v_mfma_f32_16x16x32_bf16 v[144:147], a[148:151], a[228:231], v[144:147]
 ds_read_b128 a[12:15], v3 offset:19456
 v_mul_f32 v178, v178, v205
 v_mfma_f32_16x16x32_bf16 v[148:151], a[144:147], a[232:235], 0
 ds_read_b128 a[16:19], v3 offset:6144
 v_mul_f32 v179, v179, v205
 v_mfma_f32_16x16x32_bf16 v[148:151], a[148:151], a[236:239], v[148:151]
 ds_read_b128 a[20:23], v3 offset:20480
 v_cvt_pk_bf16_f32 v180, v172, v173
 v_mfma_f32_16x16x32_bf16 v[152:155], a[144:147], a[240:243], 0
 buffer_load_dwordx4 v246, s[8:11], s34 offen offset:1024 sc1 lds
 v_mfma_f32_16x16x32_bf16 v[152:155], a[148:151], a[244:247], v[152:155]
 v_cvt_pk_bf16_f32 v181, v174, v175
 s_waitcnt lgkmcnt(8)
 v_mfma_f32_16x16x32_bf16 v[16:19], a[152:155], a[160:163], v[16:19]
 ds_read_b64_tr_b16 a[248:249], v8 offset:32
 v_cvt_pk_bf16_f32 v182, v176, v177
 v_mfma_f32_16x16x32_bf16 v[16:19], a[156:159], a[164:167], v[16:19]
 ds_read_b64_tr_b16 a[250:251], v8 offset:5152
 v_cvt_pk_bf16_f32 v183, v178, v179
 v_mfma_f32_16x16x32_bf16 v[20:23], a[152:155], a[168:171], v[20:23]
 buffer_load_dwordx4 v246, s[8:11], s34 offen offset:2048 sc1 lds
 v_mfma_f32_16x16x32_bf16 v[20:23], a[156:159], a[172:175], v[20:23]
 ds_read_b64_tr_b16 a[252:253], v8 offset:10272
 v_accvgpr_read_b32 v184, a56
 v_mfma_f32_16x16x32_bf16 v[24:27], a[152:155], a[176:179], v[24:27]
 ds_read_b64_tr_b16 a[254:255], v8 offset:15392
 v_accvgpr_read_b32 v185, a57
 v_mfma_f32_16x16x32_bf16 v[24:27], a[156:159], a[180:183], v[24:27]
 v_accvgpr_read_b32 v186, a58
 s_waitcnt lgkmcnt(4)
 v_mfma_f32_16x16x32_bf16 v[28:31], a[152:155], a[184:187], v[28:31]
 ds_read_b64_tr_b16 a[144:145], v7 offset:64
 v_accvgpr_read_b32 v187, a59
 v_mfma_f32_16x16x32_bf16 v[28:31], a[156:159], a[188:191], v[28:31]
 ds_read_b64_tr_b16 a[146:147], v7 offset:5184
 s_add_u32 m0, s30, 28672
 v_mfma_f32_16x16x32_bf16 v[32:35], a[152:155], a[0:3], v[32:35]
 buffer_load_dwordx4 v11, s[12:15], s32 offen lds
 v_mfma_f32_16x16x32_bf16 v[32:35], a[156:159], a[4:7], v[32:35]
 ds_read_b64_tr_b16 a[148:149], v7 offset:10304
 v_accvgpr_read_b32 v188, a60
 v_mfma_f32_16x16x32_bf16 v[36:39], a[152:155], a[8:11], v[36:39]
 ds_read_b64_tr_b16 a[150:151], v7 offset:15424
 v_accvgpr_read_b32 v189, a61
 v_mfma_f32_16x16x32_bf16 v[36:39], a[156:159], a[12:15], v[36:39]
 buffer_store_dwordx4 v[180:183], v246, s[24:27], s41 offen offset:1024 sc1
 v_mfma_f32_16x16x32_bf16 v[40:43], a[152:155], a[16:19], v[40:43]
 buffer_load_dwordx4 v12, s[12:15], s32 offen offset:1024 lds
 v_mfma_f32_16x16x32_bf16 v[40:43], a[156:159], a[20:23], v[40:43]
 v_accvgpr_read_b32 v190, a62
 s_waitcnt lgkmcnt(4)
 v_mfma_f32_16x16x32_bf16 v[44:47], a[248:251], a[160:163], v[44:47]
 v_accvgpr_read_b32 v191, a63
 v_mul_f32 v184, v184, v205
 v_mfma_f32_16x16x32_bf16 v[44:47], a[252:255], a[164:167], v[44:47]
 ds_read_b64_tr_b16 a[152:153], v8 offset:96
 v_mul_f32 v185, v185, v205
 v_mfma_f32_16x16x32_bf16 v[48:51], a[248:251], a[168:171], v[48:51]
 ds_read_b64_tr_b16 a[154:155], v8 offset:5216
 v_mul_f32 v186, v186, v205
 v_mfma_f32_16x16x32_bf16 v[48:51], a[252:255], a[172:175], v[48:51]
 buffer_load_dwordx4 v13, s[12:15], s32 offen offset:2048 lds
 v_mfma_f32_16x16x32_bf16 v[52:55], a[248:251], a[176:179], v[52:55]
 ds_read_b64_tr_b16 a[156:157], v8 offset:10336
 v_mul_f32 v187, v187, v205
 v_mfma_f32_16x16x32_bf16 v[52:55], a[252:255], a[180:183], v[52:55]
 ds_read_b64_tr_b16 a[158:159], v8 offset:15456
 v_mul_f32 v188, v188, v205
 v_mfma_f32_16x16x32_bf16 v[56:59], a[248:251], a[184:187], v[56:59]
 v_mul_f32 v189, v189, v205
 v_mul_f32 v190, v190, v205
 v_mfma_f32_16x16x32_bf16 v[56:59], a[252:255], a[188:191], v[56:59]
 buffer_load_dwordx4 v14, s[12:15], s32 offen offset:3072 lds
 v_mfma_f32_16x16x32_bf16 v[60:63], a[248:251], a[0:3], v[60:63]
 v_mul_f32 v191, v191, v205
 v_cvt_pk_bf16_f32 v192, v184, v185
 v_mfma_f32_16x16x32_bf16 v[60:63], a[252:255], a[4:7], v[60:63]
 v_cvt_pk_bf16_f32 v193, v186, v187
 v_cvt_pk_bf16_f32 v194, v188, v189
 v_mfma_f32_16x16x32_bf16 v[64:67], a[248:251], a[8:11], v[64:67]
 s_add_u32 m0, s30, 32768
 v_cvt_pk_bf16_f32 v195, v190, v191
 v_mfma_f32_16x16x32_bf16 v[64:67], a[252:255], a[12:15], v[64:67]
 buffer_load_dwordx4 v15, s[12:15], s32 offen lds
 v_mfma_f32_16x16x32_bf16 v[68:71], a[248:251], a[16:19], v[68:71]
 s_add_u32 s31, s31, 28672
 v_accvgpr_read_b32 v172, a64
 v_mfma_f32_16x16x32_bf16 v[68:71], a[252:255], a[20:23], v[68:71]
 s_add_u32 s32, s32, 81920
 s_waitcnt lgkmcnt(4)
 v_mfma_f32_16x16x32_bf16 v[72:75], a[144:147], a[160:163], v[72:75]
 buffer_store_dwordx4 v[192:195], v246, s[24:27], s42 offen offset:1024 sc1
 v_mfma_f32_16x16x32_bf16 v[72:75], a[148:151], a[164:167], v[72:75]
 ds_read_b64_tr_b16 a[248:249], v7 offset:128
 v_accvgpr_read_b32 v173, a65
 v_mfma_f32_16x16x32_bf16 v[76:79], a[144:147], a[168:171], v[76:79]
 ds_read_b64_tr_b16 a[250:251], v7 offset:5248
 v_accvgpr_read_b32 v174, a66
 v_mfma_f32_16x16x32_bf16 v[76:79], a[148:151], a[172:175], v[76:79]
 v_accvgpr_read_b32 v175, a67
 v_accvgpr_read_b32 v176, a68
 v_mfma_f32_16x16x32_bf16 v[80:83], a[144:147], a[176:179], v[80:83]
 ds_read_b64_tr_b16 a[252:253], v7 offset:10368
 v_accvgpr_read_b32 v177, a69
 v_mfma_f32_16x16x32_bf16 v[80:83], a[148:151], a[180:183], v[80:83]
 ds_read_b64_tr_b16 a[254:255], v7 offset:15488
 v_accvgpr_read_b32 v178, a70
 v_mfma_f32_16x16x32_bf16 v[84:87], a[144:147], a[184:187], v[84:87]
 v_accvgpr_read_b32 v179, a71
 v_mul_f32 v172, v172, v205
 v_mfma_f32_16x16x32_bf16 v[84:87], a[148:151], a[188:191], v[84:87]
 v_mul_f32 v173, v173, v205
 v_mul_f32 v174, v174, v205
 v_mfma_f32_16x16x32_bf16 v[88:91], a[144:147], a[0:3], v[88:91]
 v_mul_f32 v175, v175, v205
 v_mul_f32 v176, v176, v205
 v_mfma_f32_16x16x32_bf16 v[88:91], a[148:151], a[4:7], v[88:91]
 v_mul_f32 v177, v177, v205
 v_mul_f32 v178, v178, v205
 v_mfma_f32_16x16x32_bf16 v[92:95], a[144:147], a[8:11], v[92:95]
 v_mul_f32 v179, v179, v205
 v_cvt_pk_bf16_f32 v180, v172, v173
 v_mfma_f32_16x16x32_bf16 v[92:95], a[148:151], a[12:15], v[92:95]
 v_cvt_pk_bf16_f32 v181, v174, v175
 v_cvt_pk_bf16_f32 v182, v176, v177
 v_mfma_f32_16x16x32_bf16 v[96:99], a[144:147], a[16:19], v[96:99]
 v_cvt_pk_bf16_f32 v183, v178, v179
 v_accvgpr_read_b32 v184, a72
 v_mfma_f32_16x16x32_bf16 v[96:99], a[148:151], a[20:23], v[96:99]
 v_accvgpr_read_b32 v185, a73
 s_waitcnt lgkmcnt(4)
 v_mfma_f32_16x16x32_bf16 v[100:103], a[152:155], a[160:163], v[100:103]
 buffer_store_dwordx4 v[180:183], v246, s[24:27], s43 offen offset:1024 sc1
 v_mfma_f32_16x16x32_bf16 v[100:103], a[156:159], a[164:167], v[100:103]
 v_accvgpr_read_b32 v186, a74
 s_waitcnt vmcnt(19) lgkmcnt(0)
 v_mfma_f32_16x16x32_bf16 v[104:107], a[152:155], a[168:171], v[104:107]
 v_accvgpr_read_b32 v187, a75
 s_barrier
 v_mfma_f32_16x16x32_bf16 v[104:107], a[156:159], a[172:175], v[104:107]
 ds_read_b64_tr_b16 a[144:145], v9 offset:0
 v_accvgpr_read_b32 v188, a76
 v_mfma_f32_16x16x32_bf16 v[108:111], a[152:155], a[176:179], v[108:111]
 ds_read_b64_tr_b16 a[146:147], v9 offset:5120
 v_accvgpr_read_b32 v189, a77
 v_mfma_f32_16x16x32_bf16 v[108:111], a[156:159], a[180:183], v[108:111]
 ds_read_b128 a[192:195], v4 offset:0
 s_add_u32 m0, s29, 49152
 v_mfma_f32_16x16x32_bf16 v[112:115], a[152:155], a[184:187], v[112:115]
 buffer_load_dwordx4 v246, s[8:11], s31 offen sc1 lds
 v_mfma_f32_16x16x32_bf16 v[112:115], a[156:159], a[188:191], v[112:115]
 ds_read_b64_tr_b16 a[148:149], v9 offset:10240
 v_accvgpr_read_b32 v190, a78
 v_mfma_f32_16x16x32_bf16 v[116:119], a[152:155], a[0:3], v[116:119]
 ds_read_b64_tr_b16 a[150:151], v9 offset:15360
 v_accvgpr_read_b32 v191, a79
 v_mfma_f32_16x16x32_bf16 v[116:119], a[156:159], a[4:7], v[116:119]
 ds_read_b128 a[196:199], v4 offset:14336
 v_mul_f32 v184, v184, v205
 v_mfma_f32_16x16x32_bf16 v[120:123], a[152:155], a[8:11], v[120:123]
 buffer_load_dwordx4 v246, s[8:11], s31 offen offset:1024 sc1 lds
 v_mfma_f32_16x16x32_bf16 v[120:123], a[156:159], a[12:15], v[120:123]
 ds_read_b128 a[200:203], v4 offset:1024
 v_mul_f32 v185, v185, v205
 v_mfma_f32_16x16x32_bf16 v[124:127], a[152:155], a[16:19], v[124:127]
 ds_read_b128 a[204:207], v4 offset:15360
 v_mul_f32 v186, v186, v205
 v_mfma_f32_16x16x32_bf16 v[124:127], a[156:159], a[20:23], v[124:127]
 ds_read_b128 a[208:211], v4 offset:2048
 v_mul_f32 v187, v187, v205
 v_mfma_f32_16x16x32_bf16 v[128:131], a[248:251], a[160:163], v[128:131]
 buffer_load_dwordx4 v246, s[8:11], s31 offen offset:2048 sc1 lds
 v_mfma_f32_16x16x32_bf16 v[128:131], a[252:255], a[164:167], v[128:131]
 ds_read_b128 a[212:215], v4 offset:16384
 v_mul_f32 v188, v188, v205
 v_mfma_f32_16x16x32_bf16 v[132:135], a[248:251], a[168:171], v[132:135]
 ds_read_b128 a[216:219], v4 offset:3072
 v_mul_f32 v189, v189, v205
 v_mfma_f32_16x16x32_bf16 v[132:135], a[252:255], a[172:175], v[132:135]
 ds_read_b128 a[220:223], v4 offset:17408
 v_mul_f32 v190, v190, v205
 v_mfma_f32_16x16x32_bf16 v[136:139], a[248:251], a[176:179], v[136:139]
 buffer_load_dwordx4 v246, s[8:11], s31 offen offset:3072 sc1 lds
 v_mfma_f32_16x16x32_bf16 v[136:139], a[252:255], a[180:183], v[136:139]
 ds_read_b128 a[224:227], v4 offset:4096
 v_mul_f32 v191, v191, v205
 v_mfma_f32_16x16x32_bf16 v[140:143], a[248:251], a[184:187], v[140:143]
 ds_read_b128 a[228:231], v4 offset:18432
 s_add_u32 s34, s31, 4096
 v_mfma_f32_16x16x32_bf16 v[140:143], a[252:255], a[188:191], v[140:143]
 ds_read_b128 a[232:235], v4 offset:5120
 s_add_u32 m0, s29, 53248
 v_mfma_f32_16x16x32_bf16 v[144:147], a[248:251], a[0:3], v[144:147]
 buffer_load_dwordx4 v246, s[8:11], s34 offen sc1 lds
 v_mfma_f32_16x16x32_bf16 v[144:147], a[252:255], a[4:7], v[144:147]
 ds_read_b128 a[236:239], v4 offset:19456
 v_cvt_pk_bf16_f32 v192, v184, v185
 v_mfma_f32_16x16x32_bf16 v[148:151], a[248:251], a[8:11], v[148:151]
 ds_read_b128 a[240:243], v4 offset:6144
 v_cvt_pk_bf16_f32 v193, v186, v187
 v_mfma_f32_16x16x32_bf16 v[148:151], a[252:255], a[12:15], v[148:151]
 ds_read_b128 a[244:247], v4 offset:20480
 v_cvt_pk_bf16_f32 v194, v188, v189
 v_mfma_f32_16x16x32_bf16 v[152:155], a[248:251], a[16:19], v[152:155]
 buffer_load_dwordx4 v246, s[8:11], s34 offen offset:1024 sc1 lds
 v_mfma_f32_16x16x32_bf16 v[152:155], a[252:255], a[20:23], v[152:155]
 v_cvt_pk_bf16_f32 v195, v190, v191
 s_waitcnt lgkmcnt(8)
 v_mfma_f32_16x16x32_bf16 v[16:19], a[144:147], a[192:195], v[16:19]
 ds_read_b64_tr_b16 a[152:153], v10 offset:32
 v_accvgpr_read_b32 v172, a80
 v_mfma_f32_16x16x32_bf16 v[16:19], a[148:151], a[196:199], v[16:19]
 ds_read_b64_tr_b16 a[154:155], v10 offset:5152
 v_accvgpr_read_b32 v173, a81
 v_mfma_f32_16x16x32_bf16 v[20:23], a[144:147], a[200:203], v[20:23]
 buffer_load_dwordx4 v246, s[8:11], s34 offen offset:2048 sc1 lds
 v_mfma_f32_16x16x32_bf16 v[20:23], a[148:151], a[204:207], v[20:23]
 ds_read_b64_tr_b16 a[156:157], v10 offset:10272
 v_accvgpr_read_b32 v174, a82
 v_mfma_f32_16x16x32_bf16 v[24:27], a[144:147], a[208:211], v[24:27]
 ds_read_b64_tr_b16 a[158:159], v10 offset:15392
 v_accvgpr_read_b32 v175, a83
 v_mfma_f32_16x16x32_bf16 v[24:27], a[148:151], a[212:215], v[24:27]
 v_accvgpr_read_b32 v176, a84
 s_waitcnt lgkmcnt(4)
 v_mfma_f32_16x16x32_bf16 v[28:31], a[144:147], a[216:219], v[28:31]
 ds_read_b64_tr_b16 a[248:249], v9 offset:64
 v_accvgpr_read_b32 v177, a85
 v_mfma_f32_16x16x32_bf16 v[28:31], a[148:151], a[220:223], v[28:31]
 ds_read_b64_tr_b16 a[250:251], v9 offset:5184
 s_add_u32 m0, s30, 77824
 v_mfma_f32_16x16x32_bf16 v[32:35], a[144:147], a[224:227], v[32:35]
 buffer_load_dwordx4 v11, s[12:15], s32 offen lds
 v_mfma_f32_16x16x32_bf16 v[32:35], a[148:151], a[228:231], v[32:35]
 ds_read_b64_tr_b16 a[252:253], v9 offset:10304
 v_accvgpr_read_b32 v178, a86
 v_mfma_f32_16x16x32_bf16 v[36:39], a[144:147], a[232:235], v[36:39]
 ds_read_b64_tr_b16 a[254:255], v9 offset:15424
 v_accvgpr_read_b32 v179, a87
 v_mfma_f32_16x16x32_bf16 v[36:39], a[148:151], a[236:239], v[36:39]
 buffer_store_dwordx4 v[192:195], v246, s[24:27], s44 offen offset:1024 sc1
 v_mfma_f32_16x16x32_bf16 v[40:43], a[144:147], a[240:243], v[40:43]
 buffer_load_dwordx4 v12, s[12:15], s32 offen offset:1024 lds
 v_mfma_f32_16x16x32_bf16 v[40:43], a[148:151], a[244:247], v[40:43]
 v_mul_f32 v172, v172, v205
 s_waitcnt lgkmcnt(4)
 v_mfma_f32_16x16x32_bf16 v[44:47], a[152:155], a[192:195], v[44:47]
 v_mul_f32 v173, v173, v205
 v_mul_f32 v174, v174, v205
 v_mfma_f32_16x16x32_bf16 v[44:47], a[156:159], a[196:199], v[44:47]
 ds_read_b64_tr_b16 a[144:145], v10 offset:96
 v_mul_f32 v175, v175, v205
 v_mfma_f32_16x16x32_bf16 v[48:51], a[152:155], a[200:203], v[48:51]
 ds_read_b64_tr_b16 a[146:147], v10 offset:5216
 v_mul_f32 v176, v176, v205
 v_mfma_f32_16x16x32_bf16 v[48:51], a[156:159], a[204:207], v[48:51]
 buffer_load_dwordx4 v13, s[12:15], s32 offen offset:2048 lds
 v_mfma_f32_16x16x32_bf16 v[52:55], a[152:155], a[208:211], v[52:55]
 ds_read_b64_tr_b16 a[148:149], v10 offset:10336
 v_mul_f32 v177, v177, v205
 v_mfma_f32_16x16x32_bf16 v[52:55], a[156:159], a[212:215], v[52:55]
 ds_read_b64_tr_b16 a[150:151], v10 offset:15456
 v_mul_f32 v178, v178, v205
 v_mfma_f32_16x16x32_bf16 v[56:59], a[152:155], a[216:219], v[56:59]
 v_mul_f32 v179, v179, v205
 v_cvt_pk_bf16_f32 v180, v172, v173
 v_mfma_f32_16x16x32_bf16 v[56:59], a[156:159], a[220:223], v[56:59]
 buffer_load_dwordx4 v14, s[12:15], s32 offen offset:3072 lds
 v_mfma_f32_16x16x32_bf16 v[60:63], a[152:155], a[224:227], v[60:63]
 v_cvt_pk_bf16_f32 v181, v174, v175
 v_cvt_pk_bf16_f32 v182, v176, v177
 v_mfma_f32_16x16x32_bf16 v[60:63], a[156:159], a[228:231], v[60:63]
 v_cvt_pk_bf16_f32 v183, v178, v179
 v_accvgpr_read_b32 v184, a88
 v_mfma_f32_16x16x32_bf16 v[64:67], a[152:155], a[232:235], v[64:67]
 s_add_u32 m0, s30, 81920
 v_accvgpr_read_b32 v185, a89
 v_mfma_f32_16x16x32_bf16 v[64:67], a[156:159], a[236:239], v[64:67]
 buffer_load_dwordx4 v15, s[12:15], s32 offen lds
 v_mfma_f32_16x16x32_bf16 v[68:71], a[152:155], a[240:243], v[68:71]
 s_add_u32 s31, s31, 28672
 v_accvgpr_read_b32 v186, a90
 v_mfma_f32_16x16x32_bf16 v[68:71], a[156:159], a[244:247], v[68:71]
 s_add_u32 s32, s32, 81920
 s_waitcnt lgkmcnt(4)
 v_mfma_f32_16x16x32_bf16 v[72:75], a[248:251], a[192:195], v[72:75]
 buffer_store_dwordx4 v[180:183], v246, s[24:27], s45 offen offset:1024 sc1
 v_mfma_f32_16x16x32_bf16 v[72:75], a[252:255], a[196:199], v[72:75]
 ds_read_b64_tr_b16 a[152:153], v9 offset:128
 v_accvgpr_read_b32 v187, a91
 v_mfma_f32_16x16x32_bf16 v[76:79], a[248:251], a[200:203], v[76:79]
 ds_read_b64_tr_b16 a[154:155], v9 offset:5248
 v_accvgpr_read_b32 v188, a92
 v_mfma_f32_16x16x32_bf16 v[76:79], a[252:255], a[204:207], v[76:79]
 v_accvgpr_read_b32 v189, a93
 v_accvgpr_read_b32 v190, a94
 v_mfma_f32_16x16x32_bf16 v[80:83], a[248:251], a[208:211], v[80:83]
 ds_read_b64_tr_b16 a[156:157], v9 offset:10368
 v_accvgpr_read_b32 v191, a95
 v_mfma_f32_16x16x32_bf16 v[80:83], a[252:255], a[212:215], v[80:83]
 ds_read_b64_tr_b16 a[158:159], v9 offset:15488
 v_mul_f32 v184, v184, v205
 v_mfma_f32_16x16x32_bf16 v[84:87], a[248:251], a[216:219], v[84:87]
 v_mul_f32 v185, v185, v205
 v_mul_f32 v186, v186, v205
 v_mfma_f32_16x16x32_bf16 v[84:87], a[252:255], a[220:223], v[84:87]
 v_mul_f32 v187, v187, v205
 v_mul_f32 v188, v188, v205
 v_mfma_f32_16x16x32_bf16 v[88:91], a[248:251], a[224:227], v[88:91]
 v_mul_f32 v189, v189, v205
 v_mul_f32 v190, v190, v205
 v_mfma_f32_16x16x32_bf16 v[88:91], a[252:255], a[228:231], v[88:91]
 v_mul_f32 v191, v191, v205
 v_cvt_pk_bf16_f32 v192, v184, v185
 v_mfma_f32_16x16x32_bf16 v[92:95], a[248:251], a[232:235], v[92:95]
 v_cvt_pk_bf16_f32 v193, v186, v187
 v_cvt_pk_bf16_f32 v194, v188, v189
 v_mfma_f32_16x16x32_bf16 v[92:95], a[252:255], a[236:239], v[92:95]
 v_cvt_pk_bf16_f32 v195, v190, v191
 v_accvgpr_read_b32 v172, a96
 v_mfma_f32_16x16x32_bf16 v[96:99], a[248:251], a[240:243], v[96:99]
 buffer_store_dwordx4 v[192:195], v246, s[24:27], s46 offen offset:1024 sc1
 v_mfma_f32_16x16x32_bf16 v[96:99], a[252:255], a[244:247], v[96:99]
 v_accvgpr_read_b32 v173, a97
 s_waitcnt lgkmcnt(4)
 v_mfma_f32_16x16x32_bf16 v[100:103], a[144:147], a[192:195], v[100:103]
 v_accvgpr_read_b32 v174, a98
 v_accvgpr_read_b32 v175, a99
 v_mfma_f32_16x16x32_bf16 v[100:103], a[148:151], a[196:199], v[100:103]
 v_accvgpr_read_b32 v176, a100
 s_waitcnt vmcnt(17) lgkmcnt(0)
 v_mfma_f32_16x16x32_bf16 v[104:107], a[144:147], a[200:203], v[104:107]
 v_accvgpr_read_b32 v177, a101
 s_barrier
 v_mfma_f32_16x16x32_bf16 v[104:107], a[148:151], a[204:207], v[104:107]
 ds_read_b64_tr_b16 a[248:249], v5 offset:0
 v_accvgpr_read_b32 v178, a102
 v_mfma_f32_16x16x32_bf16 v[108:111], a[144:147], a[208:211], v[108:111]
 ds_read_b64_tr_b16 a[250:251], v5 offset:5120
 v_accvgpr_read_b32 v179, a103
 v_mfma_f32_16x16x32_bf16 v[108:111], a[148:151], a[212:215], v[108:111]
 ds_read_b128 a[160:163], v2 offset:0
 s_add_u32 m0, s29, 98304
 v_mfma_f32_16x16x32_bf16 v[112:115], a[144:147], a[216:219], v[112:115]
 buffer_load_dwordx4 v246, s[8:11], s31 offen sc1 lds
 v_mfma_f32_16x16x32_bf16 v[112:115], a[148:151], a[220:223], v[112:115]
 ds_read_b64_tr_b16 a[252:253], v5 offset:10240
 v_mul_f32 v172, v172, v206
 v_mfma_f32_16x16x32_bf16 v[116:119], a[144:147], a[224:227], v[116:119]
 ds_read_b64_tr_b16 a[254:255], v5 offset:15360
 v_mul_f32 v173, v173, v206
 v_mfma_f32_16x16x32_bf16 v[116:119], a[148:151], a[228:231], v[116:119]
 ds_read_b128 a[164:167], v2 offset:14336
 v_mul_f32 v174, v174, v206
 v_mfma_f32_16x16x32_bf16 v[120:123], a[144:147], a[232:235], v[120:123]
 buffer_load_dwordx4 v246, s[8:11], s31 offen offset:1024 sc1 lds
 v_mfma_f32_16x16x32_bf16 v[120:123], a[148:151], a[236:239], v[120:123]
 ds_read_b128 a[168:171], v2 offset:1024
 v_mul_f32 v175, v175, v206
 v_mfma_f32_16x16x32_bf16 v[124:127], a[144:147], a[240:243], v[124:127]
 ds_read_b128 a[172:175], v2 offset:15360
 v_mul_f32 v176, v176, v206
 v_mfma_f32_16x16x32_bf16 v[124:127], a[148:151], a[244:247], v[124:127]
 ds_read_b128 a[176:179], v2 offset:2048
 v_mul_f32 v177, v177, v206
 v_mfma_f32_16x16x32_bf16 v[128:131], a[152:155], a[192:195], v[128:131]
 buffer_load_dwordx4 v246, s[8:11], s31 offen offset:2048 sc1 lds
 v_mfma_f32_16x16x32_bf16 v[128:131], a[156:159], a[196:199], v[128:131]
 ds_read_b128 a[180:183], v2 offset:16384
 v_mul_f32 v178, v178, v206
 v_mfma_f32_16x16x32_bf16 v[132:135], a[152:155], a[200:203], v[132:135]
 ds_read_b128 a[184:187], v2 offset:3072
 v_mul_f32 v179, v179, v206
 v_mfma_f32_16x16x32_bf16 v[132:135], a[156:159], a[204:207], v[132:135]
 ds_read_b128 a[188:191], v2 offset:17408
 v_cvt_pk_bf16_f32 v180, v172, v173
 v_mfma_f32_16x16x32_bf16 v[136:139], a[152:155], a[208:211], v[136:139]
 buffer_load_dwordx4 v246, s[8:11], s31 offen offset:3072 sc1 lds
 v_mfma_f32_16x16x32_bf16 v[136:139], a[156:159], a[212:215], v[136:139]
 ds_read_b128 a[0:3], v2 offset:4096
 v_cvt_pk_bf16_f32 v181, v174, v175
 v_mfma_f32_16x16x32_bf16 v[140:143], a[152:155], a[216:219], v[140:143]
 ds_read_b128 a[4:7], v2 offset:18432
 s_add_u32 s34, s31, 4096
 v_mfma_f32_16x16x32_bf16 v[140:143], a[156:159], a[220:223], v[140:143]
 ds_read_b128 a[8:11], v2 offset:5120
 s_add_u32 m0, s29, 102400
 v_mfma_f32_16x16x32_bf16 v[144:147], a[152:155], a[224:227], v[144:147]
 buffer_load_dwordx4 v246, s[8:11], s34 offen sc1 lds
 v_mfma_f32_16x16x32_bf16 v[144:147], a[156:159], a[228:231], v[144:147]
 ds_read_b128 a[12:15], v2 offset:19456
 v_cvt_pk_bf16_f32 v182, v176, v177
 v_mfma_f32_16x16x32_bf16 v[148:151], a[152:155], a[232:235], v[148:151]
 ds_read_b128 a[16:19], v2 offset:6144
 v_cvt_pk_bf16_f32 v183, v178, v179
 v_mfma_f32_16x16x32_bf16 v[148:151], a[156:159], a[236:239], v[148:151]
 ds_read_b128 a[20:23], v2 offset:20480
 v_accvgpr_read_b32 v184, a104
 v_mfma_f32_16x16x32_bf16 v[152:155], a[152:155], a[240:243], v[152:155]
 buffer_load_dwordx4 v246, s[8:11], s34 offen offset:1024 sc1 lds
 v_mfma_f32_16x16x32_bf16 v[152:155], a[156:159], a[244:247], v[152:155]
 v_accvgpr_read_b32 v185, a105
 s_waitcnt lgkmcnt(8)
 v_mfma_f32_16x16x32_bf16 v[16:19], a[248:251], a[160:163], v[16:19]
 ds_read_b64_tr_b16 a[144:145], v6 offset:32
 v_accvgpr_read_b32 v186, a106
 v_mfma_f32_16x16x32_bf16 v[16:19], a[252:255], a[164:167], v[16:19]
 ds_read_b64_tr_b16 a[146:147], v6 offset:5152
 v_accvgpr_read_b32 v187, a107
 v_mfma_f32_16x16x32_bf16 v[20:23], a[248:251], a[168:171], v[20:23]
 buffer_load_dwordx4 v246, s[8:11], s34 offen offset:2048 sc1 lds
 v_mfma_f32_16x16x32_bf16 v[20:23], a[252:255], a[172:175], v[20:23]
 ds_read_b64_tr_b16 a[148:149], v6 offset:10272
 v_accvgpr_read_b32 v188, a108
 v_mfma_f32_16x16x32_bf16 v[24:27], a[248:251], a[176:179], v[24:27]
 ds_read_b64_tr_b16 a[150:151], v6 offset:15392
 v_accvgpr_read_b32 v189, a109
 v_mfma_f32_16x16x32_bf16 v[24:27], a[252:255], a[180:183], v[24:27]
 v_accvgpr_read_b32 v190, a110
 s_waitcnt lgkmcnt(4)
 v_mfma_f32_16x16x32_bf16 v[28:31], a[248:251], a[184:187], v[28:31]
 ds_read_b64_tr_b16 a[152:153], v5 offset:64
 v_accvgpr_read_b32 v191, a111
 v_mfma_f32_16x16x32_bf16 v[28:31], a[252:255], a[188:191], v[28:31]
 ds_read_b64_tr_b16 a[154:155], v5 offset:5184
 s_add_u32 m0, s30, 126976
 v_mfma_f32_16x16x32_bf16 v[32:35], a[248:251], a[0:3], v[32:35]
 buffer_load_dwordx4 v11, s[12:15], s32 offen lds
 v_mfma_f32_16x16x32_bf16 v[32:35], a[252:255], a[4:7], v[32:35]
 ds_read_b64_tr_b16 a[156:157], v5 offset:10304
 v_mul_f32 v184, v184, v206
 v_mfma_f32_16x16x32_bf16 v[36:39], a[248:251], a[8:11], v[36:39]
 ds_read_b64_tr_b16 a[158:159], v5 offset:15424
 v_mul_f32 v185, v185, v206
 v_mfma_f32_16x16x32_bf16 v[36:39], a[252:255], a[12:15], v[36:39]
 buffer_store_dwordx4 v[180:183], v246, s[24:27], s41 offen offset:2048 sc1
 v_mfma_f32_16x16x32_bf16 v[40:43], a[248:251], a[16:19], v[40:43]
 buffer_load_dwordx4 v12, s[12:15], s32 offen offset:1024 lds
 v_mfma_f32_16x16x32_bf16 v[40:43], a[252:255], a[20:23], v[40:43]
 v_mul_f32 v186, v186, v206
 s_waitcnt lgkmcnt(4)
 v_mfma_f32_16x16x32_bf16 v[44:47], a[144:147], a[160:163], v[44:47]
 v_mul_f32 v187, v187, v206
 v_mul_f32 v188, v188, v206
 v_mfma_f32_16x16x32_bf16 v[44:47], a[148:151], a[164:167], v[44:47]
 ds_read_b64_tr_b16 a[248:249], v6 offset:96
 v_mul_f32 v189, v189, v206
 v_mfma_f32_16x16x32_bf16 v[48:51], a[144:147], a[168:171], v[48:51]
 ds_read_b64_tr_b16 a[250:251], v6 offset:5216
 v_mul_f32 v190, v190, v206
 v_mfma_f32_16x16x32_bf16 v[48:51], a[148:151], a[172:175], v[48:51]
 buffer_load_dwordx4 v13, s[12:15], s32 offen offset:2048 lds
 v_mfma_f32_16x16x32_bf16 v[52:55], a[144:147], a[176:179], v[52:55]
 ds_read_b64_tr_b16 a[252:253], v6 offset:10336
 v_mul_f32 v191, v191, v206
 v_mfma_f32_16x16x32_bf16 v[52:55], a[148:151], a[180:183], v[52:55]
 ds_read_b64_tr_b16 a[254:255], v6 offset:15456
 v_cvt_pk_bf16_f32 v192, v184, v185
 v_mfma_f32_16x16x32_bf16 v[56:59], a[144:147], a[184:187], v[56:59]
 v_cvt_pk_bf16_f32 v193, v186, v187
 v_cvt_pk_bf16_f32 v194, v188, v189
 v_mfma_f32_16x16x32_bf16 v[56:59], a[148:151], a[188:191], v[56:59]
 buffer_load_dwordx4 v14, s[12:15], s32 offen offset:3072 lds
 v_mfma_f32_16x16x32_bf16 v[60:63], a[144:147], a[0:3], v[60:63]
 v_cvt_pk_bf16_f32 v195, v190, v191
 v_accvgpr_read_b32 v172, a112
 v_mfma_f32_16x16x32_bf16 v[60:63], a[148:151], a[4:7], v[60:63]
 buffer_store_dwordx4 v[192:195], v246, s[24:27], s42 offen offset:2048 sc1
 v_mfma_f32_16x16x32_bf16 v[64:67], a[144:147], a[8:11], v[64:67]
 s_add_u32 m0, s30, 131072
 v_accvgpr_read_b32 v173, a113
 v_mfma_f32_16x16x32_bf16 v[64:67], a[148:151], a[12:15], v[64:67]
 buffer_load_dwordx4 v15, s[12:15], s32 offen lds
 v_mfma_f32_16x16x32_bf16 v[68:71], a[144:147], a[16:19], v[68:71]
 s_add_u32 s31, s31, 28672
 v_accvgpr_read_b32 v174, a114
 v_mfma_f32_16x16x32_bf16 v[68:71], a[148:151], a[20:23], v[68:71]
 s_add_u32 s32, s32, 81920
 s_waitcnt lgkmcnt(4)
 v_mfma_f32_16x16x32_bf16 v[72:75], a[152:155], a[160:163], v[72:75]
 s_cmp_eq_u32 s31, s36
 s_cselect_b32 s31, s38, s31
 v_mfma_f32_16x16x32_bf16 v[72:75], a[156:159], a[164:167], v[72:75]
 ds_read_b64_tr_b16 a[144:145], v5 offset:128
 s_cmp_eq_u32 s32, s37
 s_cselect_b32 s32, s39, s32
 v_mfma_f32_16x16x32_bf16 v[76:79], a[152:155], a[168:171], v[76:79]
 ds_read_b64_tr_b16 a[146:147], v5 offset:5248
 v_accvgpr_read_b32 v175, a115
 v_mfma_f32_16x16x32_bf16 v[76:79], a[156:159], a[172:175], v[76:79]
 v_accvgpr_read_b32 v176, a116
 v_accvgpr_read_b32 v177, a117
 v_mfma_f32_16x16x32_bf16 v[80:83], a[152:155], a[176:179], v[80:83]
 ds_read_b64_tr_b16 a[148:149], v5 offset:10368
 v_accvgpr_read_b32 v178, a118
 v_mfma_f32_16x16x32_bf16 v[80:83], a[156:159], a[180:183], v[80:83]
 ds_read_b64_tr_b16 a[150:151], v5 offset:15488
 v_accvgpr_read_b32 v179, a119
 v_mfma_f32_16x16x32_bf16 v[84:87], a[152:155], a[184:187], v[84:87]
 v_mul_f32 v172, v172, v206
 v_mul_f32 v173, v173, v206
 v_mfma_f32_16x16x32_bf16 v[84:87], a[156:159], a[188:191], v[84:87]
 v_mul_f32 v174, v174, v206
 v_mul_f32 v175, v175, v206
 v_mfma_f32_16x16x32_bf16 v[88:91], a[152:155], a[0:3], v[88:91]
 v_mul_f32 v176, v176, v206
 v_mul_f32 v177, v177, v206
 v_mfma_f32_16x16x32_bf16 v[88:91], a[156:159], a[4:7], v[88:91]
 v_mul_f32 v178, v178, v206
 v_mul_f32 v179, v179, v206
 v_mfma_f32_16x16x32_bf16 v[92:95], a[152:155], a[8:11], v[92:95]
 v_cvt_pk_bf16_f32 v180, v172, v173
 v_cvt_pk_bf16_f32 v181, v174, v175
 v_mfma_f32_16x16x32_bf16 v[92:95], a[156:159], a[12:15], v[92:95]
 v_cvt_pk_bf16_f32 v182, v176, v177
 v_cvt_pk_bf16_f32 v183, v178, v179
 v_mfma_f32_16x16x32_bf16 v[96:99], a[152:155], a[16:19], v[96:99]
 buffer_store_dwordx4 v[180:183], v246, s[24:27], s43 offen offset:2048 sc1
 v_mfma_f32_16x16x32_bf16 v[96:99], a[156:159], a[20:23], v[96:99]
 v_accvgpr_read_b32 v184, a120
 s_waitcnt lgkmcnt(4)
 v_mfma_f32_16x16x32_bf16 v[100:103], a[248:251], a[160:163], v[100:103]
 v_accvgpr_read_b32 v185, a121
 v_accvgpr_read_b32 v186, a122
 v_mfma_f32_16x16x32_bf16 v[100:103], a[252:255], a[164:167], v[100:103]
 v_accvgpr_read_b32 v187, a123
 s_waitcnt vmcnt(17) lgkmcnt(0)
 v_mfma_f32_16x16x32_bf16 v[104:107], a[248:251], a[168:171], v[104:107]
 v_accvgpr_read_b32 v188, a124
 s_barrier
 v_mfma_f32_16x16x32_bf16 v[104:107], a[252:255], a[172:175], v[104:107]
 ds_read_b64_tr_b16 a[152:153], v7 offset:0
 v_accvgpr_read_b32 v189, a125
 v_mfma_f32_16x16x32_bf16 v[108:111], a[248:251], a[176:179], v[108:111]
 ds_read_b64_tr_b16 a[154:155], v7 offset:5120
 v_accvgpr_read_b32 v190, a126
 v_mfma_f32_16x16x32_bf16 v[108:111], a[252:255], a[180:183], v[108:111]
 ds_read_b128 a[192:195], v3 offset:0
 s_add_u32 m0, s29, 0
 v_mfma_f32_16x16x32_bf16 v[112:115], a[248:251], a[184:187], v[112:115]
 buffer_load_dwordx4 v246, s[8:11], s31 offen sc1 lds
 v_mfma_f32_16x16x32_bf16 v[112:115], a[252:255], a[188:191], v[112:115]
 ds_read_b64_tr_b16 a[156:157], v7 offset:10240
 v_accvgpr_read_b32 v191, a127
 v_mfma_f32_16x16x32_bf16 v[116:119], a[248:251], a[0:3], v[116:119]
 ds_read_b64_tr_b16 a[158:159], v7 offset:15360
 v_mul_f32 v184, v184, v206
 v_mfma_f32_16x16x32_bf16 v[116:119], a[252:255], a[4:7], v[116:119]
 ds_read_b128 a[196:199], v3 offset:14336
 v_mul_f32 v185, v185, v206
 v_mfma_f32_16x16x32_bf16 v[120:123], a[248:251], a[8:11], v[120:123]
 buffer_load_dwordx4 v246, s[8:11], s31 offen offset:1024 sc1 lds
 v_mfma_f32_16x16x32_bf16 v[120:123], a[252:255], a[12:15], v[120:123]
 ds_read_b128 a[200:203], v3 offset:1024
 v_mul_f32 v186, v186, v206
 v_mfma_f32_16x16x32_bf16 v[124:127], a[248:251], a[16:19], v[124:127]
 ds_read_b128 a[204:207], v3 offset:15360
 v_mul_f32 v187, v187, v206
 v_mfma_f32_16x16x32_bf16 v[124:127], a[252:255], a[20:23], v[124:127]
 ds_read_b128 a[208:211], v3 offset:2048
 v_mul_f32 v188, v188, v206
 v_mfma_f32_16x16x32_bf16 v[128:131], a[144:147], a[160:163], v[128:131]
 buffer_load_dwordx4 v246, s[8:11], s31 offen offset:2048 sc1 lds
 v_mfma_f32_16x16x32_bf16 v[128:131], a[148:151], a[164:167], v[128:131]
 ds_read_b128 a[212:215], v3 offset:16384
 v_mul_f32 v189, v189, v206
 v_mfma_f32_16x16x32_bf16 v[132:135], a[144:147], a[168:171], v[132:135]
 ds_read_b128 a[216:219], v3 offset:3072
 v_mul_f32 v190, v190, v206
 v_mfma_f32_16x16x32_bf16 v[132:135], a[148:151], a[172:175], v[132:135]
 ds_read_b128 a[220:223], v3 offset:17408
 v_mul_f32 v191, v191, v206
 v_mfma_f32_16x16x32_bf16 v[136:139], a[144:147], a[176:179], v[136:139]
 buffer_load_dwordx4 v246, s[8:11], s31 offen offset:3072 sc1 lds
 v_mfma_f32_16x16x32_bf16 v[136:139], a[148:151], a[180:183], v[136:139]
 ds_read_b128 a[224:227], v3 offset:4096
 v_cvt_pk_bf16_f32 v192, v184, v185
 v_mfma_f32_16x16x32_bf16 v[140:143], a[144:147], a[184:187], v[140:143]
 ds_read_b128 a[228:231], v3 offset:18432
 s_add_u32 s34, s31, 4096
 v_mfma_f32_16x16x32_bf16 v[140:143], a[148:151], a[188:191], v[140:143]
 ds_read_b128 a[232:235], v3 offset:5120
 s_add_u32 m0, s29, 4096
 v_mfma_f32_16x16x32_bf16 v[144:147], a[144:147], a[0:3], v[144:147]
 buffer_load_dwordx4 v246, s[8:11], s34 offen sc1 lds
 v_mfma_f32_16x16x32_bf16 v[144:147], a[148:151], a[4:7], v[144:147]
 ds_read_b128 a[236:239], v3 offset:19456
 v_cvt_pk_bf16_f32 v193, v186, v187
 v_mfma_f32_16x16x32_bf16 v[148:151], a[144:147], a[8:11], v[148:151]
 ds_read_b128 a[240:243], v3 offset:6144
 v_cvt_pk_bf16_f32 v194, v188, v189
 v_mfma_f32_16x16x32_bf16 v[148:151], a[148:151], a[12:15], v[148:151]
 ds_read_b128 a[244:247], v3 offset:20480
 v_cvt_pk_bf16_f32 v195, v190, v191
 v_mfma_f32_16x16x32_bf16 v[152:155], a[144:147], a[16:19], v[152:155]
 buffer_load_dwordx4 v246, s[8:11], s34 offen offset:1024 sc1 lds
 v_mfma_f32_16x16x32_bf16 v[152:155], a[148:151], a[20:23], v[152:155]
 v_accvgpr_read_b32 v172, a128
 s_waitcnt lgkmcnt(8)
 v_mfma_f32_16x16x32_bf16 v[16:19], a[152:155], a[192:195], v[16:19]
 ds_read_b64_tr_b16 a[248:249], v8 offset:32
 v_accvgpr_read_b32 v173, a129
 v_mfma_f32_16x16x32_bf16 v[16:19], a[156:159], a[196:199], v[16:19]
 ds_read_b64_tr_b16 a[250:251], v8 offset:5152
 v_accvgpr_read_b32 v174, a130
 v_mfma_f32_16x16x32_bf16 v[20:23], a[152:155], a[200:203], v[20:23]
 buffer_load_dwordx4 v246, s[8:11], s34 offen offset:2048 sc1 lds
 v_mfma_f32_16x16x32_bf16 v[20:23], a[156:159], a[204:207], v[20:23]
 ds_read_b64_tr_b16 a[252:253], v8 offset:10272
 v_accvgpr_read_b32 v175, a131
 v_mfma_f32_16x16x32_bf16 v[24:27], a[152:155], a[208:211], v[24:27]
 ds_read_b64_tr_b16 a[254:255], v8 offset:15392
 v_accvgpr_read_b32 v176, a132
 v_mfma_f32_16x16x32_bf16 v[24:27], a[156:159], a[212:215], v[24:27]
 v_accvgpr_read_b32 v177, a133
 s_waitcnt lgkmcnt(4)
 v_mfma_f32_16x16x32_bf16 v[28:31], a[152:155], a[216:219], v[28:31]
 ds_read_b64_tr_b16 a[144:145], v7 offset:64
 v_accvgpr_read_b32 v178, a134
 v_mfma_f32_16x16x32_bf16 v[28:31], a[156:159], a[220:223], v[28:31]
 ds_read_b64_tr_b16 a[146:147], v7 offset:5184
 s_add_u32 m0, s30, 28672
 v_mfma_f32_16x16x32_bf16 v[32:35], a[152:155], a[224:227], v[32:35]
 buffer_load_dwordx4 v11, s[12:15], s32 offen lds
 v_mfma_f32_16x16x32_bf16 v[32:35], a[156:159], a[228:231], v[32:35]
 ds_read_b64_tr_b16 a[148:149], v7 offset:10304
 v_accvgpr_read_b32 v179, a135
 v_mfma_f32_16x16x32_bf16 v[36:39], a[152:155], a[232:235], v[36:39]
 ds_read_b64_tr_b16 a[150:151], v7 offset:15424
 v_mul_f32 v172, v172, v206
 v_mfma_f32_16x16x32_bf16 v[36:39], a[156:159], a[236:239], v[36:39]
 buffer_store_dwordx4 v[192:195], v246, s[24:27], s44 offen offset:2048 sc1
 v_mfma_f32_16x16x32_bf16 v[40:43], a[152:155], a[240:243], v[40:43]
 buffer_load_dwordx4 v12, s[12:15], s32 offen offset:1024 lds
 v_mfma_f32_16x16x32_bf16 v[40:43], a[156:159], a[244:247], v[40:43]
 v_mul_f32 v173, v173, v206
 s_waitcnt lgkmcnt(4)
 v_mfma_f32_16x16x32_bf16 v[44:47], a[248:251], a[192:195], v[44:47]
 v_mul_f32 v174, v174, v206
 v_mul_f32 v175, v175, v206
 v_mfma_f32_16x16x32_bf16 v[44:47], a[252:255], a[196:199], v[44:47]
 ds_read_b64_tr_b16 a[152:153], v8 offset:96
 v_mul_f32 v176, v176, v206
 v_mfma_f32_16x16x32_bf16 v[48:51], a[248:251], a[200:203], v[48:51]
 ds_read_b64_tr_b16 a[154:155], v8 offset:5216
 v_mul_f32 v177, v177, v206
 v_mfma_f32_16x16x32_bf16 v[48:51], a[252:255], a[204:207], v[48:51]
 buffer_load_dwordx4 v13, s[12:15], s32 offen offset:2048 lds
 v_mfma_f32_16x16x32_bf16 v[52:55], a[248:251], a[208:211], v[52:55]
 ds_read_b64_tr_b16 a[156:157], v8 offset:10336
 v_mul_f32 v178, v178, v206
 v_mfma_f32_16x16x32_bf16 v[52:55], a[252:255], a[212:215], v[52:55]
 ds_read_b64_tr_b16 a[158:159], v8 offset:15456
 v_mul_f32 v179, v179, v206
 v_mfma_f32_16x16x32_bf16 v[56:59], a[248:251], a[216:219], v[56:59]
 v_cvt_pk_bf16_f32 v180, v172, v173
 v_cvt_pk_bf16_f32 v181, v174, v175
 v_mfma_f32_16x16x32_bf16 v[56:59], a[252:255], a[220:223], v[56:59]
 buffer_load_dwordx4 v14, s[12:15], s32 offen offset:3072 lds
 v_mfma_f32_16x16x32_bf16 v[60:63], a[248:251], a[224:227], v[60:63]
 v_cvt_pk_bf16_f32 v182, v176, v177
 v_cvt_pk_bf16_f32 v183, v178, v179
 v_mfma_f32_16x16x32_bf16 v[60:63], a[252:255], a[228:231], v[60:63]
 buffer_store_dwordx4 v[180:183], v246, s[24:27], s45 offen offset:2048 sc1
 v_mfma_f32_16x16x32_bf16 v[64:67], a[248:251], a[232:235], v[64:67]
 s_add_u32 m0, s30, 32768
 v_accvgpr_read_b32 v184, a136
 v_mfma_f32_16x16x32_bf16 v[64:67], a[252:255], a[236:239], v[64:67]
 buffer_load_dwordx4 v15, s[12:15], s32 offen lds
 v_mfma_f32_16x16x32_bf16 v[68:71], a[248:251], a[240:243], v[68:71]
 s_add_u32 s31, s31, 28672
 v_accvgpr_read_b32 v185, a137
 v_mfma_f32_16x16x32_bf16 v[68:71], a[252:255], a[244:247], v[68:71]
 s_add_u32 s32, s32, 81920
 s_waitcnt lgkmcnt(4)
 v_mfma_f32_16x16x32_bf16 v[72:75], a[144:147], a[192:195], v[72:75]
 v_accvgpr_read_b32 v186, a138
 v_accvgpr_read_b32 v187, a139
 v_mfma_f32_16x16x32_bf16 v[72:75], a[148:151], a[196:199], v[72:75]
 ds_read_b64_tr_b16 a[248:249], v7 offset:128
 v_accvgpr_read_b32 v188, a140
 v_mfma_f32_16x16x32_bf16 v[76:79], a[144:147], a[200:203], v[76:79]
 ds_read_b64_tr_b16 a[250:251], v7 offset:5248
 v_accvgpr_read_b32 v189, a141
 v_mfma_f32_16x16x32_bf16 v[76:79], a[148:151], a[204:207], v[76:79]
 v_accvgpr_read_b32 v190, a142
 v_accvgpr_read_b32 v191, a143
 v_mfma_f32_16x16x32_bf16 v[80:83], a[144:147], a[208:211], v[80:83]
 ds_read_b64_tr_b16 a[252:253], v7 offset:10368
 v_mul_f32 v184, v184, v206
 v_mfma_f32_16x16x32_bf16 v[80:83], a[148:151], a[212:215], v[80:83]
 ds_read_b64_tr_b16 a[254:255], v7 offset:15488
 v_mul_f32 v185, v185, v206
 v_mfma_f32_16x16x32_bf16 v[84:87], a[144:147], a[216:219], v[84:87]
 v_mul_f32 v186, v186, v206
 v_mul_f32 v187, v187, v206
 v_mfma_f32_16x16x32_bf16 v[84:87], a[148:151], a[220:223], v[84:87]
 v_mul_f32 v188, v188, v206
 v_mul_f32 v189, v189, v206
 v_mfma_f32_16x16x32_bf16 v[88:91], a[144:147], a[224:227], v[88:91]
 v_mul_f32 v190, v190, v206
 v_mul_f32 v191, v191, v206
 v_mfma_f32_16x16x32_bf16 v[88:91], a[148:151], a[228:231], v[88:91]
 v_cvt_pk_bf16_f32 v192, v184, v185
 v_cvt_pk_bf16_f32 v193, v186, v187
 v_mfma_f32_16x16x32_bf16 v[92:95], a[144:147], a[232:235], v[92:95]
 v_cvt_pk_bf16_f32 v194, v188, v189
 v_cvt_pk_bf16_f32 v195, v190, v191
 v_mfma_f32_16x16x32_bf16 v[92:95], a[148:151], a[236:239], v[92:95]
 buffer_store_dwordx4 v[192:195], v246, s[24:27], s46 offen offset:2048 sc1
 v_mfma_f32_16x16x32_bf16 v[96:99], a[144:147], a[240:243], v[96:99]
 v_mfma_f32_16x16x32_bf16 v[96:99], a[148:151], a[244:247], v[96:99]
 s_waitcnt lgkmcnt(4)
 v_mfma_f32_16x16x32_bf16 v[100:103], a[152:155], a[192:195], v[100:103]
 v_mfma_f32_16x16x32_bf16 v[100:103], a[156:159], a[196:199], v[100:103]
 s_waitcnt vmcnt(16) lgkmcnt(0)
 v_mfma_f32_16x16x32_bf16 v[104:107], a[152:155], a[200:203], v[104:107]
 s_barrier
 v_mfma_f32_16x16x32_bf16 v[104:107], a[156:159], a[204:207], v[104:107]
 ds_read_b64_tr_b16 a[144:145], v9 offset:0
 v_mfma_f32_16x16x32_bf16 v[108:111], a[152:155], a[208:211], v[108:111]
 ds_read_b64_tr_b16 a[146:147], v9 offset:5120
 v_mfma_f32_16x16x32_bf16 v[108:111], a[156:159], a[212:215], v[108:111]
 ds_read_b128 a[160:163], v4 offset:0
 s_add_u32 m0, s29, 49152
 v_mfma_f32_16x16x32_bf16 v[112:115], a[152:155], a[216:219], v[112:115]
 buffer_load_dwordx4 v246, s[8:11], s31 offen sc1 lds
 v_mfma_f32_16x16x32_bf16 v[112:115], a[156:159], a[220:223], v[112:115]
 ds_read_b64_tr_b16 a[148:149], v9 offset:10240
 v_mfma_f32_16x16x32_bf16 v[116:119], a[152:155], a[224:227], v[116:119]
 ds_read_b64_tr_b16 a[150:151], v9 offset:15360
 v_mfma_f32_16x16x32_bf16 v[116:119], a[156:159], a[228:231], v[116:119]
 ds_read_b128 a[164:167], v4 offset:14336
 v_mfma_f32_16x16x32_bf16 v[120:123], a[152:155], a[232:235], v[120:123]
 buffer_load_dwordx4 v246, s[8:11], s31 offen offset:1024 sc1 lds
 v_mfma_f32_16x16x32_bf16 v[120:123], a[156:159], a[236:239], v[120:123]
 ds_read_b128 a[168:171], v4 offset:1024
 v_mfma_f32_16x16x32_bf16 v[124:127], a[152:155], a[240:243], v[124:127]
 ds_read_b128 a[172:175], v4 offset:15360
 v_mfma_f32_16x16x32_bf16 v[124:127], a[156:159], a[244:247], v[124:127]
 ds_read_b128 a[176:179], v4 offset:2048
 v_mfma_f32_16x16x32_bf16 v[128:131], a[248:251], a[192:195], v[128:131]
 buffer_load_dwordx4 v246, s[8:11], s31 offen offset:2048 sc1 lds
 v_mfma_f32_16x16x32_bf16 v[128:131], a[252:255], a[196:199], v[128:131]
 ds_read_b128 a[180:183], v4 offset:16384
 v_mfma_f32_16x16x32_bf16 v[132:135], a[248:251], a[200:203], v[132:135]
 ds_read_b128 a[184:187], v4 offset:3072
 v_mfma_f32_16x16x32_bf16 v[132:135], a[252:255], a[204:207], v[132:135]
 ds_read_b128 a[188:191], v4 offset:17408
 v_mfma_f32_16x16x32_bf16 v[136:139], a[248:251], a[208:211], v[136:139]
 buffer_load_dwordx4 v246, s[8:11], s31 offen offset:3072 sc1 lds
 v_mfma_f32_16x16x32_bf16 v[136:139], a[252:255], a[212:215], v[136:139]
 ds_read_b128 a[0:3], v4 offset:4096
 v_mfma_f32_16x16x32_bf16 v[140:143], a[248:251], a[216:219], v[140:143]
 ds_read_b128 a[4:7], v4 offset:18432
 s_add_u32 s34, s31, 4096
 v_mfma_f32_16x16x32_bf16 v[140:143], a[252:255], a[220:223], v[140:143]
 ds_read_b128 a[8:11], v4 offset:5120
 s_add_u32 m0, s29, 53248
 v_mfma_f32_16x16x32_bf16 v[144:147], a[248:251], a[224:227], v[144:147]
 buffer_load_dwordx4 v246, s[8:11], s34 offen sc1 lds
 v_mfma_f32_16x16x32_bf16 v[144:147], a[252:255], a[228:231], v[144:147]
 ds_read_b128 a[12:15], v4 offset:19456
 v_mfma_f32_16x16x32_bf16 v[148:151], a[248:251], a[232:235], v[148:151]
 ds_read_b128 a[16:19], v4 offset:6144
 v_mfma_f32_16x16x32_bf16 v[148:151], a[252:255], a[236:239], v[148:151]
 ds_read_b128 a[20:23], v4 offset:20480
 v_mfma_f32_16x16x32_bf16 v[152:155], a[248:251], a[240:243], v[152:155]
 buffer_load_dwordx4 v246, s[8:11], s34 offen offset:1024 sc1 lds
 v_mfma_f32_16x16x32_bf16 v[152:155], a[252:255], a[244:247], v[152:155]
 s_waitcnt lgkmcnt(8)
 v_mfma_f32_16x16x32_bf16 v[16:19], a[144:147], a[160:163], v[16:19]
 ds_read_b64_tr_b16 a[152:153], v10 offset:32
 v_mfma_f32_16x16x32_bf16 v[16:19], a[148:151], a[164:167], v[16:19]
 ds_read_b64_tr_b16 a[154:155], v10 offset:5152
 v_mfma_f32_16x16x32_bf16 v[20:23], a[144:147], a[168:171], v[20:23]
 buffer_load_dwordx4 v246, s[8:11], s34 offen offset:2048 sc1 lds
 v_mfma_f32_16x16x32_bf16 v[20:23], a[148:151], a[172:175], v[20:23]
 ds_read_b64_tr_b16 a[156:157], v10 offset:10272
 v_mfma_f32_16x16x32_bf16 v[24:27], a[144:147], a[176:179], v[24:27]
 ds_read_b64_tr_b16 a[158:159], v10 offset:15392
 v_mfma_f32_16x16x32_bf16 v[24:27], a[148:151], a[180:183], v[24:27]
 s_waitcnt lgkmcnt(4)
 v_mfma_f32_16x16x32_bf16 v[28:31], a[144:147], a[184:187], v[28:31]
 ds_read_b64_tr_b16 a[248:249], v9 offset:64
 v_mfma_f32_16x16x32_bf16 v[28:31], a[148:151], a[188:191], v[28:31]
 ds_read_b64_tr_b16 a[250:251], v9 offset:5184
 s_add_u32 m0, s30, 77824
 v_mfma_f32_16x16x32_bf16 v[32:35], a[144:147], a[0:3], v[32:35]
 buffer_load_dwordx4 v11, s[12:15], s32 offen lds
 v_mfma_f32_16x16x32_bf16 v[32:35], a[148:151], a[4:7], v[32:35]
 ds_read_b64_tr_b16 a[252:253], v9 offset:10304
 v_mfma_f32_16x16x32_bf16 v[36:39], a[144:147], a[8:11], v[36:39]
 ds_read_b64_tr_b16 a[254:255], v9 offset:15424
 v_mfma_f32_16x16x32_bf16 v[36:39], a[148:151], a[12:15], v[36:39]
 v_mfma_f32_16x16x32_bf16 v[40:43], a[144:147], a[16:19], v[40:43]
 buffer_load_dwordx4 v12, s[12:15], s32 offen offset:1024 lds
 v_mfma_f32_16x16x32_bf16 v[40:43], a[148:151], a[20:23], v[40:43]
 s_waitcnt lgkmcnt(4)
 v_mfma_f32_16x16x32_bf16 v[44:47], a[152:155], a[160:163], v[44:47]
 v_mfma_f32_16x16x32_bf16 v[44:47], a[156:159], a[164:167], v[44:47]
 ds_read_b64_tr_b16 a[144:145], v10 offset:96
 v_mfma_f32_16x16x32_bf16 v[48:51], a[152:155], a[168:171], v[48:51]
 ds_read_b64_tr_b16 a[146:147], v10 offset:5216
 v_mfma_f32_16x16x32_bf16 v[48:51], a[156:159], a[172:175], v[48:51]
 buffer_load_dwordx4 v13, s[12:15], s32 offen offset:2048 lds
 v_mfma_f32_16x16x32_bf16 v[52:55], a[152:155], a[176:179], v[52:55]
 ds_read_b64_tr_b16 a[148:149], v10 offset:10336
 v_mfma_f32_16x16x32_bf16 v[52:55], a[156:159], a[180:183], v[52:55]
 ds_read_b64_tr_b16 a[150:151], v10 offset:15456
 v_mfma_f32_16x16x32_bf16 v[56:59], a[152:155], a[184:187], v[56:59]
 v_mfma_f32_16x16x32_bf16 v[56:59], a[156:159], a[188:191], v[56:59]
 buffer_load_dwordx4 v14, s[12:15], s32 offen offset:3072 lds
 v_mfma_f32_16x16x32_bf16 v[60:63], a[152:155], a[0:3], v[60:63]
 v_mfma_f32_16x16x32_bf16 v[60:63], a[156:159], a[4:7], v[60:63]
 v_mfma_f32_16x16x32_bf16 v[64:67], a[152:155], a[8:11], v[64:67]
 s_add_u32 m0, s30, 81920
 v_mfma_f32_16x16x32_bf16 v[64:67], a[156:159], a[12:15], v[64:67]
 buffer_load_dwordx4 v15, s[12:15], s32 offen lds
 v_mfma_f32_16x16x32_bf16 v[68:71], a[152:155], a[16:19], v[68:71]
 s_add_u32 s31, s31, 28672
 v_mfma_f32_16x16x32_bf16 v[68:71], a[156:159], a[20:23], v[68:71]
 s_add_u32 s32, s32, 81920
 s_waitcnt lgkmcnt(4)
 v_mfma_f32_16x16x32_bf16 v[72:75], a[248:251], a[160:163], v[72:75]
 v_mfma_f32_16x16x32_bf16 v[72:75], a[252:255], a[164:167], v[72:75]
 ds_read_b64_tr_b16 a[152:153], v9 offset:128
 v_mfma_f32_16x16x32_bf16 v[76:79], a[248:251], a[168:171], v[76:79]
 ds_read_b64_tr_b16 a[154:155], v9 offset:5248
 v_mfma_f32_16x16x32_bf16 v[76:79], a[252:255], a[172:175], v[76:79]
 v_mfma_f32_16x16x32_bf16 v[80:83], a[248:251], a[176:179], v[80:83]
 ds_read_b64_tr_b16 a[156:157], v9 offset:10368
 v_mfma_f32_16x16x32_bf16 v[80:83], a[252:255], a[180:183], v[80:83]
 ds_read_b64_tr_b16 a[158:159], v9 offset:15488
 v_mfma_f32_16x16x32_bf16 v[84:87], a[248:251], a[184:187], v[84:87]
 v_mfma_f32_16x16x32_bf16 v[84:87], a[252:255], a[188:191], v[84:87]
 v_mfma_f32_16x16x32_bf16 v[88:91], a[248:251], a[0:3], v[88:91]
 v_mfma_f32_16x16x32_bf16 v[88:91], a[252:255], a[4:7], v[88:91]
 v_mfma_f32_16x16x32_bf16 v[92:95], a[248:251], a[8:11], v[92:95]
 v_mfma_f32_16x16x32_bf16 v[92:95], a[252:255], a[12:15], v[92:95]
 v_mfma_f32_16x16x32_bf16 v[96:99], a[248:251], a[16:19], v[96:99]
 v_mfma_f32_16x16x32_bf16 v[96:99], a[252:255], a[20:23], v[96:99]
 s_waitcnt lgkmcnt(4)
 v_mfma_f32_16x16x32_bf16 v[100:103], a[144:147], a[160:163], v[100:103]
 v_mfma_f32_16x16x32_bf16 v[100:103], a[148:151], a[164:167], v[100:103]
 s_waitcnt vmcnt(13) lgkmcnt(0)
 v_mfma_f32_16x16x32_bf16 v[104:107], a[144:147], a[168:171], v[104:107]
 s_barrier
 v_mfma_f32_16x16x32_bf16 v[104:107], a[148:151], a[172:175], v[104:107]
 ds_read_b64_tr_b16 a[248:249], v5 offset:0
 v_mfma_f32_16x16x32_bf16 v[108:111], a[144:147], a[176:179], v[108:111]
 ds_read_b64_tr_b16 a[250:251], v5 offset:5120
 v_mfma_f32_16x16x32_bf16 v[108:111], a[148:151], a[180:183], v[108:111]
 ds_read_b128 a[192:195], v2 offset:0
 s_add_u32 m0, s29, 98304
 v_mfma_f32_16x16x32_bf16 v[112:115], a[144:147], a[184:187], v[112:115]
 buffer_load_dwordx4 v246, s[8:11], s31 offen sc1 lds
 v_mfma_f32_16x16x32_bf16 v[112:115], a[148:151], a[188:191], v[112:115]
 ds_read_b64_tr_b16 a[252:253], v5 offset:10240
 v_mfma_f32_16x16x32_bf16 v[116:119], a[144:147], a[0:3], v[116:119]
 ds_read_b64_tr_b16 a[254:255], v5 offset:15360
 v_mfma_f32_16x16x32_bf16 v[116:119], a[148:151], a[4:7], v[116:119]
 ds_read_b128 a[196:199], v2 offset:14336
 v_mfma_f32_16x16x32_bf16 v[120:123], a[144:147], a[8:11], v[120:123]
 buffer_load_dwordx4 v246, s[8:11], s31 offen offset:1024 sc1 lds
 v_mfma_f32_16x16x32_bf16 v[120:123], a[148:151], a[12:15], v[120:123]
 ds_read_b128 a[200:203], v2 offset:1024
 v_mfma_f32_16x16x32_bf16 v[124:127], a[144:147], a[16:19], v[124:127]
 ds_read_b128 a[204:207], v2 offset:15360
 v_mfma_f32_16x16x32_bf16 v[124:127], a[148:151], a[20:23], v[124:127]
 ds_read_b128 a[208:211], v2 offset:2048
 v_mfma_f32_16x16x32_bf16 v[128:131], a[152:155], a[160:163], v[128:131]
 buffer_load_dwordx4 v246, s[8:11], s31 offen offset:2048 sc1 lds
 v_mfma_f32_16x16x32_bf16 v[128:131], a[156:159], a[164:167], v[128:131]
 ds_read_b128 a[212:215], v2 offset:16384
 v_mfma_f32_16x16x32_bf16 v[132:135], a[152:155], a[168:171], v[132:135]
 ds_read_b128 a[216:219], v2 offset:3072
 v_mfma_f32_16x16x32_bf16 v[132:135], a[156:159], a[172:175], v[132:135]
 ds_read_b128 a[220:223], v2 offset:17408
 v_mfma_f32_16x16x32_bf16 v[136:139], a[152:155], a[176:179], v[136:139]
 buffer_load_dwordx4 v246, s[8:11], s31 offen offset:3072 sc1 lds
 v_mfma_f32_16x16x32_bf16 v[136:139], a[156:159], a[180:183], v[136:139]
 ds_read_b128 a[224:227], v2 offset:4096
 v_mfma_f32_16x16x32_bf16 v[140:143], a[152:155], a[184:187], v[140:143]
 ds_read_b128 a[228:231], v2 offset:18432
 s_add_u32 s34, s31, 4096
 v_mfma_f32_16x16x32_bf16 v[140:143], a[156:159], a[188:191], v[140:143]
 ds_read_b128 a[232:235], v2 offset:5120
 s_add_u32 m0, s29, 102400
 v_mfma_f32_16x16x32_bf16 v[144:147], a[152:155], a[0:3], v[144:147]
 buffer_load_dwordx4 v246, s[8:11], s34 offen sc1 lds
 v_mfma_f32_16x16x32_bf16 v[144:147], a[156:159], a[4:7], v[144:147]
 ds_read_b128 a[236:239], v2 offset:19456
 v_mfma_f32_16x16x32_bf16 v[148:151], a[152:155], a[8:11], v[148:151]
 ds_read_b128 a[240:243], v2 offset:6144
 v_mfma_f32_16x16x32_bf16 v[148:151], a[156:159], a[12:15], v[148:151]
 ds_read_b128 a[244:247], v2 offset:20480
 v_mfma_f32_16x16x32_bf16 v[152:155], a[152:155], a[16:19], v[152:155]
 buffer_load_dwordx4 v246, s[8:11], s34 offen offset:1024 sc1 lds
 v_mfma_f32_16x16x32_bf16 v[152:155], a[156:159], a[20:23], v[152:155]
 s_waitcnt lgkmcnt(8)
.p2align 3
P_loop:
 v_mfma_f32_16x16x32_bf16 v[16:19], a[248:251], a[192:195], v[16:19]
 ds_read_b64_tr_b16 a[144:145], v6 offset:32
 v_mfma_f32_16x16x32_bf16 v[16:19], a[252:255], a[196:199], v[16:19]
 ds_read_b64_tr_b16 a[146:147], v6 offset:5152
 v_mfma_f32_16x16x32_bf16 v[20:23], a[248:251], a[200:203], v[20:23]
 buffer_load_dwordx4 v246, s[8:11], s34 offen offset:2048 sc1 lds
 v_mfma_f32_16x16x32_bf16 v[20:23], a[252:255], a[204:207], v[20:23]
 ds_read_b64_tr_b16 a[148:149], v6 offset:10272
 v_mfma_f32_16x16x32_bf16 v[24:27], a[248:251], a[208:211], v[24:27]
 ds_read_b64_tr_b16 a[150:151], v6 offset:15392
 v_mfma_f32_16x16x32_bf16 v[24:27], a[252:255], a[212:215], v[24:27]
 s_waitcnt lgkmcnt(4)
 v_mfma_f32_16x16x32_bf16 v[28:31], a[248:251], a[216:219], v[28:31]
 ds_read_b64_tr_b16 a[152:153], v5 offset:64
 v_mfma_f32_16x16x32_bf16 v[28:31], a[252:255], a[220:223], v[28:31]
 ds_read_b64_tr_b16 a[154:155], v5 offset:5184
 s_add_u32 m0, s30, 126976
 v_mfma_f32_16x16x32_bf16 v[32:35], a[248:251], a[224:227], v[32:35]
 buffer_load_dwordx4 v11, s[12:15], s32 offen lds
 v_mfma_f32_16x16x32_bf16 v[32:35], a[252:255], a[228:231], v[32:35]
 ds_read_b64_tr_b16 a[156:157], v5 offset:10304
 v_mfma_f32_16x16x32_bf16 v[36:39], a[248:251], a[232:235], v[36:39]
 ds_read_b64_tr_b16 a[158:159], v5 offset:15424
 v_mfma_f32_16x16x32_bf16 v[36:39], a[252:255], a[236:239], v[36:39]
 v_mfma_f32_16x16x32_bf16 v[40:43], a[248:251], a[240:243], v[40:43]
 buffer_load_dwordx4 v12, s[12:15], s32 offen offset:1024 lds
 v_mfma_f32_16x16x32_bf16 v[40:43], a[252:255], a[244:247], v[40:43]
 s_waitcnt lgkmcnt(4)
 v_mfma_f32_16x16x32_bf16 v[44:47], a[144:147], a[192:195], v[44:47]
 v_mfma_f32_16x16x32_bf16 v[44:47], a[148:151], a[196:199], v[44:47]
 ds_read_b64_tr_b16 a[248:249], v6 offset:96
 v_mfma_f32_16x16x32_bf16 v[48:51], a[144:147], a[200:203], v[48:51]
 ds_read_b64_tr_b16 a[250:251], v6 offset:5216
 v_mfma_f32_16x16x32_bf16 v[48:51], a[148:151], a[204:207], v[48:51]
 buffer_load_dwordx4 v13, s[12:15], s32 offen offset:2048 lds
 v_mfma_f32_16x16x32_bf16 v[52:55], a[144:147], a[208:211], v[52:55]
 ds_read_b64_tr_b16 a[252:253], v6 offset:10336
 v_mfma_f32_16x16x32_bf16 v[52:55], a[148:151], a[212:215], v[52:55]
 ds_read_b64_tr_b16 a[254:255], v6 offset:15456
 v_mfma_f32_16x16x32_bf16 v[56:59], a[144:147], a[216:219], v[56:59]
 v_mfma_f32_16x16x32_bf16 v[56:59], a[148:151], a[220:223], v[56:59]
 buffer_load_dwordx4 v14, s[12:15], s32 offen offset:3072 lds
 v_mfma_f32_16x16x32_bf16 v[60:63], a[144:147], a[224:227], v[60:63]
 v_mfma_f32_16x16x32_bf16 v[60:63], a[148:151], a[228:231], v[60:63]
 v_mfma_f32_16x16x32_bf16 v[64:67], a[144:147], a[232:235], v[64:67]
 s_add_u32 m0, s30, 131072
 v_mfma_f32_16x16x32_bf16 v[64:67], a[148:151], a[236:239], v[64:67]
 buffer_load_dwordx4 v15, s[12:15], s32 offen lds
 v_mfma_f32_16x16x32_bf16 v[68:71], a[144:147], a[240:243], v[68:71]
 s_add_u32 s31, s31, 28672
 v_mfma_f32_16x16x32_bf16 v[68:71], a[148:151], a[244:247], v[68:71]
 s_add_u32 s32, s32, 81920
 s_waitcnt lgkmcnt(4)
 v_mfma_f32_16x16x32_bf16 v[72:75], a[152:155], a[192:195], v[72:75]
 s_cmp_eq_u32 s31, s36
 s_cselect_b32 s31, s38, s31
 v_mfma_f32_16x16x32_bf16 v[72:75], a[156:159], a[196:199], v[72:75]
 ds_read_b64_tr_b16 a[144:145], v5 offset:128
 s_cmp_eq_u32 s32, s37
 s_cselect_b32 s32, s39, s32
 v_mfma_f32_16x16x32_bf16 v[76:79], a[152:155], a[200:203], v[76:79]
 ds_read_b64_tr_b16 a[146:147], v5 offset:5248
 v_mfma_f32_16x16x32_bf16 v[76:79], a[156:159], a[204:207], v[76:79]
 v_mfma_f32_16x16x32_bf16 v[80:83], a[152:155], a[208:211], v[80:83]
 ds_read_b64_tr_b16 a[148:149], v5 offset:10368
 v_mfma_f32_16x16x32_bf16 v[80:83], a[156:159], a[212:215], v[80:83]
 ds_read_b64_tr_b16 a[150:151], v5 offset:15488
 v_mfma_f32_16x16x32_bf16 v[84:87], a[152:155], a[216:219], v[84:87]
 v_mfma_f32_16x16x32_bf16 v[84:87], a[156:159], a[220:223], v[84:87]
 v_mfma_f32_16x16x32_bf16 v[88:91], a[152:155], a[224:227], v[88:91]
 v_mfma_f32_16x16x32_bf16 v[88:91], a[156:159], a[228:231], v[88:91]
 v_mfma_f32_16x16x32_bf16 v[92:95], a[152:155], a[232:235], v[92:95]
 v_mfma_f32_16x16x32_bf16 v[92:95], a[156:159], a[236:239], v[92:95]
 v_mfma_f32_16x16x32_bf16 v[96:99], a[152:155], a[240:243], v[96:99]
 v_mfma_f32_16x16x32_bf16 v[96:99], a[156:159], a[244:247], v[96:99]
 s_waitcnt lgkmcnt(4)
 v_mfma_f32_16x16x32_bf16 v[100:103], a[248:251], a[192:195], v[100:103]
 v_mfma_f32_16x16x32_bf16 v[100:103], a[252:255], a[196:199], v[100:103]
 s_waitcnt vmcnt(12) lgkmcnt(0)
 v_mfma_f32_16x16x32_bf16 v[104:107], a[248:251], a[200:203], v[104:107]
 v_readfirstlane_b32 s35, v159
 s_cmp_lt_u32 s35, s64
 s_cbranch_scc1 P_spin2
P_back2:
 s_barrier
 v_mfma_f32_16x16x32_bf16 v[104:107], a[252:255], a[204:207], v[104:107]
 ds_read_b64_tr_b16 a[152:153], v7 offset:0
 v_mfma_f32_16x16x32_bf16 v[108:111], a[248:251], a[208:211], v[108:111]
 ds_read_b64_tr_b16 a[154:155], v7 offset:5120
 v_mfma_f32_16x16x32_bf16 v[108:111], a[252:255], a[212:215], v[108:111]
 ds_read_b128 a[160:163], v3 offset:0
 s_add_u32 m0, s29, 0
 v_mfma_f32_16x16x32_bf16 v[112:115], a[248:251], a[216:219], v[112:115]
 buffer_load_dwordx4 v246, s[8:11], s31 offen sc1 lds
 v_mfma_f32_16x16x32_bf16 v[112:115], a[252:255], a[220:223], v[112:115]
 ds_read_b64_tr_b16 a[156:157], v7 offset:10240
 v_mfma_f32_16x16x32_bf16 v[116:119], a[248:251], a[224:227], v[116:119]
 ds_read_b64_tr_b16 a[158:159], v7 offset:15360
 v_mfma_f32_16x16x32_bf16 v[116:119], a[252:255], a[228:231], v[116:119]
 ds_read_b128 a[164:167], v3 offset:14336
 v_mfma_f32_16x16x32_bf16 v[120:123], a[248:251], a[232:235], v[120:123]
 buffer_load_dwordx4 v246, s[8:11], s31 offen offset:1024 sc1 lds
 v_mfma_f32_16x16x32_bf16 v[120:123], a[252:255], a[236:239], v[120:123]
 ds_read_b128 a[168:171], v3 offset:1024
 v_mfma_f32_16x16x32_bf16 v[124:127], a[248:251], a[240:243], v[124:127]
 ds_read_b128 a[172:175], v3 offset:15360
 v_mfma_f32_16x16x32_bf16 v[124:127], a[252:255], a[244:247], v[124:127]
 ds_read_b128 a[176:179], v3 offset:2048
 v_mfma_f32_16x16x32_bf16 v[128:131], a[144:147], a[192:195], v[128:131]
 buffer_load_dwordx4 v246, s[8:11], s31 offen offset:2048 sc1 lds
 v_mfma_f32_16x16x32_bf16 v[128:131], a[148:151], a[196:199], v[128:131]
 ds_read_b128 a[180:183], v3 offset:16384
 v_mfma_f32_16x16x32_bf16 v[132:135], a[144:147], a[200:203], v[132:135]
 ds_read_b128 a[184:187], v3 offset:3072
 v_mfma_f32_16x16x32_bf16 v[132:135], a[148:151], a[204:207], v[132:135]
 ds_read_b128 a[188:191], v3 offset:17408
 v_mfma_f32_16x16x32_bf16 v[136:139], a[144:147], a[208:211], v[136:139]
 buffer_load_dwordx4 v246, s[8:11], s31 offen offset:3072 sc1 lds
 v_mfma_f32_16x16x32_bf16 v[136:139], a[148:151], a[212:215], v[136:139]
 ds_read_b128 a[0:3], v3 offset:4096
 v_mfma_f32_16x16x32_bf16 v[140:143], a[144:147], a[216:219], v[140:143]
 ds_read_b128 a[4:7], v3 offset:18432
 s_add_u32 s34, s31, 4096
 v_mfma_f32_16x16x32_bf16 v[140:143], a[148:151], a[220:223], v[140:143]
 ds_read_b128 a[8:11], v3 offset:5120
 s_add_u32 m0, s29, 4096
 v_mfma_f32_16x16x32_bf16 v[144:147], a[144:147], a[224:227], v[144:147]
 buffer_load_dwordx4 v246, s[8:11], s34 offen sc1 lds
 v_mfma_f32_16x16x32_bf16 v[144:147], a[148:151], a[228:231], v[144:147]
 ds_read_b128 a[12:15], v3 offset:19456
 v_mfma_f32_16x16x32_bf16 v[148:151], a[144:147], a[232:235], v[148:151]
 ds_read_b128 a[16:19], v3 offset:6144
 v_mfma_f32_16x16x32_bf16 v[148:151], a[148:151], a[236:239], v[148:151]
 ds_read_b128 a[20:23], v3 offset:20480
 v_mfma_f32_16x16x32_bf16 v[152:155], a[144:147], a[240:243], v[152:155]
 buffer_load_dwordx4 v246, s[8:11], s34 offen offset:1024 sc1 lds
 v_mfma_f32_16x16x32_bf16 v[152:155], a[148:151], a[244:247], v[152:155]
 s_waitcnt lgkmcnt(8)
 v_mfma_f32_16x16x32_bf16 v[16:19], a[152:155], a[160:163], v[16:19]
 ds_read_b64_tr_b16 a[248:249], v8 offset:32
 v_mfma_f32_16x16x32_bf16 v[16:19], a[156:159], a[164:167], v[16:19]
 ds_read_b64_tr_b16 a[250:251], v8 offset:5152
 v_mfma_f32_16x16x32_bf16 v[20:23], a[152:155], a[168:171], v[20:23]
 buffer_load_dwordx4 v246, s[8:11], s34 offen offset:2048 sc1 lds
 v_mfma_f32_16x16x32_bf16 v[20:23], a[156:159], a[172:175], v[20:23]
 ds_read_b64_tr_b16 a[252:253], v8 offset:10272
 v_mfma_f32_16x16x32_bf16 v[24:27], a[152:155], a[176:179], v[24:27]
 ds_read_b64_tr_b16 a[254:255], v8 offset:15392
 v_mfma_f32_16x16x32_bf16 v[24:27], a[156:159], a[180:183], v[24:27]
 s_waitcnt lgkmcnt(4)
 v_mfma_f32_16x16x32_bf16 v[28:31], a[152:155], a[184:187], v[28:31]
 ds_read_b64_tr_b16 a[144:145], v7 offset:64
 v_mfma_f32_16x16x32_bf16 v[28:31], a[156:159], a[188:191], v[28:31]
 ds_read_b64_tr_b16 a[146:147], v7 offset:5184
 s_add_u32 m0, s30, 28672
 v_mfma_f32_16x16x32_bf16 v[32:35], a[152:155], a[0:3], v[32:35]
 buffer_load_dwordx4 v11, s[12:15], s32 offen lds
 v_mfma_f32_16x16x32_bf16 v[32:35], a[156:159], a[4:7], v[32:35]
 ds_read_b64_tr_b16 a[148:149], v7 offset:10304
 v_mfma_f32_16x16x32_bf16 v[36:39], a[152:155], a[8:11], v[36:39]
 ds_read_b64_tr_b16 a[150:151], v7 offset:15424
 v_mfma_f32_16x16x32_bf16 v[36:39], a[156:159], a[12:15], v[36:39]
 v_mfma_f32_16x16x32_bf16 v[40:43], a[152:155], a[16:19], v[40:43]
 buffer_load_dwordx4 v12, s[12:15], s32 offen offset:1024 lds
 v_mfma_f32_16x16x32_bf16 v[40:43], a[156:159], a[20:23], v[40:43]
 s_waitcnt lgkmcnt(4)
 v_mfma_f32_16x16x32_bf16 v[44:47], a[248:251], a[160:163], v[44:47]
 v_mfma_f32_16x16x32_bf16 v[44:47], a[252:255], a[164:167], v[44:47]
 ds_read_b64_tr_b16 a[152:153], v8 offset:96
 v_mfma_f32_16x16x32_bf16 v[48:51], a[248:251], a[168:171], v[48:51]
 ds_read_b64_tr_b16 a[154:155], v8 offset:5216
 v_mfma_f32_16x16x32_bf16 v[48:51], a[252:255], a[172:175], v[48:51]
 buffer_load_dwordx4 v13, s[12:15], s32 offen offset:2048 lds
 v_mfma_f32_16x16x32_bf16 v[52:55], a[248:251], a[176:179], v[52:55]
 ds_read_b64_tr_b16 a[156:157], v8 offset:10336
 v_mfma_f32_16x16x32_bf16 v[52:55], a[252:255], a[180:183], v[52:55]
 ds_read_b64_tr_b16 a[158:159], v8 offset:15456
 v_mfma_f32_16x16x32_bf16 v[56:59], a[248:251], a[184:187], v[56:59]
 v_mfma_f32_16x16x32_bf16 v[56:59], a[252:255], a[188:191], v[56:59]
 buffer_load_dwordx4 v14, s[12:15], s32 offen offset:3072 lds
 v_mfma_f32_16x16x32_bf16 v[60:63], a[248:251], a[0:3], v[60:63]
 v_mfma_f32_16x16x32_bf16 v[60:63], a[252:255], a[4:7], v[60:63]
 v_mfma_f32_16x16x32_bf16 v[64:67], a[248:251], a[8:11], v[64:67]
 s_add_u32 m0, s30, 32768
 v_mfma_f32_16x16x32_bf16 v[64:67], a[252:255], a[12:15], v[64:67]
 buffer_load_dwordx4 v15, s[12:15], s32 offen lds
 v_mfma_f32_16x16x32_bf16 v[68:71], a[248:251], a[16:19], v[68:71]
 s_add_u32 s31, s31, 28672
 v_mfma_f32_16x16x32_bf16 v[68:71], a[252:255], a[20:23], v[68:71]
 s_add_u32 s32, s32, 81920
 s_waitcnt lgkmcnt(4)
 v_mfma_f32_16x16x32_bf16 v[72:75], a[144:147], a[160:163], v[72:75]
 v_mfma_f32_16x16x32_bf16 v[72:75], a[148:151], a[164:167], v[72:75]
 ds_read_b64_tr_b16 a[248:249], v7 offset:128
 v_mfma_f32_16x16x32_bf16 v[76:79], a[144:147], a[168:171], v[76:79]
 ds_read_b64_tr_b16 a[250:251], v7 offset:5248
 v_mfma_f32_16x16x32_bf16 v[76:79], a[148:151], a[172:175], v[76:79]
 v_mfma_f32_16x16x32_bf16 v[80:83], a[144:147], a[176:179], v[80:83]
 ds_read_b64_tr_b16 a[252:253], v7 offset:10368
 v_mfma_f32_16x16x32_bf16 v[80:83], a[148:151], a[180:183], v[80:83]
 ds_read_b64_tr_b16 a[254:255], v7 offset:15488
 v_mfma_f32_16x16x32_bf16 v[84:87], a[144:147], a[184:187], v[84:87]
 v_mfma_f32_16x16x32_bf16 v[84:87], a[148:151], a[188:191], v[84:87]
 v_mfma_f32_16x16x32_bf16 v[88:91], a[144:147], a[0:3], v[88:91]
 v_mfma_f32_16x16x32_bf16 v[88:91], a[148:151], a[4:7], v[88:91]
 v_mfma_f32_16x16x32_bf16 v[92:95], a[144:147], a[8:11], v[92:95]
 v_mfma_f32_16x16x32_bf16 v[92:95], a[148:151], a[12:15], v[92:95]
 v_mfma_f32_16x16x32_bf16 v[96:99], a[144:147], a[16:19], v[96:99]
 v_mfma_f32_16x16x32_bf16 v[96:99], a[148:151], a[20:23], v[96:99]
 s_waitcnt lgkmcnt(4)
 v_mfma_f32_16x16x32_bf16 v[100:103], a[152:155], a[160:163], v[100:103]
 v_mfma_f32_16x16x32_bf16 v[100:103], a[156:159], a[164:167], v[100:103]
 s_waitcnt vmcnt(12) lgkmcnt(0)
 v_mfma_f32_16x16x32_bf16 v[104:107], a[152:155], a[168:171], v[104:107]
 s_barrier
 v_mfma_f32_16x16x32_bf16 v[104:107], a[156:159], a[172:175], v[104:107]
 ds_read_b64_tr_b16 a[144:145], v9 offset:0
 v_mfma_f32_16x16x32_bf16 v[108:111], a[152:155], a[176:179], v[108:111]
 ds_read_b64_tr_b16 a[146:147], v9 offset:5120
 v_mfma_f32_16x16x32_bf16 v[108:111], a[156:159], a[180:183], v[108:111]
 ds_read_b128 a[192:195], v4 offset:0
 s_add_u32 m0, s29, 49152
 v_mfma_f32_16x16x32_bf16 v[112:115], a[152:155], a[184:187], v[112:115]
 buffer_load_dwordx4 v246, s[8:11], s31 offen sc1 lds
 v_mfma_f32_16x16x32_bf16 v[112:115], a[156:159], a[188:191], v[112:115]
 ds_read_b64_tr_b16 a[148:149], v9 offset:10240
 v_mfma_f32_16x16x32_bf16 v[116:119], a[152:155], a[0:3], v[116:119]
 ds_read_b64_tr_b16 a[150:151], v9 offset:15360
 v_mfma_f32_16x16x32_bf16 v[116:119], a[156:159], a[4:7], v[116:119]
 ds_read_b128 a[196:199], v4 offset:14336
 v_mfma_f32_16x16x32_bf16 v[120:123], a[152:155], a[8:11], v[120:123]
 buffer_load_dwordx4 v246, s[8:11], s31 offen offset:1024 sc1 lds
 v_mfma_f32_16x16x32_bf16 v[120:123], a[156:159], a[12:15], v[120:123]
 ds_read_b128 a[200:203], v4 offset:1024
 v_mfma_f32_16x16x32_bf16 v[124:127], a[152:155], a[16:19], v[124:127]
 ds_read_b128 a[204:207], v4 offset:15360
 v_mfma_f32_16x16x32_bf16 v[124:127], a[156:159], a[20:23], v[124:127]
 ds_read_b128 a[208:211], v4 offset:2048
 v_mfma_f32_16x16x32_bf16 v[128:131], a[248:251], a[160:163], v[128:131]
 buffer_load_dwordx4 v246, s[8:11], s31 offen offset:2048 sc1 lds
 v_mfma_f32_16x16x32_bf16 v[128:131], a[252:255], a[164:167], v[128:131]
 ds_read_b128 a[212:215], v4 offset:16384
 v_mfma_f32_16x16x32_bf16 v[132:135], a[248:251], a[168:171], v[132:135]
 ds_read_b128 a[216:219], v4 offset:3072
 v_mfma_f32_16x16x32_bf16 v[132:135], a[252:255], a[172:175], v[132:135]
 ds_read_b128 a[220:223], v4 offset:17408
 v_mfma_f32_16x16x32_bf16 v[136:139], a[248:251], a[176:179], v[136:139]
 buffer_load_dwordx4 v246, s[8:11], s31 offen offset:3072 sc1 lds
 v_mfma_f32_16x16x32_bf16 v[136:139], a[252:255], a[180:183], v[136:139]
 ds_read_b128 a[224:227], v4 offset:4096
 v_mfma_f32_16x16x32_bf16 v[140:143], a[248:251], a[184:187], v[140:143]
 ds_read_b128 a[228:231], v4 offset:18432
 s_add_u32 s34, s31, 4096
 v_mfma_f32_16x16x32_bf16 v[140:143], a[252:255], a[188:191], v[140:143]
 ds_read_b128 a[232:235], v4 offset:5120
 s_add_u32 m0, s29, 53248
 v_mfma_f32_16x16x32_bf16 v[144:147], a[248:251], a[0:3], v[144:147]
 buffer_load_dwordx4 v246, s[8:11], s34 offen sc1 lds
 v_mfma_f32_16x16x32_bf16 v[144:147], a[252:255], a[4:7], v[144:147]
 ds_read_b128 a[236:239], v4 offset:19456
 v_mfma_f32_16x16x32_bf16 v[148:151], a[248:251], a[8:11], v[148:151]
 ds_read_b128 a[240:243], v4 offset:6144
 v_mfma_f32_16x16x32_bf16 v[148:151], a[252:255], a[12:15], v[148:151]
 ds_read_b128 a[244:247], v4 offset:20480
 v_mfma_f32_16x16x32_bf16 v[152:155], a[248:251], a[16:19], v[152:155]
 buffer_load_dwordx4 v246, s[8:11], s34 offen offset:1024 sc1 lds
 v_mfma_f32_16x16x32_bf16 v[152:155], a[252:255], a[20:23], v[152:155]
 s_waitcnt lgkmcnt(8)
 v_mfma_f32_16x16x32_bf16 v[16:19], a[144:147], a[192:195], v[16:19]
 ds_read_b64_tr_b16 a[152:153], v10 offset:32
 v_mfma_f32_16x16x32_bf16 v[16:19], a[148:151], a[196:199], v[16:19]
 ds_read_b64_tr_b16 a[154:155], v10 offset:5152
 v_mfma_f32_16x16x32_bf16 v[20:23], a[144:147], a[200:203], v[20:23]
 buffer_atomic_add v160, v163, s[96:99], 0 offen
 v_mfma_f32_16x16x32_bf16 v[20:23], a[148:151], a[204:207], v[20:23]
 ds_read_b64_tr_b16 a[156:157], v10 offset:10272
 v_mov_b32 v163, 0x7ff00000
 v_mfma_f32_16x16x32_bf16 v[24:27], a[144:147], a[208:211], v[24:27]
 ds_read_b64_tr_b16 a[158:159], v10 offset:15392
 v_mfma_f32_16x16x32_bf16 v[24:27], a[148:151], a[212:215], v[24:27]
 s_waitcnt lgkmcnt(4)
 v_mfma_f32_16x16x32_bf16 v[28:31], a[144:147], a[216:219], v[28:31]
 ds_read_b64_tr_b16 a[248:249], v9 offset:64
 v_mfma_f32_16x16x32_bf16 v[28:31], a[148:151], a[220:223], v[28:31]
 ds_read_b64_tr_b16 a[250:251], v9 offset:5184
 v_mfma_f32_16x16x32_bf16 v[32:35], a[144:147], a[224:227], v[32:35]
 buffer_load_dwordx4 v246, s[8:11], s34 offen offset:2048 sc1 lds
 v_mfma_f32_16x16x32_bf16 v[32:35], a[148:151], a[228:231], v[32:35]
 ds_read_b64_tr_b16 a[252:253], v9 offset:10304
 v_mfma_f32_16x16x32_bf16 v[36:39], a[144:147], a[232:235], v[36:39]
 ds_read_b64_tr_b16 a[254:255], v9 offset:15424
 v_mfma_f32_16x16x32_bf16 v[36:39], a[148:151], a[236:239], v[36:39]
 s_add_u32 m0, s30, 77824
 v_mfma_f32_16x16x32_bf16 v[40:43], a[144:147], a[240:243], v[40:43]
 buffer_load_dwordx4 v11, s[12:15], s32 offen lds
 v_mfma_f32_16x16x32_bf16 v[40:43], a[148:151], a[244:247], v[40:43]
 s_waitcnt lgkmcnt(4)
 v_mfma_f32_16x16x32_bf16 v[44:47], a[152:155], a[192:195], v[44:47]
 v_mfma_f32_16x16x32_bf16 v[44:47], a[156:159], a[196:199], v[44:47]
 ds_read_b64_tr_b16 a[144:145], v10 offset:96
 v_mfma_f32_16x16x32_bf16 v[48:51], a[152:155], a[200:203], v[48:51]
 ds_read_b64_tr_b16 a[146:147], v10 offset:5216
 v_mfma_f32_16x16x32_bf16 v[48:51], a[156:159], a[204:207], v[48:51]
 buffer_load_dwordx4 v12, s[12:15], s32 offen offset:1024 lds
 v_mfma_f32_16x16x32_bf16 v[52:55], a[152:155], a[208:211], v[52:55]
 ds_read_b64_tr_b16 a[148:149], v10 offset:10336
 v_mfma_f32_16x16x32_bf16 v[52:55], a[156:159], a[212:215], v[52:55]
 ds_read_b64_tr_b16 a[150:151], v10 offset:15456
 v_mfma_f32_16x16x32_bf16 v[56:59], a[152:155], a[216:219], v[56:59]
 v_mfma_f32_16x16x32_bf16 v[56:59], a[156:159], a[220:223], v[56:59]
 buffer_load_dwordx4 v13, s[12:15], s32 offen offset:2048 lds
 v_mfma_f32_16x16x32_bf16 v[60:63], a[152:155], a[224:227], v[60:63]
 v_mfma_f32_16x16x32_bf16 v[60:63], a[156:159], a[228:231], v[60:63]
 v_mfma_f32_16x16x32_bf16 v[64:67], a[152:155], a[232:235], v[64:67]
 v_mfma_f32_16x16x32_bf16 v[64:67], a[156:159], a[236:239], v[64:67]
 buffer_load_dwordx4 v14, s[12:15], s32 offen offset:3072 lds
 v_mfma_f32_16x16x32_bf16 v[68:71], a[152:155], a[240:243], v[68:71]
 v_mfma_f32_16x16x32_bf16 v[68:71], a[156:159], a[244:247], v[68:71]
 s_waitcnt lgkmcnt(4)
 v_mfma_f32_16x16x32_bf16 v[72:75], a[248:251], a[192:195], v[72:75]
 v_mfma_f32_16x16x32_bf16 v[72:75], a[252:255], a[196:199], v[72:75]
 ds_read_b64_tr_b16 a[152:153], v9 offset:128
 v_mfma_f32_16x16x32_bf16 v[76:79], a[248:251], a[200:203], v[76:79]
 ds_read_b64_tr_b16 a[154:155], v9 offset:5248
 s_add_u32 m0, s30, 81920
 v_mfma_f32_16x16x32_bf16 v[76:79], a[252:255], a[204:207], v[76:79]
 buffer_load_dwordx4 v15, s[12:15], s32 offen lds
 v_mfma_f32_16x16x32_bf16 v[80:83], a[248:251], a[208:211], v[80:83]
 ds_read_b64_tr_b16 a[156:157], v9 offset:10368
 s_add_u32 s31, s31, 28672
 v_mfma_f32_16x16x32_bf16 v[80:83], a[252:255], a[212:215], v[80:83]
 ds_read_b64_tr_b16 a[158:159], v9 offset:15488
 s_add_u32 s32, s32, 81920
 v_mfma_f32_16x16x32_bf16 v[84:87], a[248:251], a[216:219], v[84:87]
 v_mfma_f32_16x16x32_bf16 v[84:87], a[252:255], a[220:223], v[84:87]
 v_mfma_f32_16x16x32_bf16 v[88:91], a[248:251], a[224:227], v[88:91]
 v_mfma_f32_16x16x32_bf16 v[88:91], a[252:255], a[228:231], v[88:91]
 v_mfma_f32_16x16x32_bf16 v[92:95], a[248:251], a[232:235], v[92:95]
 v_mfma_f32_16x16x32_bf16 v[92:95], a[252:255], a[236:239], v[92:95]
 v_mfma_f32_16x16x32_bf16 v[96:99], a[248:251], a[240:243], v[96:99]
 v_mfma_f32_16x16x32_bf16 v[96:99], a[252:255], a[244:247], v[96:99]
 s_waitcnt lgkmcnt(4)
 v_mfma_f32_16x16x32_bf16 v[100:103], a[144:147], a[192:195], v[100:103]
 v_mfma_f32_16x16x32_bf16 v[100:103], a[148:151], a[196:199], v[100:103]
 s_waitcnt vmcnt(13) lgkmcnt(0)
 v_mfma_f32_16x16x32_bf16 v[104:107], a[144:147], a[200:203], v[104:107]
 s_barrier
 v_mfma_f32_16x16x32_bf16 v[104:107], a[148:151], a[204:207], v[104:107]
 ds_read_b64_tr_b16 a[248:249], v5 offset:0
 v_mfma_f32_16x16x32_bf16 v[108:111], a[144:147], a[208:211], v[108:111]
 ds_read_b64_tr_b16 a[250:251], v5 offset:5120
 v_mfma_f32_16x16x32_bf16 v[108:111], a[148:151], a[212:215], v[108:111]
 ds_read_b128 a[160:163], v2 offset:0
 s_add_u32 m0, s29, 98304
 v_mfma_f32_16x16x32_bf16 v[112:115], a[144:147], a[216:219], v[112:115]
 buffer_load_dwordx4 v246, s[8:11], s31 offen sc1 lds
 v_mfma_f32_16x16x32_bf16 v[112:115], a[148:151], a[220:223], v[112:115]
 ds_read_b64_tr_b16 a[252:253], v5 offset:10240
 v_mfma_f32_16x16x32_bf16 v[116:119], a[144:147], a[224:227], v[116:119]
 ds_read_b64_tr_b16 a[254:255], v5 offset:15360
 v_mfma_f32_16x16x32_bf16 v[116:119], a[148:151], a[228:231], v[116:119]
 ds_read_b128 a[164:167], v2 offset:14336
 v_mfma_f32_16x16x32_bf16 v[120:123], a[144:147], a[232:235], v[120:123]
 buffer_load_dwordx4 v246, s[8:11], s31 offen offset:1024 sc1 lds
 v_mfma_f32_16x16x32_bf16 v[120:123], a[148:151], a[236:239], v[120:123]
 ds_read_b128 a[168:171], v2 offset:1024
 v_mfma_f32_16x16x32_bf16 v[124:127], a[144:147], a[240:243], v[124:127]
 ds_read_b128 a[172:175], v2 offset:15360
 v_mfma_f32_16x16x32_bf16 v[124:127], a[148:151], a[244:247], v[124:127]
 ds_read_b128 a[176:179], v2 offset:2048
 v_mfma_f32_16x16x32_bf16 v[128:131], a[152:155], a[192:195], v[128:131]
 buffer_load_dwordx4 v246, s[8:11], s31 offen offset:2048 sc1 lds
 v_mfma_f32_16x16x32_bf16 v[128:131], a[156:159], a[196:199], v[128:131]
 ds_read_b128 a[180:183], v2 offset:16384
 v_mfma_f32_16x16x32_bf16 v[132:135], a[152:155], a[200:203], v[132:135]
 ds_read_b128 a[184:187], v2 offset:3072
 v_mfma_f32_16x16x32_bf16 v[132:135], a[156:159], a[204:207], v[132:135]
 ds_read_b128 a[188:191], v2 offset:17408
 v_mfma_f32_16x16x32_bf16 v[136:139], a[152:155], a[208:211], v[136:139]
 buffer_load_dwordx4 v246, s[8:11], s31 offen offset:3072 sc1 lds
 v_mfma_f32_16x16x32_bf16 v[136:139], a[156:159], a[212:215], v[136:139]
 ds_read_b128 a[0:3], v2 offset:4096
 v_mfma_f32_16x16x32_bf16 v[140:143], a[152:155], a[216:219], v[140:143]
 ds_read_b128 a[4:7], v2 offset:18432
 s_add_u32 s34, s31, 4096
 v_mfma_f32_16x16x32_bf16 v[140:143], a[156:159], a[220:223], v[140:143]
 ds_read_b128 a[8:11], v2 offset:5120
 s_add_u32 m0, s29, 102400
 v_mfma_f32_16x16x32_bf16 v[144:147], a[152:155], a[224:227], v[144:147]
 buffer_load_dwordx4 v246, s[8:11], s34 offen sc1 lds
 v_mfma_f32_16x16x32_bf16 v[144:147], a[156:159], a[228:231], v[144:147]
 ds_read_b128 a[12:15], v2 offset:19456
 v_mfma_f32_16x16x32_bf16 v[148:151], a[152:155], a[232:235], v[148:151]
 ds_read_b128 a[16:19], v2 offset:6144
 v_mfma_f32_16x16x32_bf16 v[148:151], a[156:159], a[236:239], v[148:151]
 ds_read_b128 a[20:23], v2 offset:20480
 v_mfma_f32_16x16x32_bf16 v[152:155], a[152:155], a[240:243], v[152:155]
 buffer_load_dwordx4 v246, s[8:11], s34 offen offset:1024 sc1 lds
 v_mfma_f32_16x16x32_bf16 v[152:155], a[156:159], a[244:247], v[152:155]
 s_waitcnt lgkmcnt(8)
 v_mfma_f32_16x16x32_bf16 v[16:19], a[248:251], a[160:163], v[16:19]
 ds_read_b64_tr_b16 a[144:145], v6 offset:32
 v_mfma_f32_16x16x32_bf16 v[16:19], a[252:255], a[164:167], v[16:19]
 ds_read_b64_tr_b16 a[146:147], v6 offset:5152
 v_mfma_f32_16x16x32_bf16 v[20:23], a[248:251], a[168:171], v[20:23]
 buffer_load_dwordx4 v246, s[8:11], s34 offen offset:2048 sc1 lds
 v_mfma_f32_16x16x32_bf16 v[20:23], a[252:255], a[172:175], v[20:23]
 ds_read_b64_tr_b16 a[148:149], v6 offset:10272
 v_mfma_f32_16x16x32_bf16 v[24:27], a[248:251], a[176:179], v[24:27]
 ds_read_b64_tr_b16 a[150:151], v6 offset:15392
 v_mfma_f32_16x16x32_bf16 v[24:27], a[252:255], a[180:183], v[24:27]
 s_waitcnt lgkmcnt(4)
 v_mfma_f32_16x16x32_bf16 v[28:31], a[248:251], a[184:187], v[28:31]
 ds_read_b64_tr_b16 a[152:153], v5 offset:64
 v_mfma_f32_16x16x32_bf16 v[28:31], a[252:255], a[188:191], v[28:31]
 ds_read_b64_tr_b16 a[154:155], v5 offset:5184
 s_add_u32 m0, s30, 126976
 v_mfma_f32_16x16x32_bf16 v[32:35], a[248:251], a[0:3], v[32:35]
 buffer_load_dwordx4 v11, s[12:15], s32 offen lds
 v_mfma_f32_16x16x32_bf16 v[32:35], a[252:255], a[4:7], v[32:35]
 ds_read_b64_tr_b16 a[156:157], v5 offset:10304
 v_mfma_f32_16x16x32_bf16 v[36:39], a[248:251], a[8:11], v[36:39]
 ds_read_b64_tr_b16 a[158:159], v5 offset:15424
 v_mfma_f32_16x16x32_bf16 v[36:39], a[252:255], a[12:15], v[36:39]
 v_mfma_f32_16x16x32_bf16 v[40:43], a[248:251], a[16:19], v[40:43]
 buffer_load_dwordx4 v12, s[12:15], s32 offen offset:1024 lds
 v_mfma_f32_16x16x32_bf16 v[40:43], a[252:255], a[20:23], v[40:43]
 s_waitcnt lgkmcnt(4)
 v_mfma_f32_16x16x32_bf16 v[44:47], a[144:147], a[160:163], v[44:47]
 v_mfma_f32_16x16x32_bf16 v[44:47], a[148:151], a[164:167], v[44:47]
 ds_read_b64_tr_b16 a[248:249], v6 offset:96
 v_mfma_f32_16x16x32_bf16 v[48:51], a[144:147], a[168:171], v[48:51]
 ds_read_b64_tr_b16 a[250:251], v6 offset:5216
 v_mfma_f32_16x16x32_bf16 v[48:51], a[148:151], a[172:175], v[48:51]
 buffer_load_dwordx4 v13, s[12:15], s32 offen offset:2048 lds
 v_mfma_f32_16x16x32_bf16 v[52:55], a[144:147], a[176:179], v[52:55]
 ds_read_b64_tr_b16 a[252:253], v6 offset:10336
 v_mfma_f32_16x16x32_bf16 v[52:55], a[148:151], a[180:183], v[52:55]
 ds_read_b64_tr_b16 a[254:255], v6 offset:15456
 v_mfma_f32_16x16x32_bf16 v[56:59], a[144:147], a[184:187], v[56:59]
 v_mfma_f32_16x16x32_bf16 v[56:59], a[148:151], a[188:191], v[56:59]
 buffer_load_dwordx4 v14, s[12:15], s32 offen offset:3072 lds
 v_mfma_f32_16x16x32_bf16 v[60:63], a[144:147], a[0:3], v[60:63]
 v_mfma_f32_16x16x32_bf16 v[60:63], a[148:151], a[4:7], v[60:63]
 v_mfma_f32_16x16x32_bf16 v[64:67], a[144:147], a[8:11], v[64:67]
 s_add_u32 m0, s30, 131072
 v_mfma_f32_16x16x32_bf16 v[64:67], a[148:151], a[12:15], v[64:67]
 buffer_load_dwordx4 v15, s[12:15], s32 offen lds
 v_mfma_f32_16x16x32_bf16 v[68:71], a[144:147], a[16:19], v[68:71]
 s_add_u32 s31, s31, 28672
 v_mfma_f32_16x16x32_bf16 v[68:71], a[148:151], a[20:23], v[68:71]
 s_add_u32 s32, s32, 81920
 s_waitcnt lgkmcnt(4)
 v_mfma_f32_16x16x32_bf16 v[72:75], a[152:155], a[160:163], v[72:75]
 s_cmp_eq_u32 s31, s36
 s_cselect_b32 s31, s38, s31
 v_mfma_f32_16x16x32_bf16 v[72:75], a[156:159], a[164:167], v[72:75]
 ds_read_b64_tr_b16 a[144:145], v5 offset:128
 s_cmp_eq_u32 s32, s37
 s_cselect_b32 s32, s39, s32
 v_mfma_f32_16x16x32_bf16 v[76:79], a[152:155], a[168:171], v[76:79]
 ds_read_b64_tr_b16 a[146:147], v5 offset:5248
 v_mfma_f32_16x16x32_bf16 v[76:79], a[156:159], a[172:175], v[76:79]
 v_mfma_f32_16x16x32_bf16 v[80:83], a[152:155], a[176:179], v[80:83]
 ds_read_b64_tr_b16 a[148:149], v5 offset:10368
 v_mfma_f32_16x16x32_bf16 v[80:83], a[156:159], a[180:183], v[80:83]
 ds_read_b64_tr_b16 a[150:151], v5 offset:15488
 v_mfma_f32_16x16x32_bf16 v[84:87], a[152:155], a[184:187], v[84:87]
 v_mfma_f32_16x16x32_bf16 v[84:87], a[156:159], a[188:191], v[84:87]
 v_mfma_f32_16x16x32_bf16 v[88:91], a[152:155], a[0:3], v[88:91]
 v_mfma_f32_16x16x32_bf16 v[88:91], a[156:159], a[4:7], v[88:91]
 v_mfma_f32_16x16x32_bf16 v[92:95], a[152:155], a[8:11], v[92:95]
 v_mfma_f32_16x16x32_bf16 v[92:95], a[156:159], a[12:15], v[92:95]
 v_mfma_f32_16x16x32_bf16 v[96:99], a[152:155], a[16:19], v[96:99]
 v_mfma_f32_16x16x32_bf16 v[96:99], a[156:159], a[20:23], v[96:99]
 s_waitcnt lgkmcnt(4)
 v_mfma_f32_16x16x32_bf16 v[100:103], a[248:251], a[160:163], v[100:103]
 v_mfma_f32_16x16x32_bf16 v[100:103], a[252:255], a[164:167], v[100:103]
 s_waitcnt vmcnt(12) lgkmcnt(0)
 v_mfma_f32_16x16x32_bf16 v[104:107], a[248:251], a[168:171], v[104:107]
 s_barrier
 v_mfma_f32_16x16x32_bf16 v[104:107], a[252:255], a[172:175], v[104:107]
 ds_read_b64_tr_b16 a[152:153], v7 offset:0
 v_mfma_f32_16x16x32_bf16 v[108:111], a[248:251], a[176:179], v[108:111]
 ds_read_b64_tr_b16 a[154:155], v7 offset:5120
 v_mfma_f32_16x16x32_bf16 v[108:111], a[252:255], a[180:183], v[108:111]
 ds_read_b128 a[192:195], v3 offset:0
 s_add_u32 m0, s29, 0
 v_mfma_f32_16x16x32_bf16 v[112:115], a[248:251], a[184:187], v[112:115]
 buffer_load_dwordx4 v246, s[8:11], s31 offen sc1 lds
 v_mfma_f32_16x16x32_bf16 v[112:115], a[252:255], a[188:191], v[112:115]
 ds_read_b64_tr_b16 a[156:157], v7 offset:10240
 v_mfma_f32_16x16x32_bf16 v[116:119], a[248:251], a[0:3], v[116:119]
 ds_read_b64_tr_b16 a[158:159], v7 offset:15360
 v_mfma_f32_16x16x32_bf16 v[116:119], a[252:255], a[4:7], v[116:119]
 ds_read_b128 a[196:199], v3 offset:14336
 v_mfma_f32_16x16x32_bf16 v[120:123], a[248:251], a[8:11], v[120:123]
 buffer_load_dwordx4 v246, s[8:11], s31 offen offset:1024 sc1 lds
 v_mfma_f32_16x16x32_bf16 v[120:123], a[252:255], a[12:15], v[120:123]
 ds_read_b128 a[200:203], v3 offset:1024
 v_mfma_f32_16x16x32_bf16 v[124:127], a[248:251], a[16:19], v[124:127]
 ds_read_b128 a[204:207], v3 offset:15360
 v_mfma_f32_16x16x32_bf16 v[124:127], a[252:255], a[20:23], v[124:127]
 ds_read_b128 a[208:211], v3 offset:2048
 v_mfma_f32_16x16x32_bf16 v[128:131], a[144:147], a[160:163], v[128:131]
 buffer_load_dwordx4 v246, s[8:11], s31 offen offset:2048 sc1 lds
 v_mfma_f32_16x16x32_bf16 v[128:131], a[148:151], a[164:167], v[128:131]
 ds_read_b128 a[212:215], v3 offset:16384
 v_mfma_f32_16x16x32_bf16 v[132:135], a[144:147], a[168:171], v[132:135]
 ds_read_b128 a[216:219], v3 offset:3072
 v_mfma_f32_16x16x32_bf16 v[132:135], a[148:151], a[172:175], v[132:135]
 ds_read_b128 a[220:223], v3 offset:17408
 v_mfma_f32_16x16x32_bf16 v[136:139], a[144:147], a[176:179], v[136:139]
 buffer_load_dwordx4 v246, s[8:11], s31 offen offset:3072 sc1 lds
 v_mfma_f32_16x16x32_bf16 v[136:139], a[148:151], a[180:183], v[136:139]
 ds_read_b128 a[224:227], v3 offset:4096
 v_mfma_f32_16x16x32_bf16 v[140:143], a[144:147], a[184:187], v[140:143]
 ds_read_b128 a[228:231], v3 offset:18432
 s_add_u32 s34, s31, 4096
 v_mfma_f32_16x16x32_bf16 v[140:143], a[148:151], a[188:191], v[140:143]
 ds_read_b128 a[232:235], v3 offset:5120
 s_add_u32 m0, s29, 4096
 v_mfma_f32_16x16x32_bf16 v[144:147], a[144:147], a[0:3], v[144:147]
 buffer_load_dwordx4 v246, s[8:11], s34 offen sc1 lds
 v_mfma_f32_16x16x32_bf16 v[144:147], a[148:151], a[4:7], v[144:147]
 ds_read_b128 a[236:239], v3 offset:19456
 v_mfma_f32_16x16x32_bf16 v[148:151], a[144:147], a[8:11], v[148:151]
 ds_read_b128 a[240:243], v3 offset:6144
 v_mfma_f32_16x16x32_bf16 v[148:151], a[148:151], a[12:15], v[148:151]
 ds_read_b128 a[244:247], v3 offset:20480
 v_mfma_f32_16x16x32_bf16 v[152:155], a[144:147], a[16:19], v[152:155]
 buffer_load_dwordx4 v246, s[8:11], s34 offen offset:1024 sc1 lds
 v_mfma_f32_16x16x32_bf16 v[152:155], a[148:151], a[20:23], v[152:155]
 s_waitcnt lgkmcnt(8)
 v_mfma_f32_16x16x32_bf16 v[16:19], a[152:155], a[192:195], v[16:19]
 ds_read_b64_tr_b16 a[248:249], v8 offset:32
 v_mfma_f32_16x16x32_bf16 v[16:19], a[156:159], a[196:199], v[16:19]
 ds_read_b64_tr_b16 a[250:251], v8 offset:5152
 v_mfma_f32_16x16x32_bf16 v[20:23], a[152:155], a[200:203], v[20:23]
 buffer_load_dwordx4 v246, s[8:11], s34 offen offset:2048 sc1 lds
 v_mfma_f32_16x16x32_bf16 v[20:23], a[156:159], a[204:207], v[20:23]
 ds_read_b64_tr_b16 a[252:253], v8 offset:10272
 v_mfma_f32_16x16x32_bf16 v[24:27], a[152:155], a[208:211], v[24:27]
 ds_read_b64_tr_b16 a[254:255], v8 offset:15392
 v_mfma_f32_16x16x32_bf16 v[24:27], a[156:159], a[212:215], v[24:27]
 s_waitcnt lgkmcnt(4)
 v_mfma_f32_16x16x32_bf16 v[28:31], a[152:155], a[216:219], v[28:31]
 ds_read_b64_tr_b16 a[144:145], v7 offset:64
 v_mfma_f32_16x16x32_bf16 v[28:31], a[156:159], a[220:223], v[28:31]
 ds_read_b64_tr_b16 a[146:147], v7 offset:5184
 s_add_u32 m0, s30, 28672
 v_mfma_f32_16x16x32_bf16 v[32:35], a[152:155], a[224:227], v[32:35]
 buffer_load_dwordx4 v11, s[12:15], s32 offen lds
 v_mfma_f32_16x16x32_bf16 v[32:35], a[156:159], a[228:231], v[32:35]
 ds_read_b64_tr_b16 a[148:149], v7 offset:10304
 v_mfma_f32_16x16x32_bf16 v[36:39], a[152:155], a[232:235], v[36:39]
 ds_read_b64_tr_b16 a[150:151], v7 offset:15424
 v_mfma_f32_16x16x32_bf16 v[36:39], a[156:159], a[236:239], v[36:39]
 v_mfma_f32_16x16x32_bf16 v[40:43], a[152:155], a[240:243], v[40:43]
 buffer_load_dwordx4 v12, s[12:15], s32 offen offset:1024 lds
 v_mfma_f32_16x16x32_bf16 v[40:43], a[156:159], a[244:247], v[40:43]
 s_waitcnt lgkmcnt(4)
 v_mfma_f32_16x16x32_bf16 v[44:47], a[248:251], a[192:195], v[44:47]
 v_mfma_f32_16x16x32_bf16 v[44:47], a[252:255], a[196:199], v[44:47]
 ds_read_b64_tr_b16 a[152:153], v8 offset:96
 v_mfma_f32_16x16x32_bf16 v[48:51], a[248:251], a[200:203], v[48:51]
 ds_read_b64_tr_b16 a[154:155], v8 offset:5216
 v_mfma_f32_16x16x32_bf16 v[48:51], a[252:255], a[204:207], v[48:51]
 buffer_load_dwordx4 v13, s[12:15], s32 offen offset:2048 lds
 v_mfma_f32_16x16x32_bf16 v[52:55], a[248:251], a[208:211], v[52:55]
 ds_read_b64_tr_b16 a[156:157], v8 offset:10336
 v_mfma_f32_16x16x32_bf16 v[52:55], a[252:255], a[212:215], v[52:55]
 ds_read_b64_tr_b16 a[158:159], v8 offset:15456
 v_mfma_f32_16x16x32_bf16 v[56:59], a[248:251], a[216:219], v[56:59]
 v_mfma_f32_16x16x32_bf16 v[56:59], a[252:255], a[220:223], v[56:59]
 buffer_load_dwordx4 v14, s[12:15], s32 offen offset:3072 lds
 v_mfma_f32_16x16x32_bf16 v[60:63], a[248:251], a[224:227], v[60:63]
 v_mfma_f32_16x16x32_bf16 v[60:63], a[252:255], a[228:231], v[60:63]
 v_mfma_f32_16x16x32_bf16 v[64:67], a[248:251], a[232:235], v[64:67]
 s_add_u32 m0, s30, 32768
 v_mfma_f32_16x16x32_bf16 v[64:67], a[252:255], a[236:239], v[64:67]
 buffer_load_dwordx4 v15, s[12:15], s32 offen lds
 v_mfma_f32_16x16x32_bf16 v[68:71], a[248:251], a[240:243], v[68:71]
 s_add_u32 s31, s31, 28672
 v_mfma_f32_16x16x32_bf16 v[68:71], a[252:255], a[244:247], v[68:71]
 s_add_u32 s32, s32, 81920
 s_waitcnt lgkmcnt(4)
 v_mfma_f32_16x16x32_bf16 v[72:75], a[144:147], a[192:195], v[72:75]
 v_mfma_f32_16x16x32_bf16 v[72:75], a[148:151], a[196:199], v[72:75]
 ds_read_b64_tr_b16 a[248:249], v7 offset:128
 v_mfma_f32_16x16x32_bf16 v[76:79], a[144:147], a[200:203], v[76:79]
 ds_read_b64_tr_b16 a[250:251], v7 offset:5248
 s_add_u32 s36, s29, 688128
 v_mfma_f32_16x16x32_bf16 v[76:79], a[148:151], a[204:207], v[76:79]
 s_add_u32 s38, s29, 344064
 s_add_u32 s37, s40, 1966080
 v_mfma_f32_16x16x32_bf16 v[80:83], a[144:147], a[208:211], v[80:83]
 ds_read_b64_tr_b16 a[252:253], v7 offset:10368
 s_add_u32 s39, s40, 983040
 v_mfma_f32_16x16x32_bf16 v[80:83], a[148:151], a[212:215], v[80:83]
 ds_read_b64_tr_b16 a[254:255], v7 offset:15488
 v_mfma_f32_16x16x32_bf16 v[84:87], a[144:147], a[216:219], v[84:87]
 v_mfma_f32_16x16x32_bf16 v[84:87], a[148:151], a[220:223], v[84:87]
 v_mfma_f32_16x16x32_bf16 v[88:91], a[144:147], a[224:227], v[88:91]
 v_mfma_f32_16x16x32_bf16 v[88:91], a[148:151], a[228:231], v[88:91]
 v_mfma_f32_16x16x32_bf16 v[92:95], a[144:147], a[232:235], v[92:95]
 v_mfma_f32_16x16x32_bf16 v[92:95], a[148:151], a[236:239], v[92:95]
 v_mfma_f32_16x16x32_bf16 v[96:99], a[144:147], a[240:243], v[96:99]
 v_mfma_f32_16x16x32_bf16 v[96:99], a[148:151], a[244:247], v[96:99]
 s_waitcnt lgkmcnt(4)
 v_mfma_f32_16x16x32_bf16 v[100:103], a[152:155], a[192:195], v[100:103]
 v_mfma_f32_16x16x32_bf16 v[100:103], a[156:159], a[196:199], v[100:103]
 s_waitcnt vmcnt(12) lgkmcnt(0)
 v_mfma_f32_16x16x32_bf16 v[104:107], a[152:155], a[200:203], v[104:107]
 buffer_load_dword v159, v158, s[96:99], 0 offen sc1
 s_barrier
 v_mfma_f32_16x16x32_bf16 v[104:107], a[156:159], a[204:207], v[104:107]
 ds_read_b64_tr_b16 a[144:145], v9 offset:0
 v_mfma_f32_16x16x32_bf16 v[108:111], a[152:155], a[208:211], v[108:111]
 ds_read_b64_tr_b16 a[146:147], v9 offset:5120
 v_mfma_f32_16x16x32_bf16 v[108:111], a[156:159], a[212:215], v[108:111]
 ds_read_b128 a[160:163], v4 offset:0
 s_add_u32 m0, s29, 49152
 v_mfma_f32_16x16x32_bf16 v[112:115], a[152:155], a[216:219], v[112:115]
 buffer_load_dwordx4 v246, s[8:11], s31 offen sc1 lds
 v_mfma_f32_16x16x32_bf16 v[112:115], a[156:159], a[220:223], v[112:115]
 ds_read_b64_tr_b16 a[148:149], v9 offset:10240
 v_mfma_f32_16x16x32_bf16 v[116:119], a[152:155], a[224:227], v[116:119]
 ds_read_b64_tr_b16 a[150:151], v9 offset:15360
 v_mfma_f32_16x16x32_bf16 v[116:119], a[156:159], a[228:231], v[116:119]
 ds_read_b128 a[164:167], v4 offset:14336
 v_mfma_f32_16x16x32_bf16 v[120:123], a[152:155], a[232:235], v[120:123]
 buffer_load_dwordx4 v246, s[8:11], s31 offen offset:1024 sc1 lds
 v_mfma_f32_16x16x32_bf16 v[120:123], a[156:159], a[236:239], v[120:123]
 ds_read_b128 a[168:171], v4 offset:1024
 v_mfma_f32_16x16x32_bf16 v[124:127], a[152:155], a[240:243], v[124:127]
 ds_read_b128 a[172:175], v4 offset:15360
 v_mfma_f32_16x16x32_bf16 v[124:127], a[156:159], a[244:247], v[124:127]
 ds_read_b128 a[176:179], v4 offset:2048
 v_mfma_f32_16x16x32_bf16 v[128:131], a[248:251], a[192:195], v[128:131]
 buffer_load_dwordx4 v246, s[8:11], s31 offen offset:2048 sc1 lds
 v_mfma_f32_16x16x32_bf16 v[128:131], a[252:255], a[196:199], v[128:131]
 ds_read_b128 a[180:183], v4 offset:16384
 v_mfma_f32_16x16x32_bf16 v[132:135], a[248:251], a[200:203], v[132:135]
 ds_read_b128 a[184:187], v4 offset:3072
 v_mfma_f32_16x16x32_bf16 v[132:135], a[252:255], a[204:207], v[132:135]
 ds_read_b128 a[188:191], v4 offset:17408
 v_mfma_f32_16x16x32_bf16 v[136:139], a[248:251], a[208:211], v[136:139]
 buffer_load_dwordx4 v246, s[8:11], s31 offen offset:3072 sc1 lds
 v_mfma_f32_16x16x32_bf16 v[136:139], a[252:255], a[212:215], v[136:139]
 ds_read_b128 a[0:3], v4 offset:4096
 v_mfma_f32_16x16x32_bf16 v[140:143], a[248:251], a[216:219], v[140:143]
 ds_read_b128 a[4:7], v4 offset:18432
 s_add_u32 s34, s31, 4096
 v_mfma_f32_16x16x32_bf16 v[140:143], a[252:255], a[220:223], v[140:143]
 ds_read_b128 a[8:11], v4 offset:5120
 s_add_u32 m0, s29, 53248
 v_mfma_f32_16x16x32_bf16 v[144:147], a[248:251], a[224:227], v[144:147]
 buffer_load_dwordx4 v246, s[8:11], s34 offen sc1 lds
 v_mfma_f32_16x16x32_bf16 v[144:147], a[252:255], a[228:231], v[144:147]
 ds_read_b128 a[12:15], v4 offset:19456
 v_mfma_f32_16x16x32_bf16 v[148:151], a[248:251], a[232:235], v[148:151]
 ds_read_b128 a[16:19], v4 offset:6144
 v_mfma_f32_16x16x32_bf16 v[148:151], a[252:255], a[236:239], v[148:151]
 ds_read_b128 a[20:23], v4 offset:20480
 v_mfma_f32_16x16x32_bf16 v[152:155], a[248:251], a[240:243], v[152:155]
 buffer_load_dwordx4 v246, s[8:11], s34 offen offset:1024 sc1 lds
 v_mfma_f32_16x16x32_bf16 v[152:155], a[252:255], a[244:247], v[152:155]
 s_waitcnt lgkmcnt(8)
 v_mfma_f32_16x16x32_bf16 v[16:19], a[144:147], a[160:163], v[16:19]
 ds_read_b64_tr_b16 a[152:153], v10 offset:32
 v_mfma_f32_16x16x32_bf16 v[16:19], a[148:151], a[164:167], v[16:19]
 ds_read_b64_tr_b16 a[154:155], v10 offset:5152
 v_mfma_f32_16x16x32_bf16 v[20:23], a[144:147], a[168:171], v[20:23]
 buffer_load_dwordx4 v246, s[8:11], s34 offen offset:2048 sc1 lds
 v_mfma_f32_16x16x32_bf16 v[20:23], a[148:151], a[172:175], v[20:23]
 ds_read_b64_tr_b16 a[156:157], v10 offset:10272
 v_mfma_f32_16x16x32_bf16 v[24:27], a[144:147], a[176:179], v[24:27]
 ds_read_b64_tr_b16 a[158:159], v10 offset:15392
 v_mfma_f32_16x16x32_bf16 v[24:27], a[148:151], a[180:183], v[24:27]
 s_waitcnt lgkmcnt(4)
 v_mfma_f32_16x16x32_bf16 v[28:31], a[144:147], a[184:187], v[28:31]
 ds_read_b64_tr_b16 a[248:249], v9 offset:64
 v_mfma_f32_16x16x32_bf16 v[28:31], a[148:151], a[188:191], v[28:31]
 ds_read_b64_tr_b16 a[250:251], v9 offset:5184
 s_add_u32 m0, s30, 77824
 v_mfma_f32_16x16x32_bf16 v[32:35], a[144:147], a[0:3], v[32:35]
 buffer_load_dwordx4 v11, s[12:15], s32 offen lds
 v_mfma_f32_16x16x32_bf16 v[32:35], a[148:151], a[4:7], v[32:35]
 ds_read_b64_tr_b16 a[252:253], v9 offset:10304
 v_mfma_f32_16x16x32_bf16 v[36:39], a[144:147], a[8:11], v[36:39]
 ds_read_b64_tr_b16 a[254:255], v9 offset:15424
 v_mfma_f32_16x16x32_bf16 v[36:39], a[148:151], a[12:15], v[36:39]
 v_mfma_f32_16x16x32_bf16 v[40:43], a[144:147], a[16:19], v[40:43]
 buffer_load_dwordx4 v12, s[12:15], s32 offen offset:1024 lds
 v_mfma_f32_16x16x32_bf16 v[40:43], a[148:151], a[20:23], v[40:43]
 s_waitcnt lgkmcnt(4)
 v_mfma_f32_16x16x32_bf16 v[44:47], a[152:155], a[160:163], v[44:47]
 v_mfma_f32_16x16x32_bf16 v[44:47], a[156:159], a[164:167], v[44:47]
 ds_read_b64_tr_b16 a[144:145], v10 offset:96
 v_mfma_f32_16x16x32_bf16 v[48:51], a[152:155], a[168:171], v[48:51]
 ds_read_b64_tr_b16 a[146:147], v10 offset:5216
 v_mfma_f32_16x16x32_bf16 v[48:51], a[156:159], a[172:175], v[48:51]
 buffer_load_dwordx4 v13, s[12:15], s32 offen offset:2048 lds
 v_mfma_f32_16x16x32_bf16 v[52:55], a[152:155], a[176:179], v[52:55]
 ds_read_b64_tr_b16 a[148:149], v10 offset:10336
 v_mfma_f32_16x16x32_bf16 v[52:55], a[156:159], a[180:183], v[52:55]
 ds_read_b64_tr_b16 a[150:151], v10 offset:15456
 v_mfma_f32_16x16x32_bf16 v[56:59], a[152:155], a[184:187], v[56:59]
 v_mfma_f32_16x16x32_bf16 v[56:59], a[156:159], a[188:191], v[56:59]
 buffer_load_dwordx4 v14, s[12:15], s32 offen offset:3072 lds
 v_mfma_f32_16x16x32_bf16 v[60:63], a[152:155], a[0:3], v[60:63]
 v_mfma_f32_16x16x32_bf16 v[60:63], a[156:159], a[4:7], v[60:63]
 v_mfma_f32_16x16x32_bf16 v[64:67], a[152:155], a[8:11], v[64:67]
 s_add_u32 m0, s30, 81920
 v_mfma_f32_16x16x32_bf16 v[64:67], a[156:159], a[12:15], v[64:67]
 buffer_load_dwordx4 v15, s[12:15], s32 offen lds
 v_mfma_f32_16x16x32_bf16 v[68:71], a[152:155], a[16:19], v[68:71]
 s_add_u32 s31, s31, 28672
 v_mfma_f32_16x16x32_bf16 v[68:71], a[156:159], a[20:23], v[68:71]
 s_add_u32 s32, s32, 81920
 s_waitcnt lgkmcnt(4)
 v_mfma_f32_16x16x32_bf16 v[72:75], a[248:251], a[160:163], v[72:75]
 v_mfma_f32_16x16x32_bf16 v[72:75], a[252:255], a[164:167], v[72:75]
 ds_read_b64_tr_b16 a[152:153], v9 offset:128
 v_mfma_f32_16x16x32_bf16 v[76:79], a[248:251], a[168:171], v[76:79]
 ds_read_b64_tr_b16 a[154:155], v9 offset:5248
 v_mfma_f32_16x16x32_bf16 v[76:79], a[252:255], a[172:175], v[76:79]
 v_mfma_f32_16x16x32_bf16 v[80:83], a[248:251], a[176:179], v[80:83]
 ds_read_b64_tr_b16 a[156:157], v9 offset:10368
 v_mfma_f32_16x16x32_bf16 v[80:83], a[252:255], a[180:183], v[80:83]
 ds_read_b64_tr_b16 a[158:159], v9 offset:15488
 v_mfma_f32_16x16x32_bf16 v[84:87], a[248:251], a[184:187], v[84:87]
 v_mfma_f32_16x16x32_bf16 v[84:87], a[252:255], a[188:191], v[84:87]
 v_mfma_f32_16x16x32_bf16 v[88:91], a[248:251], a[0:3], v[88:91]
 v_mfma_f32_16x16x32_bf16 v[88:91], a[252:255], a[4:7], v[88:91]
 v_mfma_f32_16x16x32_bf16 v[92:95], a[248:251], a[8:11], v[92:95]
 v_mfma_f32_16x16x32_bf16 v[92:95], a[252:255], a[12:15], v[92:95]
 v_mfma_f32_16x16x32_bf16 v[96:99], a[248:251], a[16:19], v[96:99]
 v_mfma_f32_16x16x32_bf16 v[96:99], a[252:255], a[20:23], v[96:99]
 s_waitcnt lgkmcnt(4)
 v_mfma_f32_16x16x32_bf16 v[100:103], a[144:147], a[160:163], v[100:103]
 v_mfma_f32_16x16x32_bf16 v[100:103], a[148:151], a[164:167], v[100:103]
 s_waitcnt vmcnt(13) lgkmcnt(0)
 v_mfma_f32_16x16x32_bf16 v[104:107], a[144:147], a[168:171], v[104:107]
 s_barrier
 v_mfma_f32_16x16x32_bf16 v[104:107], a[148:151], a[172:175], v[104:107]
 ds_read_b64_tr_b16 a[248:249], v5 offset:0
 v_mfma_f32_16x16x32_bf16 v[108:111], a[144:147], a[176:179], v[108:111]
 ds_read_b64_tr_b16 a[250:251], v5 offset:5120
 v_mfma_f32_16x16x32_bf16 v[108:111], a[148:151], a[180:183], v[108:111]
 ds_read_b128 a[192:195], v2 offset:0
 s_add_u32 m0, s29, 98304
 v_mfma_f32_16x16x32_bf16 v[112:115], a[144:147], a[184:187], v[112:115]
 buffer_load_dwordx4 v246, s[8:11], s31 offen sc1 lds
 v_mfma_f32_16x16x32_bf16 v[112:115], a[148:151], a[188:191], v[112:115]
 ds_read_b64_tr_b16 a[252:253], v5 offset:10240
 v_mfma_f32_16x16x32_bf16 v[116:119], a[144:147], a[0:3], v[116:119]
 ds_read_b64_tr_b16 a[254:255], v5 offset:15360
 v_mfma_f32_16x16x32_bf16 v[116:119], a[148:151], a[4:7], v[116:119]
 ds_read_b128 a[196:199], v2 offset:14336
 v_mfma_f32_16x16x32_bf16 v[120:123], a[144:147], a[8:11], v[120:123]
 buffer_load_dwordx4 v246, s[8:11], s31 offen offset:1024 sc1 lds
 v_mfma_f32_16x16x32_bf16 v[120:123], a[148:151], a[12:15], v[120:123]
 ds_read_b128 a[200:203], v2 offset:1024
 v_mfma_f32_16x16x32_bf16 v[124:127], a[144:147], a[16:19], v[124:127]
 ds_read_b128 a[204:207], v2 offset:15360
 v_mfma_f32_16x16x32_bf16 v[124:127], a[148:151], a[20:23], v[124:127]
 ds_read_b128 a[208:211], v2 offset:2048
 v_mfma_f32_16x16x32_bf16 v[128:131], a[152:155], a[160:163], v[128:131]
 buffer_load_dwordx4 v246, s[8:11], s31 offen offset:2048 sc1 lds
 v_mfma_f32_16x16x32_bf16 v[128:131], a[156:159], a[164:167], v[128:131]
 ds_read_b128 a[212:215], v2 offset:16384
 v_mfma_f32_16x16x32_bf16 v[132:135], a[152:155], a[168:171], v[132:135]
 ds_read_b128 a[216:219], v2 offset:3072
 v_mfma_f32_16x16x32_bf16 v[132:135], a[156:159], a[172:175], v[132:135]
 ds_read_b128 a[220:223], v2 offset:17408
 v_mfma_f32_16x16x32_bf16 v[136:139], a[152:155], a[176:179], v[136:139]
 buffer_load_dwordx4 v246, s[8:11], s31 offen offset:3072 sc1 lds
 v_mfma_f32_16x16x32_bf16 v[136:139], a[156:159], a[180:183], v[136:139]
 ds_read_b128 a[224:227], v2 offset:4096
 v_mfma_f32_16x16x32_bf16 v[140:143], a[152:155], a[184:187], v[140:143]
 ds_read_b128 a[228:231], v2 offset:18432
 s_add_u32 s34, s31, 4096
 v_mfma_f32_16x16x32_bf16 v[140:143], a[156:159], a[188:191], v[140:143]
 ds_read_b128 a[232:235], v2 offset:5120
 s_add_u32 m0, s29, 102400
 v_mfma_f32_16x16x32_bf16 v[144:147], a[152:155], a[0:3], v[144:147]
 buffer_load_dwordx4 v246, s[8:11], s34 offen sc1 lds
 v_mfma_f32_16x16x32_bf16 v[144:147], a[156:159], a[4:7], v[144:147]
 ds_read_b128 a[236:239], v2 offset:19456
 v_mfma_f32_16x16x32_bf16 v[148:151], a[152:155], a[8:11], v[148:151]
 ds_read_b128 a[240:243], v2 offset:6144
 v_mfma_f32_16x16x32_bf16 v[148:151], a[156:159], a[12:15], v[148:151]
 ds_read_b128 a[244:247], v2 offset:20480
 v_mfma_f32_16x16x32_bf16 v[152:155], a[152:155], a[16:19], v[152:155]
 buffer_load_dwordx4 v246, s[8:11], s34 offen offset:1024 sc1 lds
 v_mfma_f32_16x16x32_bf16 v[152:155], a[156:159], a[20:23], v[152:155]
 s_waitcnt lgkmcnt(8)
 s_sub_u32 s33, s33, 1
 s_cbranch_scc0 P_loop
 v_mfma_f32_16x16x32_bf16 v[16:19], a[248:251], a[192:195], v[16:19]
 ds_read_b64_tr_b16 a[144:145], v6 offset:32
 v_mfma_f32_16x16x32_bf16 v[16:19], a[252:255], a[196:199], v[16:19]
 ds_read_b64_tr_b16 a[146:147], v6 offset:5152
 v_mfma_f32_16x16x32_bf16 v[20:23], a[248:251], a[200:203], v[20:23]
 buffer_load_dwordx4 v246, s[8:11], s34 offen offset:2048 sc1 lds
 v_mfma_f32_16x16x32_bf16 v[20:23], a[252:255], a[204:207], v[20:23]
 ds_read_b64_tr_b16 a[148:149], v6 offset:10272
 v_mfma_f32_16x16x32_bf16 v[24:27], a[248:251], a[208:211], v[24:27]
 ds_read_b64_tr_b16 a[150:151], v6 offset:15392
 v_mfma_f32_16x16x32_bf16 v[24:27], a[252:255], a[212:215], v[24:27]
 s_waitcnt lgkmcnt(4)
 v_mfma_f32_16x16x32_bf16 v[28:31], a[248:251], a[216:219], v[28:31]
 ds_read_b64_tr_b16 a[152:153], v5 offset:64
 v_mfma_f32_16x16x32_bf16 v[28:31], a[252:255], a[220:223], v[28:31]
 ds_read_b64_tr_b16 a[154:155], v5 offset:5184
 s_add_u32 m0, s30, 126976
 v_mfma_f32_16x16x32_bf16 v[32:35], a[248:251], a[224:227], v[32:35]
 buffer_load_dwordx4 v11, s[12:15], s32 offen lds
 v_mfma_f32_16x16x32_bf16 v[32:35], a[252:255], a[228:231], v[32:35]
 ds_read_b64_tr_b16 a[156:157], v5 offset:10304
 v_mfma_f32_16x16x32_bf16 v[36:39], a[248:251], a[232:235], v[36:39]
 ds_read_b64_tr_b16 a[158:159], v5 offset:15424
 v_mfma_f32_16x16x32_bf16 v[36:39], a[252:255], a[236:239], v[36:39]
 v_mfma_f32_16x16x32_bf16 v[40:43], a[248:251], a[240:243], v[40:43]
 buffer_load_dwordx4 v12, s[12:15], s32 offen offset:1024 lds
 v_mfma_f32_16x16x32_bf16 v[40:43], a[252:255], a[244:247], v[40:43]
 s_waitcnt lgkmcnt(4)
 v_mfma_f32_16x16x32_bf16 v[44:47], a[144:147], a[192:195], v[44:47]
 v_mfma_f32_16x16x32_bf16 v[44:47], a[148:151], a[196:199], v[44:47]
 ds_read_b64_tr_b16 a[248:249], v6 offset:96
 v_mfma_f32_16x16x32_bf16 v[48:51], a[144:147], a[200:203], v[48:51]
 ds_read_b64_tr_b16 a[250:251], v6 offset:5216
 v_mfma_f32_16x16x32_bf16 v[48:51], a[148:151], a[204:207], v[48:51]
 buffer_load_dwordx4 v13, s[12:15], s32 offen offset:2048 lds
 v_mfma_f32_16x16x32_bf16 v[52:55], a[144:147], a[208:211], v[52:55]
 ds_read_b64_tr_b16 a[252:253], v6 offset:10336
 v_mfma_f32_16x16x32_bf16 v[52:55], a[148:151], a[212:215], v[52:55]
 ds_read_b64_tr_b16 a[254:255], v6 offset:15456
 v_mfma_f32_16x16x32_bf16 v[56:59], a[144:147], a[216:219], v[56:59]
 v_mfma_f32_16x16x32_bf16 v[56:59], a[148:151], a[220:223], v[56:59]
 buffer_load_dwordx4 v14, s[12:15], s32 offen offset:3072 lds
 v_mfma_f32_16x16x32_bf16 v[60:63], a[144:147], a[224:227], v[60:63]
 v_mfma_f32_16x16x32_bf16 v[60:63], a[148:151], a[228:231], v[60:63]
 v_mfma_f32_16x16x32_bf16 v[64:67], a[144:147], a[232:235], v[64:67]
 s_add_u32 m0, s30, 131072
 v_mfma_f32_16x16x32_bf16 v[64:67], a[148:151], a[236:239], v[64:67]
 buffer_load_dwordx4 v15, s[12:15], s32 offen lds
 v_mfma_f32_16x16x32_bf16 v[68:71], a[144:147], a[240:243], v[68:71]
 s_add_u32 s31, s31, 28672
 v_mfma_f32_16x16x32_bf16 v[68:71], a[148:151], a[244:247], v[68:71]
 s_add_u32 s32, s32, 81920
 s_waitcnt lgkmcnt(4)
 v_mfma_f32_16x16x32_bf16 v[72:75], a[152:155], a[192:195], v[72:75]
 s_cmp_eq_u32 s31, s36
 s_cselect_b32 s31, s38, s31
 v_mfma_f32_16x16x32_bf16 v[72:75], a[156:159], a[196:199], v[72:75]
 ds_read_b64_tr_b16 a[144:145], v5 offset:128
 s_cmp_eq_u32 s32, s37
 s_cselect_b32 s32, s39, s32
 v_mfma_f32_16x16x32_bf16 v[76:79], a[152:155], a[200:203], v[76:79]
 ds_read_b64_tr_b16 a[146:147], v5 offset:5248
 v_mfma_f32_16x16x32_bf16 v[76:79], a[156:159], a[204:207], v[76:79]
 v_mfma_f32_16x16x32_bf16 v[80:83], a[152:155], a[208:211], v[80:83]
 ds_read_b64_tr_b16 a[148:149], v5 offset:10368
 v_mfma_f32_16x16x32_bf16 v[80:83], a[156:159], a[212:215], v[80:83]
 ds_read_b64_tr_b16 a[150:151], v5 offset:15488
 v_mfma_f32_16x16x32_bf16 v[84:87], a[152:155], a[216:219], v[84:87]
 v_mfma_f32_16x16x32_bf16 v[84:87], a[156:159], a[220:223], v[84:87]
 v_mfma_f32_16x16x32_bf16 v[88:91], a[152:155], a[224:227], v[88:91]
 v_mfma_f32_16x16x32_bf16 v[88:91], a[156:159], a[228:231], v[88:91]
 v_mfma_f32_16x16x32_bf16 v[92:95], a[152:155], a[232:235], v[92:95]
 v_mfma_f32_16x16x32_bf16 v[92:95], a[156:159], a[236:239], v[92:95]
 v_mfma_f32_16x16x32_bf16 v[96:99], a[152:155], a[240:243], v[96:99]
 v_mfma_f32_16x16x32_bf16 v[96:99], a[156:159], a[244:247], v[96:99]
 s_waitcnt lgkmcnt(4)
 v_mfma_f32_16x16x32_bf16 v[100:103], a[248:251], a[192:195], v[100:103]
 v_mfma_f32_16x16x32_bf16 v[100:103], a[252:255], a[196:199], v[100:103]
 s_waitcnt vmcnt(12) lgkmcnt(0)
 v_mfma_f32_16x16x32_bf16 v[104:107], a[248:251], a[200:203], v[104:107]
 s_barrier
 v_mfma_f32_16x16x32_bf16 v[104:107], a[252:255], a[204:207], v[104:107]
 ds_read_b64_tr_b16 a[152:153], v7 offset:0
 v_mfma_f32_16x16x32_bf16 v[108:111], a[248:251], a[208:211], v[108:111]
 ds_read_b64_tr_b16 a[154:155], v7 offset:5120
 v_mfma_f32_16x16x32_bf16 v[108:111], a[252:255], a[212:215], v[108:111]
 ds_read_b128 a[160:163], v3 offset:0
 s_add_u32 m0, s29, 0
 v_mfma_f32_16x16x32_bf16 v[112:115], a[248:251], a[216:219], v[112:115]
 buffer_load_dwordx4 v246, s[8:11], s31 offen sc1 lds
 v_mfma_f32_16x16x32_bf16 v[112:115], a[252:255], a[220:223], v[112:115]
 ds_read_b64_tr_b16 a[156:157], v7 offset:10240
 v_mfma_f32_16x16x32_bf16 v[116:119], a[248:251], a[224:227], v[116:119]
 ds_read_b64_tr_b16 a[158:159], v7 offset:15360
 v_mfma_f32_16x16x32_bf16 v[116:119], a[252:255], a[228:231], v[116:119]
 ds_read_b128 a[164:167], v3 offset:14336
 v_mfma_f32_16x16x32_bf16 v[120:123], a[248:251], a[232:235], v[120:123]
 buffer_load_dwordx4 v246, s[8:11], s31 offen offset:1024 sc1 lds
 v_mfma_f32_16x16x32_bf16 v[120:123], a[252:255], a[236:239], v[120:123]
 ds_read_b128 a[168:171], v3 offset:1024
 v_mfma_f32_16x16x32_bf16 v[124:127], a[248:251], a[240:243], v[124:127]
 ds_read_b128 a[172:175], v3 offset:15360
 v_mfma_f32_16x16x32_bf16 v[124:127], a[252:255], a[244:247], v[124:127]
 ds_read_b128 a[176:179], v3 offset:2048
 v_mfma_f32_16x16x32_bf16 v[128:131], a[144:147], a[192:195], v[128:131]
 buffer_load_dwordx4 v246, s[8:11], s31 offen offset:2048 sc1 lds
 v_mfma_f32_16x16x32_bf16 v[128:131], a[148:151], a[196:199], v[128:131]
 ds_read_b128 a[180:183], v3 offset:16384
 v_mfma_f32_16x16x32_bf16 v[132:135], a[144:147], a[200:203], v[132:135]
 ds_read_b128 a[184:187], v3 offset:3072
 v_mfma_f32_16x16x32_bf16 v[132:135], a[148:151], a[204:207], v[132:135]
 ds_read_b128 a[188:191], v3 offset:17408
 v_mfma_f32_16x16x32_bf16 v[136:139], a[144:147], a[208:211], v[136:139]
 buffer_load_dwordx4 v246, s[8:11], s31 offen offset:3072 sc1 lds
 v_mfma_f32_16x16x32_bf16 v[136:139], a[148:151], a[212:215], v[136:139]
 ds_read_b128 a[0:3], v3 offset:4096
 v_mfma_f32_16x16x32_bf16 v[140:143], a[144:147], a[216:219], v[140:143]
 ds_read_b128 a[4:7], v3 offset:18432
 s_add_u32 s34, s31, 4096
 v_mfma_f32_16x16x32_bf16 v[140:143], a[148:151], a[220:223], v[140:143]
 ds_read_b128 a[8:11], v3 offset:5120
 s_add_u32 m0, s29, 4096
 v_mfma_f32_16x16x32_bf16 v[144:147], a[144:147], a[224:227], v[144:147]
 buffer_load_dwordx4 v246, s[8:11], s34 offen sc1 lds
 v_mfma_f32_16x16x32_bf16 v[144:147], a[148:151], a[228:231], v[144:147]
 ds_read_b128 a[12:15], v3 offset:19456
 v_mfma_f32_16x16x32_bf16 v[148:151], a[144:147], a[232:235], v[148:151]
 ds_read_b128 a[16:19], v3 offset:6144
 v_mfma_f32_16x16x32_bf16 v[148:151], a[148:151], a[236:239], v[148:151]
 ds_read_b128 a[20:23], v3 offset:20480
 v_mfma_f32_16x16x32_bf16 v[152:155], a[144:147], a[240:243], v[152:155]
 buffer_load_dwordx4 v246, s[8:11], s34 offen offset:1024 sc1 lds
 v_mfma_f32_16x16x32_bf16 v[152:155], a[148:151], a[244:247], v[152:155]
 s_waitcnt lgkmcnt(8)
 v_mfma_f32_16x16x32_bf16 v[16:19], a[152:155], a[160:163], v[16:19]
 ds_read_b64_tr_b16 a[248:249], v8 offset:32
 v_mfma_f32_16x16x32_bf16 v[16:19], a[156:159], a[164:167], v[16:19]
 ds_read_b64_tr_b16 a[250:251], v8 offset:5152
 v_mfma_f32_16x16x32_bf16 v[20:23], a[152:155], a[168:171], v[20:23]
 buffer_load_dwordx4 v246, s[8:11], s34 offen offset:2048 sc1 lds
 v_mfma_f32_16x16x32_bf16 v[20:23], a[156:159], a[172:175], v[20:23]
 ds_read_b64_tr_b16 a[252:253], v8 offset:10272
 v_mfma_f32_16x16x32_bf16 v[24:27], a[152:155], a[176:179], v[24:27]
 ds_read_b64_tr_b16 a[254:255], v8 offset:15392
 v_mfma_f32_16x16x32_bf16 v[24:27], a[156:159], a[180:183], v[24:27]
 s_waitcnt lgkmcnt(4)
 v_mfma_f32_16x16x32_bf16 v[28:31], a[152:155], a[184:187], v[28:31]
 ds_read_b64_tr_b16 a[144:145], v7 offset:64
 v_mfma_f32_16x16x32_bf16 v[28:31], a[156:159], a[188:191], v[28:31]
 ds_read_b64_tr_b16 a[146:147], v7 offset:5184
 s_add_u32 m0, s30, 28672
 v_mfma_f32_16x16x32_bf16 v[32:35], a[152:155], a[0:3], v[32:35]
 buffer_load_dwordx4 v11, s[12:15], s32 offen lds
 v_mfma_f32_16x16x32_bf16 v[32:35], a[156:159], a[4:7], v[32:35]
 ds_read_b64_tr_b16 a[148:149], v7 offset:10304
 v_mfma_f32_16x16x32_bf16 v[36:39], a[152:155], a[8:11], v[36:39]
 ds_read_b64_tr_b16 a[150:151], v7 offset:15424
 v_mfma_f32_16x16x32_bf16 v[36:39], a[156:159], a[12:15], v[36:39]
 v_mfma_f32_16x16x32_bf16 v[40:43], a[152:155], a[16:19], v[40:43]
 buffer_load_dwordx4 v12, s[12:15], s32 offen offset:1024 lds
 v_mfma_f32_16x16x32_bf16 v[40:43], a[156:159], a[20:23], v[40:43]
 s_waitcnt lgkmcnt(4)
 v_mfma_f32_16x16x32_bf16 v[44:47], a[248:251], a[160:163], v[44:47]
 v_mfma_f32_16x16x32_bf16 v[44:47], a[252:255], a[164:167], v[44:47]
 ds_read_b64_tr_b16 a[152:153], v8 offset:96
 v_mfma_f32_16x16x32_bf16 v[48:51], a[248:251], a[168:171], v[48:51]
 ds_read_b64_tr_b16 a[154:155], v8 offset:5216
 v_mfma_f32_16x16x32_bf16 v[48:51], a[252:255], a[172:175], v[48:51]
 buffer_load_dwordx4 v13, s[12:15], s32 offen offset:2048 lds
 v_mfma_f32_16x16x32_bf16 v[52:55], a[248:251], a[176:179], v[52:55]
 ds_read_b64_tr_b16 a[156:157], v8 offset:10336
 v_mfma_f32_16x16x32_bf16 v[52:55], a[252:255], a[180:183], v[52:55]
 ds_read_b64_tr_b16 a[158:159], v8 offset:15456
 v_mfma_f32_16x16x32_bf16 v[56:59], a[248:251], a[184:187], v[56:59]
 v_mfma_f32_16x16x32_bf16 v[56:59], a[252:255], a[188:191], v[56:59]
 buffer_load_dwordx4 v14, s[12:15], s32 offen offset:3072 lds
 v_mfma_f32_16x16x32_bf16 v[60:63], a[248:251], a[0:3], v[60:63]
 v_mfma_f32_16x16x32_bf16 v[60:63], a[252:255], a[4:7], v[60:63]
 v_mfma_f32_16x16x32_bf16 v[64:67], a[248:251], a[8:11], v[64:67]
 s_add_u32 m0, s30, 32768
 v_mfma_f32_16x16x32_bf16 v[64:67], a[252:255], a[12:15], v[64:67]
 buffer_load_dwordx4 v15, s[12:15], s32 offen lds
 v_mfma_f32_16x16x32_bf16 v[68:71], a[248:251], a[16:19], v[68:71]
 s_add_u32 s31, s31, 28672
 v_mfma_f32_16x16x32_bf16 v[68:71], a[252:255], a[20:23], v[68:71]
 s_add_u32 s32, s32, 81920
 s_waitcnt lgkmcnt(4)
 v_mfma_f32_16x16x32_bf16 v[72:75], a[144:147], a[160:163], v[72:75]
 v_mfma_f32_16x16x32_bf16 v[72:75], a[148:151], a[164:167], v[72:75]
 ds_read_b64_tr_b16 a[248:249], v7 offset:128
 v_mfma_f32_16x16x32_bf16 v[76:79], a[144:147], a[168:171], v[76:79]
 ds_read_b64_tr_b16 a[250:251], v7 offset:5248
 v_mfma_f32_16x16x32_bf16 v[76:79], a[148:151], a[172:175], v[76:79]
 v_mfma_f32_16x16x32_bf16 v[80:83], a[144:147], a[176:179], v[80:83]
 ds_read_b64_tr_b16 a[252:253], v7 offset:10368
 v_mfma_f32_16x16x32_bf16 v[80:83], a[148:151], a[180:183], v[80:83]
 ds_read_b64_tr_b16 a[254:255], v7 offset:15488
 v_mfma_f32_16x16x32_bf16 v[84:87], a[144:147], a[184:187], v[84:87]
 v_mfma_f32_16x16x32_bf16 v[84:87], a[148:151], a[188:191], v[84:87]
 v_mfma_f32_16x16x32_bf16 v[88:91], a[144:147], a[0:3], v[88:91]
 v_mfma_f32_16x16x32_bf16 v[88:91], a[148:151], a[4:7], v[88:91]
 v_mfma_f32_16x16x32_bf16 v[92:95], a[144:147], a[8:11], v[92:95]
 v_mfma_f32_16x16x32_bf16 v[92:95], a[148:151], a[12:15], v[92:95]
 v_mfma_f32_16x16x32_bf16 v[96:99], a[144:147], a[16:19], v[96:99]
 v_mfma_f32_16x16x32_bf16 v[96:99], a[148:151], a[20:23], v[96:99]
 s_waitcnt lgkmcnt(4)
 v_mfma_f32_16x16x32_bf16 v[100:103], a[152:155], a[160:163], v[100:103]
 v_mfma_f32_16x16x32_bf16 v[100:103], a[156:159], a[164:167], v[100:103]
 s_waitcnt vmcnt(12) lgkmcnt(0)
 v_mfma_f32_16x16x32_bf16 v[104:107], a[152:155], a[168:171], v[104:107]
 s_barrier
 v_mfma_f32_16x16x32_bf16 v[104:107], a[156:159], a[172:175], v[104:107]
 ds_read_b64_tr_b16 a[144:145], v9 offset:0
 v_mfma_f32_16x16x32_bf16 v[108:111], a[152:155], a[176:179], v[108:111]
 ds_read_b64_tr_b16 a[146:147], v9 offset:5120
 v_mfma_f32_16x16x32_bf16 v[108:111], a[156:159], a[180:183], v[108:111]
 ds_read_b128 a[192:195], v4 offset:0
 s_add_u32 m0, s29, 49152
 v_mfma_f32_16x16x32_bf16 v[112:115], a[152:155], a[184:187], v[112:115]
 buffer_load_dwordx4 v246, s[8:11], s31 offen sc1 lds
 v_mfma_f32_16x16x32_bf16 v[112:115], a[156:159], a[188:191], v[112:115]
 ds_read_b64_tr_b16 a[148:149], v9 offset:10240
 v_mfma_f32_16x16x32_bf16 v[116:119], a[152:155], a[0:3], v[116:119]
 ds_read_b64_tr_b16 a[150:151], v9 offset:15360
 v_mfma_f32_16x16x32_bf16 v[116:119], a[156:159], a[4:7], v[116:119]
 ds_read_b128 a[196:199], v4 offset:14336
 v_mfma_f32_16x16x32_bf16 v[120:123], a[152:155], a[8:11], v[120:123]
 buffer_load_dwordx4 v246, s[8:11], s31 offen offset:1024 sc1 lds
 v_mfma_f32_16x16x32_bf16 v[120:123], a[156:159], a[12:15], v[120:123]
 ds_read_b128 a[200:203], v4 offset:1024
 v_mfma_f32_16x16x32_bf16 v[124:127], a[152:155], a[16:19], v[124:127]
 ds_read_b128 a[204:207], v4 offset:15360
 v_mfma_f32_16x16x32_bf16 v[124:127], a[156:159], a[20:23], v[124:127]
 ds_read_b128 a[208:211], v4 offset:2048
 v_mfma_f32_16x16x32_bf16 v[128:131], a[248:251], a[160:163], v[128:131]
 buffer_load_dwordx4 v246, s[8:11], s31 offen offset:2048 sc1 lds
 v_mfma_f32_16x16x32_bf16 v[128:131], a[252:255], a[164:167], v[128:131]
 ds_read_b128 a[212:215], v4 offset:16384
 v_mfma_f32_16x16x32_bf16 v[132:135], a[248:251], a[168:171], v[132:135]
 ds_read_b128 a[216:219], v4 offset:3072
 v_mfma_f32_16x16x32_bf16 v[132:135], a[252:255], a[172:175], v[132:135]
 ds_read_b128 a[220:223], v4 offset:17408
 v_mfma_f32_16x16x32_bf16 v[136:139], a[248:251], a[176:179], v[136:139]
 buffer_load_dwordx4 v246, s[8:11], s31 offen offset:3072 sc1 lds
 v_mfma_f32_16x16x32_bf16 v[136:139], a[252:255], a[180:183], v[136:139]
 ds_read_b128 a[224:227], v4 offset:4096
 v_mfma_f32_16x16x32_bf16 v[140:143], a[248:251], a[184:187], v[140:143]
 ds_read_b128 a[228:231], v4 offset:18432
 s_add_u32 s34, s31, 4096
 v_mfma_f32_16x16x32_bf16 v[140:143], a[252:255], a[188:191], v[140:143]
 ds_read_b128 a[232:235], v4 offset:5120
 s_add_u32 m0, s29, 53248
 v_mfma_f32_16x16x32_bf16 v[144:147], a[248:251], a[0:3], v[144:147]
 buffer_load_dwordx4 v246, s[8:11], s34 offen sc1 lds
 v_mfma_f32_16x16x32_bf16 v[144:147], a[252:255], a[4:7], v[144:147]
 ds_read_b128 a[236:239], v4 offset:19456
 v_mfma_f32_16x16x32_bf16 v[148:151], a[248:251], a[8:11], v[148:151]
 ds_read_b128 a[240:243], v4 offset:6144
 v_mfma_f32_16x16x32_bf16 v[148:151], a[252:255], a[12:15], v[148:151]
 ds_read_b128 a[244:247], v4 offset:20480
 v_mfma_f32_16x16x32_bf16 v[152:155], a[248:251], a[16:19], v[152:155]
 buffer_load_dwordx4 v246, s[8:11], s34 offen offset:1024 sc1 lds
 v_mfma_f32_16x16x32_bf16 v[152:155], a[252:255], a[20:23], v[152:155]
 s_waitcnt lgkmcnt(8)
 v_mfma_f32_16x16x32_bf16 v[16:19], a[144:147], a[192:195], v[16:19]
 ds_read_b64_tr_b16 a[152:153], v10 offset:32
 v_mfma_f32_16x16x32_bf16 v[16:19], a[148:151], a[196:199], v[16:19]
 ds_read_b64_tr_b16 a[154:155], v10 offset:5152
 v_mfma_f32_16x16x32_bf16 v[20:23], a[144:147], a[200:203], v[20:23]
 buffer_load_dwordx4 v246, s[8:11], s34 offen offset:2048 sc1 lds
 v_mfma_f32_16x16x32_bf16 v[20:23], a[148:151], a[204:207], v[20:23]
 ds_read_b64_tr_b16 a[156:157], v10 offset:10272
 v_mfma_f32_16x16x32_bf16 v[24:27], a[144:147], a[208:211], v[24:27]
 ds_read_b64_tr_b16 a[158:159], v10 offset:15392
 v_mfma_f32_16x16x32_bf16 v[24:27], a[148:151], a[212:215], v[24:27]
 s_waitcnt lgkmcnt(4)
 v_mfma_f32_16x16x32_bf16 v[28:31], a[144:147], a[216:219], v[28:31]
 ds_read_b64_tr_b16 a[248:249], v9 offset:64
 v_mfma_f32_16x16x32_bf16 v[28:31], a[148:151], a[220:223], v[28:31]
 ds_read_b64_tr_b16 a[250:251], v9 offset:5184
 s_add_u32 m0, s30, 77824
 v_mfma_f32_16x16x32_bf16 v[32:35], a[144:147], a[224:227], v[32:35]
 buffer_load_dwordx4 v11, s[12:15], s32 offen lds
 v_mfma_f32_16x16x32_bf16 v[32:35], a[148:151], a[228:231], v[32:35]
 ds_read_b64_tr_b16 a[252:253], v9 offset:10304
 v_mfma_f32_16x16x32_bf16 v[36:39], a[144:147], a[232:235], v[36:39]
 ds_read_b64_tr_b16 a[254:255], v9 offset:15424
 v_mfma_f32_16x16x32_bf16 v[36:39], a[148:151], a[236:239], v[36:39]
 v_mfma_f32_16x16x32_bf16 v[40:43], a[144:147], a[240:243], v[40:43]
 buffer_load_dwordx4 v12, s[12:15], s32 offen offset:1024 lds
 v_mfma_f32_16x16x32_bf16 v[40:43], a[148:151], a[244:247], v[40:43]
 s_waitcnt lgkmcnt(4)
 v_mfma_f32_16x16x32_bf16 v[44:47], a[152:155], a[192:195], v[44:47]
 v_mfma_f32_16x16x32_bf16 v[44:47], a[156:159], a[196:199], v[44:47]
 ds_read_b64_tr_b16 a[144:145], v10 offset:96
 v_mfma_f32_16x16x32_bf16 v[48:51], a[152:155], a[200:203], v[48:51]
 ds_read_b64_tr_b16 a[146:147], v10 offset:5216
 v_mfma_f32_16x16x32_bf16 v[48:51], a[156:159], a[204:207], v[48:51]
 buffer_load_dwordx4 v13, s[12:15], s32 offen offset:2048 lds
 v_mfma_f32_16x16x32_bf16 v[52:55], a[152:155], a[208:211], v[52:55]
 ds_read_b64_tr_b16 a[148:149], v10 offset:10336
 v_mfma_f32_16x16x32_bf16 v[52:55], a[156:159], a[212:215], v[52:55]
 ds_read_b64_tr_b16 a[150:151], v10 offset:15456
 v_mfma_f32_16x16x32_bf16 v[56:59], a[152:155], a[216:219], v[56:59]
 v_mfma_f32_16x16x32_bf16 v[56:59], a[156:159], a[220:223], v[56:59]
 buffer_load_dwordx4 v14, s[12:15], s32 offen offset:3072 lds
 v_mfma_f32_16x16x32_bf16 v[60:63], a[152:155], a[224:227], v[60:63]
 v_mfma_f32_16x16x32_bf16 v[60:63], a[156:159], a[228:231], v[60:63]
 v_mfma_f32_16x16x32_bf16 v[64:67], a[152:155], a[232:235], v[64:67]
 s_add_u32 m0, s30, 81920
 v_mfma_f32_16x16x32_bf16 v[64:67], a[156:159], a[236:239], v[64:67]
 buffer_load_dwordx4 v15, s[12:15], s32 offen lds
 v_mfma_f32_16x16x32_bf16 v[68:71], a[152:155], a[240:243], v[68:71]
 s_add_u32 s31, s31, 28672
 v_mfma_f32_16x16x32_bf16 v[68:71], a[156:159], a[244:247], v[68:71]
 s_add_u32 s32, s32, 81920
 s_waitcnt lgkmcnt(4)
 v_mfma_f32_16x16x32_bf16 v[72:75], a[248:251], a[192:195], v[72:75]
 v_mfma_f32_16x16x32_bf16 v[72:75], a[252:255], a[196:199], v[72:75]
 ds_read_b64_tr_b16 a[152:153], v9 offset:128
 v_mfma_f32_16x16x32_bf16 v[76:79], a[248:251], a[200:203], v[76:79]
 ds_read_b64_tr_b16 a[154:155], v9 offset:5248
 v_mfma_f32_16x16x32_bf16 v[76:79], a[252:255], a[204:207], v[76:79]
 v_mfma_f32_16x16x32_bf16 v[80:83], a[248:251], a[208:211], v[80:83]
 ds_read_b64_tr_b16 a[156:157], v9 offset:10368
 v_mfma_f32_16x16x32_bf16 v[80:83], a[252:255], a[212:215], v[80:83]
 ds_read_b64_tr_b16 a[158:159], v9 offset:15488
 v_mfma_f32_16x16x32_bf16 v[84:87], a[248:251], a[216:219], v[84:87]
 v_mfma_f32_16x16x32_bf16 v[84:87], a[252:255], a[220:223], v[84:87]
 v_mfma_f32_16x16x32_bf16 v[88:91], a[248:251], a[224:227], v[88:91]
 v_mfma_f32_16x16x32_bf16 v[88:91], a[252:255], a[228:231], v[88:91]
 v_mfma_f32_16x16x32_bf16 v[92:95], a[248:251], a[232:235], v[92:95]
 v_mfma_f32_16x16x32_bf16 v[92:95], a[252:255], a[236:239], v[92:95]
 v_mfma_f32_16x16x32_bf16 v[96:99], a[248:251], a[240:243], v[96:99]
 v_mfma_f32_16x16x32_bf16 v[96:99], a[252:255], a[244:247], v[96:99]
 s_waitcnt lgkmcnt(4)
 v_mfma_f32_16x16x32_bf16 v[100:103], a[144:147], a[192:195], v[100:103]
 v_mfma_f32_16x16x32_bf16 v[100:103], a[148:151], a[196:199], v[100:103]
 s_waitcnt vmcnt(12) lgkmcnt(0)
 v_mfma_f32_16x16x32_bf16 v[104:107], a[144:147], a[200:203], v[104:107]
 s_barrier
 v_mfma_f32_16x16x32_bf16 v[104:107], a[148:151], a[204:207], v[104:107]
 ds_read_b64_tr_b16 a[248:249], v5 offset:0
 v_mfma_f32_16x16x32_bf16 v[108:111], a[144:147], a[208:211], v[108:111]
 ds_read_b64_tr_b16 a[250:251], v5 offset:5120
 v_mfma_f32_16x16x32_bf16 v[108:111], a[148:151], a[212:215], v[108:111]
 ds_read_b128 a[160:163], v2 offset:0
 s_add_u32 m0, s29, 98304
 v_mfma_f32_16x16x32_bf16 v[112:115], a[144:147], a[216:219], v[112:115]
 buffer_load_dwordx4 v246, s[8:11], s31 offen sc1 lds
 v_mfma_f32_16x16x32_bf16 v[112:115], a[148:151], a[220:223], v[112:115]
 ds_read_b64_tr_b16 a[252:253], v5 offset:10240
 v_mfma_f32_16x16x32_bf16 v[116:119], a[144:147], a[224:227], v[116:119]
 ds_read_b64_tr_b16 a[254:255], v5 offset:15360
 v_mfma_f32_16x16x32_bf16 v[116:119], a[148:151], a[228:231], v[116:119]
 ds_read_b128 a[164:167], v2 offset:14336
 v_mfma_f32_16x16x32_bf16 v[120:123], a[144:147], a[232:235], v[120:123]
 buffer_load_dwordx4 v246, s[8:11], s31 offen offset:1024 sc1 lds
 v_mfma_f32_16x16x32_bf16 v[120:123], a[148:151], a[236:239], v[120:123]
 ds_read_b128 a[168:171], v2 offset:1024
 v_mfma_f32_16x16x32_bf16 v[124:127], a[144:147], a[240:243], v[124:127]
 ds_read_b128 a[172:175], v2 offset:15360
 v_mfma_f32_16x16x32_bf16 v[124:127], a[148:151], a[244:247], v[124:127]
 ds_read_b128 a[176:179], v2 offset:2048
 v_mfma_f32_16x16x32_bf16 v[128:131], a[152:155], a[192:195], v[128:131]
 buffer_load_dwordx4 v246, s[8:11], s31 offen offset:2048 sc1 lds
 v_mfma_f32_16x16x32_bf16 v[128:131], a[156:159], a[196:199], v[128:131]
 ds_read_b128 a[180:183], v2 offset:16384
 v_mfma_f32_16x16x32_bf16 v[132:135], a[152:155], a[200:203], v[132:135]
 ds_read_b128 a[184:187], v2 offset:3072
 v_mfma_f32_16x16x32_bf16 v[132:135], a[156:159], a[204:207], v[132:135]
 ds_read_b128 a[188:191], v2 offset:17408
 v_mfma_f32_16x16x32_bf16 v[136:139], a[152:155], a[208:211], v[136:139]
 buffer_load_dwordx4 v246, s[8:11], s31 offen offset:3072 sc1 lds
 v_mfma_f32_16x16x32_bf16 v[136:139], a[156:159], a[212:215], v[136:139]
 ds_read_b128 a[0:3], v2 offset:4096
 v_mfma_f32_16x16x32_bf16 v[140:143], a[152:155], a[216:219], v[140:143]
 ds_read_b128 a[4:7], v2 offset:18432
 s_add_u32 s34, s31, 4096
 v_mfma_f32_16x16x32_bf16 v[140:143], a[156:159], a[220:223], v[140:143]
 ds_read_b128 a[8:11], v2 offset:5120
 s_add_u32 m0, s29, 102400
 v_mfma_f32_16x16x32_bf16 v[144:147], a[152:155], a[224:227], v[144:147]
 buffer_load_dwordx4 v246, s[8:11], s34 offen sc1 lds
 v_mfma_f32_16x16x32_bf16 v[144:147], a[156:159], a[228:231], v[144:147]
 ds_read_b128 a[12:15], v2 offset:19456
 v_mfma_f32_16x16x32_bf16 v[148:151], a[152:155], a[232:235], v[148:151]
 ds_read_b128 a[16:19], v2 offset:6144
 v_mfma_f32_16x16x32_bf16 v[148:151], a[156:159], a[236:239], v[148:151]
 ds_read_b128 a[20:23], v2 offset:20480
 v_mfma_f32_16x16x32_bf16 v[152:155], a[152:155], a[240:243], v[152:155]
 buffer_load_dwordx4 v246, s[8:11], s34 offen offset:1024 sc1 lds
 v_mfma_f32_16x16x32_bf16 v[152:155], a[156:159], a[244:247], v[152:155]
 s_waitcnt lgkmcnt(8)
 v_mfma_f32_16x16x32_bf16 v[16:19], a[248:251], a[160:163], v[16:19]
 ds_read_b64_tr_b16 a[144:145], v6 offset:32
 v_mfma_f32_16x16x32_bf16 v[16:19], a[252:255], a[164:167], v[16:19]
 ds_read_b64_tr_b16 a[146:147], v6 offset:5152
 v_mfma_f32_16x16x32_bf16 v[20:23], a[248:251], a[168:171], v[20:23]
 buffer_load_dwordx4 v246, s[8:11], s34 offen offset:2048 sc1 lds
 v_mfma_f32_16x16x32_bf16 v[20:23], a[252:255], a[172:175], v[20:23]
 ds_read_b64_tr_b16 a[148:149], v6 offset:10272
 v_mfma_f32_16x16x32_bf16 v[24:27], a[248:251], a[176:179], v[24:27]
 ds_read_b64_tr_b16 a[150:151], v6 offset:15392
 v_mfma_f32_16x16x32_bf16 v[24:27], a[252:255], a[180:183], v[24:27]
 s_waitcnt lgkmcnt(4)
 v_mfma_f32_16x16x32_bf16 v[28:31], a[248:251], a[184:187], v[28:31]
 ds_read_b64_tr_b16 a[152:153], v5 offset:64
 v_mfma_f32_16x16x32_bf16 v[28:31], a[252:255], a[188:191], v[28:31]
 ds_read_b64_tr_b16 a[154:155], v5 offset:5184
 s_add_u32 m0, s30, 126976
 v_mfma_f32_16x16x32_bf16 v[32:35], a[248:251], a[0:3], v[32:35]
 buffer_load_dwordx4 v11, s[12:15], s32 offen lds
 v_mfma_f32_16x16x32_bf16 v[32:35], a[252:255], a[4:7], v[32:35]
 ds_read_b64_tr_b16 a[156:157], v5 offset:10304
 v_mfma_f32_16x16x32_bf16 v[36:39], a[248:251], a[8:11], v[36:39]
 ds_read_b64_tr_b16 a[158:159], v5 offset:15424
 v_mfma_f32_16x16x32_bf16 v[36:39], a[252:255], a[12:15], v[36:39]
 v_mfma_f32_16x16x32_bf16 v[40:43], a[248:251], a[16:19], v[40:43]
 buffer_load_dwordx4 v12, s[12:15], s32 offen offset:1024 lds
 v_mfma_f32_16x16x32_bf16 v[40:43], a[252:255], a[20:23], v[40:43]
 s_waitcnt lgkmcnt(4)
 v_mfma_f32_16x16x32_bf16 v[44:47], a[144:147], a[160:163], v[44:47]
 v_mfma_f32_16x16x32_bf16 v[44:47], a[148:151], a[164:167], v[44:47]
 ds_read_b64_tr_b16 a[248:249], v6 offset:96
 v_mfma_f32_16x16x32_bf16 v[48:51], a[144:147], a[168:171], v[48:51]
 ds_read_b64_tr_b16 a[250:251], v6 offset:5216
 v_mfma_f32_16x16x32_bf16 v[48:51], a[148:151], a[172:175], v[48:51]
 buffer_load_dwordx4 v13, s[12:15], s32 offen offset:2048 lds
 v_mfma_f32_16x16x32_bf16 v[52:55], a[144:147], a[176:179], v[52:55]
 ds_read_b64_tr_b16 a[252:253], v6 offset:10336
 v_mfma_f32_16x16x32_bf16 v[52:55], a[148:151], a[180:183], v[52:55]
 ds_read_b64_tr_b16 a[254:255], v6 offset:15456
 v_mfma_f32_16x16x32_bf16 v[56:59], a[144:147], a[184:187], v[56:59]
 v_mfma_f32_16x16x32_bf16 v[56:59], a[148:151], a[188:191], v[56:59]
 buffer_load_dwordx4 v14, s[12:15], s32 offen offset:3072 lds
 v_mfma_f32_16x16x32_bf16 v[60:63], a[144:147], a[0:3], v[60:63]
 v_mfma_f32_16x16x32_bf16 v[60:63], a[148:151], a[4:7], v[60:63]
 v_mfma_f32_16x16x32_bf16 v[64:67], a[144:147], a[8:11], v[64:67]
 s_add_u32 m0, s30, 131072
 v_mfma_f32_16x16x32_bf16 v[64:67], a[148:151], a[12:15], v[64:67]
 buffer_load_dwordx4 v15, s[12:15], s32 offen lds
 v_mfma_f32_16x16x32_bf16 v[68:71], a[144:147], a[16:19], v[68:71]
 s_add_u32 s31, s31, 28672
 v_mfma_f32_16x16x32_bf16 v[68:71], a[148:151], a[20:23], v[68:71]
 s_add_u32 s32, s32, 81920
 s_waitcnt lgkmcnt(4)
 v_mfma_f32_16x16x32_bf16 v[72:75], a[152:155], a[160:163], v[72:75]
 s_cmp_eq_u32 s31, s36
 s_cselect_b32 s31, s38, s31
 v_mfma_f32_16x16x32_bf16 v[72:75], a[156:159], a[164:167], v[72:75]
 ds_read_b64_tr_b16 a[144:145], v5 offset:128
 s_cmp_eq_u32 s32, s37
 s_cselect_b32 s32, s39, s32
 v_mfma_f32_16x16x32_bf16 v[76:79], a[152:155], a[168:171], v[76:79]
 ds_read_b64_tr_b16 a[146:147], v5 offset:5248
 v_mfma_f32_16x16x32_bf16 v[76:79], a[156:159], a[172:175], v[76:79]
 v_mfma_f32_16x16x32_bf16 v[80:83], a[152:155], a[176:179], v[80:83]
 ds_read_b64_tr_b16 a[148:149], v5 offset:10368
 v_mfma_f32_16x16x32_bf16 v[80:83], a[156:159], a[180:183], v[80:83]
 ds_read_b64_tr_b16 a[150:151], v5 offset:15488
 v_mfma_f32_16x16x32_bf16 v[84:87], a[152:155], a[184:187], v[84:87]
 v_mfma_f32_16x16x32_bf16 v[84:87], a[156:159], a[188:191], v[84:87]
 v_mfma_f32_16x16x32_bf16 v[88:91], a[152:155], a[0:3], v[88:91]
 v_mfma_f32_16x16x32_bf16 v[88:91], a[156:159], a[4:7], v[88:91]
 v_mfma_f32_16x16x32_bf16 v[92:95], a[152:155], a[8:11], v[92:95]
 v_mfma_f32_16x16x32_bf16 v[92:95], a[156:159], a[12:15], v[92:95]
 v_mfma_f32_16x16x32_bf16 v[96:99], a[152:155], a[16:19], v[96:99]
 v_mfma_f32_16x16x32_bf16 v[96:99], a[156:159], a[20:23], v[96:99]
 s_waitcnt lgkmcnt(4)
 v_mfma_f32_16x16x32_bf16 v[100:103], a[248:251], a[160:163], v[100:103]
 v_mfma_f32_16x16x32_bf16 v[100:103], a[252:255], a[164:167], v[100:103]
 s_waitcnt vmcnt(12) lgkmcnt(0)
 v_mfma_f32_16x16x32_bf16 v[104:107], a[248:251], a[168:171], v[104:107]
 s_barrier
 v_mfma_f32_16x16x32_bf16 v[104:107], a[252:255], a[172:175], v[104:107]
 ds_read_b64_tr_b16 a[152:153], v7 offset:0
 v_mfma_f32_16x16x32_bf16 v[108:111], a[248:251], a[176:179], v[108:111]
 ds_read_b64_tr_b16 a[154:155], v7 offset:5120
 v_mfma_f32_16x16x32_bf16 v[108:111], a[252:255], a[180:183], v[108:111]
 ds_read_b128 a[192:195], v3 offset:0
 v_mfma_f32_16x16x32_bf16 v[112:115], a[248:251], a[184:187], v[112:115]
 v_mfma_f32_16x16x32_bf16 v[112:115], a[252:255], a[188:191], v[112:115]
 ds_read_b64_tr_b16 a[156:157], v7 offset:10240
 v_mfma_f32_16x16x32_bf16 v[116:119], a[248:251], a[0:3], v[116:119]
 ds_read_b64_tr_b16 a[158:159], v7 offset:15360
 v_mfma_f32_16x16x32_bf16 v[116:119], a[252:255], a[4:7], v[116:119]
 ds_read_b128 a[196:199], v3 offset:14336
 v_mfma_f32_16x16x32_bf16 v[120:123], a[248:251], a[8:11], v[120:123]
 v_mfma_f32_16x16x32_bf16 v[120:123], a[252:255], a[12:15], v[120:123]
 ds_read_b128 a[200:203], v3 offset:1024
 v_mfma_f32_16x16x32_bf16 v[124:127], a[248:251], a[16:19], v[124:127]
 ds_read_b128 a[204:207], v3 offset:15360
 v_mfma_f32_16x16x32_bf16 v[124:127], a[252:255], a[20:23], v[124:127]
 ds_read_b128 a[208:211], v3 offset:2048
 v_mfma_f32_16x16x32_bf16 v[128:131], a[144:147], a[160:163], v[128:131]
 v_mfma_f32_16x16x32_bf16 v[128:131], a[148:151], a[164:167], v[128:131]
 ds_read_b128 a[212:215], v3 offset:16384
 v_mfma_f32_16x16x32_bf16 v[132:135], a[144:147], a[168:171], v[132:135]
 ds_read_b128 a[216:219], v3 offset:3072
 v_mfma_f32_16x16x32_bf16 v[132:135], a[148:151], a[172:175], v[132:135]
 ds_read_b128 a[220:223], v3 offset:17408
 v_mfma_f32_16x16x32_bf16 v[136:139], a[144:147], a[176:179], v[136:139]
 v_mfma_f32_16x16x32_bf16 v[136:139], a[148:151], a[180:183], v[136:139]
 ds_read_b128 a[224:227], v3 offset:4096
 v_mfma_f32_16x16x32_bf16 v[140:143], a[144:147], a[184:187], v[140:143]
 ds_read_b128 a[228:231], v3 offset:18432
 v_mfma_f32_16x16x32_bf16 v[140:143], a[148:151], a[188:191], v[140:143]
 ds_read_b128 a[232:235], v3 offset:5120
 v_mfma_f32_16x16x32_bf16 v[144:147], a[144:147], a[0:3], v[144:147]
 v_mfma_f32_16x16x32_bf16 v[144:147], a[148:151], a[4:7], v[144:147]
 ds_read_b128 a[236:239], v3 offset:19456
 v_mfma_f32_16x16x32_bf16 v[148:151], a[144:147], a[8:11], v[148:151]
 ds_read_b128 a[240:243], v3 offset:6144
 v_mfma_f32_16x16x32_bf16 v[148:151], a[148:151], a[12:15], v[148:151]
 ds_read_b128 a[244:247], v3 offset:20480
 v_mfma_f32_16x16x32_bf16 v[152:155], a[144:147], a[16:19], v[152:155]
 v_mfma_f32_16x16x32_bf16 v[152:155], a[148:151], a[20:23], v[152:155]
 s_waitcnt lgkmcnt(8)
 v_mfma_f32_16x16x32_bf16 v[16:19], a[152:155], a[192:195], v[16:19]
 ds_read_b64_tr_b16 a[248:249], v8 offset:32
 v_mfma_f32_16x16x32_bf16 v[16:19], a[156:159], a[196:199], v[16:19]
 ds_read_b64_tr_b16 a[250:251], v8 offset:5152
 v_mfma_f32_16x16x32_bf16 v[20:23], a[152:155], a[200:203], v[20:23]
 v_mfma_f32_16x16x32_bf16 v[20:23], a[156:159], a[204:207], v[20:23]
 ds_read_b64_tr_b16 a[252:253], v8 offset:10272
 v_mfma_f32_16x16x32_bf16 v[24:27], a[152:155], a[208:211], v[24:27]
 ds_read_b64_tr_b16 a[254:255], v8 offset:15392
 v_mfma_f32_16x16x32_bf16 v[24:27], a[156:159], a[212:215], v[24:27]
 s_waitcnt lgkmcnt(4)
 v_mfma_f32_16x16x32_bf16 v[28:31], a[152:155], a[216:219], v[28:31]
 ds_read_b64_tr_b16 a[144:145], v7 offset:64
 v_mfma_f32_16x16x32_bf16 v[28:31], a[156:159], a[220:223], v[28:31]
 ds_read_b64_tr_b16 a[146:147], v7 offset:5184
 v_mfma_f32_16x16x32_bf16 v[32:35], a[152:155], a[224:227], v[32:35]
 v_mfma_f32_16x16x32_bf16 v[32:35], a[156:159], a[228:231], v[32:35]
 ds_read_b64_tr_b16 a[148:149], v7 offset:10304
 v_mfma_f32_16x16x32_bf16 v[36:39], a[152:155], a[232:235], v[36:39]
 ds_read_b64_tr_b16 a[150:151], v7 offset:15424
 v_mfma_f32_16x16x32_bf16 v[36:39], a[156:159], a[236:239], v[36:39]
 v_mfma_f32_16x16x32_bf16 v[40:43], a[152:155], a[240:243], v[40:43]
 v_mfma_f32_16x16x32_bf16 v[40:43], a[156:159], a[244:247], v[40:43]
 s_waitcnt lgkmcnt(4)
 v_mfma_f32_16x16x32_bf16 v[44:47], a[248:251], a[192:195], v[44:47]
 v_mfma_f32_16x16x32_bf16 v[44:47], a[252:255], a[196:199], v[44:47]
 ds_read_b64_tr_b16 a[152:153], v8 offset:96
 v_mfma_f32_16x16x32_bf16 v[48:51], a[248:251], a[200:203], v[48:51]
 ds_read_b64_tr_b16 a[154:155], v8 offset:5216
 v_mfma_f32_16x16x32_bf16 v[48:51], a[252:255], a[204:207], v[48:51]
 v_mfma_f32_16x16x32_bf16 v[52:55], a[248:251], a[208:211], v[52:55]
 ds_read_b64_tr_b16 a[156:157], v8 offset:10336
 v_mfma_f32_16x16x32_bf16 v[52:55], a[252:255], a[212:215], v[52:55]
 ds_read_b64_tr_b16 a[158:159], v8 offset:15456
 v_mfma_f32_16x16x32_bf16 v[56:59], a[248:251], a[216:219], v[56:59]
 v_mfma_f32_16x16x32_bf16 v[56:59], a[252:255], a[220:223], v[56:59]
 v_mfma_f32_16x16x32_bf16 v[60:63], a[248:251], a[224:227], v[60:63]
 v_mfma_f32_16x16x32_bf16 v[60:63], a[252:255], a[228:231], v[60:63]
 v_mfma_f32_16x16x32_bf16 v[64:67], a[248:251], a[232:235], v[64:67]
 v_mfma_f32_16x16x32_bf16 v[64:67], a[252:255], a[236:239], v[64:67]
 v_mfma_f32_16x16x32_bf16 v[68:71], a[248:251], a[240:243], v[68:71]
 v_mfma_f32_16x16x32_bf16 v[68:71], a[252:255], a[244:247], v[68:71]
 s_waitcnt lgkmcnt(4)
 v_mfma_f32_16x16x32_bf16 v[72:75], a[144:147], a[192:195], v[72:75]
 v_mfma_f32_16x16x32_bf16 v[72:75], a[148:151], a[196:199], v[72:75]
 ds_read_b64_tr_b16 a[248:249], v7 offset:128
 v_mfma_f32_16x16x32_bf16 v[76:79], a[144:147], a[200:203], v[76:79]
 ds_read_b64_tr_b16 a[250:251], v7 offset:5248
 v_mfma_f32_16x16x32_bf16 v[76:79], a[148:151], a[204:207], v[76:79]
 v_mfma_f32_16x16x32_bf16 v[80:83], a[144:147], a[208:211], v[80:83]
 ds_read_b64_tr_b16 a[252:253], v7 offset:10368
 v_mfma_f32_16x16x32_bf16 v[80:83], a[148:151], a[212:215], v[80:83]
 ds_read_b64_tr_b16 a[254:255], v7 offset:15488
 v_mfma_f32_16x16x32_bf16 v[84:87], a[144:147], a[216:219], v[84:87]
 v_mfma_f32_16x16x32_bf16 v[84:87], a[148:151], a[220:223], v[84:87]
 v_mfma_f32_16x16x32_bf16 v[88:91], a[144:147], a[224:227], v[88:91]
 v_mfma_f32_16x16x32_bf16 v[88:91], a[148:151], a[228:231], v[88:91]
 v_mfma_f32_16x16x32_bf16 v[92:95], a[144:147], a[232:235], v[92:95]
 v_mfma_f32_16x16x32_bf16 v[92:95], a[148:151], a[236:239], v[92:95]
 v_mfma_f32_16x16x32_bf16 v[96:99], a[144:147], a[240:243], v[96:99]
 v_mfma_f32_16x16x32_bf16 v[96:99], a[148:151], a[244:247], v[96:99]
 s_waitcnt lgkmcnt(4)
 v_mfma_f32_16x16x32_bf16 v[100:103], a[152:155], a[192:195], v[100:103]
 v_mfma_f32_16x16x32_bf16 v[100:103], a[156:159], a[196:199], v[100:103]
 s_waitcnt vmcnt(0) lgkmcnt(0)
 v_mfma_f32_16x16x32_bf16 v[104:107], a[152:155], a[200:203], v[104:107]
 s_barrier
 v_mfma_f32_16x16x32_bf16 v[104:107], a[156:159], a[204:207], v[104:107]
 ds_read_b64_tr_b16 a[144:145], v9 offset:0
 v_mfma_f32_16x16x32_bf16 v[108:111], a[152:155], a[208:211], v[108:111]
 ds_read_b64_tr_b16 a[146:147], v9 offset:5120
 v_mfma_f32_16x16x32_bf16 v[108:111], a[156:159], a[212:215], v[108:111]
 ds_read_b128 a[160:163], v4 offset:0
 v_mfma_f32_16x16x32_bf16 v[112:115], a[152:155], a[216:219], v[112:115]
 v_mfma_f32_16x16x32_bf16 v[112:115], a[156:159], a[220:223], v[112:115]
 ds_read_b64_tr_b16 a[148:149], v9 offset:10240
 v_mfma_f32_16x16x32_bf16 v[116:119], a[152:155], a[224:227], v[116:119]
 ds_read_b64_tr_b16 a[150:151], v9 offset:15360
 v_mfma_f32_16x16x32_bf16 v[116:119], a[156:159], a[228:231], v[116:119]
 ds_read_b128 a[164:167], v4 offset:14336
 v_mfma_f32_16x16x32_bf16 v[120:123], a[152:155], a[232:235], v[120:123]
 v_mfma_f32_16x16x32_bf16 v[120:123], a[156:159], a[236:239], v[120:123]
 ds_read_b128 a[168:171], v4 offset:1024
 v_mfma_f32_16x16x32_bf16 v[124:127], a[152:155], a[240:243], v[124:127]
 ds_read_b128 a[172:175], v4 offset:15360
 v_mfma_f32_16x16x32_bf16 v[124:127], a[156:159], a[244:247], v[124:127]
 ds_read_b128 a[176:179], v4 offset:2048
 v_mfma_f32_16x16x32_bf16 v[128:131], a[248:251], a[192:195], v[128:131]
 v_mfma_f32_16x16x32_bf16 v[128:131], a[252:255], a[196:199], v[128:131]
 ds_read_b128 a[180:183], v4 offset:16384
 v_mfma_f32_16x16x32_bf16 v[132:135], a[248:251], a[200:203], v[132:135]
 ds_read_b128 a[184:187], v4 offset:3072
 v_mfma_f32_16x16x32_bf16 v[132:135], a[252:255], a[204:207], v[132:135]
 ds_read_b128 a[188:191], v4 offset:17408
 v_mfma_f32_16x16x32_bf16 v[136:139], a[248:251], a[208:211], v[136:139]
 v_mfma_f32_16x16x32_bf16 v[136:139], a[252:255], a[212:215], v[136:139]
 ds_read_b128 a[0:3], v4 offset:4096
 v_mfma_f32_16x16x32_bf16 v[140:143], a[248:251], a[216:219], v[140:143]
 ds_read_b128 a[4:7], v4 offset:18432
 v_mfma_f32_16x16x32_bf16 v[140:143], a[252:255], a[220:223], v[140:143]
 ds_read_b128 a[8:11], v4 offset:5120
 v_mfma_f32_16x16x32_bf16 v[144:147], a[248:251], a[224:227], v[144:147]
 v_mfma_f32_16x16x32_bf16 v[144:147], a[252:255], a[228:231], v[144:147]
 ds_read_b128 a[12:15], v4 offset:19456
 v_mfma_f32_16x16x32_bf16 v[148:151], a[248:251], a[232:235], v[148:151]
 ds_read_b128 a[16:19], v4 offset:6144
 v_mfma_f32_16x16x32_bf16 v[148:151], a[252:255], a[236:239], v[148:151]
 ds_read_b128 a[20:23], v4 offset:20480
 v_mfma_f32_16x16x32_bf16 v[152:155], a[248:251], a[240:243], v[152:155]
 v_mfma_f32_16x16x32_bf16 v[152:155], a[252:255], a[244:247], v[152:155]
 s_waitcnt lgkmcnt(8)
 v_mfma_f32_16x16x32_bf16 v[16:19], a[144:147], a[160:163], v[16:19]
 ds_read_b64_tr_b16 a[152:153], v10 offset:32
 v_mfma_f32_16x16x32_bf16 v[16:19], a[148:151], a[164:167], v[16:19]
 ds_read_b64_tr_b16 a[154:155], v10 offset:5152
 v_mfma_f32_16x16x32_bf16 v[20:23], a[144:147], a[168:171], v[20:23]
 v_mfma_f32_16x16x32_bf16 v[20:23], a[148:151], a[172:175], v[20:23]
 ds_read_b64_tr_b16 a[156:157], v10 offset:10272
 v_mfma_f32_16x16x32_bf16 v[24:27], a[144:147], a[176:179], v[24:27]
 ds_read_b64_tr_b16 a[158:159], v10 offset:15392
 v_mfma_f32_16x16x32_bf16 v[24:27], a[148:151], a[180:183], v[24:27]
 s_waitcnt lgkmcnt(4)
 v_mfma_f32_16x16x32_bf16 v[28:31], a[144:147], a[184:187], v[28:31]
 ds_read_b64_tr_b16 a[248:249], v9 offset:64
 v_mfma_f32_16x16x32_bf16 v[28:31], a[148:151], a[188:191], v[28:31]
 ds_read_b64_tr_b16 a[250:251], v9 offset:5184
 v_cvt_pk_bf16_f32 v168, v16, v17
 v_mfma_f32_16x16x32_bf16 v[32:35], a[144:147], a[0:3], v[32:35]
 v_cvt_pk_bf16_f32 v169, v18, v19
 v_cvt_pk_bf16_f32 v170, v20, v21
 v_mfma_f32_16x16x32_bf16 v[32:35], a[148:151], a[4:7], v[32:35]
 ds_read_b64_tr_b16 a[252:253], v9 offset:10304
 v_cvt_pk_bf16_f32 v171, v22, v23
 v_mfma_f32_16x16x32_bf16 v[36:39], a[144:147], a[8:11], v[36:39]
 ds_read_b64_tr_b16 a[254:255], v9 offset:15424
 v_mfma_f32_16x16x32_bf16 v[36:39], a[148:151], a[12:15], v[36:39]
 buffer_store_dwordx4 v[168:171], v246, s[16:19], s52 offen sc1
 v_mfma_f32_16x16x32_bf16 v[40:43], a[144:147], a[16:19], v[40:43]
 v_cvt_pk_bf16_f32 v172, v24, v25
 v_cvt_pk_bf16_f32 v173, v26, v27
 v_mfma_f32_16x16x32_bf16 v[40:43], a[148:151], a[20:23], v[40:43]
 v_cvt_pk_bf16_f32 v174, v28, v29
 s_waitcnt lgkmcnt(4)
 v_mfma_f32_16x16x32_bf16 v[44:47], a[152:155], a[160:163], v[44:47]
 v_cvt_pk_bf16_f32 v175, v30, v31
 v_mfma_f32_16x16x32_bf16 v[44:47], a[156:159], a[164:167], v[44:47]
 ds_read_b64_tr_b16 a[144:145], v10 offset:96
 v_cvt_pk_bf16_f32 v176, v32, v33
 v_mfma_f32_16x16x32_bf16 v[48:51], a[152:155], a[168:171], v[48:51]
 ds_read_b64_tr_b16 a[146:147], v10 offset:5216
 v_cvt_pk_bf16_f32 v177, v34, v35
 v_mfma_f32_16x16x32_bf16 v[48:51], a[156:159], a[172:175], v[48:51]
 buffer_store_dwordx4 v[172:175], v246, s[16:19], s53 offen sc1
 v_mfma_f32_16x16x32_bf16 v[52:55], a[152:155], a[176:179], v[52:55]
 ds_read_b64_tr_b16 a[148:149], v10 offset:10336
 v_cvt_pk_bf16_f32 v178, v36, v37
 v_mfma_f32_16x16x32_bf16 v[52:55], a[156:159], a[180:183], v[52:55]
 ds_read_b64_tr_b16 a[150:151], v10 offset:15456
 v_cvt_pk_bf16_f32 v179, v38, v39
 v_mfma_f32_16x16x32_bf16 v[56:59], a[152:155], a[184:187], v[56:59]
 buffer_store_dwordx4 v[176:179], v246, s[16:19], s54 offen sc1
 v_mfma_f32_16x16x32_bf16 v[56:59], a[156:159], a[188:191], v[56:59]
 v_cvt_pk_bf16_f32 v180, v40, v41
 v_cvt_pk_bf16_f32 v181, v42, v43
 v_mfma_f32_16x16x32_bf16 v[60:63], a[152:155], a[0:3], v[60:63]
 buffer_store_dwordx2 v[180:181], v246, s[16:19], s55 offen sc1
 v_mfma_f32_16x16x32_bf16 v[60:63], a[156:159], a[4:7], v[60:63]
 v_cvt_pk_bf16_f32 v184, v44, v45
 v_cvt_pk_bf16_f32 v185, v46, v47
 v_mfma_f32_16x16x32_bf16 v[64:67], a[152:155], a[8:11], v[64:67]
 v_cvt_pk_bf16_f32 v186, v48, v49
 v_cvt_pk_bf16_f32 v187, v50, v51
 v_mfma_f32_16x16x32_bf16 v[64:67], a[156:159], a[12:15], v[64:67]
 buffer_store_dwordx4 v[184:187], v246, s[16:19], s52 offen offset:1024 sc1
 v_mfma_f32_16x16x32_bf16 v[68:71], a[152:155], a[16:19], v[68:71]
 v_cvt_pk_bf16_f32 v188, v52, v53
 v_cvt_pk_bf16_f32 v189, v54, v55
 v_mfma_f32_16x16x32_bf16 v[68:71], a[156:159], a[20:23], v[68:71]
 v_cvt_pk_bf16_f32 v190, v56, v57
 s_waitcnt lgkmcnt(4)
 v_mfma_f32_16x16x32_bf16 v[72:75], a[248:251], a[160:163], v[72:75]
 v_cvt_pk_bf16_f32 v191, v58, v59
 v_mfma_f32_16x16x32_bf16 v[72:75], a[252:255], a[164:167], v[72:75]
 ds_read_b64_tr_b16 a[152:153], v9 offset:128
 v_cvt_pk_bf16_f32 v168, v60, v61
 v_mfma_f32_16x16x32_bf16 v[76:79], a[248:251], a[168:171], v[76:79]
 ds_read_b64_tr_b16 a[154:155], v9 offset:5248
 v_cvt_pk_bf16_f32 v169, v62, v63
 v_mfma_f32_16x16x32_bf16 v[76:79], a[252:255], a[172:175], v[76:79]
 buffer_store_dwordx4 v[188:191], v246, s[16:19], s53 offen offset:1024 sc1
 v_mfma_f32_16x16x32_bf16 v[80:83], a[248:251], a[176:179], v[80:83]
 ds_read_b64_tr_b16 a[156:157], v9 offset:10368
 v_cvt_pk_bf16_f32 v170, v64, v65
 v_mfma_f32_16x16x32_bf16 v[80:83], a[252:255], a[180:183], v[80:83]
 ds_read_b64_tr_b16 a[158:159], v9 offset:15488
 v_cvt_pk_bf16_f32 v171, v66, v67
 v_mfma_f32_16x16x32_bf16 v[84:87], a[248:251], a[184:187], v[84:87]
 buffer_store_dwordx4 v[168:171], v246, s[16:19], s54 offen offset:1024 sc1
 v_mfma_f32_16x16x32_bf16 v[84:87], a[252:255], a[188:191], v[84:87]
 v_cvt_pk_bf16_f32 v172, v68, v69
 v_cvt_pk_bf16_f32 v173, v70, v71
 v_mfma_f32_16x16x32_bf16 v[88:91], a[248:251], a[0:3], v[88:91]
 buffer_store_dwordx2 v[172:173], v246, s[16:19], s55 offen offset:1024 sc1
 v_mfma_f32_16x16x32_bf16 v[88:91], a[252:255], a[4:7], v[88:91]
 v_cvt_pk_bf16_f32 v176, v72, v73
 v_cvt_pk_bf16_f32 v177, v74, v75
 v_mfma_f32_16x16x32_bf16 v[92:95], a[248:251], a[8:11], v[92:95]
 v_cvt_pk_bf16_f32 v178, v76, v77
 v_cvt_pk_bf16_f32 v179, v78, v79
 v_mfma_f32_16x16x32_bf16 v[92:95], a[252:255], a[12:15], v[92:95]
 buffer_store_dwordx4 v[176:179], v246, s[16:19], s52 offen offset:2048 sc1
 v_mfma_f32_16x16x32_bf16 v[96:99], a[248:251], a[16:19], v[96:99]
 v_cvt_pk_bf16_f32 v180, v80, v81
 v_cvt_pk_bf16_f32 v181, v82, v83
 v_mfma_f32_16x16x32_bf16 v[96:99], a[252:255], a[20:23], v[96:99]
 v_cvt_pk_bf16_f32 v182, v84, v85
 s_waitcnt lgkmcnt(4)
 v_mfma_f32_16x16x32_bf16 v[100:103], a[144:147], a[160:163], v[100:103]
 v_cvt_pk_bf16_f32 v183, v86, v87
 v_mfma_f32_16x16x32_bf16 v[100:103], a[148:151], a[164:167], v[100:103]
 buffer_store_dwordx4 v[180:183], v246, s[16:19], s53 offen offset:2048 sc1
 v_mfma_f32_16x16x32_bf16 v[104:107], a[144:147], a[168:171], v[104:107]
 v_cvt_pk_bf16_f32 v184, v88, v89
 v_cvt_pk_bf16_f32 v185, v90, v91
 v_mfma_f32_16x16x32_bf16 v[104:107], a[148:151], a[172:175], v[104:107]
 v_cvt_pk_bf16_f32 v186, v92, v93
 v_cvt_pk_bf16_f32 v187, v94, v95
 v_mfma_f32_16x16x32_bf16 v[108:111], a[144:147], a[176:179], v[108:111]
 buffer_store_dwordx4 v[184:187], v246, s[16:19], s54 offen offset:2048 sc1
 v_mfma_f32_16x16x32_bf16 v[108:111], a[148:151], a[180:183], v[108:111]
 v_cvt_pk_bf16_f32 v188, v96, v97
 v_cvt_pk_bf16_f32 v189, v98, v99
 v_mfma_f32_16x16x32_bf16 v[112:115], a[144:147], a[184:187], v[112:115]
 buffer_store_dwordx2 v[188:189], v246, s[16:19], s55 offen offset:2048 sc1
 v_mfma_f32_16x16x32_bf16 v[112:115], a[148:151], a[188:191], v[112:115]
 v_cvt_pk_bf16_f32 v168, v100, v101
 v_cvt_pk_bf16_f32 v169, v102, v103
 v_mfma_f32_16x16x32_bf16 v[116:119], a[144:147], a[0:3], v[116:119]
 v_cvt_pk_bf16_f32 v170, v104, v105
 v_cvt_pk_bf16_f32 v171, v106, v107
 v_mfma_f32_16x16x32_bf16 v[116:119], a[148:151], a[4:7], v[116:119]
 buffer_store_dwordx4 v[168:171], v246, s[16:19], s52 offen offset:3072 sc1
 v_mfma_f32_16x16x32_bf16 v[120:123], a[144:147], a[8:11], v[120:123]
 v_mfma_f32_16x16x32_bf16 v[120:123], a[148:151], a[12:15], v[120:123]
 v_cvt_pk_bf16_f32 v172, v108, v109
 v_cvt_pk_bf16_f32 v173, v110, v111
 v_mfma_f32_16x16x32_bf16 v[124:127], a[144:147], a[16:19], v[124:127]
 v_cvt_pk_bf16_f32 v174, v112, v113
 v_cvt_pk_bf16_f32 v175, v114, v115
 v_mfma_f32_16x16x32_bf16 v[124:127], a[148:151], a[20:23], v[124:127]
 s_waitcnt lgkmcnt(0)
 v_mfma_f32_16x16x32_bf16 v[128:131], a[152:155], a[160:163], v[128:131]
 buffer_store_dwordx4 v[172:175], v246, s[16:19], s53 offen offset:3072 sc1
 v_mfma_f32_16x16x32_bf16 v[128:131], a[156:159], a[164:167], v[128:131]
 v_cvt_pk_bf16_f32 v176, v116, v117
 v_cvt_pk_bf16_f32 v177, v118, v119
 v_mfma_f32_16x16x32_bf16 v[132:135], a[152:155], a[168:171], v[132:135]
 v_cvt_pk_bf16_f32 v178, v120, v121
 v_cvt_pk_bf16_f32 v179, v122, v123
 v_mfma_f32_16x16x32_bf16 v[132:135], a[156:159], a[172:175], v[132:135]
 buffer_store_dwordx4 v[176:179], v246, s[16:19], s54 offen offset:3072 sc1
 v_mfma_f32_16x16x32_bf16 v[136:139], a[152:155], a[176:179], v[136:139]
 v_cvt_pk_bf16_f32 v180, v124, v125
 v_cvt_pk_bf16_f32 v181, v126, v127
 v_mfma_f32_16x16x32_bf16 v[136:139], a[156:159], a[180:183], v[136:139]
 buffer_store_dwordx2 v[180:181], v246, s[16:19], s55 offen offset:3072 sc1
 v_mfma_f32_16x16x32_bf16 v[140:143], a[152:155], a[184:187], v[140:143]
 v_mfma_f32_16x16x32_bf16 v[140:143], a[156:159], a[188:191], v[140:143]
 v_cvt_pk_bf16_f32 v184, v128, v129
 v_cvt_pk_bf16_f32 v185, v130, v131
 v_mfma_f32_16x16x32_bf16 v[144:147], a[152:155], a[0:3], v[144:147]
 v_cvt_pk_bf16_f32 v186, v132, v133
 v_cvt_pk_bf16_f32 v187, v134, v135
 v_mfma_f32_16x16x32_bf16 v[144:147], a[156:159], a[4:7], v[144:147]
 buffer_store_dwordx4 v[184:187], v162, s[16:19], s52 offen sc1
 v_mfma_f32_16x16x32_bf16 v[148:151], a[152:155], a[8:11], v[148:151]
 v_mfma_f32_16x16x32_bf16 v[148:151], a[156:159], a[12:15], v[148:151]
 v_cvt_pk_bf16_f32 v188, v136, v137
 v_cvt_pk_bf16_f32 v189, v138, v139
 v_mfma_f32_16x16x32_bf16 v[152:155], a[152:155], a[16:19], v[152:155]
 v_cvt_pk_bf16_f32 v190, v140, v141
 v_cvt_pk_bf16_f32 v191, v142, v143
 v_mfma_f32_16x16x32_bf16 v[152:155], a[156:159], a[20:23], v[152:155]
 buffer_store_dwordx4 v[188:191], v162, s[16:19], s53 offen sc1
 v_cvt_pk_bf16_f32 v168, v144, v145
 v_cvt_pk_bf16_f32 v169, v146, v147
 v_cvt_pk_bf16_f32 v170, v148, v149
 v_cvt_pk_bf16_f32 v171, v150, v151
 buffer_store_dwordx4 v[168:171], v162, s[16:19], s54 offen sc1
 s_nop 1
 v_cvt_pk_bf16_f32 v172, v152, v153
 v_cvt_pk_bf16_f32 v173, v154, v155
 buffer_store_dwordx2 v[172:173], v162, s[16:19], s55 offen sc1
 s_lshl_b32 s76, s61, 2
 s_add_u32 s76, s76, s28
 s_lshl_b32 s76, 1, s76
 v_mov_b32 v160, s76
 s_lshl_b32 s76, s70, 8
 v_lshl_add_u32 v161, v246, 10, s76
 s_add_u32 s76, s61, 1
 s_and_b32 s76, s76, 3
 s_lshl_b32 s77, s76, 2
 s_add_u32 s41, s77, s28
 s_mul_i32 s76, s76, 5120
 s_mul_i32 s77, s65, 20480
 s_add_u32 s37, s76, s77
 s_add_u32 s76, s61, 2
 s_and_b32 s76, s76, 3
 s_lshl_b32 s77, s76, 2
 s_add_u32 s42, s77, s28
 s_mul_i32 s76, s76, 5120
 s_mul_i32 s77, s65, 20480
 s_add_u32 s38, s76, s77
 s_add_u32 s76, s61, 3
 s_and_b32 s76, s76, 3
 s_lshl_b32 s77, s76, 2
 s_add_u32 s43, s77, s28
 s_mul_i32 s76, s76, 5120
 s_mul_i32 s77, s65, 20480
 s_add_u32 s39, s76, s77
 s_mov_b32 s34, 0xffff0000
 s_mov_b32 s33, 7
 s_mov_b32 s35, 0x8000
 s_waitcnt vmcnt(0)
 buffer_atomic_add v160, v161, s[96:99], 0 offen
 s_cmp_eq_u32 s65, 1
 s_cbranch_scc1 P_e1
 s_cmp_eq_u32 s65, 2
 s_cbranch_scc1 P_e2
 s_cmp_eq_u32 s65, 3
 s_cbranch_scc1 P_e3
P_e0:
 buffer_load_dword v159, v161, s[96:99], 0 offen sc1
 s_waitcnt vmcnt(0)
 v_readfirstlane_b32 s76, v159
 s_mov_b32 s32, 0
 s_bitcmp1_b32 s76, s41
 s_cselect_b32 s77, 1, 0
 s_or_b32 s32, s32, s77
 s_bitcmp1_b32 s76, s42
 s_cselect_b32 s77, 2, 0
 s_or_b32 s32, s32, s77
 s_bitcmp1_b32 s76, s43
 s_cselect_b32 s77, 4, 0
 s_or_b32 s32, s32, s77
 s_and_b32 s32, s32, s33
 s_cbranch_scc1 P_g0
 s_sleep 2
 s_sub_u32 s35, s35, 1
 s_cbranch_scc0 P_e0
 s_mov_b32 s32, s33
P_g0:
 s_bitcmp0_b32 s32, 0
 s_cbranch_scc1 P_a01
 buffer_load_dwordx4 v[180:183], v246, s[16:19], s37 offen offset:0 sc1
 buffer_load_dwordx4 v[184:187], v246, s[16:19], s37 offen offset:1024 sc1
 buffer_load_dwordx4 v[188:191], v246, s[16:19], s37 offen offset:2048 sc1
 buffer_load_dwordx4 v[192:195], v246, s[16:19], s37 offen offset:3072 sc1
 buffer_load_dwordx4 v[196:199], v162, s[16:19], s37 offen offset:0 sc1
P_a01:
 s_bitcmp0_b32 s32, 1
 s_cbranch_scc1 P_a02
 buffer_load_dwordx4 v[200:203], v246, s[16:19], s38 offen offset:0 sc1
 buffer_load_dwordx4 v[204:207], v246, s[16:19], s38 offen offset:1024 sc1
 buffer_load_dwordx4 v[208:211], v246, s[16:19], s38 offen offset:2048 sc1
 buffer_load_dwordx4 v[212:215], v246, s[16:19], s38 offen offset:3072 sc1
 buffer_load_dwordx4 v[216:219], v162, s[16:19], s38 offen offset:0 sc1
P_a02:
 s_bitcmp0_b32 s32, 2
 s_cbranch_scc1 P_a03
 buffer_load_dwordx4 v[220:223], v246, s[16:19], s39 offen offset:0 sc1
 buffer_load_dwordx4 v[224:227], v246, s[16:19], s39 offen offset:1024 sc1
 buffer_load_dwordx4 v[228:231], v246, s[16:19], s39 offen offset:2048 sc1
 buffer_load_dwordx4 v[232:235], v246, s[16:19], s39 offen offset:3072 sc1
 buffer_load_dwordx4 v[236:239], v162, s[16:19], s39 offen offset:0 sc1
P_a03:
 s_andn2_b32 s33, s33, s32
 s_cbranch_scc1 P_e0
 s_waitcnt vmcnt(0)
 v_lshlrev_b32 v168, 16, v180
 v_and_b32 v169, s34, v180
 v_pk_add_f32 v[16:17], v[16:17], v[168:169]
 v_lshlrev_b32 v170, 16, v181
 v_and_b32 v171, s34, v181
 v_pk_add_f32 v[18:19], v[18:19], v[170:171]
 v_lshlrev_b32 v172, 16, v182
 v_and_b32 v173, s34, v182
 v_pk_add_f32 v[20:21], v[20:21], v[172:173]
 v_lshlrev_b32 v174, 16, v183
 v_and_b32 v175, s34, v183
 v_pk_add_f32 v[22:23], v[22:23], v[174:175]
 v_lshlrev_b32 v168, 16, v184
 v_and_b32 v169, s34, v184
 v_pk_add_f32 v[44:45], v[44:45], v[168:169]
 v_lshlrev_b32 v170, 16, v185
 v_and_b32 v171, s34, v185
 v_pk_add_f32 v[46:47], v[46:47], v[170:171]
 v_lshlrev_b32 v172, 16, v186
 v_and_b32 v173, s34, v186
 v_pk_add_f32 v[48:49], v[48:49], v[172:173]
 v_lshlrev_b32 v174, 16, v187
 v_and_b32 v175, s34, v187
 v_pk_add_f32 v[50:51], v[50:51], v[174:175]
 v_lshlrev_b32 v168, 16, v188
 v_and_b32 v169, s34, v188
 v_pk_add_f32 v[72:73], v[72:73], v[168:169]
 v_lshlrev_b32 v170, 16, v189
 v_and_b32 v171, s34, v189
 v_pk_add_f32 v[74:75], v[74:75], v[170:171]
 v_lshlrev_b32 v172, 16, v190
 v_and_b32 v173, s34, v190
 v_pk_add_f32 v[76:77], v[76:77], v[172:173]
 v_lshlrev_b32 v174, 16, v191
 v_and_b32 v175, s34, v191
 v_pk_add_f32 v[78:79], v[78:79], v[174:175]
 v_lshlrev_b32 v168, 16, v192
 v_and_b32 v169, s34, v192
 v_pk_add_f32 v[100:101], v[100:101], v[168:169]
 v_lshlrev_b32 v170, 16, v193
 v_and_b32 v171, s34, v193
 v_pk_add_f32 v[102:103], v[102:103], v[170:171]
 v_lshlrev_b32 v172, 16, v194
 v_and_b32 v173, s34, v194
 v_pk_add_f32 v[104:105], v[104:105], v[172:173]
 v_lshlrev_b32 v174, 16, v195
 v_and_b32 v175, s34, v195
 v_pk_add_f32 v[106:107], v[106:107], v[174:175]
 v_lshlrev_b32 v168, 16, v196
 v_and_b32 v169, s34, v196
 v_pk_add_f32 v[128:129], v[128:129], v[168:169]
 v_lshlrev_b32 v170, 16, v197
 v_and_b32 v171, s34, v197
 v_pk_add_f32 v[130:131], v[130:131], v[170:171]
 v_lshlrev_b32 v172, 16, v198
 v_and_b32 v173, s34, v198
 v_pk_add_f32 v[132:133], v[132:133], v[172:173]
 v_lshlrev_b32 v174, 16, v199
 v_and_b32 v175, s34, v199
 v_pk_add_f32 v[134:135], v[134:135], v[174:175]
 v_lshlrev_b32 v168, 16, v200
 v_and_b32 v169, s34, v200
 v_pk_add_f32 v[16:17], v[16:17], v[168:169]
 v_lshlrev_b32 v170, 16, v201
 v_and_b32 v171, s34, v201
 v_pk_add_f32 v[18:19], v[18:19], v[170:171]
 v_lshlrev_b32 v172, 16, v202
 v_and_b32 v173, s34, v202
 v_pk_add_f32 v[20:21], v[20:21], v[172:173]
 v_lshlrev_b32 v174, 16, v203
 v_and_b32 v175, s34, v203
 v_pk_add_f32 v[22:23], v[22:23], v[174:175]
 v_lshlrev_b32 v168, 16, v204
 v_and_b32 v169, s34, v204
 v_pk_add_f32 v[44:45], v[44:45], v[168:169]
 v_lshlrev_b32 v170, 16, v205
 v_and_b32 v171, s34, v205
 v_pk_add_f32 v[46:47], v[46:47], v[170:171]
 v_lshlrev_b32 v172, 16, v206
 v_and_b32 v173, s34, v206
 v_pk_add_f32 v[48:49], v[48:49], v[172:173]
 v_lshlrev_b32 v174, 16, v207
 v_and_b32 v175, s34, v207
 v_pk_add_f32 v[50:51], v[50:51], v[174:175]
 v_lshlrev_b32 v168, 16, v208
 v_and_b32 v169, s34, v208
 v_pk_add_f32 v[72:73], v[72:73], v[168:169]
 v_lshlrev_b32 v170, 16, v209
 v_and_b32 v171, s34, v209
 v_pk_add_f32 v[74:75], v[74:75], v[170:171]
 v_lshlrev_b32 v172, 16, v210
 v_and_b32 v173, s34, v210
 v_pk_add_f32 v[76:77], v[76:77], v[172:173]
 v_lshlrev_b32 v174, 16, v211
 v_and_b32 v175, s34, v211
 v_pk_add_f32 v[78:79], v[78:79], v[174:175]
 v_lshlrev_b32 v168, 16, v212
 v_and_b32 v169, s34, v212
 v_pk_add_f32 v[100:101], v[100:101], v[168:169]
 v_lshlrev_b32 v170, 16, v213
 v_and_b32 v171, s34, v213
 v_pk_add_f32 v[102:103], v[102:103], v[170:171]
 v_lshlrev_b32 v172, 16, v214
 v_and_b32 v173, s34, v214
 v_pk_add_f32 v[104:105], v[104:105], v[172:173]
 v_lshlrev_b32 v174, 16, v215
 v_and_b32 v175, s34, v215
 v_pk_add_f32 v[106:107], v[106:107], v[174:175]
 v_lshlrev_b32 v168, 16, v216
 v_and_b32 v169, s34, v216
 v_pk_add_f32 v[128:129], v[128:129], v[168:169]
 v_lshlrev_b32 v170, 16, v217
 v_and_b32 v171, s34, v217
 v_pk_add_f32 v[130:131], v[130:131], v[170:171]
 v_lshlrev_b32 v172, 16, v218
 v_and_b32 v173, s34, v218
 v_pk_add_f32 v[132:133], v[132:133], v[172:173]
 v_lshlrev_b32 v174, 16, v219
 v_and_b32 v175, s34, v219
 v_pk_add_f32 v[134:135], v[134:135], v[174:175]
 v_lshlrev_b32 v168, 16, v220
 v_and_b32 v169, s34, v220
 v_pk_add_f32 v[16:17], v[16:17], v[168:169]
 v_lshlrev_b32 v170, 16, v221
 v_and_b32 v171, s34, v221
 v_pk_add_f32 v[18:19], v[18:19], v[170:171]
 v_lshlrev_b32 v172, 16, v222
 v_and_b32 v173, s34, v222
 v_pk_add_f32 v[20:21], v[20:21], v[172:173]
 v_lshlrev_b32 v174, 16, v223
 v_and_b32 v175, s34, v223
 v_pk_add_f32 v[22:23], v[22:23], v[174:175]
 v_lshlrev_b32 v168, 16, v224
 v_and_b32 v169, s34, v224
 v_pk_add_f32 v[44:45], v[44:45], v[168:169]
 v_lshlrev_b32 v170, 16, v225
 v_and_b32 v171, s34, v225
 v_pk_add_f32 v[46:47], v[46:47], v[170:171]
 v_lshlrev_b32 v172, 16, v226
 v_and_b32 v173, s34, v226
 v_pk_add_f32 v[48:49], v[48:49], v[172:173]
 v_lshlrev_b32 v174, 16, v227
 v_and_b32 v175, s34, v227
 v_pk_add_f32 v[50:51], v[50:51], v[174:175]
 v_lshlrev_b32 v168, 16, v228
 v_and_b32 v169, s34, v228
 v_pk_add_f32 v[72:73], v[72:73], v[168:169]
 v_lshlrev_b32 v170, 16, v229
 v_and_b32 v171, s34, v229
 v_pk_add_f32 v[74:75], v[74:75], v[170:171]
 v_lshlrev_b32 v172, 16, v230
 v_and_b32 v173, s34, v230
 v_pk_add_f32 v[76:77], v[76:77], v[172:173]
 v_lshlrev_b32 v174, 16, v231
 v_and_b32 v175, s34, v231
 v_pk_add_f32 v[78:79], v[78:79], v[174:175]
 v_lshlrev_b32 v168, 16, v232
 v_and_b32 v169, s34, v232
 v_pk_add_f32 v[100:101], v[100:101], v[168:169]
 v_lshlrev_b32 v170, 16, v233
 v_and_b32 v171, s34, v233
 v_pk_add_f32 v[102:103], v[102:103], v[170:171]
 v_lshlrev_b32 v172, 16, v234
 v_and_b32 v173, s34, v234
 v_pk_add_f32 v[104:105], v[104:105], v[172:173]
 v_lshlrev_b32 v174, 16, v235
 v_and_b32 v175, s34, v235
 v_pk_add_f32 v[106:107], v[106:107], v[174:175]
 v_lshlrev_b32 v168, 16, v236
 v_and_b32 v169, s34, v236
 v_pk_add_f32 v[128:129], v[128:129], v[168:169]
 v_lshlrev_b32 v170, 16, v237
 v_and_b32 v171, s34, v237
 v_pk_add_f32 v[130:131], v[130:131], v[170:171]
 v_lshlrev_b32 v172, 16, v238
 v_and_b32 v173, s34, v238
 v_pk_add_f32 v[132:133], v[132:133], v[172:173]
 v_lshlrev_b32 v174, 16, v239
 v_and_b32 v175, s34, v239
 v_pk_add_f32 v[134:135], v[134:135], v[174:175]
 v_cvt_pk_bf16_f32 v180, v16, v17
 v_cvt_pk_bf16_f32 v181, v18, v19
 v_cvt_pk_bf16_f32 v182, v44, v45
 v_cvt_pk_bf16_f32 v183, v46, v47
 v_cvt_pk_bf16_f32 v184, v72, v73
 v_cvt_pk_bf16_f32 v185, v74, v75
 v_cvt_pk_bf16_f32 v186, v100, v101
 v_cvt_pk_bf16_f32 v187, v102, v103
 v_cvt_pk_bf16_f32 v188, v128, v129
 v_cvt_pk_bf16_f32 v189, v130, v131
 s_mov_b32 s34, 0
 buffer_store_dwordx2 v[188:189], v156, s[20:23], s34 offen offset:128
 v_permlane16_swap_b32 v180, v182
 v_permlane16_swap_b32 v181, v183
 buffer_store_dwordx4 v[180:183], v157, s[20:23], s34 offen offset:0
 v_permlane16_swap_b32 v184, v186
 v_permlane16_swap_b32 v185, v187
 buffer_store_dwordx4 v[184:187], v157, s[20:23], s34 offen offset:64
 v_cvt_pk_bf16_f32 v192, v20, v21
 v_cvt_pk_bf16_f32 v193, v22, v23
 v_cvt_pk_bf16_f32 v194, v48, v49
 v_cvt_pk_bf16_f32 v195, v50, v51
 v_cvt_pk_bf16_f32 v196, v76, v77
 v_cvt_pk_bf16_f32 v197, v78, v79
 v_cvt_pk_bf16_f32 v198, v104, v105
 v_cvt_pk_bf16_f32 v199, v106, v107
 v_cvt_pk_bf16_f32 v200, v132, v133
 v_cvt_pk_bf16_f32 v201, v134, v135
 s_mov_b32 s34, 40960
 buffer_store_dwordx2 v[200:201], v156, s[20:23], s34 offen offset:128
 v_permlane16_swap_b32 v192, v194
 v_permlane16_swap_b32 v193, v195
 buffer_store_dwordx4 v[192:195], v157, s[20:23], s34 offen offset:0
 v_permlane16_swap_b32 v196, v198
 v_permlane16_swap_b32 v197, v199
 buffer_store_dwordx4 v[196:199], v157, s[20:23], s34 offen offset:64
 s_branch P_done
P_e1:
 buffer_load_dword v159, v161, s[96:99], 0 offen sc1
 s_waitcnt vmcnt(0)
 v_readfirstlane_b32 s76, v159
 s_mov_b32 s32, 0
 s_bitcmp1_b32 s76, s41
 s_cselect_b32 s77, 1, 0
 s_or_b32 s32, s32, s77
 s_bitcmp1_b32 s76, s42
 s_cselect_b32 s77, 2, 0
 s_or_b32 s32, s32, s77
 s_bitcmp1_b32 s76, s43
 s_cselect_b32 s77, 4, 0
 s_or_b32 s32, s32, s77
 s_and_b32 s32, s32, s33
 s_cbranch_scc1 P_g1
 s_sleep 2
 s_sub_u32 s35, s35, 1
 s_cbranch_scc0 P_e1
 s_mov_b32 s32, s33
P_g1:
 s_bitcmp0_b32 s32, 0
 s_cbranch_scc1 P_a11
 buffer_load_dwordx4 v[180:183], v246, s[16:19], s37 offen offset:0 sc1
 buffer_load_dwordx4 v[184:187], v246, s[16:19], s37 offen offset:1024 sc1
 buffer_load_dwordx4 v[188:191], v246, s[16:19], s37 offen offset:2048 sc1
 buffer_load_dwordx4 v[192:195], v246, s[16:19], s37 offen offset:3072 sc1
 buffer_load_dwordx4 v[196:199], v162, s[16:19], s37 offen offset:0 sc1
P_a11:
 s_bitcmp0_b32 s32, 1
 s_cbranch_scc1 P_a12
 buffer_load_dwordx4 v[200:203], v246, s[16:19], s38 offen offset:0 sc1
 buffer_load_dwordx4 v[204:207], v246, s[16:19], s38 offen offset:1024 sc1
 buffer_load_dwordx4 v[208:211], v246, s[16:19], s38 offen offset:2048 sc1
 buffer_load_dwordx4 v[212:215], v246, s[16:19], s38 offen offset:3072 sc1
 buffer_load_dwordx4 v[216:219], v162, s[16:19], s38 offen offset:0 sc1
P_a12:
 s_bitcmp0_b32 s32, 2
 s_cbranch_scc1 P_a13
 buffer_load_dwordx4 v[220:223], v246, s[16:19], s39 offen offset:0 sc1
 buffer_load_dwordx4 v[224:227], v246, s[16:19], s39 offen offset:1024 sc1
 buffer_load_dwordx4 v[228:231], v246, s[16:19], s39 offen offset:2048 sc1
 buffer_load_dwordx4 v[232:235], v246, s[16:19], s39 offen offset:3072 sc1
 buffer_load_dwordx4 v[236:239], v162, s[16:19], s39 offen offset:0 sc1
P_a13:
 s_andn2_b32 s33, s33, s32
 s_cbranch_scc1 P_e1
 s_waitcnt vmcnt(0)
 v_lshlrev_b32 v168, 16, v180
 v_and_b32 v169, s34, v180
 v_pk_add_f32 v[24:25], v[24:25], v[168:169]
 v_lshlrev_b32 v170, 16, v181
 v_and_b32 v171, s34, v181
 v_pk_add_f32 v[26:27], v[26:27], v[170:171]
 v_lshlrev_b32 v172, 16, v182
 v_and_b32 v173, s34, v182
 v_pk_add_f32 v[28:29], v[28:29], v[172:173]
 v_lshlrev_b32 v174, 16, v183
 v_and_b32 v175, s34, v183
 v_pk_add_f32 v[30:31], v[30:31], v[174:175]
 v_lshlrev_b32 v168, 16, v184
 v_and_b32 v169, s34, v184
 v_pk_add_f32 v[52:53], v[52:53], v[168:169]
 v_lshlrev_b32 v170, 16, v185
 v_and_b32 v171, s34, v185
 v_pk_add_f32 v[54:55], v[54:55], v[170:171]
 v_lshlrev_b32 v172, 16, v186
 v_and_b32 v173, s34, v186
 v_pk_add_f32 v[56:57], v[56:57], v[172:173]
 v_lshlrev_b32 v174, 16, v187
 v_and_b32 v175, s34, v187
 v_pk_add_f32 v[58:59], v[58:59], v[174:175]
 v_lshlrev_b32 v168, 16, v188
 v_and_b32 v169, s34, v188
 v_pk_add_f32 v[80:81], v[80:81], v[168:169]
 v_lshlrev_b32 v170, 16, v189
 v_and_b32 v171, s34, v189
 v_pk_add_f32 v[82:83], v[82:83], v[170:171]
 v_lshlrev_b32 v172, 16, v190
 v_and_b32 v173, s34, v190
 v_pk_add_f32 v[84:85], v[84:85], v[172:173]
 v_lshlrev_b32 v174, 16, v191
 v_and_b32 v175, s34, v191
 v_pk_add_f32 v[86:87], v[86:87], v[174:175]
 v_lshlrev_b32 v168, 16, v192
 v_and_b32 v169, s34, v192
 v_pk_add_f32 v[108:109], v[108:109], v[168:169]
 v_lshlrev_b32 v170, 16, v193
 v_and_b32 v171, s34, v193
 v_pk_add_f32 v[110:111], v[110:111], v[170:171]
 v_lshlrev_b32 v172, 16, v194
 v_and_b32 v173, s34, v194
 v_pk_add_f32 v[112:113], v[112:113], v[172:173]
 v_lshlrev_b32 v174, 16, v195
 v_and_b32 v175, s34, v195
 v_pk_add_f32 v[114:115], v[114:115], v[174:175]
 v_lshlrev_b32 v168, 16, v196
 v_and_b32 v169, s34, v196
 v_pk_add_f32 v[136:137], v[136:137], v[168:169]
 v_lshlrev_b32 v170, 16, v197
 v_and_b32 v171, s34, v197
 v_pk_add_f32 v[138:139], v[138:139], v[170:171]
 v_lshlrev_b32 v172, 16, v198
 v_and_b32 v173, s34, v198
 v_pk_add_f32 v[140:141], v[140:141], v[172:173]
 v_lshlrev_b32 v174, 16, v199
 v_and_b32 v175, s34, v199
 v_pk_add_f32 v[142:143], v[142:143], v[174:175]
 v_lshlrev_b32 v168, 16, v200
 v_and_b32 v169, s34, v200
 v_pk_add_f32 v[24:25], v[24:25], v[168:169]
 v_lshlrev_b32 v170, 16, v201
 v_and_b32 v171, s34, v201
 v_pk_add_f32 v[26:27], v[26:27], v[170:171]
 v_lshlrev_b32 v172, 16, v202
 v_and_b32 v173, s34, v202
 v_pk_add_f32 v[28:29], v[28:29], v[172:173]
 v_lshlrev_b32 v174, 16, v203
 v_and_b32 v175, s34, v203
 v_pk_add_f32 v[30:31], v[30:31], v[174:175]
 v_lshlrev_b32 v168, 16, v204
 v_and_b32 v169, s34, v204
 v_pk_add_f32 v[52:53], v[52:53], v[168:169]
 v_lshlrev_b32 v170, 16, v205
 v_and_b32 v171, s34, v205
 v_pk_add_f32 v[54:55], v[54:55], v[170:171]
 v_lshlrev_b32 v172, 16, v206
 v_and_b32 v173, s34, v206
 v_pk_add_f32 v[56:57], v[56:57], v[172:173]
 v_lshlrev_b32 v174, 16, v207
 v_and_b32 v175, s34, v207
 v_pk_add_f32 v[58:59], v[58:59], v[174:175]
 v_lshlrev_b32 v168, 16, v208
 v_and_b32 v169, s34, v208
 v_pk_add_f32 v[80:81], v[80:81], v[168:169]
 v_lshlrev_b32 v170, 16, v209
 v_and_b32 v171, s34, v209
 v_pk_add_f32 v[82:83], v[82:83], v[170:171]
 v_lshlrev_b32 v172, 16, v210
 v_and_b32 v173, s34, v210
 v_pk_add_f32 v[84:85], v[84:85], v[172:173]
 v_lshlrev_b32 v174, 16, v211
 v_and_b32 v175, s34, v211
 v_pk_add_f32 v[86:87], v[86:87], v[174:175]
 v_lshlrev_b32 v168, 16, v212
 v_and_b32 v169, s34, v212
 v_pk_add_f32 v[108:109], v[108:109], v[168:169]
 v_lshlrev_b32 v170, 16, v213
 v_and_b32 v171, s34, v213
 v_pk_add_f32 v[110:111], v[110:111], v[170:171]
 v_lshlrev_b32 v172, 16, v214
 v_and_b32 v173, s34, v214
 v_pk_add_f32 v[112:113], v[112:113], v[172:173]
 v_lshlrev_b32 v174, 16, v215
 v_and_b32 v175, s34, v215
 v_pk_add_f32 v[114:115], v[114:115], v[174:175]
 v_lshlrev_b32 v168, 16, v216
 v_and_b32 v169, s34, v216
 v_pk_add_f32 v[136:137], v[136:137], v[168:169]
 v_lshlrev_b32 v170, 16, v217
 v_and_b32 v171, s34, v217
 v_pk_add_f32 v[138:139], v[138:139], v[170:171]
 v_lshlrev_b32 v172, 16, v218
 v_and_b32 v173, s34, v218
 v_pk_add_f32 v[140:141], v[140:141], v[172:173]
 v_lshlrev_b32 v174, 16, v219
 v_and_b32 v175, s34, v219
 v_pk_add_f32 v[142:143], v[142:143], v[174:175]
 v_lshlrev_b32 v168, 16, v220
 v_and_b32 v169, s34, v220
 v_pk_add_f32 v[24:25], v[24:25], v[168:169]
 v_lshlrev_b32 v170, 16, v221
 v_and_b32 v171, s34, v221
 v_pk_add_f32 v[26:27], v[26:27], v[170:171]
 v_lshlrev_b32 v172, 16, v222
 v_and_b32 v173, s34, v222
 v_pk_add_f32 v[28:29], v[28:29], v[172:173]
 v_lshlrev_b32 v174, 16, v223
 v_and_b32 v175, s34, v223
 v_pk_add_f32 v[30:31], v[30:31], v[174:175]
 v_lshlrev_b32 v168, 16, v224
 v_and_b32 v169, s34, v224
 v_pk_add_f32 v[52:53], v[52:53], v[168:169]
 v_lshlrev_b32 v170, 16, v225
 v_and_b32 v171, s34, v225
 v_pk_add_f32 v[54:55], v[54:55], v[170:171]
 v_lshlrev_b32 v172, 16, v226
 v_and_b32 v173, s34, v226
 v_pk_add_f32 v[56:57], v[56:57], v[172:173]
 v_lshlrev_b32 v174, 16, v227
 v_and_b32 v175, s34, v227
 v_pk_add_f32 v[58:59], v[58:59], v[174:175]
 v_lshlrev_b32 v168, 16, v228
 v_and_b32 v169, s34, v228
 v_pk_add_f32 v[80:81], v[80:81], v[168:169]
 v_lshlrev_b32 v170, 16, v229
 v_and_b32 v171, s34, v229
 v_pk_add_f32 v[82:83], v[82:83], v[170:171]
 v_lshlrev_b32 v172, 16, v230
 v_and_b32 v173, s34, v230
 v_pk_add_f32 v[84:85], v[84:85], v[172:173]
 v_lshlrev_b32 v174, 16, v231
 v_and_b32 v175, s34, v231
 v_pk_add_f32 v[86:87], v[86:87], v[174:175]
 v_lshlrev_b32 v168, 16, v232
 v_and_b32 v169, s34, v232
 v_pk_add_f32 v[108:109], v[108:109], v[168:169]
 v_lshlrev_b32 v170, 16, v233
 v_and_b32 v171, s34, v233
 v_pk_add_f32 v[110:111], v[110:111], v[170:171]
 v_lshlrev_b32 v172, 16, v234
 v_and_b32 v173, s34, v234
 v_pk_add_f32 v[112:113], v[112:113], v[172:173]
 v_lshlrev_b32 v174, 16, v235
 v_and_b32 v175, s34, v235
 v_pk_add_f32 v[114:115], v[114:115], v[174:175]
 v_lshlrev_b32 v168, 16, v236
 v_and_b32 v169, s34, v236
 v_pk_add_f32 v[136:137], v[136:137], v[168:169]
 v_lshlrev_b32 v170, 16, v237
 v_and_b32 v171, s34, v237
 v_pk_add_f32 v[138:139], v[138:139], v[170:171]
 v_lshlrev_b32 v172, 16, v238
 v_and_b32 v173, s34, v238
 v_pk_add_f32 v[140:141], v[140:141], v[172:173]
 v_lshlrev_b32 v174, 16, v239
 v_and_b32 v175, s34, v239
 v_pk_add_f32 v[142:143], v[142:143], v[174:175]
 v_cvt_pk_bf16_f32 v180, v24, v25
 v_cvt_pk_bf16_f32 v181, v26, v27
 v_cvt_pk_bf16_f32 v182, v52, v53
 v_cvt_pk_bf16_f32 v183, v54, v55
 v_cvt_pk_bf16_f32 v184, v80, v81
 v_cvt_pk_bf16_f32 v185, v82, v83
 v_cvt_pk_bf16_f32 v186, v108, v109
 v_cvt_pk_bf16_f32 v187, v110, v111
 v_cvt_pk_bf16_f32 v188, v136, v137
 v_cvt_pk_bf16_f32 v189, v138, v139
 s_mov_b32 s34, 81920
 buffer_store_dwordx2 v[188:189], v156, s[20:23], s34 offen offset:128
 v_permlane16_swap_b32 v180, v182
 v_permlane16_swap_b32 v181, v183
 buffer_store_dwordx4 v[180:183], v157, s[20:23], s34 offen offset:0
 v_permlane16_swap_b32 v184, v186
 v_permlane16_swap_b32 v185, v187
 buffer_store_dwordx4 v[184:187], v157, s[20:23], s34 offen offset:64
 v_cvt_pk_bf16_f32 v192, v28, v29
 v_cvt_pk_bf16_f32 v193, v30, v31
 v_cvt_pk_bf16_f32 v194, v56, v57
 v_cvt_pk_bf16_f32 v195, v58, v59
 v_cvt_pk_bf16_f32 v196, v84, v85
 v_cvt_pk_bf16_f32 v197, v86, v87
 v_cvt_pk_bf16_f32 v198, v112, v113
 v_cvt_pk_bf16_f32 v199, v114, v115
 v_cvt_pk_bf16_f32 v200, v140, v141
 v_cvt_pk_bf16_f32 v201, v142, v143
 s_mov_b32 s34, 122880
 buffer_store_dwordx2 v[200:201], v156, s[20:23], s34 offen offset:128
 v_permlane16_swap_b32 v192, v194
 v_permlane16_swap_b32 v193, v195
 buffer_store_dwordx4 v[192:195], v157, s[20:23], s34 offen offset:0
 v_permlane16_swap_b32 v196, v198
 v_permlane16_swap_b32 v197, v199
 buffer_store_dwordx4 v[196:199], v157, s[20:23], s34 offen offset:64
 s_branch P_done
P_e2:
 buffer_load_dword v159, v161, s[96:99], 0 offen sc1
 s_waitcnt vmcnt(0)
 v_readfirstlane_b32 s76, v159
 s_mov_b32 s32, 0
 s_bitcmp1_b32 s76, s41
 s_cselect_b32 s77, 1, 0
 s_or_b32 s32, s32, s77
 s_bitcmp1_b32 s76, s42
 s_cselect_b32 s77, 2, 0
 s_or_b32 s32, s32, s77
 s_bitcmp1_b32 s76, s43
 s_cselect_b32 s77, 4, 0
 s_or_b32 s32, s32, s77
 s_and_b32 s32, s32, s33
 s_cbranch_scc1 P_g2
 s_sleep 2
 s_sub_u32 s35, s35, 1
 s_cbranch_scc0 P_e2
 s_mov_b32 s32, s33
P_g2:
 s_bitcmp0_b32 s32, 0
 s_cbranch_scc1 P_a21
 buffer_load_dwordx4 v[180:183], v246, s[16:19], s37 offen offset:0 sc1
 buffer_load_dwordx4 v[184:187], v246, s[16:19], s37 offen offset:1024 sc1
 buffer_load_dwordx4 v[188:191], v246, s[16:19], s37 offen offset:2048 sc1
 buffer_load_dwordx4 v[192:195], v246, s[16:19], s37 offen offset:3072 sc1
 buffer_load_dwordx4 v[196:199], v162, s[16:19], s37 offen offset:0 sc1
P_a21:
 s_bitcmp0_b32 s32, 1
 s_cbranch_scc1 P_a22
 buffer_load_dwordx4 v[200:203], v246, s[16:19], s38 offen offset:0 sc1
 buffer_load_dwordx4 v[204:207], v246, s[16:19], s38 offen offset:1024 sc1
 buffer_load_dwordx4 v[208:211], v246, s[16:19], s38 offen offset:2048 sc1
 buffer_load_dwordx4 v[212:215], v246, s[16:19], s38 offen offset:3072 sc1
 buffer_load_dwordx4 v[216:219], v162, s[16:19], s38 offen offset:0 sc1
P_a22:
 s_bitcmp0_b32 s32, 2
 s_cbranch_scc1 P_a23
 buffer_load_dwordx4 v[220:223], v246, s[16:19], s39 offen offset:0 sc1
 buffer_load_dwordx4 v[224:227], v246, s[16:19], s39 offen offset:1024 sc1
 buffer_load_dwordx4 v[228:231], v246, s[16:19], s39 offen offset:2048 sc1
 buffer_load_dwordx4 v[232:235], v246, s[16:19], s39 offen offset:3072 sc1
 buffer_load_dwordx4 v[236:239], v162, s[16:19], s39 offen offset:0 sc1
P_a23:
 s_andn2_b32 s33, s33, s32
 s_cbranch_scc1 P_e2
 s_waitcnt vmcnt(0)
 v_lshlrev_b32 v168, 16, v180
 v_and_b32 v169, s34, v180
 v_pk_add_f32 v[32:33], v[32:33], v[168:169]
 v_lshlrev_b32 v170, 16, v181
 v_and_b32 v171, s34, v181
 v_pk_add_f32 v[34:35], v[34:35], v[170:171]
 v_lshlrev_b32 v172, 16, v182
 v_and_b32 v173, s34, v182
 v_pk_add_f32 v[36:37], v[36:37], v[172:173]
 v_lshlrev_b32 v174, 16, v183
 v_and_b32 v175, s34, v183
 v_pk_add_f32 v[38:39], v[38:39], v[174:175]
 v_lshlrev_b32 v168, 16, v184
 v_and_b32 v169, s34, v184
 v_pk_add_f32 v[60:61], v[60:61], v[168:169]
 v_lshlrev_b32 v170, 16, v185
 v_and_b32 v171, s34, v185
 v_pk_add_f32 v[62:63], v[62:63], v[170:171]
 v_lshlrev_b32 v172, 16, v186
 v_and_b32 v173, s34, v186
 v_pk_add_f32 v[64:65], v[64:65], v[172:173]
 v_lshlrev_b32 v174, 16, v187
 v_and_b32 v175, s34, v187
 v_pk_add_f32 v[66:67], v[66:67], v[174:175]
 v_lshlrev_b32 v168, 16, v188
 v_and_b32 v169, s34, v188
 v_pk_add_f32 v[88:89], v[88:89], v[168:169]
 v_lshlrev_b32 v170, 16, v189
 v_and_b32 v171, s34, v189
 v_pk_add_f32 v[90:91], v[90:91], v[170:171]
 v_lshlrev_b32 v172, 16, v190
 v_and_b32 v173, s34, v190
 v_pk_add_f32 v[92:93], v[92:93], v[172:173]
 v_lshlrev_b32 v174, 16, v191
 v_and_b32 v175, s34, v191
 v_pk_add_f32 v[94:95], v[94:95], v[174:175]
 v_lshlrev_b32 v168, 16, v192
 v_and_b32 v169, s34, v192
 v_pk_add_f32 v[116:117], v[116:117], v[168:169]
 v_lshlrev_b32 v170, 16, v193
 v_and_b32 v171, s34, v193
 v_pk_add_f32 v[118:119], v[118:119], v[170:171]
 v_lshlrev_b32 v172, 16, v194
 v_and_b32 v173, s34, v194
 v_pk_add_f32 v[120:121], v[120:121], v[172:173]
 v_lshlrev_b32 v174, 16, v195
 v_and_b32 v175, s34, v195
 v_pk_add_f32 v[122:123], v[122:123], v[174:175]
 v_lshlrev_b32 v168, 16, v196
 v_and_b32 v169, s34, v196
 v_pk_add_f32 v[144:145], v[144:145], v[168:169]
 v_lshlrev_b32 v170, 16, v197
 v_and_b32 v171, s34, v197
 v_pk_add_f32 v[146:147], v[146:147], v[170:171]
 v_lshlrev_b32 v172, 16, v198
 v_and_b32 v173, s34, v198
 v_pk_add_f32 v[148:149], v[148:149], v[172:173]
 v_lshlrev_b32 v174, 16, v199
 v_and_b32 v175, s34, v199
 v_pk_add_f32 v[150:151], v[150:151], v[174:175]
 v_lshlrev_b32 v168, 16, v200
 v_and_b32 v169, s34, v200
 v_pk_add_f32 v[32:33], v[32:33], v[168:169]
 v_lshlrev_b32 v170, 16, v201
 v_and_b32 v171, s34, v201
 v_pk_add_f32 v[34:35], v[34:35], v[170:171]
 v_lshlrev_b32 v172, 16, v202
 v_and_b32 v173, s34, v202
 v_pk_add_f32 v[36:37], v[36:37], v[172:173]
 v_lshlrev_b32 v174, 16, v203
 v_and_b32 v175, s34, v203
 v_pk_add_f32 v[38:39], v[38:39], v[174:175]
 v_lshlrev_b32 v168, 16, v204
 v_and_b32 v169, s34, v204
 v_pk_add_f32 v[60:61], v[60:61], v[168:169]
 v_lshlrev_b32 v170, 16, v205
 v_and_b32 v171, s34, v205
 v_pk_add_f32 v[62:63], v[62:63], v[170:171]
 v_lshlrev_b32 v172, 16, v206
 v_and_b32 v173, s34, v206
 v_pk_add_f32 v[64:65], v[64:65], v[172:173]
 v_lshlrev_b32 v174, 16, v207
 v_and_b32 v175, s34, v207
 v_pk_add_f32 v[66:67], v[66:67], v[174:175]
 v_lshlrev_b32 v168, 16, v208
 v_and_b32 v169, s34, v208
 v_pk_add_f32 v[88:89], v[88:89], v[168:169]
 v_lshlrev_b32 v170, 16, v209
 v_and_b32 v171, s34, v209
 v_pk_add_f32 v[90:91], v[90:91], v[170:171]
 v_lshlrev_b32 v172, 16, v210
 v_and_b32 v173, s34, v210
 v_pk_add_f32 v[92:93], v[92:93], v[172:173]
 v_lshlrev_b32 v174, 16, v211
 v_and_b32 v175, s34, v211
 v_pk_add_f32 v[94:95], v[94:95], v[174:175]
 v_lshlrev_b32 v168, 16, v212
 v_and_b32 v169, s34, v212
 v_pk_add_f32 v[116:117], v[116:117], v[168:169]
 v_lshlrev_b32 v170, 16, v213
 v_and_b32 v171, s34, v213
 v_pk_add_f32 v[118:119], v[118:119], v[170:171]
 v_lshlrev_b32 v172, 16, v214
 v_and_b32 v173, s34, v214
 v_pk_add_f32 v[120:121], v[120:121], v[172:173]
 v_lshlrev_b32 v174, 16, v215
 v_and_b32 v175, s34, v215
 v_pk_add_f32 v[122:123], v[122:123], v[174:175]
 v_lshlrev_b32 v168, 16, v216
 v_and_b32 v169, s34, v216
 v_pk_add_f32 v[144:145], v[144:145], v[168:169]
 v_lshlrev_b32 v170, 16, v217
 v_and_b32 v171, s34, v217
 v_pk_add_f32 v[146:147], v[146:147], v[170:171]
 v_lshlrev_b32 v172, 16, v218
 v_and_b32 v173, s34, v218
 v_pk_add_f32 v[148:149], v[148:149], v[172:173]
 v_lshlrev_b32 v174, 16, v219
 v_and_b32 v175, s34, v219
 v_pk_add_f32 v[150:151], v[150:151], v[174:175]
 v_lshlrev_b32 v168, 16, v220
 v_and_b32 v169, s34, v220
 v_pk_add_f32 v[32:33], v[32:33], v[168:169]
 v_lshlrev_b32 v170, 16, v221
 v_and_b32 v171, s34, v221
 v_pk_add_f32 v[34:35], v[34:35], v[170:171]
 v_lshlrev_b32 v172, 16, v222
 v_and_b32 v173, s34, v222
 v_pk_add_f32 v[36:37], v[36:37], v[172:173]
 v_lshlrev_b32 v174, 16, v223
 v_and_b32 v175, s34, v223
 v_pk_add_f32 v[38:39], v[38:39], v[174:175]
 v_lshlrev_b32 v168, 16, v224
 v_and_b32 v169, s34, v224
 v_pk_add_f32 v[60:61], v[60:61], v[168:169]
 v_lshlrev_b32 v170, 16, v225
 v_and_b32 v171, s34, v225
 v_pk_add_f32 v[62:63], v[62:63], v[170:171]
 v_lshlrev_b32 v172, 16, v226
 v_and_b32 v173, s34, v226
 v_pk_add_f32 v[64:65], v[64:65], v[172:173]
 v_lshlrev_b32 v174, 16, v227
 v_and_b32 v175, s34, v227
 v_pk_add_f32 v[66:67], v[66:67], v[174:175]
 v_lshlrev_b32 v168, 16, v228
 v_and_b32 v169, s34, v228
 v_pk_add_f32 v[88:89], v[88:89], v[168:169]
 v_lshlrev_b32 v170, 16, v229
 v_and_b32 v171, s34, v229
 v_pk_add_f32 v[90:91], v[90:91], v[170:171]
 v_lshlrev_b32 v172, 16, v230
 v_and_b32 v173, s34, v230
 v_pk_add_f32 v[92:93], v[92:93], v[172:173]
 v_lshlrev_b32 v174, 16, v231
 v_and_b32 v175, s34, v231
 v_pk_add_f32 v[94:95], v[94:95], v[174:175]
 v_lshlrev_b32 v168, 16, v232
 v_and_b32 v169, s34, v232
 v_pk_add_f32 v[116:117], v[116:117], v[168:169]
 v_lshlrev_b32 v170, 16, v233
 v_and_b32 v171, s34, v233
 v_pk_add_f32 v[118:119], v[118:119], v[170:171]
 v_lshlrev_b32 v172, 16, v234
 v_and_b32 v173, s34, v234
 v_pk_add_f32 v[120:121], v[120:121], v[172:173]
 v_lshlrev_b32 v174, 16, v235
 v_and_b32 v175, s34, v235
 v_pk_add_f32 v[122:123], v[122:123], v[174:175]
 v_lshlrev_b32 v168, 16, v236
 v_and_b32 v169, s34, v236
 v_pk_add_f32 v[144:145], v[144:145], v[168:169]
 v_lshlrev_b32 v170, 16, v237
 v_and_b32 v171, s34, v237
 v_pk_add_f32 v[146:147], v[146:147], v[170:171]
 v_lshlrev_b32 v172, 16, v238
 v_and_b32 v173, s34, v238
 v_pk_add_f32 v[148:149], v[148:149], v[172:173]
 v_lshlrev_b32 v174, 16, v239
 v_and_b32 v175, s34, v239
 v_pk_add_f32 v[150:151], v[150:151], v[174:175]
 v_cvt_pk_bf16_f32 v180, v32, v33
 v_cvt_pk_bf16_f32 v181, v34, v35
 v_cvt_pk_bf16_f32 v182, v60, v61
 v_cvt_pk_bf16_f32 v183, v62, v63
 v_cvt_pk_bf16_f32 v184, v88, v89
 v_cvt_pk_bf16_f32 v185, v90, v91
 v_cvt_pk_bf16_f32 v186, v116, v117
 v_cvt_pk_bf16_f32 v187, v118, v119
 v_cvt_pk_bf16_f32 v188, v144, v145
 v_cvt_pk_bf16_f32 v189, v146, v147
 s_mov_b32 s34, 163840
 buffer_store_dwordx2 v[188:189], v156, s[20:23], s34 offen offset:128
 v_permlane16_swap_b32 v180, v182
 v_permlane16_swap_b32 v181, v183
 buffer_store_dwordx4 v[180:183], v157, s[20:23], s34 offen offset:0
 v_permlane16_swap_b32 v184, v186
 v_permlane16_swap_b32 v185, v187
 buffer_store_dwordx4 v[184:187], v157, s[20:23], s34 offen offset:64
 v_cvt_pk_bf16_f32 v192, v36, v37
 v_cvt_pk_bf16_f32 v193, v38, v39
 v_cvt_pk_bf16_f32 v194, v64, v65
 v_cvt_pk_bf16_f32 v195, v66, v67
 v_cvt_pk_bf16_f32 v196, v92, v93
 v_cvt_pk_bf16_f32 v197, v94, v95
 v_cvt_pk_bf16_f32 v198, v120, v121
 v_cvt_pk_bf16_f32 v199, v122, v123
 v_cvt_pk_bf16_f32 v200, v148, v149
 v_cvt_pk_bf16_f32 v201, v150, v151
 s_mov_b32 s34, 204800
 buffer_store_dwordx2 v[200:201], v156, s[20:23], s34 offen offset:128
 v_permlane16_swap_b32 v192, v194
 v_permlane16_swap_b32 v193, v195
 buffer_store_dwordx4 v[192:195], v157, s[20:23], s34 offen offset:0
 v_permlane16_swap_b32 v196, v198
 v_permlane16_swap_b32 v197, v199
 buffer_store_dwordx4 v[196:199], v157, s[20:23], s34 offen offset:64
 s_branch P_done
P_e3:
 buffer_load_dword v159, v161, s[96:99], 0 offen sc1
 s_waitcnt vmcnt(0)
 v_readfirstlane_b32 s76, v159
 s_mov_b32 s32, 0
 s_bitcmp1_b32 s76, s41
 s_cselect_b32 s77, 1, 0
 s_or_b32 s32, s32, s77
 s_bitcmp1_b32 s76, s42
 s_cselect_b32 s77, 2, 0
 s_or_b32 s32, s32, s77
 s_bitcmp1_b32 s76, s43
 s_cselect_b32 s77, 4, 0
 s_or_b32 s32, s32, s77
 s_and_b32 s32, s32, s33
 s_cbranch_scc1 P_g3
 s_sleep 2
 s_sub_u32 s35, s35, 1
 s_cbranch_scc0 P_e3
 s_mov_b32 s32, s33
P_g3:
 s_bitcmp0_b32 s32, 0
 s_cbranch_scc1 P_a31
 buffer_load_dwordx2 v[180:181], v246, s[16:19], s37 offen offset:0 sc1
 buffer_load_dwordx2 v[184:185], v246, s[16:19], s37 offen offset:1024 sc1
 buffer_load_dwordx2 v[188:189], v246, s[16:19], s37 offen offset:2048 sc1
 buffer_load_dwordx2 v[192:193], v246, s[16:19], s37 offen offset:3072 sc1
 buffer_load_dwordx2 v[196:197], v162, s[16:19], s37 offen offset:0 sc1
P_a31:
 s_bitcmp0_b32 s32, 1
 s_cbranch_scc1 P_a32
 buffer_load_dwordx2 v[200:201], v246, s[16:19], s38 offen offset:0 sc1
 buffer_load_dwordx2 v[204:205], v246, s[16:19], s38 offen offset:1024 sc1
 buffer_load_dwordx2 v[208:209], v246, s[16:19], s38 offen offset:2048 sc1
 buffer_load_dwordx2 v[212:213], v246, s[16:19], s38 offen offset:3072 sc1
 buffer_load_dwordx2 v[216:217], v162, s[16:19], s38 offen offset:0 sc1
P_a32:
 s_bitcmp0_b32 s32, 2
 s_cbranch_scc1 P_a33
 buffer_load_dwordx2 v[220:221], v246, s[16:19], s39 offen offset:0 sc1
 buffer_load_dwordx2 v[224:225], v246, s[16:19], s39 offen offset:1024 sc1
 buffer_load_dwordx2 v[228:229], v246, s[16:19], s39 offen offset:2048 sc1
 buffer_load_dwordx2 v[232:233], v246, s[16:19], s39 offen offset:3072 sc1
 buffer_load_dwordx2 v[236:237], v162, s[16:19], s39 offen offset:0 sc1
P_a33:
 s_andn2_b32 s33, s33, s32
 s_cbranch_scc1 P_e3
 s_waitcnt vmcnt(0)
 v_lshlrev_b32 v168, 16, v180
 v_and_b32 v169, s34, v180
 v_pk_add_f32 v[40:41], v[40:41], v[168:169]
 v_lshlrev_b32 v170, 16, v181
 v_and_b32 v171, s34, v181
 v_pk_add_f32 v[42:43], v[42:43], v[170:171]
 v_lshlrev_b32 v168, 16, v184
 v_and_b32 v169, s34, v184
 v_pk_add_f32 v[68:69], v[68:69], v[168:169]
 v_lshlrev_b32 v170, 16, v185
 v_and_b32 v171, s34, v185
 v_pk_add_f32 v[70:71], v[70:71], v[170:171]
 v_lshlrev_b32 v168, 16, v188
 v_and_b32 v169, s34, v188
 v_pk_add_f32 v[96:97], v[96:97], v[168:169]
 v_lshlrev_b32 v170, 16, v189
 v_and_b32 v171, s34, v189
 v_pk_add_f32 v[98:99], v[98:99], v[170:171]
 v_lshlrev_b32 v168, 16, v192
 v_and_b32 v169, s34, v192
 v_pk_add_f32 v[124:125], v[124:125], v[168:169]
 v_lshlrev_b32 v170, 16, v193
 v_and_b32 v171, s34, v193
 v_pk_add_f32 v[126:127], v[126:127], v[170:171]
 v_lshlrev_b32 v168, 16, v196
 v_and_b32 v169, s34, v196
 v_pk_add_f32 v[152:153], v[152:153], v[168:169]
 v_lshlrev_b32 v170, 16, v197
 v_and_b32 v171, s34, v197
 v_pk_add_f32 v[154:155], v[154:155], v[170:171]
 v_lshlrev_b32 v168, 16, v200
 v_and_b32 v169, s34, v200
 v_pk_add_f32 v[40:41], v[40:41], v[168:169]
 v_lshlrev_b32 v170, 16, v201
 v_and_b32 v171, s34, v201
 v_pk_add_f32 v[42:43], v[42:43], v[170:171]
 v_lshlrev_b32 v168, 16, v204
 v_and_b32 v169, s34, v204
 v_pk_add_f32 v[68:69], v[68:69], v[168:169]
 v_lshlrev_b32 v170, 16, v205
 v_and_b32 v171, s34, v205
 v_pk_add_f32 v[70:71], v[70:71], v[170:171]
 v_lshlrev_b32 v168, 16, v208
 v_and_b32 v169, s34, v208
 v_pk_add_f32 v[96:97], v[96:97], v[168:169]
 v_lshlrev_b32 v170, 16, v209
 v_and_b32 v171, s34, v209
 v_pk_add_f32 v[98:99], v[98:99], v[170:171]
 v_lshlrev_b32 v168, 16, v212
 v_and_b32 v169, s34, v212
 v_pk_add_f32 v[124:125], v[124:125], v[168:169]
 v_lshlrev_b32 v170, 16, v213
 v_and_b32 v171, s34, v213
 v_pk_add_f32 v[126:127], v[126:127], v[170:171]
 v_lshlrev_b32 v168, 16, v216
 v_and_b32 v169, s34, v216
 v_pk_add_f32 v[152:153], v[152:153], v[168:169]
 v_lshlrev_b32 v170, 16, v217
 v_and_b32 v171, s34, v217
 v_pk_add_f32 v[154:155], v[154:155], v[170:171]
 v_lshlrev_b32 v168, 16, v220
 v_and_b32 v169, s34, v220
 v_pk_add_f32 v[40:41], v[40:41], v[168:169]
 v_lshlrev_b32 v170, 16, v221
 v_and_b32 v171, s34, v221
 v_pk_add_f32 v[42:43], v[42:43], v[170:171]
 v_lshlrev_b32 v168, 16, v224
 v_and_b32 v169, s34, v224
 v_pk_add_f32 v[68:69], v[68:69], v[168:169]
 v_lshlrev_b32 v170, 16, v225
 v_and_b32 v171, s34, v225
 v_pk_add_f32 v[70:71], v[70:71], v[170:171]
 v_lshlrev_b32 v168, 16, v228
 v_and_b32 v169, s34, v228
 v_pk_add_f32 v[96:97], v[96:97], v[168:169]
 v_lshlrev_b32 v170, 16, v229
 v_and_b32 v171, s34, v229
 v_pk_add_f32 v[98:99], v[98:99], v[170:171]
 v_lshlrev_b32 v168, 16, v232
 v_and_b32 v169, s34, v232
 v_pk_add_f32 v[124:125], v[124:125], v[168:169]
 v_lshlrev_b32 v170, 16, v233
 v_and_b32 v171, s34, v233
 v_pk_add_f32 v[126:127], v[126:127], v[170:171]
 v_lshlrev_b32 v168, 16, v236
 v_and_b32 v169, s34, v236
 v_pk_add_f32 v[152:153], v[152:153], v[168:169]
 v_lshlrev_b32 v170, 16, v237
 v_and_b32 v171, s34, v237
 v_pk_add_f32 v[154:155], v[154:155], v[170:171]
 v_cvt_pk_bf16_f32 v180, v40, v41
 v_cvt_pk_bf16_f32 v181, v42, v43
 v_cvt_pk_bf16_f32 v182, v68, v69
 v_cvt_pk_bf16_f32 v183, v70, v71
 v_cvt_pk_bf16_f32 v184, v96, v97
 v_cvt_pk_bf16_f32 v185, v98, v99
 v_cvt_pk_bf16_f32 v186, v124, v125
 v_cvt_pk_bf16_f32 v187, v126, v127
 v_cvt_pk_bf16_f32 v188, v152, v153
 v_cvt_pk_bf16_f32 v189, v154, v155
 s_mov_b32 s34, 245760
 buffer_store_dwordx2 v[188:189], v156, s[20:23], s34 offen offset:128
 v_permlane16_swap_b32 v180, v182
 v_permlane16_swap_b32 v181, v183
 buffer_store_dwordx4 v[180:183], v157, s[20:23], s34 offen offset:0
 v_permlane16_swap_b32 v184, v186
 v_permlane16_swap_b32 v185, v187
 buffer_store_dwordx4 v[184:187], v157, s[20:23], s34 offen offset:64
P_done:
K1_exit:
 s_endpgm
K1_pre:
 s_nop 7
 v_mov_b32 v168, v200
 s_nop 1
 v_permlane16_swap_b32 v168, v200
 v_add_f32 v200, v200, v168
 v_mov_b32 v168, v200
 s_nop 1
 v_permlane32_swap_b32 v168, v200
 v_add_f32 v200, v200, v168
 v_rcp_f32 v204, v200
 v_mov_b32 v169, v201
 s_nop 1
 v_permlane16_swap_b32 v169, v201
 v_add_f32 v201, v201, v169
 v_mov_b32 v169, v201
 s_nop 1
 v_permlane32_swap_b32 v169, v201
 v_add_f32 v201, v201, v169
 v_rcp_f32 v205, v201
 v_mov_b32 v170, v202
 s_nop 1
 v_permlane16_swap_b32 v170, v202
 v_add_f32 v202, v202, v170
 v_mov_b32 v170, v202
 s_nop 1
 v_permlane32_swap_b32 v170, v202
 v_add_f32 v202, v202, v170
 v_rcp_f32 v206, v202
 v_accvgpr_read_b32 v172, a0
 v_accvgpr_read_b32 v173, a1
 v_accvgpr_read_b32 v174, a2
 v_accvgpr_read_b32 v175, a3
 v_accvgpr_read_b32 v176, a4
 v_accvgpr_read_b32 v177, a5
 v_accvgpr_read_b32 v178, a6
 v_accvgpr_read_b32 v179, a7
 v_mul_f32 v172, v172, v204
 v_mul_f32 v173, v173, v204
 v_mul_f32 v174, v174, v204
 v_mul_f32 v175, v175, v204
 v_mul_f32 v176, v176, v204
 v_mul_f32 v177, v177, v204
 v_mul_f32 v178, v178, v204
 v_mul_f32 v179, v179, v204
 v_cvt_pk_bf16_f32 v180, v172, v173
 v_cvt_pk_bf16_f32 v181, v174, v175
 v_cvt_pk_bf16_f32 v182, v176, v177
 v_cvt_pk_bf16_f32 v183, v178, v179
 buffer_store_dwordx4 v[180:183], v246, s[24:27], s41 offen sc1
 v_accvgpr_read_b32 v184, a8
 v_accvgpr_read_b32 v185, a9
 v_accvgpr_read_b32 v186, a10
 v_accvgpr_read_b32 v187, a11
 v_accvgpr_read_b32 v188, a12
 v_accvgpr_read_b32 v189, a13
 v_accvgpr_read_b32 v190, a14
 v_accvgpr_read_b32 v191, a15
 v_mul_f32 v184, v184, v204
 v_mul_f32 v185, v185, v204
 v_mul_f32 v186, v186, v204
 v_mul_f32 v187, v187, v204
 v_mul_f32 v188, v188, v204
 v_mul_f32 v189, v189, v204
 v_mul_f32 v190, v190, v204
 v_mul_f32 v191, v191, v204
 v_cvt_pk_bf16_f32 v192, v184, v185
 v_cvt_pk_bf16_f32 v193, v186, v187
 v_cvt_pk_bf16_f32 v194, v188, v189
 v_cvt_pk_bf16_f32 v195, v190, v191
 buffer_store_dwordx4 v[192:195], v246, s[24:27], s42 offen sc1
 v_accvgpr_read_b32 v172, a16
 v_accvgpr_read_b32 v173, a17
 v_accvgpr_read_b32 v174, a18
 v_accvgpr_read_b32 v175, a19
 v_accvgpr_read_b32 v176, a20
 v_accvgpr_read_b32 v177, a21
 v_accvgpr_read_b32 v178, a22
 v_accvgpr_read_b32 v179, a23
 v_mul_f32 v172, v172, v204
 v_mul_f32 v173, v173, v204
 v_mul_f32 v174, v174, v204
 v_mul_f32 v175, v175, v204
 v_mul_f32 v176, v176, v204
 v_mul_f32 v177, v177, v204
 v_mul_f32 v178, v178, v204
 v_mul_f32 v179, v179, v204
 v_cvt_pk_bf16_f32 v180, v172, v173
 v_cvt_pk_bf16_f32 v181, v174, v175
 v_cvt_pk_bf16_f32 v182, v176, v177
 v_cvt_pk_bf16_f32 v183, v178, v179
 buffer_store_dwordx4 v[180:183], v246, s[24:27], s43 offen sc1
 v_accvgpr_read_b32 v184, a24
 v_accvgpr_read_b32 v185, a25
 v_accvgpr_read_b32 v186, a26
 v_accvgpr_read_b32 v187, a27
 v_accvgpr_read_b32 v188, a28
 v_accvgpr_read_b32 v189, a29
 v_accvgpr_read_b32 v190, a30
 v_accvgpr_read_b32 v191, a31
 v_mul_f32 v184, v184, v204
 v_mul_f32 v185, v185, v204
 v_mul_f32 v186, v186, v204
 v_mul_f32 v187, v187, v204
 v_mul_f32 v188, v188, v204
 v_mul_f32 v189, v189, v204
 v_mul_f32 v190, v190, v204
 v_mul_f32 v191, v191, v204
 v_cvt_pk_bf16_f32 v192, v184, v185
 v_cvt_pk_bf16_f32 v193, v186, v187
 v_cvt_pk_bf16_f32 v194, v188, v189
 v_cvt_pk_bf16_f32 v195, v190, v191
 buffer_store_dwordx4 v[192:195], v246, s[24:27], s44 offen sc1
 v_accvgpr_read_b32 v172, a32
 v_accvgpr_read_b32 v173, a33
 v_accvgpr_read_b32 v174, a34
 v_accvgpr_read_b32 v175, a35
 v_accvgpr_read_b32 v176, a36
 v_accvgpr_read_b32 v177, a37
 v_accvgpr_read_b32 v178, a38
 v_accvgpr_read_b32 v179, a39
 v_mul_f32 v172, v172, v204
 v_mul_f32 v173, v173, v204
 v_mul_f32 v174, v174, v204
 v_mul_f32 v175, v175, v204
 v_mul_f32 v176, v176, v204
 v_mul_f32 v177, v177, v204
 v_mul_f32 v178, v178, v204
 v_mul_f32 v179, v179, v204
 v_cvt_pk_bf16_f32 v180, v172, v173
 v_cvt_pk_bf16_f32 v181, v174, v175
 v_cvt_pk_bf16_f32 v182, v176, v177
 v_cvt_pk_bf16_f32 v183, v178, v179
 buffer_store_dwordx4 v[180:183], v246, s[24:27], s45 offen sc1
 v_accvgpr_read_b32 v184, a40
 v_accvgpr_read_b32 v185, a41
 v_accvgpr_read_b32 v186, a42
 v_accvgpr_read_b32 v187, a43
 v_accvgpr_read_b32 v188, a44
 v_accvgpr_read_b32 v189, a45
 v_accvgpr_read_b32 v190, a46
 v_accvgpr_read_b32 v191, a47
 v_mul_f32 v184, v184, v204
 v_mul_f32 v185, v185, v204
 v_mul_f32 v186, v186, v204
 v_mul_f32 v187, v187, v204
 v_mul_f32 v188, v188, v204
 v_mul_f32 v189, v189, v204
 v_mul_f32 v190, v190, v204
 v_mul_f32 v191, v191, v204
 v_cvt_pk_bf16_f32 v192, v184, v185
 v_cvt_pk_bf16_f32 v193, v186, v187
 v_cvt_pk_bf16_f32 v194, v188, v189
 v_cvt_pk_bf16_f32 v195, v190, v191
 buffer_store_dwordx4 v[192:195], v246, s[24:27], s46 offen sc1
 s_branch K1_body
CODE_END:
K1_stub0:
 s_call_b64 s[30:31], K1_fb0
 s_branch K1_back0
K1_stub1:
 s_call_b64 s[30:31], K1_fb1
 s_branch K1_back1
K1_stub2:
 s_call_b64 s[30:31], K1_fb0
 s_branch K1_back2
K1_stub13:
 s_call_b64 s[30:31], K1_fb1
 s_branch K1_back13
K1_stub14:
 s_call_b64 s[30:31], K1_fb0
 s_branch K1_back14
K1_stub15:
 s_call_b64 s[30:31], K1_fb1
 s_branch K1_back15
K1_fb0:
 s_nop 7
 s_nop 7
 v_max3_f32 v208, v168, v169, v170
 v_max3_f32 v208, v208, v171, v184
 v_max3_f32 v208, v208, v185, v186
 v_max3_f32 v208, v208, v187, 0
 v_mov_b32 v209, v208
 s_nop 1
 v_permlane16_swap_b32 v209, v208
 v_max_f32 v208, v208, v209
 v_mov_b32 v209, v208
 s_nop 1
 v_permlane32_swap_b32 v209, v208
 v_max_f32 v208, v208, v209
 v_sub_f32 v148, v148, v208
 v_sub_f32 v149, v149, v208
 v_sub_f32 v150, v150, v208
 v_sub_f32 v151, v151, v208
 v_sub_f32 v168, v168, v208
 v_sub_f32 v169, v169, v208
 v_sub_f32 v170, v170, v208
 v_sub_f32 v171, v171, v208
 v_sub_f32 v184, v184, v208
 v_sub_f32 v185, v185, v208
 v_sub_f32 v186, v186, v208
 v_sub_f32 v187, v187, v208
 v_sub_f32 v124, v124, v208
 v_sub_f32 v125, v125, v208
 v_sub_f32 v126, v126, v208
 v_sub_f32 v127, v127, v208
 v_sub_f32 v136, v136, v208
 v_sub_f32 v137, v137, v208
 v_sub_f32 v138, v138, v208
 v_sub_f32 v139, v139, v208
 v_sub_f32 v209, 0, v208
 v_exp_f32 v210, v209
 s_nop 0
 v_mul_f32 v200, v200, v210
 v_accvgpr_read_b32 v211, a0
 v_mul_f32 v211, v211, v210
 v_accvgpr_write_b32 a0, v211
 v_accvgpr_read_b32 v212, a1
 v_mul_f32 v212, v212, v210
 v_accvgpr_write_b32 a1, v212
 v_accvgpr_read_b32 v213, a2
 v_mul_f32 v213, v213, v210
 v_accvgpr_write_b32 a2, v213
 v_accvgpr_read_b32 v211, a3
 v_mul_f32 v211, v211, v210
 v_accvgpr_write_b32 a3, v211
 v_accvgpr_read_b32 v212, a4
 v_mul_f32 v212, v212, v210
 v_accvgpr_write_b32 a4, v212
 v_accvgpr_read_b32 v213, a5
 v_mul_f32 v213, v213, v210
 v_accvgpr_write_b32 a5, v213
 v_accvgpr_read_b32 v211, a6
 v_mul_f32 v211, v211, v210
 v_accvgpr_write_b32 a6, v211
 v_accvgpr_read_b32 v212, a7
 v_mul_f32 v212, v212, v210
 v_accvgpr_write_b32 a7, v212
 v_accvgpr_read_b32 v213, a8
 v_mul_f32 v213, v213, v210
 v_accvgpr_write_b32 a8, v213
 v_accvgpr_read_b32 v211, a9
 v_mul_f32 v211, v211, v210
 v_accvgpr_write_b32 a9, v211
 v_accvgpr_read_b32 v212, a10
 v_mul_f32 v212, v212, v210
 v_accvgpr_write_b32 a10, v212
 v_accvgpr_read_b32 v213, a11
 v_mul_f32 v213, v213, v210
 v_accvgpr_write_b32 a11, v213
 v_accvgpr_read_b32 v211, a12
 v_mul_f32 v211, v211, v210
 v_accvgpr_write_b32 a12, v211
 v_accvgpr_read_b32 v212, a13
 v_mul_f32 v212, v212, v210
 v_accvgpr_write_b32 a13, v212
 v_accvgpr_read_b32 v213, a14
 v_mul_f32 v213, v213, v210
 v_accvgpr_write_b32 a14, v213
 v_accvgpr_read_b32 v211, a15
 v_mul_f32 v211, v211, v210
 v_accvgpr_write_b32 a15, v211
 v_accvgpr_read_b32 v212, a16
 v_mul_f32 v212, v212, v210
 v_accvgpr_write_b32 a16, v212
 v_accvgpr_read_b32 v213, a17
 v_mul_f32 v213, v213, v210
 v_accvgpr_write_b32 a17, v213
 v_accvgpr_read_b32 v211, a18
 v_mul_f32 v211, v211, v210
 v_accvgpr_write_b32 a18, v211
 v_accvgpr_read_b32 v212, a19
 v_mul_f32 v212, v212, v210
 v_accvgpr_write_b32 a19, v212
 v_accvgpr_read_b32 v213, a20
 v_mul_f32 v213, v213, v210
 v_accvgpr_write_b32 a20, v213
 v_accvgpr_read_b32 v211, a21
 v_mul_f32 v211, v211, v210
 v_accvgpr_write_b32 a21, v211
 v_accvgpr_read_b32 v212, a22
 v_mul_f32 v212, v212, v210
 v_accvgpr_write_b32 a22, v212
 v_accvgpr_read_b32 v213, a23
 v_mul_f32 v213, v213, v210
 v_accvgpr_write_b32 a23, v213
 v_accvgpr_read_b32 v211, a24
 v_mul_f32 v211, v211, v210
 v_accvgpr_write_b32 a24, v211
 v_accvgpr_read_b32 v212, a25
 v_mul_f32 v212, v212, v210
 v_accvgpr_write_b32 a25, v212
 v_accvgpr_read_b32 v213, a26
 v_mul_f32 v213, v213, v210
 v_accvgpr_write_b32 a26, v213
 v_accvgpr_read_b32 v211, a27
 v_mul_f32 v211, v211, v210
 v_accvgpr_write_b32 a27, v211
 v_accvgpr_read_b32 v212, a28
 v_mul_f32 v212, v212, v210
 v_accvgpr_write_b32 a28, v212
 v_accvgpr_read_b32 v213, a29
 v_mul_f32 v213, v213, v210
 v_accvgpr_write_b32 a29, v213
 v_accvgpr_read_b32 v211, a30
 v_mul_f32 v211, v211, v210
 v_accvgpr_write_b32 a30, v211
 v_accvgpr_read_b32 v212, a31
 v_mul_f32 v212, v212, v210
 v_accvgpr_write_b32 a31, v212
 v_accvgpr_read_b32 v213, a32
 v_mul_f32 v213, v213, v210
 v_accvgpr_write_b32 a32, v213
 v_accvgpr_read_b32 v211, a33
 v_mul_f32 v211, v211, v210
 v_accvgpr_write_b32 a33, v211
 v_accvgpr_read_b32 v212, a34
 v_mul_f32 v212, v212, v210
 v_accvgpr_write_b32 a34, v212
 v_accvgpr_read_b32 v213, a35
 v_mul_f32 v213, v213, v210
 v_accvgpr_write_b32 a35, v213
 v_accvgpr_read_b32 v211, a36
 v_mul_f32 v211, v211, v210
 v_accvgpr_write_b32 a36, v211
 v_accvgpr_read_b32 v212, a37
 v_mul_f32 v212, v212, v210
 v_accvgpr_write_b32 a37, v212
 v_accvgpr_read_b32 v213, a38
 v_mul_f32 v213, v213, v210
 v_accvgpr_write_b32 a38, v213
 v_accvgpr_read_b32 v211, a39
 v_mul_f32 v211, v211, v210
 v_accvgpr_write_b32 a39, v211
 v_accvgpr_read_b32 v212, a40
 v_mul_f32 v212, v212, v210
 v_accvgpr_write_b32 a40, v212
 v_accvgpr_read_b32 v213, a41
 v_mul_f32 v213, v213, v210
 v_accvgpr_write_b32 a41, v213
 v_accvgpr_read_b32 v211, a42
 v_mul_f32 v211, v211, v210
 v_accvgpr_write_b32 a42, v211
 v_accvgpr_read_b32 v212, a43
 v_mul_f32 v212, v212, v210
 v_accvgpr_write_b32 a43, v212
 v_accvgpr_read_b32 v213, a44
 v_mul_f32 v213, v213, v210
 v_accvgpr_write_b32 a44, v213
 v_accvgpr_read_b32 v211, a45
 v_mul_f32 v211, v211, v210
 v_accvgpr_write_b32 a45, v211
 v_accvgpr_read_b32 v212, a46
 v_mul_f32 v212, v212, v210
 v_accvgpr_write_b32 a46, v212
 v_accvgpr_read_b32 v213, a47
 v_mul_f32 v213, v213, v210
 v_accvgpr_write_b32 a47, v213
 v_max3_f32 v208, v172, v173, v174
 v_max3_f32 v208, v208, v175, v188
 v_max3_f32 v208, v208, v189, v190
 v_max3_f32 v208, v208, v191, 0
 v_mov_b32 v209, v208
 s_nop 1
 v_permlane16_swap_b32 v209, v208
 v_max_f32 v208, v208, v209
 v_mov_b32 v209, v208
 s_nop 1
 v_permlane32_swap_b32 v209, v208
 v_max_f32 v208, v208, v209
 v_sub_f32 v152, v152, v208
 v_sub_f32 v153, v153, v208
 v_sub_f32 v154, v154, v208
 v_sub_f32 v155, v155, v208
 v_sub_f32 v172, v172, v208
 v_sub_f32 v173, v173, v208
 v_sub_f32 v174, v174, v208
 v_sub_f32 v175, v175, v208
 v_sub_f32 v188, v188, v208
 v_sub_f32 v189, v189, v208
 v_sub_f32 v190, v190, v208
 v_sub_f32 v191, v191, v208
 v_sub_f32 v128, v128, v208
 v_sub_f32 v129, v129, v208
 v_sub_f32 v130, v130, v208
 v_sub_f32 v131, v131, v208
 v_sub_f32 v140, v140, v208
 v_sub_f32 v141, v141, v208
 v_sub_f32 v142, v142, v208
 v_sub_f32 v143, v143, v208
 v_sub_f32 v209, 0, v208
 v_exp_f32 v210, v209
 s_nop 0
 v_mul_f32 v201, v201, v210
 v_accvgpr_read_b32 v211, a48
 v_mul_f32 v211, v211, v210
 v_accvgpr_write_b32 a48, v211
 v_accvgpr_read_b32 v212, a49
 v_mul_f32 v212, v212, v210
 v_accvgpr_write_b32 a49, v212
 v_accvgpr_read_b32 v213, a50
 v_mul_f32 v213, v213, v210
 v_accvgpr_write_b32 a50, v213
 v_accvgpr_read_b32 v211, a51
 v_mul_f32 v211, v211, v210
 v_accvgpr_write_b32 a51, v211
 v_accvgpr_read_b32 v212, a52
 v_mul_f32 v212, v212, v210
 v_accvgpr_write_b32 a52, v212
 v_accvgpr_read_b32 v213, a53
 v_mul_f32 v213, v213, v210
 v_accvgpr_write_b32 a53, v213
 v_accvgpr_read_b32 v211, a54
 v_mul_f32 v211, v211, v210
 v_accvgpr_write_b32 a54, v211
 v_accvgpr_read_b32 v212, a55
 v_mul_f32 v212, v212, v210
 v_accvgpr_write_b32 a55, v212
 v_accvgpr_read_b32 v213, a56
 v_mul_f32 v213, v213, v210
 v_accvgpr_write_b32 a56, v213
 v_accvgpr_read_b32 v211, a57
 v_mul_f32 v211, v211, v210
 v_accvgpr_write_b32 a57, v211
 v_accvgpr_read_b32 v212, a58
 v_mul_f32 v212, v212, v210
 v_accvgpr_write_b32 a58, v212
 v_accvgpr_read_b32 v213, a59
 v_mul_f32 v213, v213, v210
 v_accvgpr_write_b32 a59, v213
 v_accvgpr_read_b32 v211, a60
 v_mul_f32 v211, v211, v210
 v_accvgpr_write_b32 a60, v211
 v_accvgpr_read_b32 v212, a61
 v_mul_f32 v212, v212, v210
 v_accvgpr_write_b32 a61, v212
 v_accvgpr_read_b32 v213, a62
 v_mul_f32 v213, v213, v210
 v_accvgpr_write_b32 a62, v213
 v_accvgpr_read_b32 v211, a63
 v_mul_f32 v211, v211, v210
 v_accvgpr_write_b32 a63, v211
 v_accvgpr_read_b32 v212, a64
 v_mul_f32 v212, v212, v210
 v_accvgpr_write_b32 a64, v212
 v_accvgpr_read_b32 v213, a65
 v_mul_f32 v213, v213, v210
 v_accvgpr_write_b32 a65, v213
 v_accvgpr_read_b32 v211, a66
 v_mul_f32 v211, v211, v210
 v_accvgpr_write_b32 a66, v211
 v_accvgpr_read_b32 v212, a67
 v_mul_f32 v212, v212, v210
 v_accvgpr_write_b32 a67, v212
 v_accvgpr_read_b32 v213, a68
 v_mul_f32 v213, v213, v210
 v_accvgpr_write_b32 a68, v213
 v_accvgpr_read_b32 v211, a69
 v_mul_f32 v211, v211, v210
 v_accvgpr_write_b32 a69, v211
 v_accvgpr_read_b32 v212, a70
 v_mul_f32 v212, v212, v210
 v_accvgpr_write_b32 a70, v212
 v_accvgpr_read_b32 v213, a71
 v_mul_f32 v213, v213, v210
 v_accvgpr_write_b32 a71, v213
 v_accvgpr_read_b32 v211, a72
 v_mul_f32 v211, v211, v210
 v_accvgpr_write_b32 a72, v211
 v_accvgpr_read_b32 v212, a73
 v_mul_f32 v212, v212, v210
 v_accvgpr_write_b32 a73, v212
 v_accvgpr_read_b32 v213, a74
 v_mul_f32 v213, v213, v210
 v_accvgpr_write_b32 a74, v213
 v_accvgpr_read_b32 v211, a75
 v_mul_f32 v211, v211, v210
 v_accvgpr_write_b32 a75, v211
 v_accvgpr_read_b32 v212, a76
 v_mul_f32 v212, v212, v210
 v_accvgpr_write_b32 a76, v212
 v_accvgpr_read_b32 v213, a77
 v_mul_f32 v213, v213, v210
 v_accvgpr_write_b32 a77, v213
 v_accvgpr_read_b32 v211, a78
 v_mul_f32 v211, v211, v210
 v_accvgpr_write_b32 a78, v211
 v_accvgpr_read_b32 v212, a79
 v_mul_f32 v212, v212, v210
 v_accvgpr_write_b32 a79, v212
 v_accvgpr_read_b32 v213, a80
 v_mul_f32 v213, v213, v210
 v_accvgpr_write_b32 a80, v213
 v_accvgpr_read_b32 v211, a81
 v_mul_f32 v211, v211, v210
 v_accvgpr_write_b32 a81, v211
 v_accvgpr_read_b32 v212, a82
 v_mul_f32 v212, v212, v210
 v_accvgpr_write_b32 a82, v212
 v_accvgpr_read_b32 v213, a83
 v_mul_f32 v213, v213, v210
 v_accvgpr_write_b32 a83, v213
 v_accvgpr_read_b32 v211, a84
 v_mul_f32 v211, v211, v210
 v_accvgpr_write_b32 a84, v211
 v_accvgpr_read_b32 v212, a85
 v_mul_f32 v212, v212, v210
 v_accvgpr_write_b32 a85, v212
 v_accvgpr_read_b32 v213, a86
 v_mul_f32 v213, v213, v210
 v_accvgpr_write_b32 a86, v213
 v_accvgpr_read_b32 v211, a87
 v_mul_f32 v211, v211, v210
 v_accvgpr_write_b32 a87, v211
 v_accvgpr_read_b32 v212, a88
 v_mul_f32 v212, v212, v210
 v_accvgpr_write_b32 a88, v212
 v_accvgpr_read_b32 v213, a89
 v_mul_f32 v213, v213, v210
 v_accvgpr_write_b32 a89, v213
 v_accvgpr_read_b32 v211, a90
 v_mul_f32 v211, v211, v210
 v_accvgpr_write_b32 a90, v211
 v_accvgpr_read_b32 v212, a91
 v_mul_f32 v212, v212, v210
 v_accvgpr_write_b32 a91, v212
 v_accvgpr_read_b32 v213, a92
 v_mul_f32 v213, v213, v210
 v_accvgpr_write_b32 a92, v213
 v_accvgpr_read_b32 v211, a93
 v_mul_f32 v211, v211, v210
 v_accvgpr_write_b32 a93, v211
 v_accvgpr_read_b32 v212, a94
 v_mul_f32 v212, v212, v210
 v_accvgpr_write_b32 a94, v212
 v_accvgpr_read_b32 v213, a95
 v_mul_f32 v213, v213, v210
 v_accvgpr_write_b32 a95, v213
 v_max3_f32 v208, v176, v177, v178
 v_max3_f32 v208, v208, v179, v192
 v_max3_f32 v208, v208, v193, v194
 v_max3_f32 v208, v208, v195, 0
 v_mov_b32 v209, v208
 s_nop 1
 v_permlane16_swap_b32 v209, v208
 v_max_f32 v208, v208, v209
 v_mov_b32 v209, v208
 s_nop 1
 v_permlane32_swap_b32 v209, v208
 v_max_f32 v208, v208, v209
 v_sub_f32 v156, v156, v208
 v_sub_f32 v157, v157, v208
 v_sub_f32 v158, v158, v208
 v_sub_f32 v159, v159, v208
 v_sub_f32 v176, v176, v208
 v_sub_f32 v177, v177, v208
 v_sub_f32 v178, v178, v208
 v_sub_f32 v179, v179, v208
 v_sub_f32 v192, v192, v208
 v_sub_f32 v193, v193, v208
 v_sub_f32 v194, v194, v208
 v_sub_f32 v195, v195, v208
 v_sub_f32 v132, v132, v208
 v_sub_f32 v133, v133, v208
 v_sub_f32 v134, v134, v208
 v_sub_f32 v135, v135, v208
 v_sub_f32 v144, v144, v208
 v_sub_f32 v145, v145, v208
 v_sub_f32 v146, v146, v208
 v_sub_f32 v147, v147, v208
 v_sub_f32 v209, 0, v208
 v_exp_f32 v210, v209
 s_nop 0
 v_mul_f32 v202, v202, v210
 v_accvgpr_read_b32 v211, a96
 v_mul_f32 v211, v211, v210
 v_accvgpr_write_b32 a96, v211
 v_accvgpr_read_b32 v212, a97
 v_mul_f32 v212, v212, v210
 v_accvgpr_write_b32 a97, v212
 v_accvgpr_read_b32 v213, a98
 v_mul_f32 v213, v213, v210
 v_accvgpr_write_b32 a98, v213
 v_accvgpr_read_b32 v211, a99
 v_mul_f32 v211, v211, v210
 v_accvgpr_write_b32 a99, v211
 v_accvgpr_read_b32 v212, a100
 v_mul_f32 v212, v212, v210
 v_accvgpr_write_b32 a100, v212
 v_accvgpr_read_b32 v213, a101
 v_mul_f32 v213, v213, v210
 v_accvgpr_write_b32 a101, v213
 v_accvgpr_read_b32 v211, a102
 v_mul_f32 v211, v211, v210
 v_accvgpr_write_b32 a102, v211
 v_accvgpr_read_b32 v212, a103
 v_mul_f32 v212, v212, v210
 v_accvgpr_write_b32 a103, v212
 v_accvgpr_read_b32 v213, a104
 v_mul_f32 v213, v213, v210
 v_accvgpr_write_b32 a104, v213
 v_accvgpr_read_b32 v211, a105
 v_mul_f32 v211, v211, v210
 v_accvgpr_write_b32 a105, v211
 v_accvgpr_read_b32 v212, a106
 v_mul_f32 v212, v212, v210
 v_accvgpr_write_b32 a106, v212
 v_accvgpr_read_b32 v213, a107
 v_mul_f32 v213, v213, v210
 v_accvgpr_write_b32 a107, v213
 v_accvgpr_read_b32 v211, a108
 v_mul_f32 v211, v211, v210
 v_accvgpr_write_b32 a108, v211
 v_accvgpr_read_b32 v212, a109
 v_mul_f32 v212, v212, v210
 v_accvgpr_write_b32 a109, v212
 v_accvgpr_read_b32 v213, a110
 v_mul_f32 v213, v213, v210
 v_accvgpr_write_b32 a110, v213
 v_accvgpr_read_b32 v211, a111
 v_mul_f32 v211, v211, v210
 v_accvgpr_write_b32 a111, v211
 v_accvgpr_read_b32 v212, a112
 v_mul_f32 v212, v212, v210
 v_accvgpr_write_b32 a112, v212
 v_accvgpr_read_b32 v213, a113
 v_mul_f32 v213, v213, v210
 v_accvgpr_write_b32 a113, v213
 v_accvgpr_read_b32 v211, a114
 v_mul_f32 v211, v211, v210
 v_accvgpr_write_b32 a114, v211
 v_accvgpr_read_b32 v212, a115
 v_mul_f32 v212, v212, v210
 v_accvgpr_write_b32 a115, v212
 v_accvgpr_read_b32 v213, a116
 v_mul_f32 v213, v213, v210
 v_accvgpr_write_b32 a116, v213
 v_accvgpr_read_b32 v211, a117
 v_mul_f32 v211, v211, v210
 v_accvgpr_write_b32 a117, v211
 v_accvgpr_read_b32 v212, a118
 v_mul_f32 v212, v212, v210
 v_accvgpr_write_b32 a118, v212
 v_accvgpr_read_b32 v213, a119
 v_mul_f32 v213, v213, v210
 v_accvgpr_write_b32 a119, v213
 v_accvgpr_read_b32 v211, a120
 v_mul_f32 v211, v211, v210
 v_accvgpr_write_b32 a120, v211
 v_accvgpr_read_b32 v212, a121
 v_mul_f32 v212, v212, v210
 v_accvgpr_write_b32 a121, v212
 v_accvgpr_read_b32 v213, a122
 v_mul_f32 v213, v213, v210
 v_accvgpr_write_b32 a122, v213
 v_accvgpr_read_b32 v211, a123
 v_mul_f32 v211, v211, v210
 v_accvgpr_write_b32 a123, v211
 v_accvgpr_read_b32 v212, a124
 v_mul_f32 v212, v212, v210
 v_accvgpr_write_b32 a124, v212
 v_accvgpr_read_b32 v213, a125
 v_mul_f32 v213, v213, v210
 v_accvgpr_write_b32 a125, v213
 v_accvgpr_read_b32 v211, a126
 v_mul_f32 v211, v211, v210
 v_accvgpr_write_b32 a126, v211
 v_accvgpr_read_b32 v212, a127
 v_mul_f32 v212, v212, v210
 v_accvgpr_write_b32 a127, v212
 v_accvgpr_read_b32 v213, a128
 v_mul_f32 v213, v213, v210
 v_accvgpr_write_b32 a128, v213
 v_accvgpr_read_b32 v211, a129
 v_mul_f32 v211, v211, v210
 v_accvgpr_write_b32 a129, v211
 v_accvgpr_read_b32 v212, a130
 v_mul_f32 v212, v212, v210
 v_accvgpr_write_b32 a130, v212
 v_accvgpr_read_b32 v213, a131
 v_mul_f32 v213, v213, v210
 v_accvgpr_write_b32 a131, v213
 v_accvgpr_read_b32 v211, a132
 v_mul_f32 v211, v211, v210
 v_accvgpr_write_b32 a132, v211
 v_accvgpr_read_b32 v212, a133
 v_mul_f32 v212, v212, v210
 v_accvgpr_write_b32 a133, v212
 v_accvgpr_read_b32 v213, a134
 v_mul_f32 v213, v213, v210
 v_accvgpr_write_b32 a134, v213
 v_accvgpr_read_b32 v211, a135
 v_mul_f32 v211, v211, v210
 v_accvgpr_write_b32 a135, v211
 v_accvgpr_read_b32 v212, a136
 v_mul_f32 v212, v212, v210
 v_accvgpr_write_b32 a136, v212
 v_accvgpr_read_b32 v213, a137
 v_mul_f32 v213, v213, v210
 v_accvgpr_write_b32 a137, v213
 v_accvgpr_read_b32 v211, a138
 v_mul_f32 v211, v211, v210
 v_accvgpr_write_b32 a138, v211
 v_accvgpr_read_b32 v212, a139
 v_mul_f32 v212, v212, v210
 v_accvgpr_write_b32 a139, v212
 v_accvgpr_read_b32 v213, a140
 v_mul_f32 v213, v213, v210
 v_accvgpr_write_b32 a140, v213
 v_accvgpr_read_b32 v211, a141
 v_mul_f32 v211, v211, v210
 v_accvgpr_write_b32 a141, v211
 v_accvgpr_read_b32 v212, a142
 v_mul_f32 v212, v212, v210
 v_accvgpr_write_b32 a142, v212
 v_accvgpr_read_b32 v213, a143
 v_mul_f32 v213, v213, v210
 v_accvgpr_write_b32 a143, v213
 v_max3_f32 v208, v180, v181, v182
 v_max3_f32 v208, v208, v183, v196
 v_max3_f32 v208, v208, v197, v198
 v_max3_f32 v208, v208, v199, 0
 v_mov_b32 v209, v208
 s_nop 1
 v_permlane16_swap_b32 v209, v208
 v_max_f32 v208, v208, v209
 v_mov_b32 v209, v208
 s_nop 1
 v_permlane32_swap_b32 v209, v208
 v_max_f32 v208, v208, v209
 v_sub_f32 v160, v160, v208
 v_sub_f32 v161, v161, v208
 v_sub_f32 v162, v162, v208
 v_sub_f32 v163, v163, v208
 v_sub_f32 v180, v180, v208
 v_sub_f32 v181, v181, v208
 v_sub_f32 v182, v182, v208
 v_sub_f32 v183, v183, v208
 v_sub_f32 v196, v196, v208
 v_sub_f32 v197, v197, v208
 v_sub_f32 v198, v198, v208
 v_sub_f32 v199, v199, v208
 v_sub_f32 v209, 0, v208
 v_exp_f32 v210, v209
 s_nop 0
 v_mul_f32 v203, v203, v210
 v_accvgpr_read_b32 v211, a144
 v_mul_f32 v211, v211, v210
 v_accvgpr_write_b32 a144, v211
 v_accvgpr_read_b32 v212, a145
 v_mul_f32 v212, v212, v210
 v_accvgpr_write_b32 a145, v212
 v_accvgpr_read_b32 v213, a146
 v_mul_f32 v213, v213, v210
 v_accvgpr_write_b32 a146, v213
 v_accvgpr_read_b32 v211, a147
 v_mul_f32 v211, v211, v210
 v_accvgpr_write_b32 a147, v211
 v_accvgpr_read_b32 v212, a148
 v_mul_f32 v212, v212, v210
 v_accvgpr_write_b32 a148, v212
 v_accvgpr_read_b32 v213, a149
 v_mul_f32 v213, v213, v210
 v_accvgpr_write_b32 a149, v213
 v_accvgpr_read_b32 v211, a150
 v_mul_f32 v211, v211, v210
 v_accvgpr_write_b32 a150, v211
 v_accvgpr_read_b32 v212, a151
 v_mul_f32 v212, v212, v210
 v_accvgpr_write_b32 a151, v212
 v_accvgpr_read_b32 v213, a152
 v_mul_f32 v213, v213, v210
 v_accvgpr_write_b32 a152, v213
 v_accvgpr_read_b32 v211, a153
 v_mul_f32 v211, v211, v210
 v_accvgpr_write_b32 a153, v211
 v_accvgpr_read_b32 v212, a154
 v_mul_f32 v212, v212, v210
 v_accvgpr_write_b32 a154, v212
 v_accvgpr_read_b32 v213, a155
 v_mul_f32 v213, v213, v210
 v_accvgpr_write_b32 a155, v213
 v_accvgpr_read_b32 v211, a156
 v_mul_f32 v211, v211, v210
 v_accvgpr_write_b32 a156, v211
 v_accvgpr_read_b32 v212, a157
 v_mul_f32 v212, v212, v210
 v_accvgpr_write_b32 a157, v212
 v_accvgpr_read_b32 v213, a158
 v_mul_f32 v213, v213, v210
 v_accvgpr_write_b32 a158, v213
 v_accvgpr_read_b32 v211, a159
 v_mul_f32 v211, v211, v210
 v_accvgpr_write_b32 a159, v211
 v_accvgpr_read_b32 v212, a160
 v_mul_f32 v212, v212, v210
 v_accvgpr_write_b32 a160, v212
 v_accvgpr_read_b32 v213, a161
 v_mul_f32 v213, v213, v210
 v_accvgpr_write_b32 a161, v213
 v_accvgpr_read_b32 v211, a162
 v_mul_f32 v211, v211, v210
 v_accvgpr_write_b32 a162, v211
 v_accvgpr_read_b32 v212, a163
 v_mul_f32 v212, v212, v210
 v_accvgpr_write_b32 a163, v212
 v_accvgpr_read_b32 v213, a164
 v_mul_f32 v213, v213, v210
 v_accvgpr_write_b32 a164, v213
 v_accvgpr_read_b32 v211, a165
 v_mul_f32 v211, v211, v210
 v_accvgpr_write_b32 a165, v211
 v_accvgpr_read_b32 v212, a166
 v_mul_f32 v212, v212, v210
 v_accvgpr_write_b32 a166, v212
 v_accvgpr_read_b32 v213, a167
 v_mul_f32 v213, v213, v210
 v_accvgpr_write_b32 a167, v213
 v_accvgpr_read_b32 v211, a168
 v_mul_f32 v211, v211, v210
 v_accvgpr_write_b32 a168, v211
 v_accvgpr_read_b32 v212, a169
 v_mul_f32 v212, v212, v210
 v_accvgpr_write_b32 a169, v212
 v_accvgpr_read_b32 v213, a170
 v_mul_f32 v213, v213, v210
 v_accvgpr_write_b32 a170, v213
 v_accvgpr_read_b32 v211, a171
 v_mul_f32 v211, v211, v210
 v_accvgpr_write_b32 a171, v211
 v_accvgpr_read_b32 v212, a172
 v_mul_f32 v212, v212, v210
 v_accvgpr_write_b32 a172, v212
 v_accvgpr_read_b32 v213, a173
 v_mul_f32 v213, v213, v210
 v_accvgpr_write_b32 a173, v213
 v_accvgpr_read_b32 v211, a174
 v_mul_f32 v211, v211, v210
 v_accvgpr_write_b32 a174, v211
 v_accvgpr_read_b32 v212, a175
 v_mul_f32 v212, v212, v210
 v_accvgpr_write_b32 a175, v212
 v_accvgpr_read_b32 v213, a176
 v_mul_f32 v213, v213, v210
 v_accvgpr_write_b32 a176, v213
 v_accvgpr_read_b32 v211, a177
 v_mul_f32 v211, v211, v210
 v_accvgpr_write_b32 a177, v211
 v_accvgpr_read_b32 v212, a178
 v_mul_f32 v212, v212, v210
 v_accvgpr_write_b32 a178, v212
 v_accvgpr_read_b32 v213, a179
 v_mul_f32 v213, v213, v210
 v_accvgpr_write_b32 a179, v213
 v_accvgpr_read_b32 v211, a180
 v_mul_f32 v211, v211, v210
 v_accvgpr_write_b32 a180, v211
 v_accvgpr_read_b32 v212, a181
 v_mul_f32 v212, v212, v210
 v_accvgpr_write_b32 a181, v212
 v_accvgpr_read_b32 v213, a182
 v_mul_f32 v213, v213, v210
 v_accvgpr_write_b32 a182, v213
 v_accvgpr_read_b32 v211, a183
 v_mul_f32 v211, v211, v210
 v_accvgpr_write_b32 a183, v211
 v_accvgpr_read_b32 v212, a184
 v_mul_f32 v212, v212, v210
 v_accvgpr_write_b32 a184, v212
 v_accvgpr_read_b32 v213, a185
 v_mul_f32 v213, v213, v210
 v_accvgpr_write_b32 a185, v213
 v_accvgpr_read_b32 v211, a186
 v_mul_f32 v211, v211, v210
 v_accvgpr_write_b32 a186, v211
 v_accvgpr_read_b32 v212, a187
 v_mul_f32 v212, v212, v210
 v_accvgpr_write_b32 a187, v212
 v_accvgpr_read_b32 v213, a188
 v_mul_f32 v213, v213, v210
 v_accvgpr_write_b32 a188, v213
 v_accvgpr_read_b32 v211, a189
 v_mul_f32 v211, v211, v210
 v_accvgpr_write_b32 a189, v211
 v_accvgpr_read_b32 v212, a190
 v_mul_f32 v212, v212, v210
 v_accvgpr_write_b32 a190, v212
 v_accvgpr_read_b32 v213, a191
 v_mul_f32 v213, v213, v210
 v_accvgpr_write_b32 a191, v213
 v_exp_f32 v208, v168
 v_exp_f32 v209, v169
 s_nop 0
 v_add_f32 v204, v208, v209
 v_cvt_pk_bf16_f32 v96, v208, v209
 v_exp_f32 v210, v170
 v_exp_f32 v211, v171
 v_add_f32 v204, v204, v210
 v_add_f32 v204, v204, v211
 v_cvt_pk_bf16_f32 v97, v210, v211
 v_exp_f32 v212, v172
 v_exp_f32 v213, v173
 s_nop 0
 v_add_f32 v205, v212, v213
 v_cvt_pk_bf16_f32 v100, v212, v213
 v_exp_f32 v208, v174
 v_exp_f32 v209, v175
 v_add_f32 v205, v205, v208
 v_add_f32 v205, v205, v209
 v_cvt_pk_bf16_f32 v101, v208, v209
 v_exp_f32 v210, v176
 v_exp_f32 v211, v177
 s_nop 0
 v_add_f32 v206, v210, v211
 v_cvt_pk_bf16_f32 v104, v210, v211
 v_exp_f32 v212, v178
 v_exp_f32 v213, v179
 v_add_f32 v206, v206, v212
 v_add_f32 v206, v206, v213
 v_cvt_pk_bf16_f32 v105, v212, v213
 v_exp_f32 v208, v180
 v_exp_f32 v209, v181
 s_nop 0
 v_add_f32 v207, v208, v209
 v_cvt_pk_bf16_f32 v108, v208, v209
 v_exp_f32 v210, v182
 v_exp_f32 v211, v183
 v_add_f32 v207, v207, v210
 v_add_f32 v207, v207, v211
 v_cvt_pk_bf16_f32 v109, v210, v211
 v_exp_f32 v212, v184
 v_exp_f32 v213, v185
 v_add_f32 v204, v204, v212
 v_add_f32 v204, v204, v213
 v_cvt_pk_bf16_f32 v98, v212, v213
 v_exp_f32 v208, v186
 v_exp_f32 v209, v187
 v_add_f32 v204, v204, v208
 v_add_f32 v204, v204, v209
 v_cvt_pk_bf16_f32 v99, v208, v209
 v_exp_f32 v210, v188
 v_exp_f32 v211, v189
 v_add_f32 v205, v205, v210
 v_add_f32 v205, v205, v211
 v_cvt_pk_bf16_f32 v102, v210, v211
 v_exp_f32 v212, v190
 v_exp_f32 v213, v191
 v_add_f32 v205, v205, v212
 v_add_f32 v205, v205, v213
 v_cvt_pk_bf16_f32 v103, v212, v213
 v_exp_f32 v208, v192
 v_exp_f32 v209, v193
 v_add_f32 v206, v206, v208
 v_add_f32 v206, v206, v209
 v_cvt_pk_bf16_f32 v106, v208, v209
 v_exp_f32 v210, v194
 v_exp_f32 v211, v195
 v_add_f32 v206, v206, v210
 v_add_f32 v206, v206, v211
 v_cvt_pk_bf16_f32 v107, v210, v211
 v_exp_f32 v212, v196
 v_exp_f32 v213, v197
 v_add_f32 v207, v207, v212
 v_add_f32 v207, v207, v213
 v_cvt_pk_bf16_f32 v110, v212, v213
 v_exp_f32 v208, v198
 v_exp_f32 v209, v199
 v_add_f32 v207, v207, v208
 v_add_f32 v207, v207, v209
 v_cvt_pk_bf16_f32 v111, v208, v209
 s_nop 3
 s_setpc_b64 s[30:31]
K1_fb1:
 s_nop 7
 s_nop 7
 v_max3_f32 v208, v124, v125, v126
 v_max3_f32 v208, v208, v127, v136
 v_max3_f32 v208, v208, v137, v138
 v_max3_f32 v208, v208, v139, 0
 v_mov_b32 v209, v208
 s_nop 1
 v_permlane16_swap_b32 v209, v208
 v_max_f32 v208, v208, v209
 v_mov_b32 v209, v208
 s_nop 1
 v_permlane32_swap_b32 v209, v208
 v_max_f32 v208, v208, v209
 v_sub_f32 v148, v148, v208
 v_sub_f32 v149, v149, v208
 v_sub_f32 v150, v150, v208
 v_sub_f32 v151, v151, v208
 v_sub_f32 v124, v124, v208
 v_sub_f32 v125, v125, v208
 v_sub_f32 v126, v126, v208
 v_sub_f32 v127, v127, v208
 v_sub_f32 v136, v136, v208
 v_sub_f32 v137, v137, v208
 v_sub_f32 v138, v138, v208
 v_sub_f32 v139, v139, v208
 v_sub_f32 v168, v168, v208
 v_sub_f32 v169, v169, v208
 v_sub_f32 v170, v170, v208
 v_sub_f32 v171, v171, v208
 v_sub_f32 v209, 0, v208
 v_exp_f32 v210, v209
 s_nop 0
 v_mul_f32 v200, v200, v210
 v_accvgpr_read_b32 v211, a0
 v_mul_f32 v211, v211, v210
 v_accvgpr_write_b32 a0, v211
 v_accvgpr_read_b32 v212, a1
 v_mul_f32 v212, v212, v210
 v_accvgpr_write_b32 a1, v212
 v_accvgpr_read_b32 v213, a2
 v_mul_f32 v213, v213, v210
 v_accvgpr_write_b32 a2, v213
 v_accvgpr_read_b32 v211, a3
 v_mul_f32 v211, v211, v210
 v_accvgpr_write_b32 a3, v211
 v_accvgpr_read_b32 v212, a4
 v_mul_f32 v212, v212, v210
 v_accvgpr_write_b32 a4, v212
 v_accvgpr_read_b32 v213, a5
 v_mul_f32 v213, v213, v210
 v_accvgpr_write_b32 a5, v213
 v_accvgpr_read_b32 v211, a6
 v_mul_f32 v211, v211, v210
 v_accvgpr_write_b32 a6, v211
 v_accvgpr_read_b32 v212, a7
 v_mul_f32 v212, v212, v210
 v_accvgpr_write_b32 a7, v212
 v_accvgpr_read_b32 v213, a8
 v_mul_f32 v213, v213, v210
 v_accvgpr_write_b32 a8, v213
 v_accvgpr_read_b32 v211, a9
 v_mul_f32 v211, v211, v210
 v_accvgpr_write_b32 a9, v211
 v_accvgpr_read_b32 v212, a10
 v_mul_f32 v212, v212, v210
 v_accvgpr_write_b32 a10, v212
 v_accvgpr_read_b32 v213, a11
 v_mul_f32 v213, v213, v210
 v_accvgpr_write_b32 a11, v213
 v_accvgpr_read_b32 v211, a12
 v_mul_f32 v211, v211, v210
 v_accvgpr_write_b32 a12, v211
 v_accvgpr_read_b32 v212, a13
 v_mul_f32 v212, v212, v210
 v_accvgpr_write_b32 a13, v212
 v_accvgpr_read_b32 v213, a14
 v_mul_f32 v213, v213, v210
 v_accvgpr_write_b32 a14, v213
 v_accvgpr_read_b32 v211, a15
 v_mul_f32 v211, v211, v210
 v_accvgpr_write_b32 a15, v211
 v_accvgpr_read_b32 v212, a16
 v_mul_f32 v212, v212, v210
 v_accvgpr_write_b32 a16, v212
 v_accvgpr_read_b32 v213, a17
 v_mul_f32 v213, v213, v210
 v_accvgpr_write_b32 a17, v213
 v_accvgpr_read_b32 v211, a18
 v_mul_f32 v211, v211, v210
 v_accvgpr_write_b32 a18, v211
 v_accvgpr_read_b32 v212, a19
 v_mul_f32 v212, v212, v210
 v_accvgpr_write_b32 a19, v212
 v_accvgpr_read_b32 v213, a20
 v_mul_f32 v213, v213, v210
 v_accvgpr_write_b32 a20, v213
 v_accvgpr_read_b32 v211, a21
 v_mul_f32 v211, v211, v210
 v_accvgpr_write_b32 a21, v211
 v_accvgpr_read_b32 v212, a22
 v_mul_f32 v212, v212, v210
 v_accvgpr_write_b32 a22, v212
 v_accvgpr_read_b32 v213, a23
 v_mul_f32 v213, v213, v210
 v_accvgpr_write_b32 a23, v213
 v_accvgpr_read_b32 v211, a24
 v_mul_f32 v211, v211, v210
 v_accvgpr_write_b32 a24, v211
 v_accvgpr_read_b32 v212, a25
 v_mul_f32 v212, v212, v210
 v_accvgpr_write_b32 a25, v212
 v_accvgpr_read_b32 v213, a26
 v_mul_f32 v213, v213, v210
 v_accvgpr_write_b32 a26, v213
 v_accvgpr_read_b32 v211, a27
 v_mul_f32 v211, v211, v210
 v_accvgpr_write_b32 a27, v211
 v_accvgpr_read_b32 v212, a28
 v_mul_f32 v212, v212, v210
 v_accvgpr_write_b32 a28, v212
 v_accvgpr_read_b32 v213, a29
 v_mul_f32 v213, v213, v210
 v_accvgpr_write_b32 a29, v213
 v_accvgpr_read_b32 v211, a30
 v_mul_f32 v211, v211, v210
 v_accvgpr_write_b32 a30, v211
 v_accvgpr_read_b32 v212, a31
 v_mul_f32 v212, v212, v210
 v_accvgpr_write_b32 a31, v212
 v_accvgpr_read_b32 v213, a32
 v_mul_f32 v213, v213, v210
 v_accvgpr_write_b32 a32, v213
 v_accvgpr_read_b32 v211, a33
 v_mul_f32 v211, v211, v210
 v_accvgpr_write_b32 a33, v211
 v_accvgpr_read_b32 v212, a34
 v_mul_f32 v212, v212, v210
 v_accvgpr_write_b32 a34, v212
 v_accvgpr_read_b32 v213, a35
 v_mul_f32 v213, v213, v210
 v_accvgpr_write_b32 a35, v213
 v_accvgpr_read_b32 v211, a36
 v_mul_f32 v211, v211, v210
 v_accvgpr_write_b32 a36, v211
 v_accvgpr_read_b32 v212, a37
 v_mul_f32 v212, v212, v210
 v_accvgpr_write_b32 a37, v212
 v_accvgpr_read_b32 v213, a38
 v_mul_f32 v213, v213, v210
 v_accvgpr_write_b32 a38, v213
 v_accvgpr_read_b32 v211, a39
 v_mul_f32 v211, v211, v210
 v_accvgpr_write_b32 a39, v211
 v_accvgpr_read_b32 v212, a40
 v_mul_f32 v212, v212, v210
 v_accvgpr_write_b32 a40, v212
 v_accvgpr_read_b32 v213, a41
 v_mul_f32 v213, v213, v210
 v_accvgpr_write_b32 a41, v213
 v_accvgpr_read_b32 v211, a42
 v_mul_f32 v211, v211, v210
 v_accvgpr_write_b32 a42, v211
 v_accvgpr_read_b32 v212, a43
 v_mul_f32 v212, v212, v210
 v_accvgpr_write_b32 a43, v212
 v_accvgpr_read_b32 v213, a44
 v_mul_f32 v213, v213, v210
 v_accvgpr_write_b32 a44, v213
 v_accvgpr_read_b32 v211, a45
 v_mul_f32 v211, v211, v210
 v_accvgpr_write_b32 a45, v211
 v_accvgpr_read_b32 v212, a46
 v_mul_f32 v212, v212, v210
 v_accvgpr_write_b32 a46, v212
 v_accvgpr_read_b32 v213, a47
 v_mul_f32 v213, v213, v210
 v_accvgpr_write_b32 a47, v213
 v_max3_f32 v208, v128, v129, v130
 v_max3_f32 v208, v208, v131, v140
 v_max3_f32 v208, v208, v141, v142
 v_max3_f32 v208, v208, v143, 0
 v_mov_b32 v209, v208
 s_nop 1
 v_permlane16_swap_b32 v209, v208
 v_max_f32 v208, v208, v209
 v_mov_b32 v209, v208
 s_nop 1
 v_permlane32_swap_b32 v209, v208
 v_max_f32 v208, v208, v209
 v_sub_f32 v152, v152, v208
 v_sub_f32 v153, v153, v208
 v_sub_f32 v154, v154, v208
 v_sub_f32 v155, v155, v208
 v_sub_f32 v128, v128, v208
 v_sub_f32 v129, v129, v208
 v_sub_f32 v130, v130, v208
 v_sub_f32 v131, v131, v208
 v_sub_f32 v140, v140, v208
 v_sub_f32 v141, v141, v208
 v_sub_f32 v142, v142, v208
 v_sub_f32 v143, v143, v208
 v_sub_f32 v172, v172, v208
 v_sub_f32 v173, v173, v208
 v_sub_f32 v174, v174, v208
 v_sub_f32 v175, v175, v208
 v_sub_f32 v209, 0, v208
 v_exp_f32 v210, v209
 s_nop 0
 v_mul_f32 v201, v201, v210
 v_accvgpr_read_b32 v211, a48
 v_mul_f32 v211, v211, v210
 v_accvgpr_write_b32 a48, v211
 v_accvgpr_read_b32 v212, a49
 v_mul_f32 v212, v212, v210
 v_accvgpr_write_b32 a49, v212
 v_accvgpr_read_b32 v213, a50
 v_mul_f32 v213, v213, v210
 v_accvgpr_write_b32 a50, v213
 v_accvgpr_read_b32 v211, a51
 v_mul_f32 v211, v211, v210
 v_accvgpr_write_b32 a51, v211
 v_accvgpr_read_b32 v212, a52
 v_mul_f32 v212, v212, v210
 v_accvgpr_write_b32 a52, v212
 v_accvgpr_read_b32 v213, a53
 v_mul_f32 v213, v213, v210
 v_accvgpr_write_b32 a53, v213
 v_accvgpr_read_b32 v211, a54
 v_mul_f32 v211, v211, v210
 v_accvgpr_write_b32 a54, v211
 v_accvgpr_read_b32 v212, a55
 v_mul_f32 v212, v212, v210
 v_accvgpr_write_b32 a55, v212
 v_accvgpr_read_b32 v213, a56
 v_mul_f32 v213, v213, v210
 v_accvgpr_write_b32 a56, v213
 v_accvgpr_read_b32 v211, a57
 v_mul_f32 v211, v211, v210
 v_accvgpr_write_b32 a57, v211
 v_accvgpr_read_b32 v212, a58
 v_mul_f32 v212, v212, v210
 v_accvgpr_write_b32 a58, v212
 v_accvgpr_read_b32 v213, a59
 v_mul_f32 v213, v213, v210
 v_accvgpr_write_b32 a59, v213
 v_accvgpr_read_b32 v211, a60
 v_mul_f32 v211, v211, v210
 v_accvgpr_write_b32 a60, v211
 v_accvgpr_read_b32 v212, a61
 v_mul_f32 v212, v212, v210
 v_accvgpr_write_b32 a61, v212
 v_accvgpr_read_b32 v213, a62
 v_mul_f32 v213, v213, v210
 v_accvgpr_write_b32 a62, v213
 v_accvgpr_read_b32 v211, a63
 v_mul_f32 v211, v211, v210
 v_accvgpr_write_b32 a63, v211
 v_accvgpr_read_b32 v212, a64
 v_mul_f32 v212, v212, v210
 v_accvgpr_write_b32 a64, v212
 v_accvgpr_read_b32 v213, a65
 v_mul_f32 v213, v213, v210
 v_accvgpr_write_b32 a65, v213
 v_accvgpr_read_b32 v211, a66
 v_mul_f32 v211, v211, v210
 v_accvgpr_write_b32 a66, v211
 v_accvgpr_read_b32 v212, a67
 v_mul_f32 v212, v212, v210
 v_accvgpr_write_b32 a67, v212
 v_accvgpr_read_b32 v213, a68
 v_mul_f32 v213, v213, v210
 v_accvgpr_write_b32 a68, v213
 v_accvgpr_read_b32 v211, a69
 v_mul_f32 v211, v211, v210
 v_accvgpr_write_b32 a69, v211
 v_accvgpr_read_b32 v212, a70
 v_mul_f32 v212, v212, v210
 v_accvgpr_write_b32 a70, v212
 v_accvgpr_read_b32 v213, a71
 v_mul_f32 v213, v213, v210
 v_accvgpr_write_b32 a71, v213
 v_accvgpr_read_b32 v211, a72
 v_mul_f32 v211, v211, v210
 v_accvgpr_write_b32 a72, v211
 v_accvgpr_read_b32 v212, a73
 v_mul_f32 v212, v212, v210
 v_accvgpr_write_b32 a73, v212
 v_accvgpr_read_b32 v213, a74
 v_mul_f32 v213, v213, v210
 v_accvgpr_write_b32 a74, v213
 v_accvgpr_read_b32 v211, a75
 v_mul_f32 v211, v211, v210
 v_accvgpr_write_b32 a75, v211
 v_accvgpr_read_b32 v212, a76
 v_mul_f32 v212, v212, v210
 v_accvgpr_write_b32 a76, v212
 v_accvgpr_read_b32 v213, a77
 v_mul_f32 v213, v213, v210
 v_accvgpr_write_b32 a77, v213
 v_accvgpr_read_b32 v211, a78
 v_mul_f32 v211, v211, v210
 v_accvgpr_write_b32 a78, v211
 v_accvgpr_read_b32 v212, a79
 v_mul_f32 v212, v212, v210
 v_accvgpr_write_b32 a79, v212
 v_accvgpr_read_b32 v213, a80
 v_mul_f32 v213, v213, v210
 v_accvgpr_write_b32 a80, v213
 v_accvgpr_read_b32 v211, a81
 v_mul_f32 v211, v211, v210
 v_accvgpr_write_b32 a81, v211
 v_accvgpr_read_b32 v212, a82
 v_mul_f32 v212, v212, v210
 v_accvgpr_write_b32 a82, v212
 v_accvgpr_read_b32 v213, a83
 v_mul_f32 v213, v213, v210
 v_accvgpr_write_b32 a83, v213
 v_accvgpr_read_b32 v211, a84
 v_mul_f32 v211, v211, v210
 v_accvgpr_write_b32 a84, v211
 v_accvgpr_read_b32 v212, a85
 v_mul_f32 v212, v212, v210
 v_accvgpr_write_b32 a85, v212
 v_accvgpr_read_b32 v213, a86
 v_mul_f32 v213, v213, v210
 v_accvgpr_write_b32 a86, v213
 v_accvgpr_read_b32 v211, a87
 v_mul_f32 v211, v211, v210
 v_accvgpr_write_b32 a87, v211
 v_accvgpr_read_b32 v212, a88
 v_mul_f32 v212, v212, v210
 v_accvgpr_write_b32 a88, v212
 v_accvgpr_read_b32 v213, a89
 v_mul_f32 v213, v213, v210
 v_accvgpr_write_b32 a89, v213
 v_accvgpr_read_b32 v211, a90
 v_mul_f32 v211, v211, v210
 v_accvgpr_write_b32 a90, v211
 v_accvgpr_read_b32 v212, a91
 v_mul_f32 v212, v212, v210
 v_accvgpr_write_b32 a91, v212
 v_accvgpr_read_b32 v213, a92
 v_mul_f32 v213, v213, v210
 v_accvgpr_write_b32 a92, v213
 v_accvgpr_read_b32 v211, a93
 v_mul_f32 v211, v211, v210
 v_accvgpr_write_b32 a93, v211
 v_accvgpr_read_b32 v212, a94
 v_mul_f32 v212, v212, v210
 v_accvgpr_write_b32 a94, v212
 v_accvgpr_read_b32 v213, a95
 v_mul_f32 v213, v213, v210
 v_accvgpr_write_b32 a95, v213
 v_max3_f32 v208, v132, v133, v134
 v_max3_f32 v208, v208, v135, v144
 v_max3_f32 v208, v208, v145, v146
 v_max3_f32 v208, v208, v147, 0
 v_mov_b32 v209, v208
 s_nop 1
 v_permlane16_swap_b32 v209, v208
 v_max_f32 v208, v208, v209
 v_mov_b32 v209, v208
 s_nop 1
 v_permlane32_swap_b32 v209, v208
 v_max_f32 v208, v208, v209
 v_sub_f32 v156, v156, v208
 v_sub_f32 v157, v157, v208
 v_sub_f32 v158, v158, v208
 v_sub_f32 v159, v159, v208
 v_sub_f32 v132, v132, v208
 v_sub_f32 v133, v133, v208
 v_sub_f32 v134, v134, v208
 v_sub_f32 v135, v135, v208
 v_sub_f32 v144, v144, v208
 v_sub_f32 v145, v145, v208
 v_sub_f32 v146, v146, v208
 v_sub_f32 v147, v147, v208
 v_sub_f32 v176, v176, v208
 v_sub_f32 v177, v177, v208
 v_sub_f32 v178, v178, v208
 v_sub_f32 v179, v179, v208
 v_sub_f32 v209, 0, v208
 v_exp_f32 v210, v209
 s_nop 0
 v_mul_f32 v202, v202, v210
 v_accvgpr_read_b32 v211, a96
 v_mul_f32 v211, v211, v210
 v_accvgpr_write_b32 a96, v211
 v_accvgpr_read_b32 v212, a97
 v_mul_f32 v212, v212, v210
 v_accvgpr_write_b32 a97, v212
 v_accvgpr_read_b32 v213, a98
 v_mul_f32 v213, v213, v210
 v_accvgpr_write_b32 a98, v213
 v_accvgpr_read_b32 v211, a99
 v_mul_f32 v211, v211, v210
 v_accvgpr_write_b32 a99, v211
 v_accvgpr_read_b32 v212, a100
 v_mul_f32 v212, v212, v210
 v_accvgpr_write_b32 a100, v212
 v_accvgpr_read_b32 v213, a101
 v_mul_f32 v213, v213, v210
 v_accvgpr_write_b32 a101, v213
 v_accvgpr_read_b32 v211, a102
 v_mul_f32 v211, v211, v210
 v_accvgpr_write_b32 a102, v211
 v_accvgpr_read_b32 v212, a103
 v_mul_f32 v212, v212, v210
 v_accvgpr_write_b32 a103, v212
 v_accvgpr_read_b32 v213, a104
 v_mul_f32 v213, v213, v210
 v_accvgpr_write_b32 a104, v213
 v_accvgpr_read_b32 v211, a105
 v_mul_f32 v211, v211, v210
 v_accvgpr_write_b32 a105, v211
 v_accvgpr_read_b32 v212, a106
 v_mul_f32 v212, v212, v210
 v_accvgpr_write_b32 a106, v212
 v_accvgpr_read_b32 v213, a107
 v_mul_f32 v213, v213, v210
 v_accvgpr_write_b32 a107, v213
 v_accvgpr_read_b32 v211, a108
 v_mul_f32 v211, v211, v210
 v_accvgpr_write_b32 a108, v211
 v_accvgpr_read_b32 v212, a109
 v_mul_f32 v212, v212, v210
 v_accvgpr_write_b32 a109, v212
 v_accvgpr_read_b32 v213, a110
 v_mul_f32 v213, v213, v210
 v_accvgpr_write_b32 a110, v213
 v_accvgpr_read_b32 v211, a111
 v_mul_f32 v211, v211, v210
 v_accvgpr_write_b32 a111, v211
 v_accvgpr_read_b32 v212, a112
 v_mul_f32 v212, v212, v210
 v_accvgpr_write_b32 a112, v212
 v_accvgpr_read_b32 v213, a113
 v_mul_f32 v213, v213, v210
 v_accvgpr_write_b32 a113, v213
 v_accvgpr_read_b32 v211, a114
 v_mul_f32 v211, v211, v210
 v_accvgpr_write_b32 a114, v211
 v_accvgpr_read_b32 v212, a115
 v_mul_f32 v212, v212, v210
 v_accvgpr_write_b32 a115, v212
 v_accvgpr_read_b32 v213, a116
 v_mul_f32 v213, v213, v210
 v_accvgpr_write_b32 a116, v213
 v_accvgpr_read_b32 v211, a117
 v_mul_f32 v211, v211, v210
 v_accvgpr_write_b32 a117, v211
 v_accvgpr_read_b32 v212, a118
 v_mul_f32 v212, v212, v210
 v_accvgpr_write_b32 a118, v212
 v_accvgpr_read_b32 v213, a119
 v_mul_f32 v213, v213, v210
 v_accvgpr_write_b32 a119, v213
 v_accvgpr_read_b32 v211, a120
 v_mul_f32 v211, v211, v210
 v_accvgpr_write_b32 a120, v211
 v_accvgpr_read_b32 v212, a121
 v_mul_f32 v212, v212, v210
 v_accvgpr_write_b32 a121, v212
 v_accvgpr_read_b32 v213, a122
 v_mul_f32 v213, v213, v210
 v_accvgpr_write_b32 a122, v213
 v_accvgpr_read_b32 v211, a123
 v_mul_f32 v211, v211, v210
 v_accvgpr_write_b32 a123, v211
 v_accvgpr_read_b32 v212, a124
 v_mul_f32 v212, v212, v210
 v_accvgpr_write_b32 a124, v212
 v_accvgpr_read_b32 v213, a125
 v_mul_f32 v213, v213, v210
 v_accvgpr_write_b32 a125, v213
 v_accvgpr_read_b32 v211, a126
 v_mul_f32 v211, v211, v210
 v_accvgpr_write_b32 a126, v211
 v_accvgpr_read_b32 v212, a127
 v_mul_f32 v212, v212, v210
 v_accvgpr_write_b32 a127, v212
 v_accvgpr_read_b32 v213, a128
 v_mul_f32 v213, v213, v210
 v_accvgpr_write_b32 a128, v213
 v_accvgpr_read_b32 v211, a129
 v_mul_f32 v211, v211, v210
 v_accvgpr_write_b32 a129, v211
 v_accvgpr_read_b32 v212, a130
 v_mul_f32 v212, v212, v210
 v_accvgpr_write_b32 a130, v212
 v_accvgpr_read_b32 v213, a131
 v_mul_f32 v213, v213, v210
 v_accvgpr_write_b32 a131, v213
 v_accvgpr_read_b32 v211, a132
 v_mul_f32 v211, v211, v210
 v_accvgpr_write_b32 a132, v211
 v_accvgpr_read_b32 v212, a133
 v_mul_f32 v212, v212, v210
 v_accvgpr_write_b32 a133, v212
 v_accvgpr_read_b32 v213, a134
 v_mul_f32 v213, v213, v210
 v_accvgpr_write_b32 a134, v213
 v_accvgpr_read_b32 v211, a135
 v_mul_f32 v211, v211, v210
 v_accvgpr_write_b32 a135, v211
 v_accvgpr_read_b32 v212, a136
 v_mul_f32 v212, v212, v210
 v_accvgpr_write_b32 a136, v212
 v_accvgpr_read_b32 v213, a137
 v_mul_f32 v213, v213, v210
 v_accvgpr_write_b32 a137, v213
 v_accvgpr_read_b32 v211, a138
 v_mul_f32 v211, v211, v210
 v_accvgpr_write_b32 a138, v211
 v_accvgpr_read_b32 v212, a139
 v_mul_f32 v212, v212, v210
 v_accvgpr_write_b32 a139, v212
 v_accvgpr_read_b32 v213, a140
 v_mul_f32 v213, v213, v210
 v_accvgpr_write_b32 a140, v213
 v_accvgpr_read_b32 v211, a141
 v_mul_f32 v211, v211, v210
 v_accvgpr_write_b32 a141, v211
 v_accvgpr_read_b32 v212, a142
 v_mul_f32 v212, v212, v210
 v_accvgpr_write_b32 a142, v212
 v_accvgpr_read_b32 v213, a143
 v_mul_f32 v213, v213, v210
 v_accvgpr_write_b32 a143, v213
 v_exp_f32 v208, v124
 v_exp_f32 v209, v125
 s_nop 0
 v_add_f32 v204, v208, v209
 v_cvt_pk_bf16_f32 v112, v208, v209
 v_exp_f32 v210, v126
 v_exp_f32 v211, v127
 v_add_f32 v204, v204, v210
 v_add_f32 v204, v204, v211
 v_cvt_pk_bf16_f32 v113, v210, v211
 v_exp_f32 v212, v128
 v_exp_f32 v213, v129
 s_nop 0
 v_add_f32 v205, v212, v213
 v_cvt_pk_bf16_f32 v116, v212, v213
 v_exp_f32 v208, v130
 v_exp_f32 v209, v131
 v_add_f32 v205, v205, v208
 v_add_f32 v205, v205, v209
 v_cvt_pk_bf16_f32 v117, v208, v209
 v_exp_f32 v210, v132
 v_exp_f32 v211, v133
 s_nop 0
 v_add_f32 v206, v210, v211
 v_cvt_pk_bf16_f32 v120, v210, v211
 v_exp_f32 v212, v134
 v_exp_f32 v213, v135
 v_add_f32 v206, v206, v212
 v_add_f32 v206, v206, v213
 v_cvt_pk_bf16_f32 v121, v212, v213
 v_exp_f32 v208, v136
 v_exp_f32 v209, v137
 v_add_f32 v204, v204, v208
 v_add_f32 v204, v204, v209
 v_cvt_pk_bf16_f32 v114, v208, v209
 v_exp_f32 v210, v138
 v_exp_f32 v211, v139
 v_add_f32 v204, v204, v210
 v_add_f32 v204, v204, v211
 v_cvt_pk_bf16_f32 v115, v210, v211
 v_exp_f32 v212, v140
 v_exp_f32 v213, v141
 v_add_f32 v205, v205, v212
 v_add_f32 v205, v205, v213
 v_cvt_pk_bf16_f32 v118, v212, v213
 v_exp_f32 v208, v142
 v_exp_f32 v209, v143
 v_add_f32 v205, v205, v208
 v_add_f32 v205, v205, v209
 v_cvt_pk_bf16_f32 v119, v208, v209
 v_exp_f32 v210, v144
 v_exp_f32 v211, v145
 v_add_f32 v206, v206, v210
 v_add_f32 v206, v206, v211
 v_cvt_pk_bf16_f32 v122, v210, v211
 v_exp_f32 v212, v146
 v_exp_f32 v213, v147
 v_add_f32 v206, v206, v212
 v_add_f32 v206, v206, v213
 v_cvt_pk_bf16_f32 v123, v212, v213
 s_nop 3
 s_setpc_b64 s[30:31]
P_spin3:
 s_mov_b32 s71, 0x10000
P_sl3:
 buffer_load_dword v162, v161, s[4:7], 0 offen sc1
 s_waitcnt vmcnt(0)
 v_readfirstlane_b32 s35, v162
 s_lshr_b32 s35, s35, 22
 s_cmp_ge_u32 s35, 4
 s_cbranch_scc1 P_back3
 s_sleep 8
 s_sub_u32 s71, s71, 1
 s_cbranch_scc0 P_sl3
 s_branch P_back3
P_spin1:
 s_mov_b32 s71, 0x10000
P_sl1:
 buffer_load_dword v159, v158, s[4:7], 0 offen sc1
 s_waitcnt vmcnt(0)
 v_readfirstlane_b32 s35, v159
 s_and_b32 s35, s35, 0x10000ff
 s_cmp_ge_u32 s35, 0x1000004
 s_cbranch_scc1 P_back1
 s_sleep 8
 s_sub_u32 s71, s71, 1
 s_cbranch_scc0 P_sl1
 s_branch P_back1
P_spin2:
 s_mov_b32 s71, 0x10000
P_sl2:
 buffer_load_dword v159, v158, s[96:99], 0 offen sc1
 s_waitcnt vmcnt(0)
 v_readfirstlane_b32 s35, v159
 s_nop 0
 s_cmp_ge_u32 s35, 4
 s_cbranch_scc1 P_back2
 s_sleep 8
 s_sub_u32 s71, s71, 1
 s_cbranch_scc0 P_sl2
 s_branch P_back2
.section .rodata,"a"
.p2align 6
.amdhsa_kernel concat_heads__gqa_block_cached__gqa_block_cached__near_ridge_kernel
  .amdhsa_next_free_vgpr 512
  .amdhsa_next_free_sgpr 102
  .amdhsa_accum_offset 256
  .amdhsa_group_segment_fixed_size 0
  .amdhsa_kernarg_size 104
  .amdhsa_user_sgpr_count 2
  .amdhsa_user_sgpr_kernarg_segment_ptr 1
  .amdhsa_system_sgpr_workgroup_id_x 1
.end_amdhsa_kernel
```
